```python
import torch

def _softmax(x, axis=-1):
    return torch.softmax(x, dim=axis)

def _gelu(x):
    return torch.nn.functional.gelu(x, approximate='tanh')

def _silu(x):
    return torch.nn.functional.silu(x)

def _sigmoid(x):
    return torch.sigmoid(x)

def _layernorm(x, axis=-1, eps=1e-05):
    m = x.mean(dim=axis, keepdim=True)
    v = x.var(dim=axis, keepdim=True, unbiased=False)
    return (x - m) / torch.sqrt(v + eps)

def _scatter_add(tgt, idx, src, axis=0):
    return tgt.clone().index_add_(axis, idx, src)

def _segment_sum(src, seg, n):
    out = torch.zeros((n,) + src.shape[1:], dtype=src.dtype)
    return out.index_add_(0, seg, src)

def _pad(x, pw):
    flat = tuple((v for pair in reversed(pw) for v in pair))
    return torch.nn.functional.pad(x, flat)
kernel_name = 'gated_mix__memory_aug_recurrent_mem_tr__geglu_ffn__prompt'

def setup_inputs():

    _w = lambda a: (lambda t: t.to(torch.bfloat16) if t.is_floating_point() else t)(torch.as_tensor(a))

    def _A_setup():
        B, S, Dm = (1, 2048, 512)
        H, Dh = (32, 128)
        M, seg = (8, 32)
        seg = min(seg, S)
        S = S // seg * seg
        return {'x': _w((lambda *s: torch.randn(*s, dtype=torch.bfloat16) * 0.05)(B, S, Dm)), 'mem0': _w((lambda *s: torch.randn(*s, dtype=torch.bfloat16) * 0.4)(B, M, Dm)), 'Wq': _w((lambda *s: torch.randn(*s, dtype=torch.bfloat16) * 6.4)(Dm, H, Dh) * Dm ** (-0.5)), 'Wk': _w((lambda *s: torch.randn(*s, dtype=torch.bfloat16) * 6.4)(Dm, H, Dh) * Dm ** (-0.5)), 'Wv': _w((lambda *s: torch.randn(*s, dtype=torch.bfloat16) * 0.4)(Dm, H, Dh) * Dm ** (-0.5)), 'Wo': _w((lambda *s: torch.randn(*s, dtype=torch.bfloat16) * 0.4)(H, Dh, Dm) * (H * Dh) ** (-0.5)), 'seg_len': seg}
    _A_in = _A_setup()

    def _B_setup():
        B, S, D, F = (1, 2048, 512, 1792)
        return {'x': _w((lambda *s: torch.randn(*s, dtype=torch.bfloat16) * 0.05)(B, S, D)), 'w_gate': _w((lambda *s: torch.randn(*s, dtype=torch.bfloat16) * 0.05)(D, F)), 'w_up': _w((lambda *s: torch.randn(*s, dtype=torch.bfloat16) * 0.05)(D, F)), 'w_down': _w((lambda *s: torch.randn(*s, dtype=torch.bfloat16) * 0.05)(F, D))}
    _B_in = _B_setup()
    return {'A_x': _A_in['x'], 'A_mem0': _A_in['mem0'], 'A_Wq': _A_in['Wq'], 'A_Wk': _A_in['Wk'], 'A_Wv': _A_in['Wv'], 'A_Wo': _A_in['Wo'], 'A_seg_len': _A_in['seg_len'], 'B_x': _B_in['x'], 'B_w_gate': _B_in['w_gate'], 'B_w_up': _B_in['w_up'], 'B_w_down': _B_in['w_down'], 'gate_w': _w((lambda *s: torch.randn(*s, dtype=torch.bfloat16) * 0.05)(512) * 16.0)}

def reference(A_x, A_mem0, A_Wq, A_Wk, A_Wv, A_Wo, A_seg_len, B_x, B_w_gate, B_w_up, B_w_down, gate_w):

    def _A_ref(x, mem0, Wq, Wk, Wv, Wo, seg_len):
        B, S, Dm = x.shape
        H, Dh = (Wq.shape[1], Wq.shape[2])
        M = mem0.shape[1]
        scale = Dh ** (-0.5)
        n_seg = S // seg_len
        L = M + seg_len
        idx = torch.arange(L)
        mask = (idx[:, None] < M) | (idx[:, None] >= idx[None, :])
        mem = mem0
        outs = []
        for s in range(n_seg):
            xs = x[:, s * seg_len:(s + 1) * seg_len, :].clone()
            h = torch.concatenate([mem, xs], axis=1)
            q = torch.einsum('btd,dhe->bhte', h, Wq)
            k = torch.einsum('btd,dhe->bhte', h, Wk)
            v = torch.einsum('btd,dhe->bhte', h, Wv)
            scores = torch.einsum('bhqe,bhke->bhqk', q, k) * scale
            scores = torch.where(mask[None, None], scores, -1000000000.0)
            p = _softmax(scores, axis=-1)
            o = torch.einsum('bhqk,bhke->bhqe', p, v)
            o = torch.einsum('bhte,hed->btd', o, Wo)
            mem = o[:, :M, :].clone()
            outs.append(o[:, M:, :])
        return torch.concatenate(outs, axis=1)

    def _B_ref(x, w_gate, w_up, w_down):
        return _gelu(x @ w_gate) * (x @ w_up) @ w_down
    x = A_x
    g = _sigmoid((x * gate_w).sum(-1, keepdims=True))
    a = _A_ref(x, A_mem0, A_Wq, A_Wk, A_Wv, A_Wo, A_seg_len)
    b = _B_ref(x, B_w_gate, B_w_up, B_w_down)
    return g * a + (1 - g) * b
```

```asm
; @launch grid=(256,1,1) block=(256,1,1) lds=163840
.amdgcn_target "amdgcn-amd-amdhsa--gfx950"
.text
.globl gated_mix__memory_aug_recurrent_mem_tr__geglu_ffn__prompt_kernel
.p2align 8
.type gated_mix__memory_aug_recurrent_mem_tr__geglu_ffn__prompt_kernel,@function
gated_mix__memory_aug_recurrent_mem_tr__geglu_ffn__prompt_kernel:
    s_cmp_ge_u32 s2, 256
    s_cbranch_scc1 L_exit
    s_load_dwordx8 s[40:47], s[0:1], 16
    s_load_dwordx4 s[48:51], s[0:1], 104
    s_mov_b32 s18, 0
    s_lshr_b32 s16, s2, 3
    s_add_u32 s27, s2, 6
    s_and_b32 s27, s27, 7
    s_getreg_b32 s28, hwreg(HW_REG_XCC_ID, 0, 4)
    s_cmp_ge_u32 s27, 5
    s_cbranch_scc1 L_role_mix
    s_cmp_lg_u32 s27, 0
    s_cbranch_scc1 L_role_c
L_role_a0:
    v_mov_b32 v123, v0
    v_and_b32 v127, 63, v0
    v_lshrrev_b32 v126, 6, v0
    s_nop 0
    v_readfirstlane_b32 s17, v126
    v_bfe_u32 v125, v127, 3, 1
    v_lshlrev_b32 v125, 13, v125
    v_bfe_u32 v126, v127, 4, 1
    v_lshlrev_b32 v126, 16, v126
    v_add_u32 v125, v125, v126
    v_bfe_u32 v126, v127, 5, 1
    v_lshlrev_b32 v126, 15, v126
    v_add_u32 v125, v125, v126
    v_bfe_u32 v126, v127, 0, 1
    v_lshlrev_b32 v126, 4, v126
    v_add_u32 v125, v125, v126
    v_lshrrev_b32 v126, 2, v127
    v_xor_b32 v126, v126, v127
    v_and_b32 v126, 4, v126
    v_lshl_add_u32 v125, v126, 4, v125
    v_lshrrev_b32 v126, 4, v127
    v_xor_b32 v126, v126, v127
    v_and_b32 v126, 2, v126
    v_lshl_add_u32 v125, v126, 4, v125
    s_lshl_b32 s22, s17, 13
    s_lshr_b32 s20, s17, 1
    s_lshl_b32 s20, s20, 7
    s_lshl_b32 s21, s16, 8
    s_add_u32 s21, s21, s20
    s_waitcnt lgkmcnt(0)
    s_mov_b32 s12, s48
    s_and_b32 s13, s49, 0xffff
    s_mov_b32 s14, 0x100
    s_mov_b32 s15, 0x20000
    s_cmp_lg_u32 s17, 0
    s_cbranch_scc1 L_ch_noreg
    s_mul_i32 s19, s28, s28
    s_lshl_b32 s19, s19, 18
    s_lshl_b32 s20, s28, 9
    s_add_u32 s19, s19, s20
    s_add_u32 s19, s19, 1
    s_lshl_b32 s20, s27, 2
    s_mov_b64 exec, 1
    v_mov_b32 v80, s19
    buffer_atomic_add v80, off, s[12:15], s20
    s_mov_b64 exec, -1
L_ch_noreg:
    s_mov_b32 s68, s40
    s_and_b32 s69, s41, 0xffff
    s_mov_b32 s70, 0x400000
    s_mov_b32 s71, 0x20000
    s_xor_b32 s19, s17, 0
    s_lshl_b32 s19, s19, 20
    s_add_u32 s19, s19, s21
    s_add_u32 m0, s22, 0
    s_nop 0
    buffer_load_dwordx4 v125, s[68:71], s19 offen offset:0  lds
    s_add_u32 s19, s19, 0x1fc00
    buffer_load_dwordx4 v125, s[68:71], s19 offen offset:1024  lds
    s_add_u32 s19, s19, 0xfffe3c00
    buffer_load_dwordx4 v125, s[68:71], s19 offen offset:2048  lds
    s_add_u32 s19, s19, 0x1fc00
    buffer_load_dwordx4 v125, s[68:71], s19 offen offset:3072  lds
    s_add_u32 m0, s22, 4096
    s_add_u32 s19, s19, 0x1cc00
    buffer_load_dwordx4 v125, s[68:71], s19 offen offset:0  lds
    s_add_u32 s19, s19, 0x1fc00
    buffer_load_dwordx4 v125, s[68:71], s19 offen offset:1024  lds
    s_add_u32 s19, s19, 0xfffe3c00
    buffer_load_dwordx4 v125, s[68:71], s19 offen offset:2048  lds
    s_add_u32 s19, s19, 0x1fc00
    buffer_load_dwordx4 v125, s[68:71], s19 offen offset:3072  lds
    s_xor_b32 s19, s17, 0
    s_lshl_b32 s19, s19, 20
    s_add_u32 s19, s19, s21
    s_add_u32 s19, s19, 524288
    s_add_u32 m0, s22, 32768
    s_nop 0
    buffer_load_dwordx4 v125, s[68:71], s19 offen offset:0  lds
    s_add_u32 s19, s19, 0x1fc00
    buffer_load_dwordx4 v125, s[68:71], s19 offen offset:1024  lds
    s_add_u32 s19, s19, 0xfffe3c00
    buffer_load_dwordx4 v125, s[68:71], s19 offen offset:2048  lds
    s_add_u32 s19, s19, 0x1fc00
    buffer_load_dwordx4 v125, s[68:71], s19 offen offset:3072  lds
    s_add_u32 m0, s22, 36864
    s_add_u32 s19, s19, 0x1cc00
    buffer_load_dwordx4 v125, s[68:71], s19 offen offset:0  lds
    s_add_u32 s19, s19, 0x1fc00
    buffer_load_dwordx4 v125, s[68:71], s19 offen offset:1024  lds
    s_add_u32 s19, s19, 0xfffe3c00
    buffer_load_dwordx4 v125, s[68:71], s19 offen offset:2048  lds
    s_add_u32 s19, s19, 0x1fc00
    buffer_load_dwordx4 v125, s[68:71], s19 offen offset:3072  lds
    s_xor_b32 s19, s17, 2
    s_lshl_b32 s19, s19, 20
    s_add_u32 s19, s19, s21
    s_add_u32 m0, s22, 65536
    s_nop 0
    buffer_load_dwordx4 v125, s[68:71], s19 offen offset:0  lds
    s_add_u32 s19, s19, 0x1fc00
    buffer_load_dwordx4 v125, s[68:71], s19 offen offset:1024  lds
    s_add_u32 s19, s19, 0xfffe3c00
    buffer_load_dwordx4 v125, s[68:71], s19 offen offset:2048  lds
    s_add_u32 s19, s19, 0x1fc00
    buffer_load_dwordx4 v125, s[68:71], s19 offen offset:3072  lds
    s_add_u32 m0, s22, 69632
    s_add_u32 s19, s19, 0x1cc00
    buffer_load_dwordx4 v125, s[68:71], s19 offen offset:0  lds
    s_add_u32 s19, s19, 0x1fc00
    buffer_load_dwordx4 v125, s[68:71], s19 offen offset:1024  lds
    s_add_u32 s19, s19, 0xfffe3c00
    buffer_load_dwordx4 v125, s[68:71], s19 offen offset:2048  lds
    s_add_u32 s19, s19, 0x1fc00
    buffer_load_dwordx4 v125, s[68:71], s19 offen offset:3072  lds
    s_mov_b32 s72, s42
    s_and_b32 s73, s43, 0xffff
    s_mov_b32 s74, 0x400000
    s_mov_b32 s75, 0x20000
    s_mov_b32 s76, s44
    s_and_b32 s77, s45, 0xffff
    s_mov_b32 s78, 0x400000
    s_mov_b32 s79, 0x20000
    s_mov_b32 s80, s46
    s_and_b32 s81, s47, 0xffff
    s_mov_b32 s82, 0x400000
    s_mov_b32 s83, 0x20000
    v_bfe_u32 v124, v127, 3, 1
    v_lshlrev_b32 v124, 10, v124
    v_bfe_u32 v126, v127, 4, 1
    v_lshlrev_b32 v126, 15, v126
    v_add_u32 v124, v124, v126
    v_bfe_u32 v126, v127, 5, 1
    v_lshlrev_b32 v126, 14, v126
    v_add_u32 v124, v124, v126
    v_bfe_u32 v126, v127, 0, 1
    v_lshlrev_b32 v126, 4, v126
    v_add_u32 v124, v124, v126
    v_lshrrev_b32 v126, 2, v127
    v_xor_b32 v126, v126, v127
    v_and_b32 v126, 4, v126
    v_lshl_add_u32 v124, v126, 4, v124
    v_lshrrev_b32 v126, 4, v127
    v_xor_b32 v126, v126, v127
    v_and_b32 v126, 2, v126
    v_lshl_add_u32 v124, v126, 4, v124
    s_mov_b32 s4, s50
    s_and_b32 s5, s51, 0xffff
    s_mov_b32 s6, 0x10000000
    s_mov_b32 s7, 0x20000
    s_mov_b32 s65, s21
    v_lshlrev_b32 v0, 4, v127
    s_lshl_b32 s19, s17, 13
    v_add_u32 v8, s19, v0
    v_add_u32 v0, 131072, v0
    s_xor_b32 s19, s17, 0
    s_lshl_b32 s19, s19, 11
    v_add_u32 v1, s19, v0
    s_xor_b32 s19, s17, 1
    s_lshl_b32 s19, s19, 11
    v_add_u32 v2, s19, v0
    s_xor_b32 s19, s17, 2
    s_lshl_b32 s19, s19, 11
    v_add_u32 v3, s19, v0
    s_xor_b32 s19, s17, 3
    s_lshl_b32 s19, s19, 11
    v_add_u32 v4, s19, v0
    v_bfe_u32 v5, v127, 5, 1
    v_lshlrev_b32 v5, 3, v5
    v_bfe_u32 v126, v127, 0, 4
    v_add_u32 v5, v5, v126
    v_and_b32 v5, 15, v5
    v_and_b32 v126, 48, v127
    v_add_u32 v5, v5, v126
    v_lshlrev_b32 v5, 3, v5
    s_lshl_b32 s19, s17, 10
    s_add_u32 s19, s19, 155648
    v_add_u32 v5, s19, v5
    v_bfe_u32 v7, v127, 1, 1
    v_lshlrev_b32 v7, 3, v7
    v_bfe_u32 v126, v127, 2, 4
    v_add_u32 v7, v7, v126
    v_and_b32 v7, 15, v7
    v_and_b32 v126, 3, v127
    v_lshl_add_u32 v7, v126, 4, v7
    v_lshlrev_b32 v7, 3, v7
    v_add_u32 v7, 155648, v7
    v_bfe_u32 v9, v127, 4, 2
    v_lshlrev_b32 v9, 8, v9
    v_bfe_u32 v126, v127, 2, 2
    v_lshlrev_b32 v126, 6, v126
    v_add_u32 v9, v9, v126
    v_bfe_u32 v126, v127, 0, 1
    v_lshlrev_b32 v126, 5, v126
    v_add_u32 v9, v9, v126
    v_bfe_u32 v126, v127, 1, 1
    v_lshlrev_b32 v126, 12, v126
    v_add_u32 v9, v9, v126
    v_add_u32 v9, 131072, v9
    s_lshr_b32 s19, s17, 1
    s_lshl_b32 s19, s19, 10
    s_and_b32 s20, s17, 1
    s_lshl_b32 s20, s20, 4
    s_add_u32 s19, s19, s20
    v_add_u32 v9, s19, v9
    v_bfe_u32 v126, v127, 1, 1
    v_lshlrev_b32 v126, 4, v126
    v_xor_b32 v9, v9, v126
    v_bfe_u32 v6, v127, 0, 5
    v_lshlrev_b32 v6, 2, v6
    v_bfe_u32 v10, v127, 0, 3
    v_lshlrev_b32 v10, 7, v10
    v_bfe_u32 v126, v127, 3, 1
    v_lshlrev_b32 v126, 28, v126
    v_add_u32 v10, v10, v126
    v_bfe_u32 v126, v127, 4, 1
    v_lshlrev_b32 v126, 28, v126
    v_add_u32 v10, v10, v126
    v_bfe_u32 v126, v127, 5, 1
    v_lshlrev_b32 v126, 28, v126
    v_add_u32 v10, v10, v126
    s_cmp_eq_u32 s17, 3
    s_cselect_b64 vcc, -1, 0
    v_cndmask_b32 v6, v6, v10, vcc
    s_mul_i32 s19, s16, 4
    s_add_u32 s19, s19, 196608
    s_cmp_eq_u32 s17, 3
    s_cselect_b32 s23, s19, 268435456
    s_and_b32 s19, s16, 7
    s_mul_i32 s19, s19, 128
    s_add_u32 s19, s19, 196608
    s_cmp_eq_u32 s17, 0
    s_cselect_b32 s29, s19, 268435456
    v_bfe_u32 v10, v127, 1, 3
    v_lshlrev_b32 v10, 10, v10
    v_bfe_u32 v126, v127, 4, 2
    v_lshlrev_b32 v126, 5, v126
    v_add_u32 v10, v10, v126
    v_bfe_u32 v126, v127, 0, 1
    v_lshlrev_b32 v126, 4, v126
    v_add_u32 v10, v10, v126
    s_lshl_b32 s19, s17, 8
    v_add_u32 v10, s19, v10
    v_bfe_u32 v11, v127, 4, 2
    v_lshlrev_b32 v11, 13, v11
    v_bfe_u32 v126, v127, 0, 4
    v_lshlrev_b32 v126, 4, v126
    v_add_u32 v11, v11, v126
    s_lshl_b32 s19, s17, 16
    v_add_u32 v11, s19, v11
    v_bfe_u32 v12, v127, 1, 2
    v_lshlrev_b32 v12, 8, v12
    v_bfe_u32 v126, v127, 0, 1
    v_lshlrev_b32 v126, 5, v126
    v_add_u32 v12, v12, v126
    v_bfe_u32 v126, v127, 5, 1
    v_lshlrev_b32 v126, 4, v126
    v_add_u32 v12, v12, v126
    v_bfe_u32 v126, v127, 4, 1
    v_lshlrev_b32 v126, 3, v126
    v_add_u32 v12, v12, v126
    v_bfe_u32 v126, v127, 3, 1
    v_lshlrev_b32 v126, 28, v126
    v_add_u32 v12, v12, v126
    v_and_b32 v126, 1, v127
    v_cmp_eq_u32 vcc, 1, v126
    v_mov_b32 v13, 0x44444444
    v_mov_b32 v126, 0xeeeeeeee
    v_cndmask_b32 v13, v13, v126, vcc
    v_mov_b32 v14, 0x3f80
    v_mov_b32 v126, 0x3f800000
    v_cndmask_b32 v14, v14, v126, vcc
    v_bfe_u32 v126, v127, 1, 3
    v_cmp_eq_u32 s[48:49], 0, v126
    v_cmp_eq_u32 s[50:51], 1, v126
    v_cmp_eq_u32 s[52:53], 2, v126
    v_cmp_eq_u32 s[54:55], 3, v126
    v_cmp_eq_u32 s[66:67], 64, v123
    v_mov_b32 v16, 0x3f803f80
    v_mov_b32 v20, 0
    v_mov_b32 v17, 0x3f803f80
    v_mov_b32 v21, 0
    v_mov_b32 v18, 0x3f803f80
    v_mov_b32 v22, 0
    v_mov_b32 v19, 0x3f803f80
    v_mov_b32 v23, 0
    s_mov_b32 s45, 0x3e0293ee
    s_mov_b32 s46, 0x21800000
    s_mov_b32 s47, 0x3c000000
    s_mov_b32 s94, 0
    s_mov_b32 s95, 0
    s_mov_b32 s96, 0
    s_mov_b32 s97, 0
    s_lshl_b32 s19, s16, 8
    s_add_u32 s58, s19, 1048576
    s_lshl_b32 s19, s16, 13
    s_add_u32 s59, s19, 917504
    s_add_u32 s39, s19, 16646144
    s_add_u32 s40, s19, 33423360
    s_and_b32 s19, s16, 3
    s_lshl_b32 s19, s19, 6
    s_lshr_b32 s20, s16, 2
    s_lshl_b32 s20, s20, 10
    s_add_u32 s19, s19, s20
    s_add_u32 s60, s19, 262144
    s_lshl_b32 s19, s16, 12
    s_lshl_b32 s20, s17, 10
    s_add_u32 s19, s19, s20
    s_add_u32 s41, s19, 51118080
    s_lshl_b32 s19, s16, 7
    s_add_u32 s42, s19, 0
    s_add_u32 s43, s19, 8192
    s_lshl_b32 s19, s17, 11
    s_add_u32 s56, s19, 139264
    s_add_u32 s57, s19, 147456
    s_mov_b32 s21, s65
    s_load_dwordx2 s[24:25], s[0:1], 8
    s_waitcnt lgkmcnt(0)
    s_mov_b32 s8, s24
    s_and_b32 s9, s25, 0xffff
    s_mov_b32 s10, 0x2000
    s_mov_b32 s11, 0x20000
    s_mov_b32 s64, s21
    v_bfe_u32 v60, v127, 5, 1
    v_lshlrev_b32 v60, 10, v60
    v_bfe_u32 v126, v127, 4, 1
    v_mul_u32_u24 v126, 544, v126
    v_add_u32 v60, v60, v126
    v_bfe_u32 v126, v127, 3, 1
    v_mul_u32_u24 v126, 320, v126
    v_add_u32 v60, v60, v126
    v_bfe_u32 v126, v127, 2, 1
    v_lshlrev_b32 v126, 7, v126
    v_add_u32 v60, v60, v126
    v_bfe_u32 v126, v127, 0, 2
    v_lshlrev_b32 v126, 3, v126
    v_add_u32 v60, v60, v126
    s_lshl_b32 s19, s17, 13
    v_add_u32 v60, s19, v60
    v_xor_b32 v61, 32, v60
    v_xor_b32 v62, 64, v60
    v_xor_b32 v63, 96, v60
    s_and_b32 s19, s17, 1
    s_lshl_b32 s19, s19, 6
    v_xor_b32 v56, s19, v60
    v_xor_b32 v57, 32, v56
    v_xor_b32 v58, 8192, v56
    v_xor_b32 v59, 8192, v57
    s_waitcnt vmcnt(16)
    s_barrier
    s_mov_b32 s21, s64
    s_lshl_b32 s22, s17, 13
    s_xor_b32 s19, s17, 2
    s_lshl_b32 s19, s19, 20
    s_add_u32 s19, s19, s21
    s_add_u32 s19, s19, 524288
    s_add_u32 m0, s22, 98304
    s_nop 0
    buffer_load_dwordx4 v125, s[68:71], s19 offen offset:0  lds
    s_add_u32 s19, s19, 0x1fc00
    buffer_load_dwordx4 v125, s[68:71], s19 offen offset:1024  lds
    s_add_u32 s19, s19, 0xfffe3c00
    buffer_load_dwordx4 v125, s[68:71], s19 offen offset:2048  lds
    s_add_u32 s19, s19, 0x1fc00
    buffer_load_dwordx4 v125, s[68:71], s19 offen offset:3072  lds
    s_add_u32 m0, s22, 102400
    s_add_u32 s19, s19, 0x1cc00
    buffer_load_dwordx4 v125, s[68:71], s19 offen offset:0  lds
    s_add_u32 s19, s19, 0x1fc00
    buffer_load_dwordx4 v125, s[68:71], s19 offen offset:1024  lds
    s_add_u32 s19, s19, 0xfffe3c00
    buffer_load_dwordx4 v125, s[68:71], s19 offen offset:2048  lds
    s_add_u32 s19, s19, 0x1fc00
    buffer_load_dwordx4 v125, s[68:71], s19 offen offset:3072  lds
    ds_read_b64_tr_b16 a[0:1], v56 offset:0
    ds_read_b64_tr_b16 a[2:3], v56 offset:2048
    ds_read_b64_tr_b16 a[4:5], v56 offset:4096
    ds_read_b64_tr_b16 a[6:7], v56 offset:6144
    ds_read_b64_tr_b16 a[8:9], v57 offset:0
    ds_read_b64_tr_b16 a[10:11], v57 offset:2048
    ds_read_b64_tr_b16 a[12:13], v57 offset:4096
    ds_read_b64_tr_b16 a[14:15], v57 offset:6144
    s_waitcnt lgkmcnt(0)
    ds_read_b64_tr_b16 a[32:33], v58 offset:0
    ds_read_b64_tr_b16 a[34:35], v58 offset:2048
    ds_read_b64_tr_b16 a[36:37], v58 offset:4096
    ds_read_b64_tr_b16 a[38:39], v58 offset:6144
    ds_read_b64_tr_b16 a[40:41], v59 offset:0
    ds_read_b64_tr_b16 a[42:43], v59 offset:2048
    ds_read_b64_tr_b16 a[44:45], v59 offset:4096
    ds_read_b64_tr_b16 a[46:47], v59 offset:6144
    s_waitcnt lgkmcnt(0)
    s_waitcnt vmcnt(16)
    s_barrier
    s_mov_b32 s21, s64
    s_lshl_b32 s22, s17, 13
    s_xor_b32 s19, s17, 0
    s_lshl_b32 s19, s19, 20
    s_add_u32 s19, s19, s21
    s_add_u32 m0, s22, 0
    s_nop 0
    buffer_load_dwordx4 v125, s[72:75], s19 offen offset:0  lds
    s_add_u32 s19, s19, 0x1fc00
    buffer_load_dwordx4 v125, s[72:75], s19 offen offset:1024  lds
    s_add_u32 s19, s19, 0xfffe3c00
    buffer_load_dwordx4 v125, s[72:75], s19 offen offset:2048  lds
    s_add_u32 s19, s19, 0x1fc00
    buffer_load_dwordx4 v125, s[72:75], s19 offen offset:3072  lds
    s_add_u32 m0, s22, 4096
    s_add_u32 s19, s19, 0x1cc00
    buffer_load_dwordx4 v125, s[72:75], s19 offen offset:0  lds
    s_add_u32 s19, s19, 0x1fc00
    buffer_load_dwordx4 v125, s[72:75], s19 offen offset:1024  lds
    s_add_u32 s19, s19, 0xfffe3c00
    buffer_load_dwordx4 v125, s[72:75], s19 offen offset:2048  lds
    s_add_u32 s19, s19, 0x1fc00
    buffer_load_dwordx4 v125, s[72:75], s19 offen offset:3072  lds
    ds_read_b64_tr_b16 a[16:17], v56 offset:32768
    ds_read_b64_tr_b16 a[18:19], v56 offset:34816
    ds_read_b64_tr_b16 a[20:21], v56 offset:36864
    ds_read_b64_tr_b16 a[22:23], v56 offset:38912
    ds_read_b64_tr_b16 a[24:25], v57 offset:32768
    ds_read_b64_tr_b16 a[26:27], v57 offset:34816
    ds_read_b64_tr_b16 a[28:29], v57 offset:36864
    ds_read_b64_tr_b16 a[30:31], v57 offset:38912
    s_waitcnt lgkmcnt(0)
    ds_read_b64_tr_b16 a[48:49], v58 offset:32768
    ds_read_b64_tr_b16 a[50:51], v58 offset:34816
    ds_read_b64_tr_b16 a[52:53], v58 offset:36864
    ds_read_b64_tr_b16 a[54:55], v58 offset:38912
    ds_read_b64_tr_b16 a[56:57], v59 offset:32768
    ds_read_b64_tr_b16 a[58:59], v59 offset:34816
    ds_read_b64_tr_b16 a[60:61], v59 offset:36864
    ds_read_b64_tr_b16 a[62:63], v59 offset:38912
    s_waitcnt lgkmcnt(0)
    s_waitcnt vmcnt(16)
    s_barrier
    s_mov_b32 s21, s64
    s_lshl_b32 s22, s17, 13
    s_xor_b32 s19, s17, 0
    s_lshl_b32 s19, s19, 20
    s_add_u32 s19, s19, s21
    s_add_u32 s19, s19, 524288
    s_add_u32 m0, s22, 32768
    s_nop 0
    buffer_load_dwordx4 v125, s[72:75], s19 offen offset:0  lds
    s_add_u32 s19, s19, 0x1fc00
    buffer_load_dwordx4 v125, s[72:75], s19 offen offset:1024  lds
    s_add_u32 s19, s19, 0xfffe3c00
    buffer_load_dwordx4 v125, s[72:75], s19 offen offset:2048  lds
    s_add_u32 s19, s19, 0x1fc00
    buffer_load_dwordx4 v125, s[72:75], s19 offen offset:3072  lds
    s_add_u32 m0, s22, 36864
    s_add_u32 s19, s19, 0x1cc00
    buffer_load_dwordx4 v125, s[72:75], s19 offen offset:0  lds
    s_add_u32 s19, s19, 0x1fc00
    buffer_load_dwordx4 v125, s[72:75], s19 offen offset:1024  lds
    s_add_u32 s19, s19, 0xfffe3c00
    buffer_load_dwordx4 v125, s[72:75], s19 offen offset:2048  lds
    s_add_u32 s19, s19, 0x1fc00
    buffer_load_dwordx4 v125, s[72:75], s19 offen offset:3072  lds
    v_xor_b32 v56, 0x10000, v56
    v_xor_b32 v57, 0x10000, v57
    v_xor_b32 v58, 0x10000, v58
    v_xor_b32 v59, 0x10000, v59
    v_xor_b32 v60, 0x10000, v60
    v_xor_b32 v61, 0x10000, v61
    v_xor_b32 v62, 0x10000, v62
    v_xor_b32 v63, 0x10000, v63
    ds_read_b64_tr_b16 a[64:65], v56 offset:0
    ds_read_b64_tr_b16 a[66:67], v56 offset:2048
    ds_read_b64_tr_b16 a[68:69], v56 offset:4096
    ds_read_b64_tr_b16 a[70:71], v56 offset:6144
    ds_read_b64_tr_b16 a[72:73], v57 offset:0
    ds_read_b64_tr_b16 a[74:75], v57 offset:2048
    ds_read_b64_tr_b16 a[76:77], v57 offset:4096
    ds_read_b64_tr_b16 a[78:79], v57 offset:6144
    s_waitcnt lgkmcnt(0)
    ds_read_b64_tr_b16 a[96:97], v58 offset:0
    ds_read_b64_tr_b16 a[98:99], v58 offset:2048
    ds_read_b64_tr_b16 a[100:101], v58 offset:4096
    ds_read_b64_tr_b16 a[102:103], v58 offset:6144
    ds_read_b64_tr_b16 a[104:105], v59 offset:0
    ds_read_b64_tr_b16 a[106:107], v59 offset:2048
    ds_read_b64_tr_b16 a[108:109], v59 offset:4096
    ds_read_b64_tr_b16 a[110:111], v59 offset:6144
    s_waitcnt lgkmcnt(0)
    s_waitcnt vmcnt(16)
    s_barrier
    s_mov_b32 s21, s64
    s_lshl_b32 s22, s17, 13
    s_xor_b32 s19, s17, 2
    s_lshl_b32 s19, s19, 20
    s_add_u32 s19, s19, s21
    s_add_u32 m0, s22, 65536
    s_nop 0
    buffer_load_dwordx4 v125, s[72:75], s19 offen offset:0  lds
    s_add_u32 s19, s19, 0x1fc00
    buffer_load_dwordx4 v125, s[72:75], s19 offen offset:1024  lds
    s_add_u32 s19, s19, 0xfffe3c00
    buffer_load_dwordx4 v125, s[72:75], s19 offen offset:2048  lds
    s_add_u32 s19, s19, 0x1fc00
    buffer_load_dwordx4 v125, s[72:75], s19 offen offset:3072  lds
    s_add_u32 m0, s22, 69632
    s_add_u32 s19, s19, 0x1cc00
    buffer_load_dwordx4 v125, s[72:75], s19 offen offset:0  lds
    s_add_u32 s19, s19, 0x1fc00
    buffer_load_dwordx4 v125, s[72:75], s19 offen offset:1024  lds
    s_add_u32 s19, s19, 0xfffe3c00
    buffer_load_dwordx4 v125, s[72:75], s19 offen offset:2048  lds
    s_add_u32 s19, s19, 0x1fc00
    buffer_load_dwordx4 v125, s[72:75], s19 offen offset:3072  lds
    ds_read_b64_tr_b16 a[80:81], v56 offset:32768
    ds_read_b64_tr_b16 a[82:83], v56 offset:34816
    ds_read_b64_tr_b16 a[84:85], v56 offset:36864
    ds_read_b64_tr_b16 a[86:87], v56 offset:38912
    ds_read_b64_tr_b16 a[88:89], v57 offset:32768
    ds_read_b64_tr_b16 a[90:91], v57 offset:34816
    ds_read_b64_tr_b16 a[92:93], v57 offset:36864
    ds_read_b64_tr_b16 a[94:95], v57 offset:38912
    s_waitcnt lgkmcnt(0)
    ds_read_b64_tr_b16 a[112:113], v58 offset:32768
    ds_read_b64_tr_b16 a[114:115], v58 offset:34816
    ds_read_b64_tr_b16 a[116:117], v58 offset:36864
    ds_read_b64_tr_b16 a[118:119], v58 offset:38912
    ds_read_b64_tr_b16 a[120:121], v59 offset:32768
    ds_read_b64_tr_b16 a[122:123], v59 offset:34816
    ds_read_b64_tr_b16 a[124:125], v59 offset:36864
    ds_read_b64_tr_b16 a[126:127], v59 offset:38912
    s_waitcnt lgkmcnt(0)
    s_waitcnt vmcnt(16)
    s_barrier
    s_mov_b32 s21, s64
    s_lshl_b32 s22, s17, 13
    s_xor_b32 s19, s17, 2
    s_lshl_b32 s19, s19, 20
    s_add_u32 s19, s19, s21
    s_add_u32 s19, s19, 524288
    s_add_u32 m0, s22, 98304
    s_nop 0
    buffer_load_dwordx4 v125, s[72:75], s19 offen offset:0  lds
    s_add_u32 s19, s19, 0x1fc00
    buffer_load_dwordx4 v125, s[72:75], s19 offen offset:1024  lds
    s_add_u32 s19, s19, 0xfffe3c00
    buffer_load_dwordx4 v125, s[72:75], s19 offen offset:2048  lds
    s_add_u32 s19, s19, 0x1fc00
    buffer_load_dwordx4 v125, s[72:75], s19 offen offset:3072  lds
    s_add_u32 m0, s22, 102400
    s_add_u32 s19, s19, 0x1cc00
    buffer_load_dwordx4 v125, s[72:75], s19 offen offset:0  lds
    s_add_u32 s19, s19, 0x1fc00
    buffer_load_dwordx4 v125, s[72:75], s19 offen offset:1024  lds
    s_add_u32 s19, s19, 0xfffe3c00
    buffer_load_dwordx4 v125, s[72:75], s19 offen offset:2048  lds
    s_add_u32 s19, s19, 0x1fc00
    buffer_load_dwordx4 v125, s[72:75], s19 offen offset:3072  lds
    v_xor_b32 v56, 0x10000, v56
    v_xor_b32 v57, 0x10000, v57
    v_xor_b32 v58, 0x10000, v58
    v_xor_b32 v59, 0x10000, v59
    v_xor_b32 v60, 0x10000, v60
    v_xor_b32 v61, 0x10000, v61
    v_xor_b32 v62, 0x10000, v62
    v_xor_b32 v63, 0x10000, v63
    ds_read_b64_tr_b16 a[128:129], v56 offset:0
    ds_read_b64_tr_b16 a[130:131], v56 offset:2048
    ds_read_b64_tr_b16 a[132:133], v56 offset:4096
    ds_read_b64_tr_b16 a[134:135], v56 offset:6144
    ds_read_b64_tr_b16 a[136:137], v57 offset:0
    ds_read_b64_tr_b16 a[138:139], v57 offset:2048
    ds_read_b64_tr_b16 a[140:141], v57 offset:4096
    ds_read_b64_tr_b16 a[142:143], v57 offset:6144
    s_waitcnt lgkmcnt(0)
    ds_read_b64_tr_b16 a[160:161], v58 offset:0
    ds_read_b64_tr_b16 a[162:163], v58 offset:2048
    ds_read_b64_tr_b16 a[164:165], v58 offset:4096
    ds_read_b64_tr_b16 a[166:167], v58 offset:6144
    ds_read_b64_tr_b16 a[168:169], v59 offset:0
    ds_read_b64_tr_b16 a[170:171], v59 offset:2048
    ds_read_b64_tr_b16 a[172:173], v59 offset:4096
    ds_read_b64_tr_b16 a[174:175], v59 offset:6144
    s_waitcnt lgkmcnt(0)
    s_waitcnt vmcnt(16)
    s_barrier
    s_mov_b32 s21, s64
    s_lshl_b32 s22, s17, 13
    s_xor_b32 s19, s17, 2
    s_lshl_b32 s19, s19, 20
    s_add_u32 s19, s19, s21
    s_add_u32 m0, s22, 0
    s_nop 0
    buffer_load_dwordx4 v125, s[76:79], s19 offen offset:0  lds
    s_add_u32 s19, s19, 0x1fc00
    buffer_load_dwordx4 v125, s[76:79], s19 offen offset:1024  lds
    s_add_u32 s19, s19, 0xfffe3c00
    buffer_load_dwordx4 v125, s[76:79], s19 offen offset:2048  lds
    s_add_u32 s19, s19, 0x1fc00
    buffer_load_dwordx4 v125, s[76:79], s19 offen offset:3072  lds
    s_add_u32 m0, s22, 4096
    s_add_u32 s19, s19, 0x1cc00
    buffer_load_dwordx4 v125, s[76:79], s19 offen offset:0  lds
    s_add_u32 s19, s19, 0x1fc00
    buffer_load_dwordx4 v125, s[76:79], s19 offen offset:1024  lds
    s_add_u32 s19, s19, 0xfffe3c00
    buffer_load_dwordx4 v125, s[76:79], s19 offen offset:2048  lds
    s_add_u32 s19, s19, 0x1fc00
    buffer_load_dwordx4 v125, s[76:79], s19 offen offset:3072  lds
    ds_read_b64_tr_b16 a[144:145], v56 offset:32768
    ds_read_b64_tr_b16 a[146:147], v56 offset:34816
    ds_read_b64_tr_b16 a[148:149], v56 offset:36864
    ds_read_b64_tr_b16 a[150:151], v56 offset:38912
    ds_read_b64_tr_b16 a[152:153], v57 offset:32768
    ds_read_b64_tr_b16 a[154:155], v57 offset:34816
    ds_read_b64_tr_b16 a[156:157], v57 offset:36864
    ds_read_b64_tr_b16 a[158:159], v57 offset:38912
    s_waitcnt lgkmcnt(0)
    ds_read_b64_tr_b16 a[176:177], v58 offset:32768
    ds_read_b64_tr_b16 a[178:179], v58 offset:34816
    ds_read_b64_tr_b16 a[180:181], v58 offset:36864
    ds_read_b64_tr_b16 a[182:183], v58 offset:38912
    ds_read_b64_tr_b16 a[184:185], v59 offset:32768
    ds_read_b64_tr_b16 a[186:187], v59 offset:34816
    ds_read_b64_tr_b16 a[188:189], v59 offset:36864
    ds_read_b64_tr_b16 a[190:191], v59 offset:38912
    s_waitcnt lgkmcnt(0)
    s_waitcnt vmcnt(16)
    s_barrier
    s_mov_b32 s21, s64
    s_lshl_b32 s22, s17, 13
    s_xor_b32 s19, s17, 2
    s_lshl_b32 s19, s19, 20
    s_add_u32 s19, s19, s21
    s_add_u32 s19, s19, 524288
    s_add_u32 m0, s22, 32768
    s_nop 0
    buffer_load_dwordx4 v125, s[76:79], s19 offen offset:0  lds
    s_add_u32 s19, s19, 0x1fc00
    buffer_load_dwordx4 v125, s[76:79], s19 offen offset:1024  lds
    s_add_u32 s19, s19, 0xfffe3c00
    buffer_load_dwordx4 v125, s[76:79], s19 offen offset:2048  lds
    s_add_u32 s19, s19, 0x1fc00
    buffer_load_dwordx4 v125, s[76:79], s19 offen offset:3072  lds
    s_add_u32 m0, s22, 36864
    s_add_u32 s19, s19, 0x1cc00
    buffer_load_dwordx4 v125, s[76:79], s19 offen offset:0  lds
    s_add_u32 s19, s19, 0x1fc00
    buffer_load_dwordx4 v125, s[76:79], s19 offen offset:1024  lds
    s_add_u32 s19, s19, 0xfffe3c00
    buffer_load_dwordx4 v125, s[76:79], s19 offen offset:2048  lds
    s_add_u32 s19, s19, 0x1fc00
    buffer_load_dwordx4 v125, s[76:79], s19 offen offset:3072  lds
    v_xor_b32 v56, 0x10000, v56
    v_xor_b32 v57, 0x10000, v57
    v_xor_b32 v58, 0x10000, v58
    v_xor_b32 v59, 0x10000, v59
    v_xor_b32 v60, 0x10000, v60
    v_xor_b32 v61, 0x10000, v61
    v_xor_b32 v62, 0x10000, v62
    v_xor_b32 v63, 0x10000, v63
    ds_read_b64_tr_b16 a[192:193], v56 offset:0
    ds_read_b64_tr_b16 a[194:195], v56 offset:2048
    ds_read_b64_tr_b16 a[196:197], v56 offset:4096
    ds_read_b64_tr_b16 a[198:199], v56 offset:6144
    ds_read_b64_tr_b16 a[200:201], v57 offset:0
    ds_read_b64_tr_b16 a[202:203], v57 offset:2048
    ds_read_b64_tr_b16 a[204:205], v57 offset:4096
    ds_read_b64_tr_b16 a[206:207], v57 offset:6144
    s_waitcnt lgkmcnt(0)
    ds_read_b64_tr_b16 a[224:225], v58 offset:0
    ds_read_b64_tr_b16 a[226:227], v58 offset:2048
    ds_read_b64_tr_b16 a[228:229], v58 offset:4096
    ds_read_b64_tr_b16 a[230:231], v58 offset:6144
    ds_read_b64_tr_b16 a[232:233], v59 offset:0
    ds_read_b64_tr_b16 a[234:235], v59 offset:2048
    ds_read_b64_tr_b16 a[236:237], v59 offset:4096
    ds_read_b64_tr_b16 a[238:239], v59 offset:6144
    s_waitcnt lgkmcnt(0)
    s_waitcnt vmcnt(16)
    s_barrier
    s_mov_b32 s21, s64
    s_lshl_b32 s22, s17, 13
    s_lshl_b32 s19, s16, 17
    s_lshl_b32 s20, s17, 8
    s_add_u32 s19, s19, s20
    s_add_u32 s19, s19, 0
    s_add_u32 m0, s22, 65536
    s_nop 0
    buffer_load_dwordx4 v124, s[80:83], s19 offen offset:0  lds
    s_add_u32 s19, s19, 0xc00
    buffer_load_dwordx4 v124, s[80:83], s19 offen offset:1024  lds
    s_add_u32 s19, s19, 0xfffff400
    buffer_load_dwordx4 v124, s[80:83], s19 offen offset:2048  lds
    s_add_u32 s19, s19, 0xc00
    buffer_load_dwordx4 v124, s[80:83], s19 offen offset:3072  lds
    s_add_u32 m0, s22, 69632
    s_add_u32 s19, s19, 0x1400
    buffer_load_dwordx4 v124, s[80:83], s19 offen offset:0  lds
    s_add_u32 s19, s19, 0xc00
    buffer_load_dwordx4 v124, s[80:83], s19 offen offset:1024  lds
    s_add_u32 s19, s19, 0xfffff400
    buffer_load_dwordx4 v124, s[80:83], s19 offen offset:2048  lds
    s_add_u32 s19, s19, 0xc00
    buffer_load_dwordx4 v124, s[80:83], s19 offen offset:3072  lds
    buffer_load_dwordx4 v[40:43], off, s[12:15], 0 sc1
    buffer_load_dwordx4 v[44:47], off, s[12:15], 0 offset:16 sc1
    s_lshl_b32 s20, s27, 2
    buffer_load_dword v48, off, s[12:15], s20 sc1
    s_mov_b32 s44, 0
    ds_read_b64_tr_b16 a[208:209], v56 offset:32768
    ds_read_b64_tr_b16 a[210:211], v56 offset:34816
    ds_read_b64_tr_b16 a[212:213], v56 offset:36864
    ds_read_b64_tr_b16 a[214:215], v56 offset:38912
    ds_read_b64_tr_b16 a[216:217], v57 offset:32768
    ds_read_b64_tr_b16 a[218:219], v57 offset:34816
    ds_read_b64_tr_b16 a[220:221], v57 offset:36864
    ds_read_b64_tr_b16 a[222:223], v57 offset:38912
    s_waitcnt lgkmcnt(0)
    ds_read_b64_tr_b16 a[240:241], v58 offset:32768
    ds_read_b64_tr_b16 a[242:243], v58 offset:34816
    ds_read_b64_tr_b16 a[244:245], v58 offset:36864
    ds_read_b64_tr_b16 a[246:247], v58 offset:38912
    ds_read_b64_tr_b16 a[248:249], v59 offset:32768
    ds_read_b64_tr_b16 a[250:251], v59 offset:34816
    ds_read_b64_tr_b16 a[252:253], v59 offset:36864
    ds_read_b64_tr_b16 a[254:255], v59 offset:38912
    s_waitcnt lgkmcnt(0)
    s_waitcnt vmcnt(19)
    s_barrier
    s_mov_b32 s21, s64
    s_lshl_b32 s22, s17, 13
    s_lshl_b32 s19, s16, 17
    s_lshl_b32 s20, s17, 8
    s_add_u32 s19, s19, s20
    s_add_u32 s19, s19, 65536
    s_add_u32 m0, s22, 98304
    s_nop 0
    buffer_load_dwordx4 v124, s[80:83], s19 offen offset:0  lds
    s_add_u32 s19, s19, 0xc00
    buffer_load_dwordx4 v124, s[80:83], s19 offen offset:1024  lds
    s_add_u32 s19, s19, 0xfffff400
    buffer_load_dwordx4 v124, s[80:83], s19 offen offset:2048  lds
    s_add_u32 s19, s19, 0xc00
    buffer_load_dwordx4 v124, s[80:83], s19 offen offset:3072  lds
    s_add_u32 m0, s22, 102400
    s_add_u32 s19, s19, 0x1400
    buffer_load_dwordx4 v124, s[80:83], s19 offen offset:0  lds
    s_add_u32 s19, s19, 0xc00
    buffer_load_dwordx4 v124, s[80:83], s19 offen offset:1024  lds
    s_add_u32 s19, s19, 0xfffff400
    buffer_load_dwordx4 v124, s[80:83], s19 offen offset:2048  lds
    s_add_u32 s19, s19, 0xc00
    buffer_load_dwordx4 v124, s[80:83], s19 offen offset:3072  lds
    v_xor_b32 v56, 0x10000, v56
    v_xor_b32 v57, 0x10000, v57
    v_xor_b32 v58, 0x10000, v58
    v_xor_b32 v59, 0x10000, v59
    v_xor_b32 v60, 0x10000, v60
    v_xor_b32 v61, 0x10000, v61
    v_xor_b32 v62, 0x10000, v62
    v_xor_b32 v63, 0x10000, v63
    ds_read_b64_tr_b16 v[128:129], v56 offset:0
    ds_read_b64_tr_b16 v[130:131], v56 offset:2048
    ds_read_b64_tr_b16 v[132:133], v56 offset:4096
    ds_read_b64_tr_b16 v[134:135], v56 offset:6144
    ds_read_b64_tr_b16 v[136:137], v57 offset:0
    ds_read_b64_tr_b16 v[138:139], v57 offset:2048
    ds_read_b64_tr_b16 v[140:141], v57 offset:4096
    ds_read_b64_tr_b16 v[142:143], v57 offset:6144
    s_waitcnt lgkmcnt(0)
    ds_read_b64_tr_b16 v[160:161], v58 offset:0
    ds_read_b64_tr_b16 v[162:163], v58 offset:2048
    ds_read_b64_tr_b16 v[164:165], v58 offset:4096
    ds_read_b64_tr_b16 v[166:167], v58 offset:6144
    ds_read_b64_tr_b16 v[168:169], v59 offset:0
    ds_read_b64_tr_b16 v[170:171], v59 offset:2048
    ds_read_b64_tr_b16 v[172:173], v59 offset:4096
    ds_read_b64_tr_b16 v[174:175], v59 offset:6144
    s_waitcnt lgkmcnt(0)
    s_waitcnt vmcnt(19)
    s_barrier
    s_mov_b32 s21, s64
    s_lshl_b32 s22, s17, 13
    s_xor_b32 s19, s17, 0
    s_lshl_b32 s19, s19, 20
    s_add_u32 s19, s19, s21
    s_add_u32 m0, s22, 0
    s_nop 0
    buffer_load_dwordx4 v125, s[76:79], s19 offen offset:0  lds
    s_add_u32 s19, s19, 0x1fc00
    buffer_load_dwordx4 v125, s[76:79], s19 offen offset:1024  lds
    s_add_u32 s19, s19, 0xfffe3c00
    buffer_load_dwordx4 v125, s[76:79], s19 offen offset:2048  lds
    s_add_u32 s19, s19, 0x1fc00
    buffer_load_dwordx4 v125, s[76:79], s19 offen offset:3072  lds
    s_add_u32 m0, s22, 4096
    s_add_u32 s19, s19, 0x1cc00
    buffer_load_dwordx4 v125, s[76:79], s19 offen offset:0  lds
    s_add_u32 s19, s19, 0x1fc00
    buffer_load_dwordx4 v125, s[76:79], s19 offen offset:1024  lds
    s_add_u32 s19, s19, 0xfffe3c00
    buffer_load_dwordx4 v125, s[76:79], s19 offen offset:2048  lds
    s_add_u32 s19, s19, 0x1fc00
    buffer_load_dwordx4 v125, s[76:79], s19 offen offset:3072  lds
    ds_read_b64_tr_b16 v[144:145], v56 offset:32768
    ds_read_b64_tr_b16 v[146:147], v56 offset:34816
    ds_read_b64_tr_b16 v[148:149], v56 offset:36864
    ds_read_b64_tr_b16 v[150:151], v56 offset:38912
    ds_read_b64_tr_b16 v[152:153], v57 offset:32768
    ds_read_b64_tr_b16 v[154:155], v57 offset:34816
    ds_read_b64_tr_b16 v[156:157], v57 offset:36864
    ds_read_b64_tr_b16 v[158:159], v57 offset:38912
    s_waitcnt lgkmcnt(0)
    ds_read_b64_tr_b16 v[176:177], v58 offset:32768
    ds_read_b64_tr_b16 v[178:179], v58 offset:34816
    ds_read_b64_tr_b16 v[180:181], v58 offset:36864
    ds_read_b64_tr_b16 v[182:183], v58 offset:38912
    ds_read_b64_tr_b16 v[184:185], v59 offset:32768
    ds_read_b64_tr_b16 v[186:187], v59 offset:34816
    ds_read_b64_tr_b16 v[188:189], v59 offset:36864
    ds_read_b64_tr_b16 v[190:191], v59 offset:38912
    s_waitcnt lgkmcnt(0)
    s_waitcnt vmcnt(19)
    s_barrier
    s_mov_b32 s21, s64
    s_lshl_b32 s22, s17, 13
    s_xor_b32 s19, s17, 0
    s_lshl_b32 s19, s19, 20
    s_add_u32 s19, s19, s21
    s_add_u32 s19, s19, 524288
    s_add_u32 m0, s22, 32768
    s_nop 0
    buffer_load_dwordx4 v125, s[76:79], s19 offen offset:0  lds
    s_add_u32 s19, s19, 0x1fc00
    buffer_load_dwordx4 v125, s[76:79], s19 offen offset:1024  lds
    s_add_u32 s19, s19, 0xfffe3c00
    buffer_load_dwordx4 v125, s[76:79], s19 offen offset:2048  lds
    s_add_u32 s19, s19, 0x1fc00
    buffer_load_dwordx4 v125, s[76:79], s19 offen offset:3072  lds
    s_add_u32 m0, s22, 36864
    s_add_u32 s19, s19, 0x1cc00
    buffer_load_dwordx4 v125, s[76:79], s19 offen offset:0  lds
    s_add_u32 s19, s19, 0x1fc00
    buffer_load_dwordx4 v125, s[76:79], s19 offen offset:1024  lds
    s_add_u32 s19, s19, 0xfffe3c00
    buffer_load_dwordx4 v125, s[76:79], s19 offen offset:2048  lds
    s_add_u32 s19, s19, 0x1fc00
    buffer_load_dwordx4 v125, s[76:79], s19 offen offset:3072  lds
    v_xor_b32 v56, 0x10000, v56
    v_xor_b32 v57, 0x10000, v57
    v_xor_b32 v58, 0x10000, v58
    v_xor_b32 v59, 0x10000, v59
    v_xor_b32 v60, 0x10000, v60
    v_xor_b32 v61, 0x10000, v61
    v_xor_b32 v62, 0x10000, v62
    v_xor_b32 v63, 0x10000, v63
    ds_read_b64_tr_b16 v[192:193], v60 offset:0
    ds_read_b64_tr_b16 v[194:195], v60 offset:2048
    ds_read_b64_tr_b16 v[196:197], v60 offset:4096
    ds_read_b64_tr_b16 v[198:199], v60 offset:6144
    ds_read_b64_tr_b16 v[208:209], v61 offset:0
    ds_read_b64_tr_b16 v[210:211], v61 offset:2048
    ds_read_b64_tr_b16 v[212:213], v61 offset:4096
    ds_read_b64_tr_b16 v[214:215], v61 offset:6144
    s_waitcnt lgkmcnt(0)
    ds_read_b64_tr_b16 v[224:225], v62 offset:0
    ds_read_b64_tr_b16 v[226:227], v62 offset:2048
    ds_read_b64_tr_b16 v[228:229], v62 offset:4096
    ds_read_b64_tr_b16 v[230:231], v62 offset:6144
    ds_read_b64_tr_b16 v[240:241], v63 offset:0
    ds_read_b64_tr_b16 v[242:243], v63 offset:2048
    ds_read_b64_tr_b16 v[244:245], v63 offset:4096
    ds_read_b64_tr_b16 v[246:247], v63 offset:6144
    s_waitcnt lgkmcnt(0)
    s_waitcnt vmcnt(16)
    s_barrier
    s_mov_b32 s21, s64
    s_lshl_b32 s22, s17, 13
    s_lshl_b32 s19, s16, 17
    s_lshl_b32 s20, s17, 8
    s_add_u32 s19, s19, s20
    s_add_u32 s19, s19, 128
    s_add_u32 m0, s22, 65536
    s_nop 0
    buffer_load_dwordx4 v124, s[80:83], s19 offen offset:0  lds
    s_add_u32 s19, s19, 0xc00
    buffer_load_dwordx4 v124, s[80:83], s19 offen offset:1024  lds
    s_add_u32 s19, s19, 0xfffff400
    buffer_load_dwordx4 v124, s[80:83], s19 offen offset:2048  lds
    s_add_u32 s19, s19, 0xc00
    buffer_load_dwordx4 v124, s[80:83], s19 offen offset:3072  lds
    s_add_u32 m0, s22, 69632
    s_add_u32 s19, s19, 0x1400
    buffer_load_dwordx4 v124, s[80:83], s19 offen offset:0  lds
    s_add_u32 s19, s19, 0xc00
    buffer_load_dwordx4 v124, s[80:83], s19 offen offset:1024  lds
    s_add_u32 s19, s19, 0xfffff400
    buffer_load_dwordx4 v124, s[80:83], s19 offen offset:2048  lds
    s_add_u32 s19, s19, 0xc00
    buffer_load_dwordx4 v124, s[80:83], s19 offen offset:3072  lds
    v_readfirstlane_b32 s19, v40
    s_nop 0
    s_and_b32 s19, s19, 0x1ff
    s_cmp_ge_u32 s19, 32
    s_cbranch_scc0 L_ch_h16
    v_readfirstlane_b32 s19, v41
    s_nop 0
    s_and_b32 s19, s19, 0x1ff
    s_cmp_ge_u32 s19, 32
    s_cbranch_scc0 L_ch_h16
    v_readfirstlane_b32 s19, v42
    s_nop 0
    s_and_b32 s19, s19, 0x1ff
    s_cmp_ge_u32 s19, 32
    s_cbranch_scc0 L_ch_h16
    v_readfirstlane_b32 s19, v43
    s_nop 0
    s_and_b32 s19, s19, 0x1ff
    s_cmp_ge_u32 s19, 32
    s_cbranch_scc0 L_ch_h16
    v_readfirstlane_b32 s19, v44
    s_nop 0
    s_and_b32 s19, s19, 0x1ff
    s_cmp_ge_u32 s19, 32
    s_cbranch_scc0 L_ch_h16
    v_readfirstlane_b32 s19, v45
    s_nop 0
    s_and_b32 s19, s19, 0x1ff
    s_cmp_ge_u32 s19, 32
    s_cbranch_scc0 L_ch_h16
    v_readfirstlane_b32 s19, v46
    s_nop 0
    s_and_b32 s19, s19, 0x1ff
    s_cmp_ge_u32 s19, 32
    s_cbranch_scc0 L_ch_h16
    v_readfirstlane_b32 s19, v47
    s_nop 0
    s_and_b32 s19, s19, 0x1ff
    s_cmp_ge_u32 s19, 32
    s_cbranch_scc0 L_ch_h16
    v_readfirstlane_b32 s19, v48
    s_nop 0
    s_and_b32 s20, s19, 0x1ff
    s_cmp_ge_u32 s20, 32
    s_cbranch_scc0 L_ch_h16
    s_mul_i32 s20, s28, s28
    s_lshl_b32 s20, s20, 18
    s_lshl_b32 s21, s28, 9
    s_add_u32 s20, s20, s21
    s_add_u32 s20, s20, 1
    s_lshl_b32 s20, s20, 5
    s_cmp_eq_u32 s19, s20
    s_cselect_b32 s26, 1, 0
    s_mov_b32 s44, 1
L_ch_h16:
    buffer_load_dword v15, off, s[4:7], s42 sc1
    ds_read_b64_tr_b16 v[200:201], v60 offset:32768
    ds_read_b64_tr_b16 v[202:203], v60 offset:34816
    ds_read_b64_tr_b16 v[204:205], v60 offset:36864
    ds_read_b64_tr_b16 v[206:207], v60 offset:38912
    ds_read_b64_tr_b16 v[216:217], v61 offset:32768
    ds_read_b64_tr_b16 v[218:219], v61 offset:34816
    ds_read_b64_tr_b16 v[220:221], v61 offset:36864
    ds_read_b64_tr_b16 v[222:223], v61 offset:38912
    s_waitcnt lgkmcnt(0)
    ds_read_b64_tr_b16 v[232:233], v62 offset:32768
    ds_read_b64_tr_b16 v[234:235], v62 offset:34816
    ds_read_b64_tr_b16 v[236:237], v62 offset:36864
    ds_read_b64_tr_b16 v[238:239], v62 offset:38912
    ds_read_b64_tr_b16 v[248:249], v63 offset:32768
    ds_read_b64_tr_b16 v[250:251], v63 offset:34816
    ds_read_b64_tr_b16 v[252:253], v63 offset:36864
    ds_read_b64_tr_b16 v[254:255], v63 offset:38912
    s_waitcnt lgkmcnt(0)
    s_waitcnt vmcnt(17)
    s_barrier
    s_mov_b32 s21, s64
    s_lshl_b32 s22, s17, 13
    s_lshl_b32 s19, s16, 17
    s_lshl_b32 s20, s17, 8
    s_add_u32 s19, s19, s20
    s_add_u32 s19, s19, 65664
    s_add_u32 m0, s22, 98304
    s_nop 0
    buffer_load_dwordx4 v124, s[80:83], s19 offen offset:0  lds
    s_add_u32 s19, s19, 0xc00
    buffer_load_dwordx4 v124, s[80:83], s19 offen offset:1024  lds
    s_add_u32 s19, s19, 0xfffff400
    buffer_load_dwordx4 v124, s[80:83], s19 offen offset:2048  lds
    s_add_u32 s19, s19, 0xc00
    buffer_load_dwordx4 v124, s[80:83], s19 offen offset:3072  lds
    s_add_u32 m0, s22, 102400
    s_add_u32 s19, s19, 0x1400
    buffer_load_dwordx4 v124, s[80:83], s19 offen offset:0  lds
    s_add_u32 s19, s19, 0xc00
    buffer_load_dwordx4 v124, s[80:83], s19 offen offset:1024  lds
    s_add_u32 s19, s19, 0xfffff400
    buffer_load_dwordx4 v124, s[80:83], s19 offen offset:2048  lds
    s_add_u32 s19, s19, 0xc00
    buffer_load_dwordx4 v124, s[80:83], s19 offen offset:3072  lds
    v_xor_b32 v56, 0x10000, v56
    v_xor_b32 v57, 0x10000, v57
    v_xor_b32 v58, 0x10000, v58
    v_xor_b32 v59, 0x10000, v59
    v_xor_b32 v60, 0x10000, v60
    v_xor_b32 v61, 0x10000, v61
    v_xor_b32 v62, 0x10000, v62
    v_xor_b32 v63, 0x10000, v63
    ds_read_b64_tr_b16 v[80:81], v56 offset:0
    ds_read_b64_tr_b16 v[82:83], v56 offset:2048
    ds_read_b64_tr_b16 v[84:85], v56 offset:4096
    ds_read_b64_tr_b16 v[86:87], v56 offset:6144
    ds_read_b64_tr_b16 v[88:89], v57 offset:0
    ds_read_b64_tr_b16 v[90:91], v57 offset:2048
    ds_read_b64_tr_b16 v[92:93], v57 offset:4096
    ds_read_b64_tr_b16 v[94:95], v57 offset:6144
    s_waitcnt lgkmcnt(0)
    ds_read_b64_tr_b16 v[96:97], v58 offset:0
    ds_read_b64_tr_b16 v[98:99], v58 offset:2048
    ds_read_b64_tr_b16 v[100:101], v58 offset:4096
    ds_read_b64_tr_b16 v[102:103], v58 offset:6144
    ds_read_b64_tr_b16 v[104:105], v59 offset:0
    ds_read_b64_tr_b16 v[106:107], v59 offset:2048
    ds_read_b64_tr_b16 v[108:109], v59 offset:4096
    ds_read_b64_tr_b16 v[110:111], v59 offset:6144
    s_waitcnt lgkmcnt(0)
    s_barrier
    ds_write_b128 v8, v[80:83] offset:0
    ds_write_b128 v8, v[84:87] offset:1024
    ds_write_b128 v8, v[88:91] offset:2048
    ds_write_b128 v8, v[92:95] offset:3072
    ds_write_b128 v8, v[96:99] offset:4096
    ds_write_b128 v8, v[100:103] offset:5120
    ds_write_b128 v8, v[104:107] offset:6144
    ds_write_b128 v8, v[108:111] offset:7168
    s_waitcnt lgkmcnt(0)
    s_waitcnt vmcnt(17)
    s_barrier
    ds_read_b64_tr_b16 v[80:81], v56 offset:32768
    ds_read_b64_tr_b16 v[82:83], v56 offset:34816
    ds_read_b64_tr_b16 v[84:85], v56 offset:36864
    ds_read_b64_tr_b16 v[86:87], v56 offset:38912
    ds_read_b64_tr_b16 v[88:89], v57 offset:32768
    ds_read_b64_tr_b16 v[90:91], v57 offset:34816
    ds_read_b64_tr_b16 v[92:93], v57 offset:36864
    ds_read_b64_tr_b16 v[94:95], v57 offset:38912
    s_waitcnt lgkmcnt(0)
    ds_read_b64_tr_b16 v[96:97], v58 offset:32768
    ds_read_b64_tr_b16 v[98:99], v58 offset:34816
    ds_read_b64_tr_b16 v[100:101], v58 offset:36864
    ds_read_b64_tr_b16 v[102:103], v58 offset:38912
    ds_read_b64_tr_b16 v[104:105], v59 offset:32768
    ds_read_b64_tr_b16 v[106:107], v59 offset:34816
    ds_read_b64_tr_b16 v[108:109], v59 offset:36864
    ds_read_b64_tr_b16 v[110:111], v59 offset:38912
    s_waitcnt lgkmcnt(0)
    s_barrier
    ds_write_b128 v8, v[80:83] offset:32768
    ds_write_b128 v8, v[84:87] offset:33792
    ds_write_b128 v8, v[88:91] offset:34816
    ds_write_b128 v8, v[92:95] offset:35840
    ds_write_b128 v8, v[96:99] offset:36864
    ds_write_b128 v8, v[100:103] offset:37888
    ds_write_b128 v8, v[104:107] offset:38912
    ds_write_b128 v8, v[108:111] offset:39936
    s_waitcnt lgkmcnt(0)
    s_waitcnt vmcnt(9)
    s_barrier
    v_xor_b32 v56, 0x10000, v56
    v_xor_b32 v57, 0x10000, v57
    v_xor_b32 v58, 0x10000, v58
    v_xor_b32 v59, 0x10000, v59
    v_xor_b32 v60, 0x10000, v60
    v_xor_b32 v61, 0x10000, v61
    v_xor_b32 v62, 0x10000, v62
    v_xor_b32 v63, 0x10000, v63
    ds_read_b64_tr_b16 v[80:81], v60 offset:0
    ds_read_b64_tr_b16 v[82:83], v60 offset:2048
    ds_read_b64_tr_b16 v[84:85], v60 offset:4096
    ds_read_b64_tr_b16 v[86:87], v60 offset:6144
    ds_read_b64_tr_b16 v[88:89], v61 offset:0
    ds_read_b64_tr_b16 v[90:91], v61 offset:2048
    ds_read_b64_tr_b16 v[92:93], v61 offset:4096
    ds_read_b64_tr_b16 v[94:95], v61 offset:6144
    s_waitcnt lgkmcnt(0)
    ds_read_b64_tr_b16 v[96:97], v62 offset:0
    ds_read_b64_tr_b16 v[98:99], v62 offset:2048
    ds_read_b64_tr_b16 v[100:101], v62 offset:4096
    ds_read_b64_tr_b16 v[102:103], v62 offset:6144
    ds_read_b64_tr_b16 v[104:105], v63 offset:0
    ds_read_b64_tr_b16 v[106:107], v63 offset:2048
    ds_read_b64_tr_b16 v[108:109], v63 offset:4096
    ds_read_b64_tr_b16 v[110:111], v63 offset:6144
    s_waitcnt lgkmcnt(0)
    s_barrier
    v_xor_b32 v8, 0x10000, v8
    ds_write_b128 v8, v[80:83] offset:0
    ds_write_b128 v8, v[84:87] offset:1024
    ds_write_b128 v8, v[88:91] offset:2048
    ds_write_b128 v8, v[92:95] offset:3072
    ds_write_b128 v8, v[96:99] offset:4096
    ds_write_b128 v8, v[100:103] offset:5120
    ds_write_b128 v8, v[104:107] offset:6144
    ds_write_b128 v8, v[108:111] offset:7168
    s_waitcnt lgkmcnt(0)
    s_waitcnt vmcnt(0)
    s_barrier
    buffer_load_dwordx4 v[24:27], v10, s[8:11], 0 offen
    buffer_load_dwordx4 v[28:31], v10, s[8:11], 0 offen offset:128
    v_readfirstlane_b32 s19, v15
    s_nop 0
    s_lshr_b32 s20, s19, 16
    s_and_b32 s19, s19, 0xffff
    s_min_u32 s19, s19, s20
    s_cmp_ge_u32 s19, 2
    s_cselect_b32 s19, s44, 0
    s_lshl_b32 s44, s19, 1
    s_cmp_eq_u32 s44, 0
    s_cbranch_scc1 L_ch_h24
    s_mov_b32 m0, s56
    s_nop 0
    buffer_load_dwordx4 v1, s[4:7], s39 offen sc1 lds
    buffer_load_dwordx4 v1, s[4:7], s39 offen offset:1024 sc1 lds
    buffer_load_dwordx4 v[112:115], v1, s[4:7], s40 offen sc1
    buffer_load_dwordx4 v[116:119], v1, s[4:7], s40 offen offset:1024 sc1
L_ch_h24:
    ds_read_b64_tr_b16 v[80:81], v60 offset:32768
    ds_read_b64_tr_b16 v[82:83], v60 offset:34816
    ds_read_b64_tr_b16 v[84:85], v60 offset:36864
    ds_read_b64_tr_b16 v[86:87], v60 offset:38912
    ds_read_b64_tr_b16 v[88:89], v61 offset:32768
    ds_read_b64_tr_b16 v[90:91], v61 offset:34816
    ds_read_b64_tr_b16 v[92:93], v61 offset:36864
    ds_read_b64_tr_b16 v[94:95], v61 offset:38912
    s_waitcnt lgkmcnt(0)
    ds_read_b64_tr_b16 v[96:97], v62 offset:32768
    ds_read_b64_tr_b16 v[98:99], v62 offset:34816
    ds_read_b64_tr_b16 v[100:101], v62 offset:36864
    ds_read_b64_tr_b16 v[102:103], v62 offset:38912
    ds_read_b64_tr_b16 v[104:105], v63 offset:32768
    ds_read_b64_tr_b16 v[106:107], v63 offset:34816
    ds_read_b64_tr_b16 v[108:109], v63 offset:36864
    ds_read_b64_tr_b16 v[110:111], v63 offset:38912
    s_waitcnt lgkmcnt(0)
    s_barrier
    ds_write_b128 v8, v[80:83] offset:32768
    ds_write_b128 v8, v[84:87] offset:33792
    ds_write_b128 v8, v[88:91] offset:34816
    ds_write_b128 v8, v[92:95] offset:35840
    ds_write_b128 v8, v[96:99] offset:36864
    ds_write_b128 v8, v[100:103] offset:37888
    ds_write_b128 v8, v[104:107] offset:38912
    ds_write_b128 v8, v[108:111] offset:39936
    s_waitcnt lgkmcnt(0)
    v_xor_b32 v8, 0x10000, v8
    s_mov_b32 s30, 0
    s_cmp_lg_u32 s44, 0
    s_cbranch_scc1 L_ch_ready
    s_branch L_ch_init_first
L_ch_init:
    s_sleep 16
L_ch_init_first:
    buffer_load_dwordx4 v[40:43], off, s[12:15], 0 sc1
    buffer_load_dwordx4 v[44:47], off, s[12:15], 0 offset:16 sc1
    s_lshl_b32 s20, s27, 2
    buffer_load_dword v48, off, s[12:15], s20 sc1
    s_add_u32 s18, s18, 1
    s_cmp_gt_u32 s18, 200000
    s_cbranch_scc1 L_abort
    s_waitcnt vmcnt(0)
    v_readfirstlane_b32 s19, v40
    s_nop 0
    s_and_b32 s19, s19, 0x1ff
    s_cmp_ge_u32 s19, 32
    s_cbranch_scc0 L_ch_init
    v_readfirstlane_b32 s19, v41
    s_nop 0
    s_and_b32 s19, s19, 0x1ff
    s_cmp_ge_u32 s19, 32
    s_cbranch_scc0 L_ch_init
    v_readfirstlane_b32 s19, v42
    s_nop 0
    s_and_b32 s19, s19, 0x1ff
    s_cmp_ge_u32 s19, 32
    s_cbranch_scc0 L_ch_init
    v_readfirstlane_b32 s19, v43
    s_nop 0
    s_and_b32 s19, s19, 0x1ff
    s_cmp_ge_u32 s19, 32
    s_cbranch_scc0 L_ch_init
    v_readfirstlane_b32 s19, v44
    s_nop 0
    s_and_b32 s19, s19, 0x1ff
    s_cmp_ge_u32 s19, 32
    s_cbranch_scc0 L_ch_init
    v_readfirstlane_b32 s19, v45
    s_nop 0
    s_and_b32 s19, s19, 0x1ff
    s_cmp_ge_u32 s19, 32
    s_cbranch_scc0 L_ch_init
    v_readfirstlane_b32 s19, v46
    s_nop 0
    s_and_b32 s19, s19, 0x1ff
    s_cmp_ge_u32 s19, 32
    s_cbranch_scc0 L_ch_init
    v_readfirstlane_b32 s19, v47
    s_nop 0
    s_and_b32 s19, s19, 0x1ff
    s_cmp_ge_u32 s19, 32
    s_cbranch_scc0 L_ch_init
    v_readfirstlane_b32 s19, v48
    s_nop 0
    s_and_b32 s20, s19, 0x1ff
    s_cmp_ge_u32 s20, 32
    s_cbranch_scc0 L_ch_init
    s_mul_i32 s20, s28, s28
    s_lshl_b32 s20, s20, 18
    s_lshl_b32 s21, s28, 9
    s_add_u32 s20, s20, s21
    s_add_u32 s20, s20, 1
    s_lshl_b32 s20, s20, 5
    s_cmp_eq_u32 s19, s20
    s_cselect_b32 s26, 1, 0
    v_mov_b32 v15, 0
    s_nop 0
    v_readfirstlane_b32 s44, v15
    s_nop 0
    s_lshr_b32 s19, s44, 16
    s_and_b32 s44, s44, 0xffff
    s_min_u32 s44, s44, s19
    s_add_u32 s19, s30, 2
    s_min_u32 s19, s19, 64
    s_cmp_ge_u32 s44, s19
    s_cbranch_scc0 L_ch_av_slow
L_ch_av_ok:
    s_mov_b32 m0, s56
    s_nop 0
    buffer_load_dwordx4 v1, s[4:7], s39 offen sc1 lds
    buffer_load_dwordx4 v1, s[4:7], s39 offen offset:1024 sc1 lds
    buffer_load_dwordx4 v[112:115], v1, s[4:7], s40 offen sc1
    buffer_load_dwordx4 v[116:119], v1, s[4:7], s40 offen offset:1024 sc1
L_ch_ready:
    s_add_u32 s39, s39, 262144
    s_add_u32 s40, s40, 262144
    ds_read_b128 v[80:83], v8 offset:0
    ds_read_b128 v[84:87], v8 offset:1024
    ds_read_b128 v[88:91], v8 offset:2048
    ds_read_b128 v[92:95], v8 offset:3072
    ds_read_b128 v[96:99], v8 offset:32768
    ds_read_b128 v[100:103], v8 offset:33792
    ds_read_b128 v[104:107], v8 offset:34816
    ds_read_b128 v[108:111], v8 offset:35840
    v_mov_b32 v120, v64
    v_mov_b32 v121, v65
    v_mov_b32 v122, v66
    v_mov_b32 v123, v67
    v_mov_b32 v56, 0
    v_mov_b32 v57, 0
    v_mov_b32 v58, 0
    v_mov_b32 v59, 0
    v_mov_b32 v60, 0
    v_mov_b32 v61, 0
    v_mov_b32 v62, 0
    v_mov_b32 v63, 0
    v_mov_b32 v64, 0
    v_mov_b32 v65, 0
    v_mov_b32 v66, 0
    v_mov_b32 v67, 0
    v_mov_b32 v68, 0
    v_mov_b32 v69, 0
    v_mov_b32 v70, 0
    v_mov_b32 v71, 0
    v_mov_b32 v72, 0
    v_mov_b32 v73, 0
    v_mov_b32 v74, 0
    v_mov_b32 v75, 0
    v_mov_b32 v76, 0
    v_mov_b32 v77, 0
    v_mov_b32 v78, 0
    v_mov_b32 v79, 0
    s_mov_b32 s31, 131072
    s_waitcnt vmcnt(0)
    v_cndmask_b32 v10, v16, 0, s[66:67]
    s_cmp_ge_u32 s17, 2
    s_cselect_b32 s42, 268435456, s42
    v_mov_b32 v32, 0
    v_mov_b32 v33, 0
    v_mov_b32 v34, 0
    v_mov_b32 v35, 0
    ds_write_b128 v1, v[32:35] offset:24576
    ds_write_b128 v1, v[32:35] offset:25600
    s_waitcnt vmcnt(0) lgkmcnt(0)
    s_add_u32 s20, s16, 31
    s_and_b32 s20, s20, 31
    s_lshl_b32 s20, s20, 13
    s_add_u32 s20, s20, 917504
    s_add_u32 s19, s20, 0
    buffer_load_dwordx4 v[124:127], v1, s[4:7], s19 offen offset:0 sc1
    buffer_load_dwordx4 v[124:127], v1, s[4:7], s19 offen offset:1024 sc1
    s_add_u32 s19, s20, 262144
    buffer_load_dwordx4 v[124:127], v1, s[4:7], s19 offen offset:0 sc1
    buffer_load_dwordx4 v[124:127], v1, s[4:7], s19 offen offset:1024 sc1
    s_add_u32 s19, s59, 0
    buffer_load_dwordx4 v[124:127], v1, s[4:7], s19 offen offset:0 sc1
    buffer_load_dwordx4 v[124:127], v1, s[4:7], s19 offen offset:1024 sc1
    s_add_u32 s19, s59, 262144
    buffer_load_dwordx4 v[124:127], v1, s[4:7], s19 offen offset:0 sc1
    buffer_load_dwordx4 v[124:127], v1, s[4:7], s19 offen offset:1024 sc1
    s_bfe_u32 s19, s16, 0x20002
    s_lshl_b32 s19, s19, 13
    s_add_u32 s19, s19, 131072
    buffer_load_dwordx4 v[124:127], v1, s[4:7], s19 offen offset:0 sc1
    buffer_load_dwordx4 v[124:127], v1, s[4:7], s19 offen offset:1024 sc1
    buffer_load_dword v124, v6, s[4:7], s29 offen sc1
    v_min_u32 v24, -2, v24
    v_min_u32 v25, -2, v25
    v_min_u32 v26, -2, v26
    v_min_u32 v27, -2, v27
    v_min_u32 v28, -2, v28
    v_min_u32 v29, -2, v29
    v_min_u32 v30, -2, v30
    v_min_u32 v31, -2, v31
    s_cmp_eq_u32 s26, 1
    s_cbranch_scc0 L_S0_entry
    s_branch L_F0_entry
.p2align 8
.long 0xbf800000
.long 0xbf800000
.long 0xbf800000
.long 0xbf800000
.long 0xbf800000
.long 0xbf800000
L_F0_h1:
    s_waitcnt vmcnt(0)
L_F0_entry:
    ds_write_b128 v1, v[24:27]
    v_max3_u32 v23, v25, v27, v29
    v_max_u32 v23, v23, v31
    v_cmp_eq_u32 vcc, -1, v23
L_F0_entry2:
    v_smfmac_f32_16x16x64_bf16 v[56:59], v[24:27], a[0:7], v13
    v_smfmac_f32_16x16x64_bf16 v[60:63], v[24:27], a[8:15], v13
    s_cbranch_vccnz L_F0_h1retry
    v_smfmac_f32_16x16x64_bf16 v[56:59], v[28:31], a[16:23], v13
    ds_write_b128 v1, v[28:31] offset:1024
    v_smfmac_f32_16x16x64_bf16 v[60:63], v[28:31], a[24:31], v13
    v_smfmac_f32_16x16x64_bf16 v[64:67], v[24:27], a[128:135], v13
    v_smfmac_f32_16x16x64_bf16 v[68:71], v[24:27], a[136:143], v13
    s_mov_b32 m0, s57
    v_smfmac_f32_16x16x64_bf16 v[64:67], v[28:31], a[144:151], v13
    s_waitcnt lgkmcnt(0)
    s_barrier
    ds_read_b128 v[32:35], v2 offset:0
    v_smfmac_f32_16x16x64_bf16 v[68:71], v[28:31], a[152:159], v13
    ds_read_b128 v[36:39], v2 offset:1024
    v_smfmac_f32_16x16x64_bf16 v[72:75], v[24:27], v[80:87], v13
    ds_read_b128 v[40:43], v3 offset:0
    v_smfmac_f32_16x16x64_bf16 v[76:79], v[24:27], v[88:95], v13
    ds_read_b128 v[44:47], v3 offset:1024
    v_smfmac_f32_16x16x64_bf16 v[72:75], v[28:31], v[96:103], v13
    ds_read_b128 v[48:51], v4 offset:0
    v_smfmac_f32_16x16x64_bf16 v[76:79], v[28:31], v[104:111], v13
    s_waitcnt lgkmcnt(4)
    ds_read_b128 v[52:55], v4 offset:1024
    v_smfmac_f32_16x16x64_bf16 v[56:59], v[32:35], a[32:39], v13
    v_smfmac_f32_16x16x64_bf16 v[60:63], v[32:35], a[40:47], v13
    s_waitcnt lgkmcnt(4)
    buffer_store_dwordx4 v[120:123], v0, s[4:7], s41 offen sc1
    v_smfmac_f32_16x16x64_bf16 v[56:59], v[36:39], a[48:55], v13
    ds_read_b128 v[80:83], v8 offset:4096
    v_smfmac_f32_16x16x64_bf16 v[60:63], v[36:39], a[56:63], v13
    s_waitcnt lgkmcnt(4)
    ds_read_b128 v[84:87], v8 offset:5120
    buffer_load_dwordx4 v1, s[4:7], s39 offen sc1 lds
    v_smfmac_f32_16x16x64_bf16 v[56:59], v[40:43], a[64:71], v13
    ds_read_b128 v[88:91], v8 offset:6144
    v_smfmac_f32_16x16x64_bf16 v[60:63], v[40:43], a[72:79], v13
    s_waitcnt lgkmcnt(5)
    ds_read_b128 v[92:95], v8 offset:7168
    buffer_load_dwordx4 v1, s[4:7], s39 offen offset:1024 sc1 lds
    v_smfmac_f32_16x16x64_bf16 v[56:59], v[44:47], a[80:87], v13
    ds_read_b128 v[96:99], v8 offset:36864
    v_smfmac_f32_16x16x64_bf16 v[60:63], v[44:47], a[88:95], v13
    s_waitcnt lgkmcnt(6)
    ds_read_b128 v[100:103], v8 offset:37888
    buffer_load_dwordx4 v[124:127], v1, s[4:7], s40 offen offset:1024 sc1
    v_smfmac_f32_16x16x64_bf16 v[56:59], v[48:51], a[96:103], v13
    ds_read_b128 v[104:107], v8 offset:38912
    s_sub_u32 s21, s30, 1
    s_max_i32 s21, s21, 0
    v_smfmac_f32_16x16x64_bf16 v[60:63], v[48:51], a[104:111], v13
    s_waitcnt lgkmcnt(7)
    ds_read_b128 v[108:111], v8 offset:39936
    buffer_load_dwordx4 v[120:123], v1, s[4:7], s40 offen sc1
    v_mov_b32 v20, s21
    v_smfmac_f32_16x16x64_bf16 v[56:59], v[52:55], a[112:119], v13
    buffer_load_dword v15, off, s[4:7], s42 sc1
    ds_read_b128 v[24:27], v0 offset:8192
    v_smfmac_f32_16x16x64_bf16 v[60:63], v[52:55], a[120:127], v13
    s_and_b32 s19, s30, 3
    s_waitcnt lgkmcnt(7)
    buffer_store_dword v20, v10, s[4:7], s43 offen sc1
    ds_read_b128 v[28:31], v0 offset:12288
    v_smfmac_f32_16x16x64_bf16 v[72:75], v[32:35], v[80:87], v13
    s_lshl_b32 s20, s19, 13
    s_waitcnt lgkmcnt(6)
    v_add_f32 v56, v56, v57
    v_smfmac_f32_16x16x64_bf16 v[76:79], v[32:35], v[88:95], v13
    s_add_u32 s37, s20, s60
    s_waitcnt lgkmcnt(4)
    v_add_f32 v58, v58, v59
    v_smfmac_f32_16x16x64_bf16 v[72:75], v[36:39], v[96:103], v13
    s_and_b32 s19, s19, 1
    s_waitcnt lgkmcnt(2)
    v_cvt_pk_bf16_f32 v56, v56, v58
    v_smfmac_f32_16x16x64_bf16 v[76:79], v[36:39], v[104:111], v13
    s_lshl_b32 s20, s19, 18
    ds_write_b32 v5, v56
    v_add_f32 v60, v60, v61
    v_smfmac_f32_16x16x64_bf16 v[64:67], v[32:35], a[160:167], v13
    s_add_u32 s32, s20, s58
    ds_read_b128 v[96:99], v0 offset:9216
    v_add_f32 v62, v62, v63
    v_smfmac_f32_16x16x64_bf16 v[68:71], v[32:35], a[168:175], v13
    s_add_u32 s33, s32, 32768
    ds_read_b128 v[100:103], v0 offset:13312
    v_cvt_pk_bf16_f32 v60, v60, v62
    v_smfmac_f32_16x16x64_bf16 v[64:67], v[36:39], a[176:183], v13
    s_add_u32 s34, s20, s59
    ds_write_b32 v5, v60 offset:512
    v_smfmac_f32_16x16x64_bf16 v[68:71], v[36:39], a[184:191], v13
    s_add_u32 s35, s34, 4096
    ds_read_b128 v[104:107], v0 offset:10240
    v_smfmac_f32_16x16x64_bf16 v[64:67], v[40:43], a[192:199], v13
    s_bfe_u32 s38, s30, 0x10001
    ds_read_b128 v[108:111], v0 offset:14336
    v_smfmac_f32_16x16x64_bf16 v[68:71], v[40:43], a[200:207], v13
    s_add_u32 s19, s30, 1
    ds_read_b128 v[32:35], v0 offset:11264
    v_xor_b32 v8, 0x10000, v8
    v_smfmac_f32_16x16x64_bf16 v[64:67], v[44:47], a[208:215], v13
    s_and_b32 s19, s19, 3
    s_waitcnt lgkmcnt(3)
    s_barrier
    ds_read_b64_tr_b16 v[80:81], v7 offset:0
    v_smfmac_f32_16x16x64_bf16 v[68:71], v[44:47], a[216:223], v13
    s_lshl_b32 s19, s19, 13
    ds_read_b64_tr_b16 v[82:83], v7 offset:512
    v_smfmac_f32_16x16x64_bf16 v[64:67], v[48:51], a[224:231], v13
    s_add_u32 s36, s19, s60
    ds_read_b64_tr_b16 v[84:85], v7 offset:1024
    v_smfmac_f32_16x16x64_bf16 v[68:71], v[48:51], a[232:239], v13
    s_add_u32 s31, s19, 131072
    ds_read_b64_tr_b16 v[86:87], v7 offset:1536
    v_smfmac_f32_16x16x64_bf16 v[64:67], v[52:55], a[240:247], v13
    s_add_u32 s41, s41, 131072
    ds_read_b64_tr_b16 v[88:89], v7 offset:2048
    v_smfmac_f32_16x16x64_bf16 v[68:71], v[52:55], a[248:255], v13
    s_add_u32 s39, s39, 262144
    ds_read_b64_tr_b16 v[90:91], v7 offset:2560
    v_smfmac_f32_16x16x64_bf16 v[72:75], v[40:43], v[128:135], v13
    s_add_u32 s40, s40, 262144
    ds_read_b64_tr_b16 v[92:93], v7 offset:3072
    v_add_f32 v64, v64, v65
    v_smfmac_f32_16x16x64_bf16 v[76:79], v[40:43], v[136:143], v13
    s_waitcnt lgkmcnt(5)
    ds_read_b64_tr_b16 v[94:95], v7 offset:3584
    v_add_f32 v66, v66, v67
    v_mfma_f32_16x16x32_bf16 v[56:59], v[24:27], v[80:83], 0
    v_cvt_pk_bf16_f32 v64, v64, v66
    v_add_f32 v68, v68, v69
    v_mfma_f32_16x16x32_bf16 v[60:63], v[28:31], v[80:83], 0
    s_waitcnt lgkmcnt(4)
    ds_write_b32 v5, v64 offset:4096
    v_add_f32 v70, v70, v71
    v_mfma_f32_16x16x32_bf16 v[56:59], v[96:99], v[84:87], v[56:59]
    ds_read_b128 v[36:39], v0 offset:15360
    v_cvt_pk_bf16_f32 v65, v68, v70
    v_mfma_f32_16x16x32_bf16 v[60:63], v[100:103], v[84:87], v[60:63]
    s_waitcnt lgkmcnt(4)
    ds_write_b32 v5, v65 offset:4608
    v_mfma_f32_16x16x32_bf16 v[56:59], v[104:107], v[88:91], v[56:59]
    v_mfma_f32_16x16x32_bf16 v[60:63], v[108:111], v[88:91], v[60:63]
    s_waitcnt lgkmcnt(3)
    v_mfma_f32_16x16x32_bf16 v[56:59], v[32:35], v[92:95], v[56:59]
    s_waitcnt lgkmcnt(1)
    v_mfma_f32_16x16x32_bf16 v[60:63], v[36:39], v[92:95], v[60:63]
    s_waitcnt lgkmcnt(0)
    s_barrier
    ds_read_b64_tr_b16 v[96:97], v7 offset:4096
    ds_read_b64_tr_b16 v[98:99], v7 offset:4608
    v_smfmac_f32_16x16x64_bf16 v[72:75], v[44:47], v[144:151], v13
    ds_read_b64_tr_b16 v[100:101], v7 offset:5120
    v_exp_f32 v56, v56
    v_smfmac_f32_16x16x64_bf16 v[76:79], v[44:47], v[152:159], v13
    ds_read_b64_tr_b16 v[102:103], v7 offset:5632
    v_exp_f32 v57, v57
    v_smfmac_f32_16x16x64_bf16 v[72:75], v[48:51], v[160:167], v13
    ds_read_b64_tr_b16 v[104:105], v7 offset:6144
    v_exp_f32 v58, v58
    v_smfmac_f32_16x16x64_bf16 v[76:79], v[48:51], v[168:175], v13
    ds_read_b64_tr_b16 v[106:107], v7 offset:6656
    v_exp_f32 v59, v59
    v_smfmac_f32_16x16x64_bf16 v[72:75], v[52:55], v[176:183], v13
    ds_read_b64_tr_b16 v[108:109], v7 offset:7168
    v_exp_f32 v60, v60
    v_smfmac_f32_16x16x64_bf16 v[76:79], v[52:55], v[184:191], v13
    s_waitcnt lgkmcnt(5)
    ds_read_b64_tr_b16 v[110:111], v7 offset:7680
    v_exp_f32 v61, v61
    v_mfma_f32_16x16x32_bf16 v[68:71], v[96:99], v[80:83], 0
    s_waitcnt lgkmcnt(4)
    v_exp_f32 v62, v62
    v_mfma_f32_16x16x32_bf16 v[68:71], v[100:103], v[84:87], v[68:71]
    s_waitcnt lgkmcnt(2)
    v_exp_f32 v63, v63
    v_mfma_f32_16x16x32_bf16 v[68:71], v[104:107], v[88:91], v[68:71]
    s_waitcnt lgkmcnt(0)
    v_cvt_pk_bf16_f32 v56, v56, v57
    v_cvt_pk_bf16_f32 v57, v58, v59
    v_mfma_f32_16x16x32_bf16 v[68:71], v[108:111], v[92:95], v[68:71]
    v_cvt_pk_bf16_f32 v58, v60, v61
    v_cvt_pk_bf16_f32 v59, v62, v63
    v_add_f32 v72, v72, v73
    v_add_f32 v74, v74, v75
    v_mfma_f32_16x16x32_bf16 v[32:35], v[16:19], v[56:59], 0
    s_nop 2
    v_mul_f32 v68, s45, v68
    v_mul_f32 v69, s45, v69
    v_mfma_f32_16x16x32_bf16 v[24:27], v[112:115], v[56:59], 0
    v_exp_f32 v68, v68
    v_exp_f32 v69, v69
    v_mfma_f32_16x16x32_bf16 v[28:31], v[116:119], v[56:59], 0
    v_cvt_pk_bf16_f32 v66, v72, v74
    v_cvt_pk_bf16_f32 v20, v68, v69
    v_add_f32 v76, v76, v77
    v_add_f32 v78, v78, v79
    v_mfma_f32_16x16x16_bf16 v[32:35], v[16:17], v[20:21], v[32:35]
    v_cvt_pk_bf16_f32 v67, v76, v78
    v_cvt_pk_bf16_f32 v23, v68, v69
    s_nop 0
    v_mfma_f32_16x16x16_bf16 v[24:27], v[66:67], v[20:21], v[24:27]
    ds_read_b128 v[80:83], v8 offset:0
    ds_read_b128 v[84:87], v8 offset:1024
    v_mfma_f32_16x16x16_bf16 v[28:31], v[66:67], v[22:23], v[28:31]
    ds_read_b128 v[88:91], v8 offset:32768
    ds_read_b128 v[92:95], v8 offset:33792
    v_rcp_f32 v56, v32
    s_nop 0
    v_pk_mul_f32 v[24:25], v[24:25], v[56:57] op_sel_hi:[1,0]
    v_pk_mul_f32 v[26:27], v[26:27], v[56:57] op_sel_hi:[1,0]
    v_cvt_pk_bf16_f32 v60, v24, v25
    v_cvt_pk_bf16_f32 v61, v26, v27
    ds_write_b64 v9, v[60:61] offset:0
    v_pk_mul_f32 v[28:29], v[28:29], v[56:57] op_sel_hi:[1,0]
    v_pk_mul_f32 v[30:31], v[30:31], v[56:57] op_sel_hi:[1,0]
    v_cvt_pk_bf16_f32 v62, v28, v29
    v_cvt_pk_bf16_f32 v63, v30, v31
    ds_write_b64 v9, v[62:63] offset:8
    v_subrev_u32 v57, s46, v32
    v_cmp_le_u32 vcc, s47, v57
    v_mfma_f32_16x16x16_bf16 v[24:27], v[22:23], v[20:21], 0
    v_mfma_f32_16x16x16_bf16 v[28:31], v[22:23], v[20:21], 0
    v_mfma_f32_16x16x16_bf16 v[32:35], v[22:23], v[20:21], 0
    v_mfma_f32_16x16x16_bf16 v[36:39], v[22:23], v[20:21], 0
    s_cbranch_vccnz L_F0_fallback
L_F0_fbdone:
    s_waitcnt lgkmcnt(0)
    s_barrier
    ds_read_b128 v[112:115], v0
    ds_read_b128 v[116:119], v0 offset:1024
    s_add_u32 s30, s30, 1
    v_mfma_f32_16x16x16_bf16 v[40:43], v[22:23], v[20:21], 0
    v_mov_b32 v68, s30
    v_mfma_f32_16x16x16_bf16 v[44:47], v[22:23], v[20:21], 0
    v_mfma_f32_16x16x16_bf16 v[48:51], v[22:23], v[20:21], 0
    v_mfma_f32_16x16x16_bf16 v[52:55], v[22:23], v[20:21], 0
    s_waitcnt lgkmcnt(1)
    v_smfmac_f32_16x16x64_bf16 v[24:27], v[112:115], v[192:199], v13
    s_waitcnt lgkmcnt(0)
    ds_read_b128 v[96:99], v8 offset:2048
    v_smfmac_f32_16x16x64_bf16 v[24:27], v[116:119], v[200:207], v13
    ds_read_b128 v[100:103], v8 offset:3072
    v_smfmac_f32_16x16x64_bf16 v[28:31], v[112:115], v[208:215], v13
    ds_read_b128 v[104:107], v8 offset:34816
    v_smfmac_f32_16x16x64_bf16 v[28:31], v[116:119], v[216:223], v13
    ds_read_b128 v[108:111], v8 offset:35840
    v_add_f32 v24, v24, v25
    v_smfmac_f32_16x16x64_bf16 v[32:35], v[112:115], v[224:231], v13
    ds_read_b128 v[56:59], v8 offset:4096
    v_add_f32 v26, v26, v27
    v_cvt_pk_bf16_f32 v24, v24, v26
    v_smfmac_f32_16x16x64_bf16 v[32:35], v[116:119], v[232:239], v13
    ds_read_b128 v[60:63], v8 offset:5120
    v_and_or_b32 v24, v24, -2, s38
    v_add_f32 v28, v28, v29
    v_smfmac_f32_16x16x64_bf16 v[36:39], v[112:115], v[240:247], v13
    ds_read_b128 v[72:75], v8 offset:36864
    v_add_f32 v30, v30, v31
    v_cvt_pk_bf16_f32 v25, v28, v30
    v_smfmac_f32_16x16x64_bf16 v[36:39], v[116:119], v[248:255], v13
    buffer_store_dword v68, v6, s[4:7], s23 offen
    ds_read_b128 v[76:79], v8 offset:37888
    v_add_f32 v32, v32, v33
    v_smfmac_f32_16x16x64_bf16 v[40:43], v[112:115], v[80:87], v13
    ds_read_b128 v[80:83], v8 offset:6144
    v_add_f32 v34, v34, v35
    v_cvt_pk_bf16_f32 v26, v32, v34
    v_smfmac_f32_16x16x64_bf16 v[40:43], v[116:119], v[88:95], v13
    s_waitcnt lgkmcnt(7)
    ds_read_b128 v[84:87], v8 offset:7168
    ds_read_b128 v[88:91], v8 offset:38912
    v_add_f32 v36, v36, v37
    v_smfmac_f32_16x16x64_bf16 v[44:47], v[112:115], v[96:103], v13
    s_waitcnt lgkmcnt(7)
    ds_read_b128 v[92:95], v8 offset:39936
    v_add_f32 v38, v38, v39
    v_cvt_pk_bf16_f32 v27, v36, v38
    v_smfmac_f32_16x16x64_bf16 v[44:47], v[116:119], v[104:111], v13
    s_waitcnt lgkmcnt(6)
    buffer_store_dwordx4 v[24:27], v11, s[4:7], s32 offen
    v_add_f32 v40, v40, v41
    v_xor_b32 v8, 0x10000, v8
    v_smfmac_f32_16x16x64_bf16 v[48:51], v[112:115], v[56:63], v13
    s_waitcnt lgkmcnt(4)
    v_add_f32 v42, v42, v43
    v_cvt_pk_bf16_f32 v40, v40, v42
    v_smfmac_f32_16x16x64_bf16 v[48:51], v[116:119], v[72:79], v13
    s_waitcnt lgkmcnt(2)
    v_and_or_b32 v40, v40, -2, s38
    v_add_f32 v44, v44, v45
    v_smfmac_f32_16x16x64_bf16 v[52:55], v[112:115], v[80:87], v13
    s_waitcnt lgkmcnt(0)
    buffer_load_dword v69, v6, s[4:7], s29 offen sc1
    v_add_f32 v46, v46, v47
    v_cvt_pk_bf16_f32 v41, v44, v46
    v_smfmac_f32_16x16x64_bf16 v[52:55], v[116:119], v[88:95], v13
    v_add_f32 v48, v48, v49
    v_add_f32 v50, v50, v51
    v_cvt_pk_bf16_f32 v42, v48, v50
    buffer_load_dword v70, v6, s[4:7], s29 offen sc1
    s_nop 3
    v_add_f32 v52, v52, v53
    v_add_f32 v54, v54, v55
    v_cvt_pk_bf16_f32 v43, v52, v54
    buffer_store_dwordx4 v[40:43], v11, s[4:7], s33 offen
    s_cmp_lg_u32 s17, 0
    s_cbranch_scc1 L_F0_others
    buffer_load_dword v71, v6, s[4:7], s29 offen sc1
    v_cndmask_b32 v56, 0, v14, s[48:49]
    v_cndmask_b32 v57, 0, v14, s[50:51]
    v_cndmask_b32 v58, 0, v14, s[52:53]
    v_cndmask_b32 v59, 0, v14, s[54:55]
    v_mov_b32 v112, v64
    v_mov_b32 v113, v65
    v_mov_b32 v114, v66
    v_mov_b32 v115, v67
    v_mov_b32 v60, 0
    v_mov_b32 v61, 0
    v_mov_b32 v62, 0
    v_mov_b32 v63, 0
    v_mov_b32 v64, 0
    v_mov_b32 v65, 0
    v_mov_b32 v66, 0
    v_mov_b32 v67, 0
    buffer_load_dword v72, v6, s[4:7], s29 offen sc1
    s_waitcnt vmcnt(4)
    v_cmp_gt_u32 vcc, s30, v69
    s_cbranch_vccz L_F0_go
    buffer_load_dword v69, v6, s[4:7], s29 offen sc1
    s_waitcnt vmcnt(4)
    v_cmp_gt_u32 vcc, s30, v70
    s_cbranch_vccz L_F0_go
    buffer_load_dword v70, v6, s[4:7], s29 offen sc1
L_F0_hl:
    s_waitcnt vmcnt(3)
    v_cmp_gt_u32 vcc, s30, v71
    s_cbranch_vccz L_F0_go
    buffer_load_dword v71, v6, s[4:7], s29 offen sc1
    s_add_u32 s97, s97, 1
    s_waitcnt vmcnt(3)
    v_cmp_gt_u32 vcc, s30, v72
    s_cbranch_vccz L_F0_go
    buffer_load_dword v72, v6, s[4:7], s29 offen sc1
    s_add_u32 s97, s97, 1
    s_waitcnt vmcnt(3)
    v_cmp_gt_u32 vcc, s30, v69
    s_cbranch_vccz L_F0_go
    buffer_load_dword v69, v6, s[4:7], s29 offen sc1
    s_add_u32 s97, s97, 1
    s_waitcnt vmcnt(3)
    v_cmp_gt_u32 vcc, s30, v70
    s_cbranch_vccz L_F0_go
    buffer_load_dword v70, v6, s[4:7], s29 offen sc1
    s_add_u32 s97, s97, 1
    s_add_u32 s18, s18, 1
    s_cmp_gt_u32 s18, 200000
    s_cbranch_scc0 L_F0_hl
    s_branch L_abort
.p2align 5
L_F0_go:
    buffer_load_dwordx4 v[24:27], v0, s[4:7], s34 offen offset:0 sc1
    buffer_load_dwordx4 v[28:31], v0, s[4:7], s34 offen offset:1024 sc1
    buffer_load_dwordx4 v[32:35], v0, s[4:7], s34 offen offset:2048 sc1
    buffer_load_dwordx4 v[36:39], v0, s[4:7], s34 offen offset:3072 sc1
    buffer_load_dwordx4 v[40:43], v0, s[4:7], s35 offen offset:0 sc1
    buffer_load_dwordx4 v[44:47], v0, s[4:7], s35 offen offset:1024 sc1
    buffer_load_dwordx4 v[48:51], v0, s[4:7], s35 offen offset:2048 sc1
    buffer_load_dwordx4 v[52:55], v0, s[4:7], s35 offen offset:3072 sc1
L_F0_h2:
    s_waitcnt vmcnt(7)
    v_mfma_f32_16x16x32_bf16 v[72:75], v[24:27], v[56:59], 0
    s_waitcnt vmcnt(6)
    v_xor_b32 v76, s38, v24
    v_mfma_f32_16x16x32_bf16 v[72:75], v[28:31], v[56:59], v[72:75]
    s_waitcnt vmcnt(5)
    v_bitop3_b32 v76, v76, v28, s38 bitop3:0xf6
    v_mfma_f32_16x16x32_bf16 v[72:75], v[32:35], v[56:59], v[72:75]
    s_waitcnt vmcnt(4)
    v_bitop3_b32 v76, v76, v32, s38 bitop3:0xf6
    v_mfma_f32_16x16x32_bf16 v[72:75], v[36:39], v[56:59], v[72:75]
    s_waitcnt vmcnt(3)
    v_bitop3_b32 v76, v76, v36, s38 bitop3:0xf6
    v_mfma_f32_16x16x32_bf16 v[72:75], v[40:43], v[56:59], v[72:75]
    s_waitcnt vmcnt(2)
    v_bitop3_b32 v76, v76, v40, s38 bitop3:0xf6
    v_mfma_f32_16x16x32_bf16 v[72:75], v[44:47], v[56:59], v[72:75]
    s_waitcnt vmcnt(1)
    v_bitop3_b32 v76, v76, v44, s38 bitop3:0xf6
    v_mfma_f32_16x16x32_bf16 v[72:75], v[48:51], v[56:59], v[72:75]
    s_waitcnt vmcnt(0)
    v_bitop3_b32 v76, v76, v48, s38 bitop3:0xf6
    v_mfma_f32_16x16x32_bf16 v[72:75], v[52:55], v[56:59], v[72:75]
    v_bitop3_b32 v76, v76, v52, s38 bitop3:0xf6
    v_and_b32 v76, 1, v76
    v_cmp_ne_u32 vcc, 0, v76
    v_mov_b32 v76, -1
    v_mov_b32 v77, -1
    s_nop 2
    v_cvt_pk_bf16_f32 v78, v72, v73
    v_cvt_pk_bf16_f32 v79, v74, v75
    s_cbranch_vccnz L_F0_h2r
L_F0_pubit:
    buffer_store_dwordx2 v[78:79], v12, s[4:7], s36 offen
    buffer_store_dwordx2 v[76:77], v12, s[4:7], s37 offen
    ds_read_b128 v[80:83], v8 offset:0
    ds_read_b128 v[84:87], v8 offset:1024
    ds_read_b128 v[88:91], v8 offset:2048
    ds_read_b128 v[92:95], v8 offset:3072
    ds_read_b128 v[96:99], v8 offset:32768
    ds_read_b128 v[100:103], v8 offset:33792
    ds_read_b128 v[104:107], v8 offset:34816
    ds_read_b128 v[108:111], v8 offset:35840
    v_mov_b32 v60, 0
    v_mov_b32 v61, 0
    v_mov_b32 v62, 0
    v_mov_b32 v63, 0
    v_mov_b32 v64, 0
    v_mov_b32 v65, 0
    v_mov_b32 v66, 0
    v_mov_b32 v67, 0
    s_waitcnt vmcnt(63)
    v_readfirstlane_b32 s44, v15
    s_nop 0
    s_lshr_b32 s19, s44, 16
    s_and_b32 s44, s44, 0xffff
    s_min_u32 s44, s44, s19
    s_add_u32 s19, s30, 2
    s_min_u32 s19, s19, 64
    s_cmp_ge_u32 s44, s19
    s_cbranch_scc0 L_F0_av0_slow
L_F0_av0_ok:
    v_mov_b32 v56, 0
    v_mov_b32 v57, 0
    v_mov_b32 v58, 0
    v_mov_b32 v59, 0
    v_mov_b32 v72, 0
    v_mov_b32 v73, 0
    v_mov_b32 v74, 0
    v_mov_b32 v75, 0
    v_mov_b32 v76, 0
    v_mov_b32 v77, 0
    v_mov_b32 v78, 0
    v_mov_b32 v79, 0
    s_branch L_F0_join
.p2align 5
L_F0_others:
    v_mov_b32 v56, 0
    v_mov_b32 v57, 0
    v_mov_b32 v58, 0
    v_mov_b32 v59, 0
    v_mov_b32 v72, 0
    v_mov_b32 v73, 0
    v_mov_b32 v74, 0
    v_mov_b32 v75, 0
    v_mov_b32 v76, 0
    v_mov_b32 v77, 0
    v_mov_b32 v78, 0
    v_mov_b32 v79, 0
    ds_read_b128 v[80:83], v8 offset:0
    ds_read_b128 v[84:87], v8 offset:1024
    ds_read_b128 v[88:91], v8 offset:2048
    ds_read_b128 v[92:95], v8 offset:3072
    ds_read_b128 v[96:99], v8 offset:32768
    ds_read_b128 v[100:103], v8 offset:33792
    ds_read_b128 v[104:107], v8 offset:34816
    ds_read_b128 v[108:111], v8 offset:35840
    v_mov_b32 v112, v64
    v_mov_b32 v113, v65
    v_mov_b32 v114, v66
    v_mov_b32 v115, v67
    v_mov_b32 v60, 0
    v_mov_b32 v61, 0
    v_mov_b32 v62, 0
    v_mov_b32 v63, 0
    v_mov_b32 v64, 0
    v_mov_b32 v65, 0
    v_mov_b32 v66, 0
    v_mov_b32 v67, 0
    s_cmp_lg_u32 s17, 1
    s_cbranch_scc1 L_F0_av2_ok
    s_waitcnt vmcnt(4)
    v_readfirstlane_b32 s44, v15
    s_nop 0
    s_lshr_b32 s19, s44, 16
    s_and_b32 s44, s44, 0xffff
    s_min_u32 s44, s44, s19
    s_add_u32 s19, s30, 2
    s_min_u32 s19, s19, 64
    s_cmp_ge_u32 s44, s19
    s_cbranch_scc0 L_F0_av2_slow
L_F0_av2_ok:
L_F0_join:
    s_barrier
    s_cmp_eq_u32 s30, 63
    s_cbranch_scc1 L_last
    buffer_load_dwordx4 v[24:27], v1, s[4:7], s31 offen sc1
    buffer_load_dwordx4 v[28:31], v1, s[4:7], s31 offen offset:1024 sc1
    s_waitcnt vmcnt(2)
    v_mov_b32 v68, 0
    v_mov_b32 v69, 0
    v_mov_b32 v70, 0
    v_mov_b32 v71, 0
    s_waitcnt lgkmcnt(0)
L_F1_h1:
    s_waitcnt vmcnt(0)
L_F1_entry:
    ds_write_b128 v1, v[24:27]
    v_max3_u32 v23, v25, v27, v29
    v_max_u32 v23, v23, v31
    v_cmp_eq_u32 vcc, -1, v23
L_F1_entry2:
    v_smfmac_f32_16x16x64_bf16 v[56:59], v[24:27], a[0:7], v13
    v_smfmac_f32_16x16x64_bf16 v[60:63], v[24:27], a[8:15], v13
    s_cbranch_vccnz L_F1_h1retry
    v_smfmac_f32_16x16x64_bf16 v[56:59], v[28:31], a[16:23], v13
    ds_write_b128 v1, v[28:31] offset:1024
    v_smfmac_f32_16x16x64_bf16 v[60:63], v[28:31], a[24:31], v13
    v_smfmac_f32_16x16x64_bf16 v[64:67], v[24:27], a[128:135], v13
    v_smfmac_f32_16x16x64_bf16 v[68:71], v[24:27], a[136:143], v13
    s_mov_b32 m0, s56
    v_smfmac_f32_16x16x64_bf16 v[64:67], v[28:31], a[144:151], v13
    s_waitcnt lgkmcnt(0)
    s_barrier
    ds_read_b128 v[32:35], v2 offset:0
    v_smfmac_f32_16x16x64_bf16 v[68:71], v[28:31], a[152:159], v13
    ds_read_b128 v[36:39], v2 offset:1024
    v_smfmac_f32_16x16x64_bf16 v[72:75], v[24:27], v[80:87], v13
    ds_read_b128 v[40:43], v3 offset:0
    v_smfmac_f32_16x16x64_bf16 v[76:79], v[24:27], v[88:95], v13
    ds_read_b128 v[44:47], v3 offset:1024
    v_smfmac_f32_16x16x64_bf16 v[72:75], v[28:31], v[96:103], v13
    ds_read_b128 v[48:51], v4 offset:0
    v_smfmac_f32_16x16x64_bf16 v[76:79], v[28:31], v[104:111], v13
    s_waitcnt lgkmcnt(4)
    ds_read_b128 v[52:55], v4 offset:1024
    v_smfmac_f32_16x16x64_bf16 v[56:59], v[32:35], a[32:39], v13
    v_smfmac_f32_16x16x64_bf16 v[60:63], v[32:35], a[40:47], v13
    s_waitcnt lgkmcnt(4)
    buffer_store_dwordx4 v[112:115], v0, s[4:7], s41 offen sc1
    v_smfmac_f32_16x16x64_bf16 v[56:59], v[36:39], a[48:55], v13
    ds_read_b128 v[80:83], v8 offset:4096
    v_smfmac_f32_16x16x64_bf16 v[60:63], v[36:39], a[56:63], v13
    s_waitcnt lgkmcnt(4)
    ds_read_b128 v[84:87], v8 offset:5120
    buffer_load_dwordx4 v1, s[4:7], s39 offen sc1 lds
    v_smfmac_f32_16x16x64_bf16 v[56:59], v[40:43], a[64:71], v13
    ds_read_b128 v[88:91], v8 offset:6144
    v_smfmac_f32_16x16x64_bf16 v[60:63], v[40:43], a[72:79], v13
    s_waitcnt lgkmcnt(5)
    ds_read_b128 v[92:95], v8 offset:7168
    buffer_load_dwordx4 v1, s[4:7], s39 offen offset:1024 sc1 lds
    v_smfmac_f32_16x16x64_bf16 v[56:59], v[44:47], a[80:87], v13
    ds_read_b128 v[96:99], v8 offset:36864
    v_smfmac_f32_16x16x64_bf16 v[60:63], v[44:47], a[88:95], v13
    s_waitcnt lgkmcnt(6)
    ds_read_b128 v[100:103], v8 offset:37888
    buffer_load_dwordx4 v[116:119], v1, s[4:7], s40 offen offset:1024 sc1
    v_smfmac_f32_16x16x64_bf16 v[56:59], v[48:51], a[96:103], v13
    ds_read_b128 v[104:107], v8 offset:38912
    s_sub_u32 s21, s30, 1
    s_max_i32 s21, s21, 0
    v_smfmac_f32_16x16x64_bf16 v[60:63], v[48:51], a[104:111], v13
    s_waitcnt lgkmcnt(7)
    ds_read_b128 v[108:111], v8 offset:39936
    buffer_load_dwordx4 v[112:115], v1, s[4:7], s40 offen sc1
    v_mov_b32 v20, s21
    v_smfmac_f32_16x16x64_bf16 v[56:59], v[52:55], a[112:119], v13
    buffer_load_dword v15, off, s[4:7], s42 sc1
    ds_read_b128 v[24:27], v0 offset:16384
    v_smfmac_f32_16x16x64_bf16 v[60:63], v[52:55], a[120:127], v13
    s_and_b32 s19, s30, 3
    s_waitcnt lgkmcnt(7)
    buffer_store_dword v20, v10, s[4:7], s43 offen sc1
    ds_read_b128 v[28:31], v0 offset:20480
    v_smfmac_f32_16x16x64_bf16 v[72:75], v[32:35], v[80:87], v13
    s_lshl_b32 s20, s19, 13
    s_waitcnt lgkmcnt(6)
    v_add_f32 v56, v56, v57
    v_smfmac_f32_16x16x64_bf16 v[76:79], v[32:35], v[88:95], v13
    s_add_u32 s37, s20, s60
    s_waitcnt lgkmcnt(4)
    v_add_f32 v58, v58, v59
    v_smfmac_f32_16x16x64_bf16 v[72:75], v[36:39], v[96:103], v13
    s_and_b32 s19, s19, 1
    s_waitcnt lgkmcnt(2)
    v_cvt_pk_bf16_f32 v56, v56, v58
    v_smfmac_f32_16x16x64_bf16 v[76:79], v[36:39], v[104:111], v13
    s_lshl_b32 s20, s19, 18
    ds_write_b32 v5, v56
    v_add_f32 v60, v60, v61
    v_smfmac_f32_16x16x64_bf16 v[64:67], v[32:35], a[160:167], v13
    s_add_u32 s32, s20, s58
    ds_read_b128 v[96:99], v0 offset:17408
    v_add_f32 v62, v62, v63
    v_smfmac_f32_16x16x64_bf16 v[68:71], v[32:35], a[168:175], v13
    s_add_u32 s33, s32, 32768
    ds_read_b128 v[100:103], v0 offset:21504
    v_cvt_pk_bf16_f32 v60, v60, v62
    v_smfmac_f32_16x16x64_bf16 v[64:67], v[36:39], a[176:183], v13
    s_add_u32 s34, s20, s59
    ds_write_b32 v5, v60 offset:512
    v_smfmac_f32_16x16x64_bf16 v[68:71], v[36:39], a[184:191], v13
    s_add_u32 s35, s34, 4096
    ds_read_b128 v[104:107], v0 offset:18432
    v_smfmac_f32_16x16x64_bf16 v[64:67], v[40:43], a[192:199], v13
    s_bfe_u32 s38, s30, 0x10001
    ds_read_b128 v[108:111], v0 offset:22528
    v_smfmac_f32_16x16x64_bf16 v[68:71], v[40:43], a[200:207], v13
    s_add_u32 s19, s30, 1
    ds_read_b128 v[32:35], v0 offset:19456
    v_xor_b32 v8, 0x10000, v8
    v_smfmac_f32_16x16x64_bf16 v[64:67], v[44:47], a[208:215], v13
    s_and_b32 s19, s19, 3
    s_waitcnt lgkmcnt(3)
    s_barrier
    ds_read_b64_tr_b16 v[80:81], v7 offset:0
    v_smfmac_f32_16x16x64_bf16 v[68:71], v[44:47], a[216:223], v13
    s_lshl_b32 s19, s19, 13
    ds_read_b64_tr_b16 v[82:83], v7 offset:512
    v_smfmac_f32_16x16x64_bf16 v[64:67], v[48:51], a[224:231], v13
    s_add_u32 s36, s19, s60
    ds_read_b64_tr_b16 v[84:85], v7 offset:1024
    v_smfmac_f32_16x16x64_bf16 v[68:71], v[48:51], a[232:239], v13
    s_add_u32 s31, s19, 131072
    ds_read_b64_tr_b16 v[86:87], v7 offset:1536
    v_smfmac_f32_16x16x64_bf16 v[64:67], v[52:55], a[240:247], v13
    s_add_u32 s41, s41, 131072
    ds_read_b64_tr_b16 v[88:89], v7 offset:2048
    v_smfmac_f32_16x16x64_bf16 v[68:71], v[52:55], a[248:255], v13
    s_add_u32 s39, s39, 262144
    ds_read_b64_tr_b16 v[90:91], v7 offset:2560
    v_smfmac_f32_16x16x64_bf16 v[72:75], v[40:43], v[128:135], v13
    s_add_u32 s40, s40, 262144
    ds_read_b64_tr_b16 v[92:93], v7 offset:3072
    v_add_f32 v64, v64, v65
    v_smfmac_f32_16x16x64_bf16 v[76:79], v[40:43], v[136:143], v13
    s_waitcnt lgkmcnt(5)
    ds_read_b64_tr_b16 v[94:95], v7 offset:3584
    v_add_f32 v66, v66, v67
    v_mfma_f32_16x16x32_bf16 v[56:59], v[24:27], v[80:83], 0
    v_cvt_pk_bf16_f32 v64, v64, v66
    v_add_f32 v68, v68, v69
    v_mfma_f32_16x16x32_bf16 v[60:63], v[28:31], v[80:83], 0
    s_waitcnt lgkmcnt(4)
    ds_write_b32 v5, v64 offset:4096
    v_add_f32 v70, v70, v71
    v_mfma_f32_16x16x32_bf16 v[56:59], v[96:99], v[84:87], v[56:59]
    ds_read_b128 v[36:39], v0 offset:23552
    v_cvt_pk_bf16_f32 v65, v68, v70
    v_mfma_f32_16x16x32_bf16 v[60:63], v[100:103], v[84:87], v[60:63]
    s_waitcnt lgkmcnt(4)
    ds_write_b32 v5, v65 offset:4608
    v_mfma_f32_16x16x32_bf16 v[56:59], v[104:107], v[88:91], v[56:59]
    v_mfma_f32_16x16x32_bf16 v[60:63], v[108:111], v[88:91], v[60:63]
    s_waitcnt lgkmcnt(3)
    v_mfma_f32_16x16x32_bf16 v[56:59], v[32:35], v[92:95], v[56:59]
    s_waitcnt lgkmcnt(1)
    v_mfma_f32_16x16x32_bf16 v[60:63], v[36:39], v[92:95], v[60:63]
    s_waitcnt lgkmcnt(0)
    s_barrier
    ds_read_b64_tr_b16 v[96:97], v7 offset:4096
    ds_read_b64_tr_b16 v[98:99], v7 offset:4608
    v_smfmac_f32_16x16x64_bf16 v[72:75], v[44:47], v[144:151], v13
    ds_read_b64_tr_b16 v[100:101], v7 offset:5120
    v_exp_f32 v56, v56
    v_smfmac_f32_16x16x64_bf16 v[76:79], v[44:47], v[152:159], v13
    ds_read_b64_tr_b16 v[102:103], v7 offset:5632
    v_exp_f32 v57, v57
    v_smfmac_f32_16x16x64_bf16 v[72:75], v[48:51], v[160:167], v13
    ds_read_b64_tr_b16 v[104:105], v7 offset:6144
    v_exp_f32 v58, v58
    v_smfmac_f32_16x16x64_bf16 v[76:79], v[48:51], v[168:175], v13
    ds_read_b64_tr_b16 v[106:107], v7 offset:6656
    v_exp_f32 v59, v59
    v_smfmac_f32_16x16x64_bf16 v[72:75], v[52:55], v[176:183], v13
    ds_read_b64_tr_b16 v[108:109], v7 offset:7168
    v_exp_f32 v60, v60
    v_smfmac_f32_16x16x64_bf16 v[76:79], v[52:55], v[184:191], v13
    s_waitcnt lgkmcnt(5)
    ds_read_b64_tr_b16 v[110:111], v7 offset:7680
    v_exp_f32 v61, v61
    v_mfma_f32_16x16x32_bf16 v[68:71], v[96:99], v[80:83], 0
    s_waitcnt lgkmcnt(4)
    v_exp_f32 v62, v62
    v_mfma_f32_16x16x32_bf16 v[68:71], v[100:103], v[84:87], v[68:71]
    s_waitcnt lgkmcnt(2)
    v_exp_f32 v63, v63
    v_mfma_f32_16x16x32_bf16 v[68:71], v[104:107], v[88:91], v[68:71]
    s_waitcnt lgkmcnt(0)
    v_cvt_pk_bf16_f32 v56, v56, v57
    v_cvt_pk_bf16_f32 v57, v58, v59
    v_mfma_f32_16x16x32_bf16 v[68:71], v[108:111], v[92:95], v[68:71]
    v_cvt_pk_bf16_f32 v58, v60, v61
    v_cvt_pk_bf16_f32 v59, v62, v63
    v_add_f32 v72, v72, v73
    v_add_f32 v74, v74, v75
    v_mfma_f32_16x16x32_bf16 v[32:35], v[16:19], v[56:59], 0
    s_nop 2
    v_mul_f32 v68, s45, v68
    v_mul_f32 v69, s45, v69
    v_mfma_f32_16x16x32_bf16 v[24:27], v[120:123], v[56:59], 0
    v_exp_f32 v68, v68
    v_exp_f32 v69, v69
    v_mfma_f32_16x16x32_bf16 v[28:31], v[124:127], v[56:59], 0
    v_cvt_pk_bf16_f32 v66, v72, v74
    v_cvt_pk_bf16_f32 v20, v68, v69
    v_add_f32 v76, v76, v77
    v_add_f32 v78, v78, v79
    v_mfma_f32_16x16x16_bf16 v[32:35], v[16:17], v[20:21], v[32:35]
    v_cvt_pk_bf16_f32 v67, v76, v78
    v_cvt_pk_bf16_f32 v23, v68, v69
    s_nop 0
    v_mfma_f32_16x16x16_bf16 v[24:27], v[66:67], v[20:21], v[24:27]
    ds_read_b128 v[80:83], v8 offset:0
    ds_read_b128 v[84:87], v8 offset:1024
    v_mfma_f32_16x16x16_bf16 v[28:31], v[66:67], v[22:23], v[28:31]
    ds_read_b128 v[88:91], v8 offset:32768
    ds_read_b128 v[92:95], v8 offset:33792
    v_rcp_f32 v56, v32
    s_nop 0
    v_pk_mul_f32 v[24:25], v[24:25], v[56:57] op_sel_hi:[1,0]
    v_pk_mul_f32 v[26:27], v[26:27], v[56:57] op_sel_hi:[1,0]
    v_cvt_pk_bf16_f32 v60, v24, v25
    v_cvt_pk_bf16_f32 v61, v26, v27
    ds_write_b64 v9, v[60:61] offset:0
    v_pk_mul_f32 v[28:29], v[28:29], v[56:57] op_sel_hi:[1,0]
    v_pk_mul_f32 v[30:31], v[30:31], v[56:57] op_sel_hi:[1,0]
    v_cvt_pk_bf16_f32 v62, v28, v29
    v_cvt_pk_bf16_f32 v63, v30, v31
    ds_write_b64 v9, v[62:63] offset:8
    v_subrev_u32 v57, s46, v32
    v_cmp_le_u32 vcc, s47, v57
    v_mfma_f32_16x16x16_bf16 v[24:27], v[22:23], v[20:21], 0
    v_mfma_f32_16x16x16_bf16 v[28:31], v[22:23], v[20:21], 0
    v_mfma_f32_16x16x16_bf16 v[32:35], v[22:23], v[20:21], 0
    v_mfma_f32_16x16x16_bf16 v[36:39], v[22:23], v[20:21], 0
    s_cbranch_vccnz L_F1_fallback
L_F1_fbdone:
    s_waitcnt lgkmcnt(0)
    s_barrier
    ds_read_b128 v[120:123], v0
    ds_read_b128 v[124:127], v0 offset:1024
    s_add_u32 s30, s30, 1
    v_mfma_f32_16x16x16_bf16 v[40:43], v[22:23], v[20:21], 0
    v_mov_b32 v68, s30
    v_mfma_f32_16x16x16_bf16 v[44:47], v[22:23], v[20:21], 0
    v_mfma_f32_16x16x16_bf16 v[48:51], v[22:23], v[20:21], 0
    v_mfma_f32_16x16x16_bf16 v[52:55], v[22:23], v[20:21], 0
    s_waitcnt lgkmcnt(1)
    v_smfmac_f32_16x16x64_bf16 v[24:27], v[120:123], v[192:199], v13
    s_waitcnt lgkmcnt(0)
    ds_read_b128 v[96:99], v8 offset:2048
    v_smfmac_f32_16x16x64_bf16 v[24:27], v[124:127], v[200:207], v13
    ds_read_b128 v[100:103], v8 offset:3072
    v_smfmac_f32_16x16x64_bf16 v[28:31], v[120:123], v[208:215], v13
    ds_read_b128 v[104:107], v8 offset:34816
    v_smfmac_f32_16x16x64_bf16 v[28:31], v[124:127], v[216:223], v13
    ds_read_b128 v[108:111], v8 offset:35840
    v_add_f32 v24, v24, v25
    v_smfmac_f32_16x16x64_bf16 v[32:35], v[120:123], v[224:231], v13
    ds_read_b128 v[56:59], v8 offset:4096
    v_add_f32 v26, v26, v27
    v_cvt_pk_bf16_f32 v24, v24, v26
    v_smfmac_f32_16x16x64_bf16 v[32:35], v[124:127], v[232:239], v13
    ds_read_b128 v[60:63], v8 offset:5120
    v_and_or_b32 v24, v24, -2, s38
    v_add_f32 v28, v28, v29
    v_smfmac_f32_16x16x64_bf16 v[36:39], v[120:123], v[240:247], v13
    ds_read_b128 v[72:75], v8 offset:36864
    v_add_f32 v30, v30, v31
    v_cvt_pk_bf16_f32 v25, v28, v30
    v_smfmac_f32_16x16x64_bf16 v[36:39], v[124:127], v[248:255], v13
    buffer_store_dword v68, v6, s[4:7], s23 offen
    ds_read_b128 v[76:79], v8 offset:37888
    v_add_f32 v32, v32, v33
    v_smfmac_f32_16x16x64_bf16 v[40:43], v[120:123], v[80:87], v13
    ds_read_b128 v[80:83], v8 offset:6144
    v_add_f32 v34, v34, v35
    v_cvt_pk_bf16_f32 v26, v32, v34
    v_smfmac_f32_16x16x64_bf16 v[40:43], v[124:127], v[88:95], v13
    s_waitcnt lgkmcnt(7)
    ds_read_b128 v[84:87], v8 offset:7168
    ds_read_b128 v[88:91], v8 offset:38912
    v_add_f32 v36, v36, v37
    v_smfmac_f32_16x16x64_bf16 v[44:47], v[120:123], v[96:103], v13
    s_waitcnt lgkmcnt(7)
    ds_read_b128 v[92:95], v8 offset:39936
    v_add_f32 v38, v38, v39
    v_cvt_pk_bf16_f32 v27, v36, v38
    v_smfmac_f32_16x16x64_bf16 v[44:47], v[124:127], v[104:111], v13
    s_waitcnt lgkmcnt(6)
    buffer_store_dwordx4 v[24:27], v11, s[4:7], s32 offen
    v_add_f32 v40, v40, v41
    v_xor_b32 v8, 0x10000, v8
    v_smfmac_f32_16x16x64_bf16 v[48:51], v[120:123], v[56:63], v13
    s_waitcnt lgkmcnt(4)
    v_add_f32 v42, v42, v43
    v_cvt_pk_bf16_f32 v40, v40, v42
    v_smfmac_f32_16x16x64_bf16 v[48:51], v[124:127], v[72:79], v13
    s_waitcnt lgkmcnt(2)
    v_and_or_b32 v40, v40, -2, s38
    v_add_f32 v44, v44, v45
    v_smfmac_f32_16x16x64_bf16 v[52:55], v[120:123], v[80:87], v13
    s_waitcnt lgkmcnt(0)
    buffer_load_dword v69, v6, s[4:7], s29 offen sc1
    v_add_f32 v46, v46, v47
    v_cvt_pk_bf16_f32 v41, v44, v46
    v_smfmac_f32_16x16x64_bf16 v[52:55], v[124:127], v[88:95], v13
    v_add_f32 v48, v48, v49
    v_add_f32 v50, v50, v51
    v_cvt_pk_bf16_f32 v42, v48, v50
    buffer_load_dword v70, v6, s[4:7], s29 offen sc1
    s_nop 3
    v_add_f32 v52, v52, v53
    v_add_f32 v54, v54, v55
    v_cvt_pk_bf16_f32 v43, v52, v54
    buffer_store_dwordx4 v[40:43], v11, s[4:7], s33 offen
    s_cmp_lg_u32 s17, 0
    s_cbranch_scc1 L_F1_others
    buffer_load_dword v71, v6, s[4:7], s29 offen sc1
    v_cndmask_b32 v56, 0, v14, s[48:49]
    v_cndmask_b32 v57, 0, v14, s[50:51]
    v_cndmask_b32 v58, 0, v14, s[52:53]
    v_cndmask_b32 v59, 0, v14, s[54:55]
    v_mov_b32 v120, v64
    v_mov_b32 v121, v65
    v_mov_b32 v122, v66
    v_mov_b32 v123, v67
    v_mov_b32 v60, 0
    v_mov_b32 v61, 0
    v_mov_b32 v62, 0
    v_mov_b32 v63, 0
    v_mov_b32 v64, 0
    v_mov_b32 v65, 0
    v_mov_b32 v66, 0
    v_mov_b32 v67, 0
    buffer_load_dword v72, v6, s[4:7], s29 offen sc1
    s_waitcnt vmcnt(4)
    v_cmp_gt_u32 vcc, s30, v69
    s_cbranch_vccz L_F1_go
    buffer_load_dword v69, v6, s[4:7], s29 offen sc1
    s_waitcnt vmcnt(4)
    v_cmp_gt_u32 vcc, s30, v70
    s_cbranch_vccz L_F1_go
    buffer_load_dword v70, v6, s[4:7], s29 offen sc1
L_F1_hl:
    s_waitcnt vmcnt(3)
    v_cmp_gt_u32 vcc, s30, v71
    s_cbranch_vccz L_F1_go
    buffer_load_dword v71, v6, s[4:7], s29 offen sc1
    s_add_u32 s97, s97, 1
    s_waitcnt vmcnt(3)
    v_cmp_gt_u32 vcc, s30, v72
    s_cbranch_vccz L_F1_go
    buffer_load_dword v72, v6, s[4:7], s29 offen sc1
    s_add_u32 s97, s97, 1
    s_waitcnt vmcnt(3)
    v_cmp_gt_u32 vcc, s30, v69
    s_cbranch_vccz L_F1_go
    buffer_load_dword v69, v6, s[4:7], s29 offen sc1
    s_add_u32 s97, s97, 1
    s_waitcnt vmcnt(3)
    v_cmp_gt_u32 vcc, s30, v70
    s_cbranch_vccz L_F1_go
    buffer_load_dword v70, v6, s[4:7], s29 offen sc1
    s_add_u32 s97, s97, 1
    s_add_u32 s18, s18, 1
    s_cmp_gt_u32 s18, 200000
    s_cbranch_scc0 L_F1_hl
    s_branch L_abort
.p2align 5
L_F1_go:
    buffer_load_dwordx4 v[24:27], v0, s[4:7], s34 offen offset:0 sc1
    buffer_load_dwordx4 v[28:31], v0, s[4:7], s34 offen offset:1024 sc1
    buffer_load_dwordx4 v[32:35], v0, s[4:7], s34 offen offset:2048 sc1
    buffer_load_dwordx4 v[36:39], v0, s[4:7], s34 offen offset:3072 sc1
    buffer_load_dwordx4 v[40:43], v0, s[4:7], s35 offen offset:0 sc1
    buffer_load_dwordx4 v[44:47], v0, s[4:7], s35 offen offset:1024 sc1
    buffer_load_dwordx4 v[48:51], v0, s[4:7], s35 offen offset:2048 sc1
    buffer_load_dwordx4 v[52:55], v0, s[4:7], s35 offen offset:3072 sc1
L_F1_h2:
    s_waitcnt vmcnt(7)
    v_mfma_f32_16x16x32_bf16 v[72:75], v[24:27], v[56:59], 0
    s_waitcnt vmcnt(6)
    v_xor_b32 v76, s38, v24
    v_mfma_f32_16x16x32_bf16 v[72:75], v[28:31], v[56:59], v[72:75]
    s_waitcnt vmcnt(5)
    v_bitop3_b32 v76, v76, v28, s38 bitop3:0xf6
    v_mfma_f32_16x16x32_bf16 v[72:75], v[32:35], v[56:59], v[72:75]
    s_waitcnt vmcnt(4)
    v_bitop3_b32 v76, v76, v32, s38 bitop3:0xf6
    v_mfma_f32_16x16x32_bf16 v[72:75], v[36:39], v[56:59], v[72:75]
    s_waitcnt vmcnt(3)
    v_bitop3_b32 v76, v76, v36, s38 bitop3:0xf6
    v_mfma_f32_16x16x32_bf16 v[72:75], v[40:43], v[56:59], v[72:75]
    s_waitcnt vmcnt(2)
    v_bitop3_b32 v76, v76, v40, s38 bitop3:0xf6
    v_mfma_f32_16x16x32_bf16 v[72:75], v[44:47], v[56:59], v[72:75]
    s_waitcnt vmcnt(1)
    v_bitop3_b32 v76, v76, v44, s38 bitop3:0xf6
    v_mfma_f32_16x16x32_bf16 v[72:75], v[48:51], v[56:59], v[72:75]
    s_waitcnt vmcnt(0)
    v_bitop3_b32 v76, v76, v48, s38 bitop3:0xf6
    v_mfma_f32_16x16x32_bf16 v[72:75], v[52:55], v[56:59], v[72:75]
    v_bitop3_b32 v76, v76, v52, s38 bitop3:0xf6
    v_and_b32 v76, 1, v76
    v_cmp_ne_u32 vcc, 0, v76
    v_mov_b32 v76, -1
    v_mov_b32 v77, -1
    s_nop 2
    v_cvt_pk_bf16_f32 v78, v72, v73
    v_cvt_pk_bf16_f32 v79, v74, v75
    s_cbranch_vccnz L_F1_h2r
L_F1_pubit:
    buffer_store_dwordx2 v[78:79], v12, s[4:7], s36 offen
    buffer_store_dwordx2 v[76:77], v12, s[4:7], s37 offen
    ds_read_b128 v[80:83], v8 offset:0
    ds_read_b128 v[84:87], v8 offset:1024
    ds_read_b128 v[88:91], v8 offset:2048
    ds_read_b128 v[92:95], v8 offset:3072
    ds_read_b128 v[96:99], v8 offset:32768
    ds_read_b128 v[100:103], v8 offset:33792
    ds_read_b128 v[104:107], v8 offset:34816
    ds_read_b128 v[108:111], v8 offset:35840
    v_mov_b32 v60, 0
    v_mov_b32 v61, 0
    v_mov_b32 v62, 0
    v_mov_b32 v63, 0
    v_mov_b32 v64, 0
    v_mov_b32 v65, 0
    v_mov_b32 v66, 0
    v_mov_b32 v67, 0
    s_waitcnt vmcnt(63)
    v_readfirstlane_b32 s44, v15
    s_nop 0
    s_lshr_b32 s19, s44, 16
    s_and_b32 s44, s44, 0xffff
    s_min_u32 s44, s44, s19
    s_add_u32 s19, s30, 2
    s_min_u32 s19, s19, 64
    s_cmp_ge_u32 s44, s19
    s_cbranch_scc0 L_F1_av0_slow
L_F1_av0_ok:
    v_mov_b32 v56, 0
    v_mov_b32 v57, 0
    v_mov_b32 v58, 0
    v_mov_b32 v59, 0
    v_mov_b32 v72, 0
    v_mov_b32 v73, 0
    v_mov_b32 v74, 0
    v_mov_b32 v75, 0
    v_mov_b32 v76, 0
    v_mov_b32 v77, 0
    v_mov_b32 v78, 0
    v_mov_b32 v79, 0
    s_branch L_F1_join
.p2align 5
L_F1_others:
    v_mov_b32 v56, 0
    v_mov_b32 v57, 0
    v_mov_b32 v58, 0
    v_mov_b32 v59, 0
    v_mov_b32 v72, 0
    v_mov_b32 v73, 0
    v_mov_b32 v74, 0
    v_mov_b32 v75, 0
    v_mov_b32 v76, 0
    v_mov_b32 v77, 0
    v_mov_b32 v78, 0
    v_mov_b32 v79, 0
    ds_read_b128 v[80:83], v8 offset:0
    ds_read_b128 v[84:87], v8 offset:1024
    ds_read_b128 v[88:91], v8 offset:2048
    ds_read_b128 v[92:95], v8 offset:3072
    ds_read_b128 v[96:99], v8 offset:32768
    ds_read_b128 v[100:103], v8 offset:33792
    ds_read_b128 v[104:107], v8 offset:34816
    ds_read_b128 v[108:111], v8 offset:35840
    v_mov_b32 v120, v64
    v_mov_b32 v121, v65
    v_mov_b32 v122, v66
    v_mov_b32 v123, v67
    v_mov_b32 v60, 0
    v_mov_b32 v61, 0
    v_mov_b32 v62, 0
    v_mov_b32 v63, 0
    v_mov_b32 v64, 0
    v_mov_b32 v65, 0
    v_mov_b32 v66, 0
    v_mov_b32 v67, 0
    s_cmp_lg_u32 s17, 1
    s_cbranch_scc1 L_F1_av2_ok
    s_waitcnt vmcnt(4)
    v_readfirstlane_b32 s44, v15
    s_nop 0
    s_lshr_b32 s19, s44, 16
    s_and_b32 s44, s44, 0xffff
    s_min_u32 s44, s44, s19
    s_add_u32 s19, s30, 2
    s_min_u32 s19, s19, 64
    s_cmp_ge_u32 s44, s19
    s_cbranch_scc0 L_F1_av2_slow
L_F1_av2_ok:
L_F1_join:
    s_barrier
    buffer_load_dwordx4 v[24:27], v1, s[4:7], s31 offen sc1
    buffer_load_dwordx4 v[28:31], v1, s[4:7], s31 offen offset:1024 sc1
    s_waitcnt vmcnt(2)
    v_mov_b32 v68, 0
    v_mov_b32 v69, 0
    v_mov_b32 v70, 0
    v_mov_b32 v71, 0
    s_waitcnt lgkmcnt(0)
    s_branch L_F0_h1
L_F0_h1retry:
    s_mov_b64 exec, vcc
    buffer_load_dwordx4 v[24:27], v1, s[4:7], s31 offen sc1
    buffer_load_dwordx4 v[28:31], v1, s[4:7], s31 offen offset:1024 sc1
    s_mov_b64 exec, -1
    s_add_u32 s18, s18, 1
    s_cmp_gt_u32 s18, 200000
    s_cbranch_scc1 L_abort
    s_add_u32 s95, s95, 1
    s_nop 2
    v_mov_b32 v56, 0
    v_mov_b32 v57, 0
    v_mov_b32 v58, 0
    v_mov_b32 v59, 0
    v_mov_b32 v60, 0
    v_mov_b32 v61, 0
    v_mov_b32 v62, 0
    v_mov_b32 v63, 0
    s_branch L_F0_h1
L_F0_h2r:
    s_mov_b64 exec, vcc
    buffer_load_dwordx4 v[24:27], v0, s[4:7], s34 offen offset:0 sc1
    buffer_load_dwordx4 v[28:31], v0, s[4:7], s34 offen offset:1024 sc1
    buffer_load_dwordx4 v[32:35], v0, s[4:7], s34 offen offset:2048 sc1
    buffer_load_dwordx4 v[36:39], v0, s[4:7], s34 offen offset:3072 sc1
    buffer_load_dwordx4 v[40:43], v0, s[4:7], s35 offen offset:0 sc1
    buffer_load_dwordx4 v[44:47], v0, s[4:7], s35 offen offset:1024 sc1
    buffer_load_dwordx4 v[48:51], v0, s[4:7], s35 offen offset:2048 sc1
    buffer_load_dwordx4 v[52:55], v0, s[4:7], s35 offen offset:3072 sc1
    s_mov_b64 exec, -1
    s_add_u32 s18, s18, 1
    s_cmp_gt_u32 s18, 200000
    s_cbranch_scc1 L_abort
    s_add_u32 s96, s96, 1
    s_branch L_F0_h2
L_F0_av0_slow:
    buffer_load_dword v15, off, s[4:7], s42 sc1
    s_add_u32 s18, s18, 1
    s_cmp_gt_u32 s18, 200000
    s_cbranch_scc1 L_abort
    s_waitcnt vmcnt(0)
    v_readfirstlane_b32 s44, v15
    s_nop 0
    s_lshr_b32 s20, s44, 16
    s_and_b32 s44, s44, 0xffff
    s_min_u32 s44, s44, s20
    s_cmp_ge_u32 s44, s19
    s_cbranch_scc0 L_F0_av0_slow
    s_branch L_F0_av0_ok
L_F0_av2_slow:
    buffer_load_dword v15, off, s[4:7], s42 sc1
    s_add_u32 s18, s18, 1
    s_cmp_gt_u32 s18, 200000
    s_cbranch_scc1 L_abort
    s_waitcnt vmcnt(0)
    v_readfirstlane_b32 s44, v15
    s_nop 0
    s_lshr_b32 s20, s44, 16
    s_and_b32 s44, s44, 0xffff
    s_min_u32 s44, s44, s20
    s_cmp_ge_u32 s44, s19
    s_cbranch_scc0 L_F0_av2_slow
    s_branch L_F0_av2_ok
L_F0_fallback:
    s_nop 7
    s_nop 3
    s_waitcnt lgkmcnt(0)
    ds_read_b64_tr_b16 v[80:81], v7 offset:0
    ds_read_b64_tr_b16 v[82:83], v7 offset:512
    ds_read_b64_tr_b16 v[84:85], v7 offset:1024
    ds_read_b64_tr_b16 v[86:87], v7 offset:1536
    ds_read_b64_tr_b16 v[88:89], v7 offset:2048
    ds_read_b64_tr_b16 v[90:91], v7 offset:2560
    ds_read_b64_tr_b16 v[92:93], v7 offset:3072
    ds_read_b64_tr_b16 v[94:95], v7 offset:3584
    ds_read_b128 v[96:99], v0 offset:8192
    s_waitcnt lgkmcnt(0)
    ds_read_b128 v[100:103], v0 offset:9216
    ds_read_b128 v[104:107], v0 offset:10240
    ds_read_b128 v[108:111], v0 offset:11264
    v_mfma_f32_16x16x32_bf16 v[72:75], v[96:99], v[80:83], 0
    s_waitcnt lgkmcnt(2)
    v_mfma_f32_16x16x32_bf16 v[72:75], v[100:103], v[84:87], v[72:75]
    s_waitcnt lgkmcnt(1)
    v_mfma_f32_16x16x32_bf16 v[72:75], v[104:107], v[88:91], v[72:75]
    s_waitcnt lgkmcnt(0)
    v_mfma_f32_16x16x32_bf16 v[72:75], v[108:111], v[92:95], v[72:75]
    s_nop 7
    ds_read_b128 v[96:99], v0 offset:12288
    s_waitcnt lgkmcnt(0)
    ds_read_b128 v[100:103], v0 offset:13312
    ds_read_b128 v[104:107], v0 offset:14336
    ds_read_b128 v[108:111], v0 offset:15360
    v_mfma_f32_16x16x32_bf16 v[76:79], v[96:99], v[80:83], 0
    s_waitcnt lgkmcnt(2)
    v_mfma_f32_16x16x32_bf16 v[76:79], v[100:103], v[84:87], v[76:79]
    s_waitcnt lgkmcnt(1)
    v_mfma_f32_16x16x32_bf16 v[76:79], v[104:107], v[88:91], v[76:79]
    s_waitcnt lgkmcnt(0)
    v_mfma_f32_16x16x32_bf16 v[76:79], v[108:111], v[92:95], v[76:79]
    s_nop 7
    ds_read_b64_tr_b16 v[96:97], v7 offset:4096
    ds_read_b64_tr_b16 v[98:99], v7 offset:4608
    ds_read_b64_tr_b16 v[100:101], v7 offset:5120
    ds_read_b64_tr_b16 v[102:103], v7 offset:5632
    ds_read_b64_tr_b16 v[104:105], v7 offset:6144
    s_waitcnt lgkmcnt(3)
    ds_read_b64_tr_b16 v[106:107], v7 offset:6656
    ds_read_b64_tr_b16 v[108:109], v7 offset:7168
    ds_read_b64_tr_b16 v[110:111], v7 offset:7680
    v_mfma_f32_16x16x32_bf16 v[68:71], v[96:99], v[80:83], 0
    s_waitcnt lgkmcnt(4)
    v_mfma_f32_16x16x32_bf16 v[68:71], v[100:103], v[84:87], v[68:71]
    s_waitcnt lgkmcnt(2)
    v_mfma_f32_16x16x32_bf16 v[68:71], v[104:107], v[88:91], v[68:71]
    s_waitcnt lgkmcnt(0)
    v_mfma_f32_16x16x32_bf16 v[68:71], v[108:111], v[92:95], v[68:71]
    s_nop 7
    v_mul_f32 v68, s45, v68
    v_mul_f32 v69, s45, v69
    v_max3_f32 v70, v68, v69, v72
    v_max3_f32 v70, v70, v73, v74
    v_max3_f32 v70, v70, v75, v76
    v_max3_f32 v70, v70, v77, v78
    v_max_f32 v70, v70, v79
    v_mov_b32 v71, v70
    s_nop 1
    v_permlane16_swap_b32 v70, v71
    v_max_f32 v70, v70, v71
    v_mov_b32 v71, v70
    s_nop 1
    v_permlane32_swap_b32 v70, v71
    v_max_f32 v70, v70, v71
    v_sub_f32 v72, v72, v70
    v_exp_f32 v72, v72
    v_sub_f32 v73, v73, v70
    v_exp_f32 v73, v73
    v_sub_f32 v74, v74, v70
    v_exp_f32 v74, v74
    v_sub_f32 v75, v75, v70
    v_exp_f32 v75, v75
    v_sub_f32 v76, v76, v70
    v_exp_f32 v76, v76
    v_sub_f32 v77, v77, v70
    v_exp_f32 v77, v77
    v_sub_f32 v78, v78, v70
    v_exp_f32 v78, v78
    v_sub_f32 v79, v79, v70
    v_exp_f32 v79, v79
    v_sub_f32 v68, v68, v70
    v_exp_f32 v68, v68
    v_sub_f32 v69, v69, v70
    v_exp_f32 v69, v69
    v_cvt_pk_bf16_f32 v56, v72, v73
    v_cvt_pk_bf16_f32 v57, v74, v75
    v_cvt_pk_bf16_f32 v58, v76, v77
    v_cvt_pk_bf16_f32 v59, v78, v79
    v_cvt_pk_bf16_f32 v20, v68, v69
    v_cvt_pk_bf16_f32 v23, v68, v69
    v_mfma_f32_16x16x32_bf16 v[32:35], v[16:19], v[56:59], 0
    v_mfma_f32_16x16x32_bf16 v[24:27], v[112:115], v[56:59], 0
    v_mfma_f32_16x16x32_bf16 v[28:31], v[116:119], v[56:59], 0
    v_mfma_f32_16x16x16_bf16 v[32:35], v[16:17], v[20:21], v[32:35]
    v_mfma_f32_16x16x16_bf16 v[24:27], v[66:67], v[20:21], v[24:27]
    v_mfma_f32_16x16x16_bf16 v[28:31], v[66:67], v[22:23], v[28:31]
    ds_read_b128 v[80:83], v8 offset:0
    ds_read_b128 v[84:87], v8 offset:1024
    ds_read_b128 v[88:91], v8 offset:32768
    ds_read_b128 v[92:95], v8 offset:33792
    ds_read_b128 v[96:99], v8 offset:2048
    ds_read_b128 v[100:103], v8 offset:3072
    ds_read_b128 v[104:107], v8 offset:34816
    ds_read_b128 v[108:111], v8 offset:35840
    v_rcp_f32 v56, v32
    s_nop 0
    v_mul_f32 v24, v24, v56
    v_mul_f32 v25, v25, v56
    v_mul_f32 v26, v26, v56
    v_mul_f32 v27, v27, v56
    v_mul_f32 v28, v28, v56
    v_mul_f32 v29, v29, v56
    v_mul_f32 v30, v30, v56
    v_mul_f32 v31, v31, v56
    v_cvt_pk_bf16_f32 v60, v24, v25
    v_cvt_pk_bf16_f32 v61, v26, v27
    v_cvt_pk_bf16_f32 v62, v28, v29
    v_cvt_pk_bf16_f32 v63, v30, v31
    ds_write_b128 v9, v[60:63]
    v_mov_b32 v24, 0
    v_mov_b32 v25, 0
    v_mov_b32 v26, 0
    v_mov_b32 v27, 0
    v_mov_b32 v28, 0
    v_mov_b32 v29, 0
    v_mov_b32 v30, 0
    v_mov_b32 v31, 0
    v_mov_b32 v32, 0
    v_mov_b32 v33, 0
    v_mov_b32 v34, 0
    v_mov_b32 v35, 0
    v_mov_b32 v36, 0
    v_mov_b32 v37, 0
    v_mov_b32 v38, 0
    v_mov_b32 v39, 0
    s_waitcnt lgkmcnt(0)
    s_nop 1
    s_branch L_F0_fbdone
L_F1_h1retry:
    s_mov_b64 exec, vcc
    buffer_load_dwordx4 v[24:27], v1, s[4:7], s31 offen sc1
    buffer_load_dwordx4 v[28:31], v1, s[4:7], s31 offen offset:1024 sc1
    s_mov_b64 exec, -1
    s_add_u32 s18, s18, 1
    s_cmp_gt_u32 s18, 200000
    s_cbranch_scc1 L_abort
    s_add_u32 s95, s95, 1
    s_nop 2
    v_mov_b32 v56, 0
    v_mov_b32 v57, 0
    v_mov_b32 v58, 0
    v_mov_b32 v59, 0
    v_mov_b32 v60, 0
    v_mov_b32 v61, 0
    v_mov_b32 v62, 0
    v_mov_b32 v63, 0
    s_branch L_F1_h1
L_F1_h2r:
    s_mov_b64 exec, vcc
    buffer_load_dwordx4 v[24:27], v0, s[4:7], s34 offen offset:0 sc1
    buffer_load_dwordx4 v[28:31], v0, s[4:7], s34 offen offset:1024 sc1
    buffer_load_dwordx4 v[32:35], v0, s[4:7], s34 offen offset:2048 sc1
    buffer_load_dwordx4 v[36:39], v0, s[4:7], s34 offen offset:3072 sc1
    buffer_load_dwordx4 v[40:43], v0, s[4:7], s35 offen offset:0 sc1
    buffer_load_dwordx4 v[44:47], v0, s[4:7], s35 offen offset:1024 sc1
    buffer_load_dwordx4 v[48:51], v0, s[4:7], s35 offen offset:2048 sc1
    buffer_load_dwordx4 v[52:55], v0, s[4:7], s35 offen offset:3072 sc1
    s_mov_b64 exec, -1
    s_add_u32 s18, s18, 1
    s_cmp_gt_u32 s18, 200000
    s_cbranch_scc1 L_abort
    s_add_u32 s96, s96, 1
    s_branch L_F1_h2
L_F1_av0_slow:
    buffer_load_dword v15, off, s[4:7], s42 sc1
    s_add_u32 s18, s18, 1
    s_cmp_gt_u32 s18, 200000
    s_cbranch_scc1 L_abort
    s_waitcnt vmcnt(0)
    v_readfirstlane_b32 s44, v15
    s_nop 0
    s_lshr_b32 s20, s44, 16
    s_and_b32 s44, s44, 0xffff
    s_min_u32 s44, s44, s20
    s_cmp_ge_u32 s44, s19
    s_cbranch_scc0 L_F1_av0_slow
    s_branch L_F1_av0_ok
L_F1_av2_slow:
    buffer_load_dword v15, off, s[4:7], s42 sc1
    s_add_u32 s18, s18, 1
    s_cmp_gt_u32 s18, 200000
    s_cbranch_scc1 L_abort
    s_waitcnt vmcnt(0)
    v_readfirstlane_b32 s44, v15
    s_nop 0
    s_lshr_b32 s20, s44, 16
    s_and_b32 s44, s44, 0xffff
    s_min_u32 s44, s44, s20
    s_cmp_ge_u32 s44, s19
    s_cbranch_scc0 L_F1_av2_slow
    s_branch L_F1_av2_ok
L_F1_fallback:
    s_nop 7
    s_nop 3
    s_waitcnt lgkmcnt(0)
    ds_read_b64_tr_b16 v[80:81], v7 offset:0
    ds_read_b64_tr_b16 v[82:83], v7 offset:512
    ds_read_b64_tr_b16 v[84:85], v7 offset:1024
    ds_read_b64_tr_b16 v[86:87], v7 offset:1536
    ds_read_b64_tr_b16 v[88:89], v7 offset:2048
    ds_read_b64_tr_b16 v[90:91], v7 offset:2560
    ds_read_b64_tr_b16 v[92:93], v7 offset:3072
    ds_read_b64_tr_b16 v[94:95], v7 offset:3584
    ds_read_b128 v[96:99], v0 offset:16384
    s_waitcnt lgkmcnt(0)
    ds_read_b128 v[100:103], v0 offset:17408
    ds_read_b128 v[104:107], v0 offset:18432
    ds_read_b128 v[108:111], v0 offset:19456
    v_mfma_f32_16x16x32_bf16 v[72:75], v[96:99], v[80:83], 0
    s_waitcnt lgkmcnt(2)
    v_mfma_f32_16x16x32_bf16 v[72:75], v[100:103], v[84:87], v[72:75]
    s_waitcnt lgkmcnt(1)
    v_mfma_f32_16x16x32_bf16 v[72:75], v[104:107], v[88:91], v[72:75]
    s_waitcnt lgkmcnt(0)
    v_mfma_f32_16x16x32_bf16 v[72:75], v[108:111], v[92:95], v[72:75]
    s_nop 7
    ds_read_b128 v[96:99], v0 offset:20480
    s_waitcnt lgkmcnt(0)
    ds_read_b128 v[100:103], v0 offset:21504
    ds_read_b128 v[104:107], v0 offset:22528
    ds_read_b128 v[108:111], v0 offset:23552
    v_mfma_f32_16x16x32_bf16 v[76:79], v[96:99], v[80:83], 0
    s_waitcnt lgkmcnt(2)
    v_mfma_f32_16x16x32_bf16 v[76:79], v[100:103], v[84:87], v[76:79]
    s_waitcnt lgkmcnt(1)
    v_mfma_f32_16x16x32_bf16 v[76:79], v[104:107], v[88:91], v[76:79]
    s_waitcnt lgkmcnt(0)
    v_mfma_f32_16x16x32_bf16 v[76:79], v[108:111], v[92:95], v[76:79]
    s_nop 7
    ds_read_b64_tr_b16 v[96:97], v7 offset:4096
    ds_read_b64_tr_b16 v[98:99], v7 offset:4608
    ds_read_b64_tr_b16 v[100:101], v7 offset:5120
    ds_read_b64_tr_b16 v[102:103], v7 offset:5632
    ds_read_b64_tr_b16 v[104:105], v7 offset:6144
    s_waitcnt lgkmcnt(3)
    ds_read_b64_tr_b16 v[106:107], v7 offset:6656
    ds_read_b64_tr_b16 v[108:109], v7 offset:7168
    ds_read_b64_tr_b16 v[110:111], v7 offset:7680
    v_mfma_f32_16x16x32_bf16 v[68:71], v[96:99], v[80:83], 0
    s_waitcnt lgkmcnt(4)
    v_mfma_f32_16x16x32_bf16 v[68:71], v[100:103], v[84:87], v[68:71]
    s_waitcnt lgkmcnt(2)
    v_mfma_f32_16x16x32_bf16 v[68:71], v[104:107], v[88:91], v[68:71]
    s_waitcnt lgkmcnt(0)
    v_mfma_f32_16x16x32_bf16 v[68:71], v[108:111], v[92:95], v[68:71]
    s_nop 7
    v_mul_f32 v68, s45, v68
    v_mul_f32 v69, s45, v69
    v_max3_f32 v70, v68, v69, v72
    v_max3_f32 v70, v70, v73, v74
    v_max3_f32 v70, v70, v75, v76
    v_max3_f32 v70, v70, v77, v78
    v_max_f32 v70, v70, v79
    v_mov_b32 v71, v70
    s_nop 1
    v_permlane16_swap_b32 v70, v71
    v_max_f32 v70, v70, v71
    v_mov_b32 v71, v70
    s_nop 1
    v_permlane32_swap_b32 v70, v71
    v_max_f32 v70, v70, v71
    v_sub_f32 v72, v72, v70
    v_exp_f32 v72, v72
    v_sub_f32 v73, v73, v70
    v_exp_f32 v73, v73
    v_sub_f32 v74, v74, v70
    v_exp_f32 v74, v74
    v_sub_f32 v75, v75, v70
    v_exp_f32 v75, v75
    v_sub_f32 v76, v76, v70
    v_exp_f32 v76, v76
    v_sub_f32 v77, v77, v70
    v_exp_f32 v77, v77
    v_sub_f32 v78, v78, v70
    v_exp_f32 v78, v78
    v_sub_f32 v79, v79, v70
    v_exp_f32 v79, v79
    v_sub_f32 v68, v68, v70
    v_exp_f32 v68, v68
    v_sub_f32 v69, v69, v70
    v_exp_f32 v69, v69
    v_cvt_pk_bf16_f32 v56, v72, v73
    v_cvt_pk_bf16_f32 v57, v74, v75
    v_cvt_pk_bf16_f32 v58, v76, v77
    v_cvt_pk_bf16_f32 v59, v78, v79
    v_cvt_pk_bf16_f32 v20, v68, v69
    v_cvt_pk_bf16_f32 v23, v68, v69
    v_mfma_f32_16x16x32_bf16 v[32:35], v[16:19], v[56:59], 0
    v_mfma_f32_16x16x32_bf16 v[24:27], v[120:123], v[56:59], 0
    v_mfma_f32_16x16x32_bf16 v[28:31], v[124:127], v[56:59], 0
    v_mfma_f32_16x16x16_bf16 v[32:35], v[16:17], v[20:21], v[32:35]
    v_mfma_f32_16x16x16_bf16 v[24:27], v[66:67], v[20:21], v[24:27]
    v_mfma_f32_16x16x16_bf16 v[28:31], v[66:67], v[22:23], v[28:31]
    ds_read_b128 v[80:83], v8 offset:0
    ds_read_b128 v[84:87], v8 offset:1024
    ds_read_b128 v[88:91], v8 offset:32768
    ds_read_b128 v[92:95], v8 offset:33792
    ds_read_b128 v[96:99], v8 offset:2048
    ds_read_b128 v[100:103], v8 offset:3072
    ds_read_b128 v[104:107], v8 offset:34816
    ds_read_b128 v[108:111], v8 offset:35840
    v_rcp_f32 v56, v32
    s_nop 0
    v_mul_f32 v24, v24, v56
    v_mul_f32 v25, v25, v56
    v_mul_f32 v26, v26, v56
    v_mul_f32 v27, v27, v56
    v_mul_f32 v28, v28, v56
    v_mul_f32 v29, v29, v56
    v_mul_f32 v30, v30, v56
    v_mul_f32 v31, v31, v56
    v_cvt_pk_bf16_f32 v60, v24, v25
    v_cvt_pk_bf16_f32 v61, v26, v27
    v_cvt_pk_bf16_f32 v62, v28, v29
    v_cvt_pk_bf16_f32 v63, v30, v31
    ds_write_b128 v9, v[60:63]
    v_mov_b32 v24, 0
    v_mov_b32 v25, 0
    v_mov_b32 v26, 0
    v_mov_b32 v27, 0
    v_mov_b32 v28, 0
    v_mov_b32 v29, 0
    v_mov_b32 v30, 0
    v_mov_b32 v31, 0
    v_mov_b32 v32, 0
    v_mov_b32 v33, 0
    v_mov_b32 v34, 0
    v_mov_b32 v35, 0
    v_mov_b32 v36, 0
    v_mov_b32 v37, 0
    v_mov_b32 v38, 0
    v_mov_b32 v39, 0
    s_waitcnt lgkmcnt(0)
    s_nop 1
    s_branch L_F1_fbdone
.p2align 8
.long 0xbf800000
.long 0xbf800000
.long 0xbf800000
.long 0xbf800000
.long 0xbf800000
.long 0xbf800000
L_S0_h1:
    s_waitcnt vmcnt(0)
L_S0_entry:
    ds_write_b128 v1, v[24:27]
    v_max3_u32 v23, v25, v27, v29
    v_max_u32 v23, v23, v31
    v_cmp_eq_u32 vcc, -1, v23
L_S0_entry2:
    v_smfmac_f32_16x16x64_bf16 v[56:59], v[24:27], a[0:7], v13
    v_smfmac_f32_16x16x64_bf16 v[60:63], v[24:27], a[8:15], v13
    s_cbranch_vccnz L_S0_h1retry
    v_smfmac_f32_16x16x64_bf16 v[56:59], v[28:31], a[16:23], v13
    ds_write_b128 v1, v[28:31] offset:1024
    v_smfmac_f32_16x16x64_bf16 v[60:63], v[28:31], a[24:31], v13
    v_smfmac_f32_16x16x64_bf16 v[64:67], v[24:27], a[128:135], v13
    v_smfmac_f32_16x16x64_bf16 v[68:71], v[24:27], a[136:143], v13
    s_mov_b32 m0, s57
    v_smfmac_f32_16x16x64_bf16 v[64:67], v[28:31], a[144:151], v13
    s_waitcnt lgkmcnt(0)
    s_barrier
    ds_read_b128 v[32:35], v2 offset:0
    v_smfmac_f32_16x16x64_bf16 v[68:71], v[28:31], a[152:159], v13
    ds_read_b128 v[36:39], v2 offset:1024
    v_smfmac_f32_16x16x64_bf16 v[72:75], v[24:27], v[80:87], v13
    ds_read_b128 v[40:43], v3 offset:0
    v_smfmac_f32_16x16x64_bf16 v[76:79], v[24:27], v[88:95], v13
    ds_read_b128 v[44:47], v3 offset:1024
    v_smfmac_f32_16x16x64_bf16 v[72:75], v[28:31], v[96:103], v13
    ds_read_b128 v[48:51], v4 offset:0
    v_smfmac_f32_16x16x64_bf16 v[76:79], v[28:31], v[104:111], v13
    s_waitcnt lgkmcnt(4)
    ds_read_b128 v[52:55], v4 offset:1024
    v_smfmac_f32_16x16x64_bf16 v[56:59], v[32:35], a[32:39], v13
    v_smfmac_f32_16x16x64_bf16 v[60:63], v[32:35], a[40:47], v13
    s_waitcnt lgkmcnt(4)
    buffer_store_dwordx4 v[120:123], v0, s[4:7], s41 offen sc1
    v_smfmac_f32_16x16x64_bf16 v[56:59], v[36:39], a[48:55], v13
    ds_read_b128 v[80:83], v8 offset:4096
    v_smfmac_f32_16x16x64_bf16 v[60:63], v[36:39], a[56:63], v13
    s_waitcnt lgkmcnt(4)
    ds_read_b128 v[84:87], v8 offset:5120
    buffer_load_dwordx4 v1, s[4:7], s39 offen sc1 lds
    v_smfmac_f32_16x16x64_bf16 v[56:59], v[40:43], a[64:71], v13
    ds_read_b128 v[88:91], v8 offset:6144
    v_smfmac_f32_16x16x64_bf16 v[60:63], v[40:43], a[72:79], v13
    s_waitcnt lgkmcnt(5)
    ds_read_b128 v[92:95], v8 offset:7168
    buffer_load_dwordx4 v1, s[4:7], s39 offen offset:1024 sc1 lds
    v_smfmac_f32_16x16x64_bf16 v[56:59], v[44:47], a[80:87], v13
    ds_read_b128 v[96:99], v8 offset:36864
    v_smfmac_f32_16x16x64_bf16 v[60:63], v[44:47], a[88:95], v13
    s_waitcnt lgkmcnt(6)
    ds_read_b128 v[100:103], v8 offset:37888
    buffer_load_dwordx4 v[124:127], v1, s[4:7], s40 offen offset:1024 sc1
    v_smfmac_f32_16x16x64_bf16 v[56:59], v[48:51], a[96:103], v13
    ds_read_b128 v[104:107], v8 offset:38912
    s_sub_u32 s21, s30, 1
    s_max_i32 s21, s21, 0
    v_smfmac_f32_16x16x64_bf16 v[60:63], v[48:51], a[104:111], v13
    s_waitcnt lgkmcnt(7)
    ds_read_b128 v[108:111], v8 offset:39936
    buffer_load_dwordx4 v[120:123], v1, s[4:7], s40 offen sc1
    v_mov_b32 v20, s21
    v_smfmac_f32_16x16x64_bf16 v[56:59], v[52:55], a[112:119], v13
    buffer_load_dword v15, off, s[4:7], s42 sc1
    ds_read_b128 v[24:27], v0 offset:8192
    v_smfmac_f32_16x16x64_bf16 v[60:63], v[52:55], a[120:127], v13
    s_and_b32 s19, s30, 3
    s_waitcnt lgkmcnt(7)
    buffer_store_dword v20, v10, s[4:7], s43 offen sc1
    ds_read_b128 v[28:31], v0 offset:12288
    v_smfmac_f32_16x16x64_bf16 v[72:75], v[32:35], v[80:87], v13
    s_lshl_b32 s20, s19, 13
    s_waitcnt lgkmcnt(6)
    v_add_f32 v56, v56, v57
    v_smfmac_f32_16x16x64_bf16 v[76:79], v[32:35], v[88:95], v13
    s_add_u32 s37, s20, s60
    s_waitcnt lgkmcnt(4)
    v_add_f32 v58, v58, v59
    v_smfmac_f32_16x16x64_bf16 v[72:75], v[36:39], v[96:103], v13
    s_and_b32 s19, s19, 1
    s_waitcnt lgkmcnt(2)
    v_cvt_pk_bf16_f32 v56, v56, v58
    v_smfmac_f32_16x16x64_bf16 v[76:79], v[36:39], v[104:111], v13
    s_lshl_b32 s20, s19, 18
    ds_write_b32 v5, v56
    v_add_f32 v60, v60, v61
    v_smfmac_f32_16x16x64_bf16 v[64:67], v[32:35], a[160:167], v13
    s_add_u32 s32, s20, s58
    ds_read_b128 v[96:99], v0 offset:9216
    v_add_f32 v62, v62, v63
    v_smfmac_f32_16x16x64_bf16 v[68:71], v[32:35], a[168:175], v13
    s_add_u32 s33, s32, 32768
    ds_read_b128 v[100:103], v0 offset:13312
    v_cvt_pk_bf16_f32 v60, v60, v62
    v_smfmac_f32_16x16x64_bf16 v[64:67], v[36:39], a[176:183], v13
    s_add_u32 s34, s20, s59
    ds_write_b32 v5, v60 offset:512
    v_smfmac_f32_16x16x64_bf16 v[68:71], v[36:39], a[184:191], v13
    s_add_u32 s35, s34, 4096
    ds_read_b128 v[104:107], v0 offset:10240
    v_smfmac_f32_16x16x64_bf16 v[64:67], v[40:43], a[192:199], v13
    s_bfe_u32 s38, s30, 0x10001
    ds_read_b128 v[108:111], v0 offset:14336
    v_smfmac_f32_16x16x64_bf16 v[68:71], v[40:43], a[200:207], v13
    s_add_u32 s19, s30, 1
    ds_read_b128 v[32:35], v0 offset:11264
    v_xor_b32 v8, 0x10000, v8
    v_smfmac_f32_16x16x64_bf16 v[64:67], v[44:47], a[208:215], v13
    s_and_b32 s19, s19, 3
    s_waitcnt lgkmcnt(3)
    s_barrier
    ds_read_b64_tr_b16 v[80:81], v7 offset:0
    v_smfmac_f32_16x16x64_bf16 v[68:71], v[44:47], a[216:223], v13
    s_lshl_b32 s19, s19, 13
    ds_read_b64_tr_b16 v[82:83], v7 offset:512
    v_smfmac_f32_16x16x64_bf16 v[64:67], v[48:51], a[224:231], v13
    s_add_u32 s36, s19, s60
    ds_read_b64_tr_b16 v[84:85], v7 offset:1024
    v_smfmac_f32_16x16x64_bf16 v[68:71], v[48:51], a[232:239], v13
    s_add_u32 s31, s19, 131072
    ds_read_b64_tr_b16 v[86:87], v7 offset:1536
    v_smfmac_f32_16x16x64_bf16 v[64:67], v[52:55], a[240:247], v13
    s_add_u32 s41, s41, 131072
    ds_read_b64_tr_b16 v[88:89], v7 offset:2048
    v_smfmac_f32_16x16x64_bf16 v[68:71], v[52:55], a[248:255], v13
    s_add_u32 s39, s39, 262144
    ds_read_b64_tr_b16 v[90:91], v7 offset:2560
    v_smfmac_f32_16x16x64_bf16 v[72:75], v[40:43], v[128:135], v13
    s_add_u32 s40, s40, 262144
    ds_read_b64_tr_b16 v[92:93], v7 offset:3072
    v_add_f32 v64, v64, v65
    v_smfmac_f32_16x16x64_bf16 v[76:79], v[40:43], v[136:143], v13
    s_waitcnt lgkmcnt(5)
    ds_read_b64_tr_b16 v[94:95], v7 offset:3584
    v_add_f32 v66, v66, v67
    v_mfma_f32_16x16x32_bf16 v[56:59], v[24:27], v[80:83], 0
    v_cvt_pk_bf16_f32 v64, v64, v66
    v_add_f32 v68, v68, v69
    v_mfma_f32_16x16x32_bf16 v[60:63], v[28:31], v[80:83], 0
    s_waitcnt lgkmcnt(4)
    ds_write_b32 v5, v64 offset:4096
    v_add_f32 v70, v70, v71
    v_mfma_f32_16x16x32_bf16 v[56:59], v[96:99], v[84:87], v[56:59]
    ds_read_b128 v[36:39], v0 offset:15360
    v_cvt_pk_bf16_f32 v65, v68, v70
    v_mfma_f32_16x16x32_bf16 v[60:63], v[100:103], v[84:87], v[60:63]
    s_waitcnt lgkmcnt(4)
    ds_write_b32 v5, v65 offset:4608
    v_mfma_f32_16x16x32_bf16 v[56:59], v[104:107], v[88:91], v[56:59]
    v_mfma_f32_16x16x32_bf16 v[60:63], v[108:111], v[88:91], v[60:63]
    s_waitcnt lgkmcnt(3)
    v_mfma_f32_16x16x32_bf16 v[56:59], v[32:35], v[92:95], v[56:59]
    s_waitcnt lgkmcnt(1)
    v_mfma_f32_16x16x32_bf16 v[60:63], v[36:39], v[92:95], v[60:63]
    s_waitcnt lgkmcnt(0)
    s_barrier
    ds_read_b64_tr_b16 v[96:97], v7 offset:4096
    ds_read_b64_tr_b16 v[98:99], v7 offset:4608
    v_smfmac_f32_16x16x64_bf16 v[72:75], v[44:47], v[144:151], v13
    ds_read_b64_tr_b16 v[100:101], v7 offset:5120
    v_exp_f32 v56, v56
    v_smfmac_f32_16x16x64_bf16 v[76:79], v[44:47], v[152:159], v13
    ds_read_b64_tr_b16 v[102:103], v7 offset:5632
    v_exp_f32 v57, v57
    v_smfmac_f32_16x16x64_bf16 v[72:75], v[48:51], v[160:167], v13
    ds_read_b64_tr_b16 v[104:105], v7 offset:6144
    v_exp_f32 v58, v58
    v_smfmac_f32_16x16x64_bf16 v[76:79], v[48:51], v[168:175], v13
    ds_read_b64_tr_b16 v[106:107], v7 offset:6656
    v_exp_f32 v59, v59
    v_smfmac_f32_16x16x64_bf16 v[72:75], v[52:55], v[176:183], v13
    ds_read_b64_tr_b16 v[108:109], v7 offset:7168
    v_exp_f32 v60, v60
    v_smfmac_f32_16x16x64_bf16 v[76:79], v[52:55], v[184:191], v13
    s_waitcnt lgkmcnt(5)
    ds_read_b64_tr_b16 v[110:111], v7 offset:7680
    v_exp_f32 v61, v61
    v_mfma_f32_16x16x32_bf16 v[68:71], v[96:99], v[80:83], 0
    s_waitcnt lgkmcnt(4)
    v_exp_f32 v62, v62
    v_mfma_f32_16x16x32_bf16 v[68:71], v[100:103], v[84:87], v[68:71]
    s_waitcnt lgkmcnt(2)
    v_exp_f32 v63, v63
    v_mfma_f32_16x16x32_bf16 v[68:71], v[104:107], v[88:91], v[68:71]
    s_waitcnt lgkmcnt(0)
    v_cvt_pk_bf16_f32 v56, v56, v57
    v_cvt_pk_bf16_f32 v57, v58, v59
    v_mfma_f32_16x16x32_bf16 v[68:71], v[108:111], v[92:95], v[68:71]
    v_cvt_pk_bf16_f32 v58, v60, v61
    v_cvt_pk_bf16_f32 v59, v62, v63
    v_add_f32 v72, v72, v73
    v_add_f32 v74, v74, v75
    v_mfma_f32_16x16x32_bf16 v[32:35], v[16:19], v[56:59], 0
    s_nop 2
    v_mul_f32 v68, s45, v68
    v_mul_f32 v69, s45, v69
    v_mfma_f32_16x16x32_bf16 v[24:27], v[112:115], v[56:59], 0
    v_exp_f32 v68, v68
    v_exp_f32 v69, v69
    v_mfma_f32_16x16x32_bf16 v[28:31], v[116:119], v[56:59], 0
    v_cvt_pk_bf16_f32 v66, v72, v74
    v_cvt_pk_bf16_f32 v20, v68, v69
    v_add_f32 v76, v76, v77
    v_add_f32 v78, v78, v79
    v_mfma_f32_16x16x16_bf16 v[32:35], v[16:17], v[20:21], v[32:35]
    v_cvt_pk_bf16_f32 v67, v76, v78
    v_cvt_pk_bf16_f32 v23, v68, v69
    s_nop 0
    v_mfma_f32_16x16x16_bf16 v[24:27], v[66:67], v[20:21], v[24:27]
    ds_read_b128 v[80:83], v8 offset:0
    ds_read_b128 v[84:87], v8 offset:1024
    v_mfma_f32_16x16x16_bf16 v[28:31], v[66:67], v[22:23], v[28:31]
    ds_read_b128 v[88:91], v8 offset:32768
    ds_read_b128 v[92:95], v8 offset:33792
    v_rcp_f32 v56, v32
    s_nop 0
    v_pk_mul_f32 v[24:25], v[24:25], v[56:57] op_sel_hi:[1,0]
    v_pk_mul_f32 v[26:27], v[26:27], v[56:57] op_sel_hi:[1,0]
    v_cvt_pk_bf16_f32 v60, v24, v25
    v_cvt_pk_bf16_f32 v61, v26, v27
    ds_write_b64 v9, v[60:61] offset:0
    v_pk_mul_f32 v[28:29], v[28:29], v[56:57] op_sel_hi:[1,0]
    v_pk_mul_f32 v[30:31], v[30:31], v[56:57] op_sel_hi:[1,0]
    v_cvt_pk_bf16_f32 v62, v28, v29
    v_cvt_pk_bf16_f32 v63, v30, v31
    ds_write_b64 v9, v[62:63] offset:8
    v_subrev_u32 v57, s46, v32
    v_cmp_le_u32 vcc, s47, v57
    v_mfma_f32_16x16x16_bf16 v[24:27], v[22:23], v[20:21], 0
    v_mfma_f32_16x16x16_bf16 v[28:31], v[22:23], v[20:21], 0
    v_mfma_f32_16x16x16_bf16 v[32:35], v[22:23], v[20:21], 0
    v_mfma_f32_16x16x16_bf16 v[36:39], v[22:23], v[20:21], 0
    s_cbranch_vccnz L_S0_fallback
L_S0_fbdone:
    s_waitcnt lgkmcnt(0)
    s_barrier
    ds_read_b128 v[112:115], v0
    ds_read_b128 v[116:119], v0 offset:1024
    s_add_u32 s30, s30, 1
    v_mfma_f32_16x16x16_bf16 v[40:43], v[22:23], v[20:21], 0
    v_mov_b32 v68, s30
    v_mfma_f32_16x16x16_bf16 v[44:47], v[22:23], v[20:21], 0
    v_mfma_f32_16x16x16_bf16 v[48:51], v[22:23], v[20:21], 0
    v_mfma_f32_16x16x16_bf16 v[52:55], v[22:23], v[20:21], 0
    s_waitcnt lgkmcnt(1)
    v_smfmac_f32_16x16x64_bf16 v[24:27], v[112:115], v[192:199], v13
    s_waitcnt lgkmcnt(0)
    ds_read_b128 v[96:99], v8 offset:2048
    v_smfmac_f32_16x16x64_bf16 v[24:27], v[116:119], v[200:207], v13
    ds_read_b128 v[100:103], v8 offset:3072
    v_smfmac_f32_16x16x64_bf16 v[28:31], v[112:115], v[208:215], v13
    ds_read_b128 v[104:107], v8 offset:34816
    v_smfmac_f32_16x16x64_bf16 v[28:31], v[116:119], v[216:223], v13
    ds_read_b128 v[108:111], v8 offset:35840
    v_add_f32 v24, v24, v25
    v_smfmac_f32_16x16x64_bf16 v[32:35], v[112:115], v[224:231], v13
    ds_read_b128 v[56:59], v8 offset:4096
    v_add_f32 v26, v26, v27
    v_cvt_pk_bf16_f32 v24, v24, v26
    v_smfmac_f32_16x16x64_bf16 v[32:35], v[116:119], v[232:239], v13
    ds_read_b128 v[60:63], v8 offset:5120
    v_and_or_b32 v24, v24, -2, s38
    v_add_f32 v28, v28, v29
    v_smfmac_f32_16x16x64_bf16 v[36:39], v[112:115], v[240:247], v13
    ds_read_b128 v[72:75], v8 offset:36864
    v_add_f32 v30, v30, v31
    v_cvt_pk_bf16_f32 v25, v28, v30
    v_smfmac_f32_16x16x64_bf16 v[36:39], v[116:119], v[248:255], v13
    buffer_store_dword v68, v6, s[4:7], s23 offen sc1
    ds_read_b128 v[76:79], v8 offset:37888
    v_add_f32 v32, v32, v33
    v_smfmac_f32_16x16x64_bf16 v[40:43], v[112:115], v[80:87], v13
    ds_read_b128 v[80:83], v8 offset:6144
    v_add_f32 v34, v34, v35
    v_cvt_pk_bf16_f32 v26, v32, v34
    v_smfmac_f32_16x16x64_bf16 v[40:43], v[116:119], v[88:95], v13
    s_waitcnt lgkmcnt(7)
    ds_read_b128 v[84:87], v8 offset:7168
    ds_read_b128 v[88:91], v8 offset:38912
    v_add_f32 v36, v36, v37
    v_smfmac_f32_16x16x64_bf16 v[44:47], v[112:115], v[96:103], v13
    s_waitcnt lgkmcnt(7)
    ds_read_b128 v[92:95], v8 offset:39936
    v_add_f32 v38, v38, v39
    v_cvt_pk_bf16_f32 v27, v36, v38
    v_smfmac_f32_16x16x64_bf16 v[44:47], v[116:119], v[104:111], v13
    s_waitcnt lgkmcnt(6)
    buffer_store_dwordx4 v[24:27], v11, s[4:7], s32 offen sc1
    v_add_f32 v40, v40, v41
    v_xor_b32 v8, 0x10000, v8
    v_smfmac_f32_16x16x64_bf16 v[48:51], v[112:115], v[56:63], v13
    s_waitcnt lgkmcnt(4)
    v_add_f32 v42, v42, v43
    v_cvt_pk_bf16_f32 v40, v40, v42
    v_smfmac_f32_16x16x64_bf16 v[48:51], v[116:119], v[72:79], v13
    s_waitcnt lgkmcnt(2)
    v_and_or_b32 v40, v40, -2, s38
    v_add_f32 v44, v44, v45
    v_smfmac_f32_16x16x64_bf16 v[52:55], v[112:115], v[80:87], v13
    s_waitcnt lgkmcnt(0)
    buffer_load_dword v69, v6, s[4:7], s29 offen sc1
    v_add_f32 v46, v46, v47
    v_cvt_pk_bf16_f32 v41, v44, v46
    v_smfmac_f32_16x16x64_bf16 v[52:55], v[116:119], v[88:95], v13
    v_add_f32 v48, v48, v49
    v_add_f32 v50, v50, v51
    v_cvt_pk_bf16_f32 v42, v48, v50
    buffer_load_dword v70, v6, s[4:7], s29 offen sc1
    s_nop 3
    v_add_f32 v52, v52, v53
    v_add_f32 v54, v54, v55
    v_cvt_pk_bf16_f32 v43, v52, v54
    buffer_store_dwordx4 v[40:43], v11, s[4:7], s33 offen sc1
    s_cmp_lg_u32 s17, 0
    s_cbranch_scc1 L_S0_others
    buffer_load_dword v71, v6, s[4:7], s29 offen sc1
    v_cndmask_b32 v56, 0, v14, s[48:49]
    v_cndmask_b32 v57, 0, v14, s[50:51]
    v_cndmask_b32 v58, 0, v14, s[52:53]
    v_cndmask_b32 v59, 0, v14, s[54:55]
    v_mov_b32 v112, v64
    v_mov_b32 v113, v65
    v_mov_b32 v114, v66
    v_mov_b32 v115, v67
    v_mov_b32 v60, 0
    v_mov_b32 v61, 0
    v_mov_b32 v62, 0
    v_mov_b32 v63, 0
    v_mov_b32 v64, 0
    v_mov_b32 v65, 0
    v_mov_b32 v66, 0
    v_mov_b32 v67, 0
    buffer_load_dword v72, v6, s[4:7], s29 offen sc1
    s_waitcnt vmcnt(4)
    v_cmp_gt_u32 vcc, s30, v69
    s_cbranch_vccz L_S0_go
    buffer_load_dword v69, v6, s[4:7], s29 offen sc1
    s_waitcnt vmcnt(4)
    v_cmp_gt_u32 vcc, s30, v70
    s_cbranch_vccz L_S0_go
    buffer_load_dword v70, v6, s[4:7], s29 offen sc1
L_S0_hl:
    s_waitcnt vmcnt(3)
    v_cmp_gt_u32 vcc, s30, v71
    s_cbranch_vccz L_S0_go
    buffer_load_dword v71, v6, s[4:7], s29 offen sc1
    s_add_u32 s97, s97, 1
    s_waitcnt vmcnt(3)
    v_cmp_gt_u32 vcc, s30, v72
    s_cbranch_vccz L_S0_go
    buffer_load_dword v72, v6, s[4:7], s29 offen sc1
    s_add_u32 s97, s97, 1
    s_waitcnt vmcnt(3)
    v_cmp_gt_u32 vcc, s30, v69
    s_cbranch_vccz L_S0_go
    buffer_load_dword v69, v6, s[4:7], s29 offen sc1
    s_add_u32 s97, s97, 1
    s_waitcnt vmcnt(3)
    v_cmp_gt_u32 vcc, s30, v70
    s_cbranch_vccz L_S0_go
    buffer_load_dword v70, v6, s[4:7], s29 offen sc1
    s_add_u32 s97, s97, 1
    s_add_u32 s18, s18, 1
    s_cmp_gt_u32 s18, 200000
    s_cbranch_scc0 L_S0_hl
    s_branch L_abort
.p2align 5
L_S0_go:
    buffer_load_dwordx4 v[24:27], v0, s[4:7], s34 offen offset:0 sc1
    buffer_load_dwordx4 v[28:31], v0, s[4:7], s34 offen offset:1024 sc1
    buffer_load_dwordx4 v[32:35], v0, s[4:7], s34 offen offset:2048 sc1
    buffer_load_dwordx4 v[36:39], v0, s[4:7], s34 offen offset:3072 sc1
    buffer_load_dwordx4 v[40:43], v0, s[4:7], s35 offen offset:0 sc1
    buffer_load_dwordx4 v[44:47], v0, s[4:7], s35 offen offset:1024 sc1
    buffer_load_dwordx4 v[48:51], v0, s[4:7], s35 offen offset:2048 sc1
    buffer_load_dwordx4 v[52:55], v0, s[4:7], s35 offen offset:3072 sc1
L_S0_h2:
    s_waitcnt vmcnt(7)
    v_mfma_f32_16x16x32_bf16 v[72:75], v[24:27], v[56:59], 0
    s_waitcnt vmcnt(6)
    v_xor_b32 v76, s38, v24
    v_mfma_f32_16x16x32_bf16 v[72:75], v[28:31], v[56:59], v[72:75]
    s_waitcnt vmcnt(5)
    v_bitop3_b32 v76, v76, v28, s38 bitop3:0xf6
    v_mfma_f32_16x16x32_bf16 v[72:75], v[32:35], v[56:59], v[72:75]
    s_waitcnt vmcnt(4)
    v_bitop3_b32 v76, v76, v32, s38 bitop3:0xf6
    v_mfma_f32_16x16x32_bf16 v[72:75], v[36:39], v[56:59], v[72:75]
    s_waitcnt vmcnt(3)
    v_bitop3_b32 v76, v76, v36, s38 bitop3:0xf6
    v_mfma_f32_16x16x32_bf16 v[72:75], v[40:43], v[56:59], v[72:75]
    s_waitcnt vmcnt(2)
    v_bitop3_b32 v76, v76, v40, s38 bitop3:0xf6
    v_mfma_f32_16x16x32_bf16 v[72:75], v[44:47], v[56:59], v[72:75]
    s_waitcnt vmcnt(1)
    v_bitop3_b32 v76, v76, v44, s38 bitop3:0xf6
    v_mfma_f32_16x16x32_bf16 v[72:75], v[48:51], v[56:59], v[72:75]
    s_waitcnt vmcnt(0)
    v_bitop3_b32 v76, v76, v48, s38 bitop3:0xf6
    v_mfma_f32_16x16x32_bf16 v[72:75], v[52:55], v[56:59], v[72:75]
    v_bitop3_b32 v76, v76, v52, s38 bitop3:0xf6
    v_and_b32 v76, 1, v76
    v_cmp_ne_u32 vcc, 0, v76
    v_mov_b32 v76, -1
    v_mov_b32 v77, -1
    s_nop 2
    v_cvt_pk_bf16_f32 v78, v72, v73
    v_cvt_pk_bf16_f32 v79, v74, v75
    s_cbranch_vccnz L_S0_h2r
L_S0_pubit:
    buffer_store_dwordx2 v[78:79], v12, s[4:7], s36 offen sc1
    buffer_store_dwordx2 v[76:77], v12, s[4:7], s37 offen sc1
    ds_read_b128 v[80:83], v8 offset:0
    ds_read_b128 v[84:87], v8 offset:1024
    ds_read_b128 v[88:91], v8 offset:2048
    ds_read_b128 v[92:95], v8 offset:3072
    ds_read_b128 v[96:99], v8 offset:32768
    ds_read_b128 v[100:103], v8 offset:33792
    ds_read_b128 v[104:107], v8 offset:34816
    ds_read_b128 v[108:111], v8 offset:35840
    v_mov_b32 v60, 0
    v_mov_b32 v61, 0
    v_mov_b32 v62, 0
    v_mov_b32 v63, 0
    v_mov_b32 v64, 0
    v_mov_b32 v65, 0
    v_mov_b32 v66, 0
    v_mov_b32 v67, 0
    s_waitcnt vmcnt(63)
    v_readfirstlane_b32 s44, v15
    s_nop 0
    s_lshr_b32 s19, s44, 16
    s_and_b32 s44, s44, 0xffff
    s_min_u32 s44, s44, s19
    s_add_u32 s19, s30, 2
    s_min_u32 s19, s19, 64
    s_cmp_ge_u32 s44, s19
    s_cbranch_scc0 L_S0_av0_slow
L_S0_av0_ok:
    v_mov_b32 v56, 0
    v_mov_b32 v57, 0
    v_mov_b32 v58, 0
    v_mov_b32 v59, 0
    v_mov_b32 v72, 0
    v_mov_b32 v73, 0
    v_mov_b32 v74, 0
    v_mov_b32 v75, 0
    v_mov_b32 v76, 0
    v_mov_b32 v77, 0
    v_mov_b32 v78, 0
    v_mov_b32 v79, 0
    s_branch L_S0_join
.p2align 5
L_S0_others:
    v_mov_b32 v56, 0
    v_mov_b32 v57, 0
    v_mov_b32 v58, 0
    v_mov_b32 v59, 0
    v_mov_b32 v72, 0
    v_mov_b32 v73, 0
    v_mov_b32 v74, 0
    v_mov_b32 v75, 0
    v_mov_b32 v76, 0
    v_mov_b32 v77, 0
    v_mov_b32 v78, 0
    v_mov_b32 v79, 0
    ds_read_b128 v[80:83], v8 offset:0
    ds_read_b128 v[84:87], v8 offset:1024
    ds_read_b128 v[88:91], v8 offset:2048
    ds_read_b128 v[92:95], v8 offset:3072
    ds_read_b128 v[96:99], v8 offset:32768
    ds_read_b128 v[100:103], v8 offset:33792
    ds_read_b128 v[104:107], v8 offset:34816
    ds_read_b128 v[108:111], v8 offset:35840
    v_mov_b32 v112, v64
    v_mov_b32 v113, v65
    v_mov_b32 v114, v66
    v_mov_b32 v115, v67
    v_mov_b32 v60, 0
    v_mov_b32 v61, 0
    v_mov_b32 v62, 0
    v_mov_b32 v63, 0
    v_mov_b32 v64, 0
    v_mov_b32 v65, 0
    v_mov_b32 v66, 0
    v_mov_b32 v67, 0
    s_cmp_lg_u32 s17, 1
    s_cbranch_scc1 L_S0_av2_ok
    s_waitcnt vmcnt(4)
    v_readfirstlane_b32 s44, v15
    s_nop 0
    s_lshr_b32 s19, s44, 16
    s_and_b32 s44, s44, 0xffff
    s_min_u32 s44, s44, s19
    s_add_u32 s19, s30, 2
    s_min_u32 s19, s19, 64
    s_cmp_ge_u32 s44, s19
    s_cbranch_scc0 L_S0_av2_slow
L_S0_av2_ok:
L_S0_join:
    s_barrier
    s_cmp_eq_u32 s30, 63
    s_cbranch_scc1 L_last
    buffer_load_dwordx4 v[24:27], v1, s[4:7], s31 offen sc1
    buffer_load_dwordx4 v[28:31], v1, s[4:7], s31 offen offset:1024 sc1
    s_waitcnt vmcnt(2)
    v_mov_b32 v68, 0
    v_mov_b32 v69, 0
    v_mov_b32 v70, 0
    v_mov_b32 v71, 0
    s_waitcnt lgkmcnt(0)
L_S1_h1:
    s_waitcnt vmcnt(0)
L_S1_entry:
    ds_write_b128 v1, v[24:27]
    v_max3_u32 v23, v25, v27, v29
    v_max_u32 v23, v23, v31
    v_cmp_eq_u32 vcc, -1, v23
L_S1_entry2:
    v_smfmac_f32_16x16x64_bf16 v[56:59], v[24:27], a[0:7], v13
    v_smfmac_f32_16x16x64_bf16 v[60:63], v[24:27], a[8:15], v13
    s_cbranch_vccnz L_S1_h1retry
    v_smfmac_f32_16x16x64_bf16 v[56:59], v[28:31], a[16:23], v13
    ds_write_b128 v1, v[28:31] offset:1024
    v_smfmac_f32_16x16x64_bf16 v[60:63], v[28:31], a[24:31], v13
    v_smfmac_f32_16x16x64_bf16 v[64:67], v[24:27], a[128:135], v13
    v_smfmac_f32_16x16x64_bf16 v[68:71], v[24:27], a[136:143], v13
    s_mov_b32 m0, s56
    v_smfmac_f32_16x16x64_bf16 v[64:67], v[28:31], a[144:151], v13
    s_waitcnt lgkmcnt(0)
    s_barrier
    ds_read_b128 v[32:35], v2 offset:0
    v_smfmac_f32_16x16x64_bf16 v[68:71], v[28:31], a[152:159], v13
    ds_read_b128 v[36:39], v2 offset:1024
    v_smfmac_f32_16x16x64_bf16 v[72:75], v[24:27], v[80:87], v13
    ds_read_b128 v[40:43], v3 offset:0
    v_smfmac_f32_16x16x64_bf16 v[76:79], v[24:27], v[88:95], v13
    ds_read_b128 v[44:47], v3 offset:1024
    v_smfmac_f32_16x16x64_bf16 v[72:75], v[28:31], v[96:103], v13
    ds_read_b128 v[48:51], v4 offset:0
    v_smfmac_f32_16x16x64_bf16 v[76:79], v[28:31], v[104:111], v13
    s_waitcnt lgkmcnt(4)
    ds_read_b128 v[52:55], v4 offset:1024
    v_smfmac_f32_16x16x64_bf16 v[56:59], v[32:35], a[32:39], v13
    v_smfmac_f32_16x16x64_bf16 v[60:63], v[32:35], a[40:47], v13
    s_waitcnt lgkmcnt(4)
    buffer_store_dwordx4 v[112:115], v0, s[4:7], s41 offen sc1
    v_smfmac_f32_16x16x64_bf16 v[56:59], v[36:39], a[48:55], v13
    ds_read_b128 v[80:83], v8 offset:4096
    v_smfmac_f32_16x16x64_bf16 v[60:63], v[36:39], a[56:63], v13
    s_waitcnt lgkmcnt(4)
    ds_read_b128 v[84:87], v8 offset:5120
    buffer_load_dwordx4 v1, s[4:7], s39 offen sc1 lds
    v_smfmac_f32_16x16x64_bf16 v[56:59], v[40:43], a[64:71], v13
    ds_read_b128 v[88:91], v8 offset:6144
    v_smfmac_f32_16x16x64_bf16 v[60:63], v[40:43], a[72:79], v13
    s_waitcnt lgkmcnt(5)
    ds_read_b128 v[92:95], v8 offset:7168
    buffer_load_dwordx4 v1, s[4:7], s39 offen offset:1024 sc1 lds
    v_smfmac_f32_16x16x64_bf16 v[56:59], v[44:47], a[80:87], v13
    ds_read_b128 v[96:99], v8 offset:36864
    v_smfmac_f32_16x16x64_bf16 v[60:63], v[44:47], a[88:95], v13
    s_waitcnt lgkmcnt(6)
    ds_read_b128 v[100:103], v8 offset:37888
    buffer_load_dwordx4 v[116:119], v1, s[4:7], s40 offen offset:1024 sc1
    v_smfmac_f32_16x16x64_bf16 v[56:59], v[48:51], a[96:103], v13
    ds_read_b128 v[104:107], v8 offset:38912
    s_sub_u32 s21, s30, 1
    s_max_i32 s21, s21, 0
    v_smfmac_f32_16x16x64_bf16 v[60:63], v[48:51], a[104:111], v13
    s_waitcnt lgkmcnt(7)
    ds_read_b128 v[108:111], v8 offset:39936
    buffer_load_dwordx4 v[112:115], v1, s[4:7], s40 offen sc1
    v_mov_b32 v20, s21
    v_smfmac_f32_16x16x64_bf16 v[56:59], v[52:55], a[112:119], v13
    buffer_load_dword v15, off, s[4:7], s42 sc1
    ds_read_b128 v[24:27], v0 offset:16384
    v_smfmac_f32_16x16x64_bf16 v[60:63], v[52:55], a[120:127], v13
    s_and_b32 s19, s30, 3
    s_waitcnt lgkmcnt(7)
    buffer_store_dword v20, v10, s[4:7], s43 offen sc1
    ds_read_b128 v[28:31], v0 offset:20480
    v_smfmac_f32_16x16x64_bf16 v[72:75], v[32:35], v[80:87], v13
    s_lshl_b32 s20, s19, 13
    s_waitcnt lgkmcnt(6)
    v_add_f32 v56, v56, v57
    v_smfmac_f32_16x16x64_bf16 v[76:79], v[32:35], v[88:95], v13
    s_add_u32 s37, s20, s60
    s_waitcnt lgkmcnt(4)
    v_add_f32 v58, v58, v59
    v_smfmac_f32_16x16x64_bf16 v[72:75], v[36:39], v[96:103], v13
    s_and_b32 s19, s19, 1
    s_waitcnt lgkmcnt(2)
    v_cvt_pk_bf16_f32 v56, v56, v58
    v_smfmac_f32_16x16x64_bf16 v[76:79], v[36:39], v[104:111], v13
    s_lshl_b32 s20, s19, 18
    ds_write_b32 v5, v56
    v_add_f32 v60, v60, v61
    v_smfmac_f32_16x16x64_bf16 v[64:67], v[32:35], a[160:167], v13
    s_add_u32 s32, s20, s58
    ds_read_b128 v[96:99], v0 offset:17408
    v_add_f32 v62, v62, v63
    v_smfmac_f32_16x16x64_bf16 v[68:71], v[32:35], a[168:175], v13
    s_add_u32 s33, s32, 32768
    ds_read_b128 v[100:103], v0 offset:21504
    v_cvt_pk_bf16_f32 v60, v60, v62
    v_smfmac_f32_16x16x64_bf16 v[64:67], v[36:39], a[176:183], v13
    s_add_u32 s34, s20, s59
    ds_write_b32 v5, v60 offset:512
    v_smfmac_f32_16x16x64_bf16 v[68:71], v[36:39], a[184:191], v13
    s_add_u32 s35, s34, 4096
    ds_read_b128 v[104:107], v0 offset:18432
    v_smfmac_f32_16x16x64_bf16 v[64:67], v[40:43], a[192:199], v13
    s_bfe_u32 s38, s30, 0x10001
    ds_read_b128 v[108:111], v0 offset:22528
    v_smfmac_f32_16x16x64_bf16 v[68:71], v[40:43], a[200:207], v13
    s_add_u32 s19, s30, 1
    ds_read_b128 v[32:35], v0 offset:19456
    v_xor_b32 v8, 0x10000, v8
    v_smfmac_f32_16x16x64_bf16 v[64:67], v[44:47], a[208:215], v13
    s_and_b32 s19, s19, 3
    s_waitcnt lgkmcnt(3)
    s_barrier
    ds_read_b64_tr_b16 v[80:81], v7 offset:0
    v_smfmac_f32_16x16x64_bf16 v[68:71], v[44:47], a[216:223], v13
    s_lshl_b32 s19, s19, 13
    ds_read_b64_tr_b16 v[82:83], v7 offset:512
    v_smfmac_f32_16x16x64_bf16 v[64:67], v[48:51], a[224:231], v13
    s_add_u32 s36, s19, s60
    ds_read_b64_tr_b16 v[84:85], v7 offset:1024
    v_smfmac_f32_16x16x64_bf16 v[68:71], v[48:51], a[232:239], v13
    s_add_u32 s31, s19, 131072
    ds_read_b64_tr_b16 v[86:87], v7 offset:1536
    v_smfmac_f32_16x16x64_bf16 v[64:67], v[52:55], a[240:247], v13
    s_add_u32 s41, s41, 131072
    ds_read_b64_tr_b16 v[88:89], v7 offset:2048
    v_smfmac_f32_16x16x64_bf16 v[68:71], v[52:55], a[248:255], v13
    s_add_u32 s39, s39, 262144
    ds_read_b64_tr_b16 v[90:91], v7 offset:2560
    v_smfmac_f32_16x16x64_bf16 v[72:75], v[40:43], v[128:135], v13
    s_add_u32 s40, s40, 262144
    ds_read_b64_tr_b16 v[92:93], v7 offset:3072
    v_add_f32 v64, v64, v65
    v_smfmac_f32_16x16x64_bf16 v[76:79], v[40:43], v[136:143], v13
    s_waitcnt lgkmcnt(5)
    ds_read_b64_tr_b16 v[94:95], v7 offset:3584
    v_add_f32 v66, v66, v67
    v_mfma_f32_16x16x32_bf16 v[56:59], v[24:27], v[80:83], 0
    v_cvt_pk_bf16_f32 v64, v64, v66
    v_add_f32 v68, v68, v69
    v_mfma_f32_16x16x32_bf16 v[60:63], v[28:31], v[80:83], 0
    s_waitcnt lgkmcnt(4)
    ds_write_b32 v5, v64 offset:4096
    v_add_f32 v70, v70, v71
    v_mfma_f32_16x16x32_bf16 v[56:59], v[96:99], v[84:87], v[56:59]
    ds_read_b128 v[36:39], v0 offset:23552
    v_cvt_pk_bf16_f32 v65, v68, v70
    v_mfma_f32_16x16x32_bf16 v[60:63], v[100:103], v[84:87], v[60:63]
    s_waitcnt lgkmcnt(4)
    ds_write_b32 v5, v65 offset:4608
    v_mfma_f32_16x16x32_bf16 v[56:59], v[104:107], v[88:91], v[56:59]
    v_mfma_f32_16x16x32_bf16 v[60:63], v[108:111], v[88:91], v[60:63]
    s_waitcnt lgkmcnt(3)
    v_mfma_f32_16x16x32_bf16 v[56:59], v[32:35], v[92:95], v[56:59]
    s_waitcnt lgkmcnt(1)
    v_mfma_f32_16x16x32_bf16 v[60:63], v[36:39], v[92:95], v[60:63]
    s_waitcnt lgkmcnt(0)
    s_barrier
    ds_read_b64_tr_b16 v[96:97], v7 offset:4096
    ds_read_b64_tr_b16 v[98:99], v7 offset:4608
    v_smfmac_f32_16x16x64_bf16 v[72:75], v[44:47], v[144:151], v13
    ds_read_b64_tr_b16 v[100:101], v7 offset:5120
    v_exp_f32 v56, v56
    v_smfmac_f32_16x16x64_bf16 v[76:79], v[44:47], v[152:159], v13
    ds_read_b64_tr_b16 v[102:103], v7 offset:5632
    v_exp_f32 v57, v57
    v_smfmac_f32_16x16x64_bf16 v[72:75], v[48:51], v[160:167], v13
    ds_read_b64_tr_b16 v[104:105], v7 offset:6144
    v_exp_f32 v58, v58
    v_smfmac_f32_16x16x64_bf16 v[76:79], v[48:51], v[168:175], v13
    ds_read_b64_tr_b16 v[106:107], v7 offset:6656
    v_exp_f32 v59, v59
    v_smfmac_f32_16x16x64_bf16 v[72:75], v[52:55], v[176:183], v13
    ds_read_b64_tr_b16 v[108:109], v7 offset:7168
    v_exp_f32 v60, v60
    v_smfmac_f32_16x16x64_bf16 v[76:79], v[52:55], v[184:191], v13
    s_waitcnt lgkmcnt(5)
    ds_read_b64_tr_b16 v[110:111], v7 offset:7680
    v_exp_f32 v61, v61
    v_mfma_f32_16x16x32_bf16 v[68:71], v[96:99], v[80:83], 0
    s_waitcnt lgkmcnt(4)
    v_exp_f32 v62, v62
    v_mfma_f32_16x16x32_bf16 v[68:71], v[100:103], v[84:87], v[68:71]
    s_waitcnt lgkmcnt(2)
    v_exp_f32 v63, v63
    v_mfma_f32_16x16x32_bf16 v[68:71], v[104:107], v[88:91], v[68:71]
    s_waitcnt lgkmcnt(0)
    v_cvt_pk_bf16_f32 v56, v56, v57
    v_cvt_pk_bf16_f32 v57, v58, v59
    v_mfma_f32_16x16x32_bf16 v[68:71], v[108:111], v[92:95], v[68:71]
    v_cvt_pk_bf16_f32 v58, v60, v61
    v_cvt_pk_bf16_f32 v59, v62, v63
    v_add_f32 v72, v72, v73
    v_add_f32 v74, v74, v75
    v_mfma_f32_16x16x32_bf16 v[32:35], v[16:19], v[56:59], 0
    s_nop 2
    v_mul_f32 v68, s45, v68
    v_mul_f32 v69, s45, v69
    v_mfma_f32_16x16x32_bf16 v[24:27], v[120:123], v[56:59], 0
    v_exp_f32 v68, v68
    v_exp_f32 v69, v69
    v_mfma_f32_16x16x32_bf16 v[28:31], v[124:127], v[56:59], 0
    v_cvt_pk_bf16_f32 v66, v72, v74
    v_cvt_pk_bf16_f32 v20, v68, v69
    v_add_f32 v76, v76, v77
    v_add_f32 v78, v78, v79
    v_mfma_f32_16x16x16_bf16 v[32:35], v[16:17], v[20:21], v[32:35]
    v_cvt_pk_bf16_f32 v67, v76, v78
    v_cvt_pk_bf16_f32 v23, v68, v69
    s_nop 0
    v_mfma_f32_16x16x16_bf16 v[24:27], v[66:67], v[20:21], v[24:27]
    ds_read_b128 v[80:83], v8 offset:0
    ds_read_b128 v[84:87], v8 offset:1024
    v_mfma_f32_16x16x16_bf16 v[28:31], v[66:67], v[22:23], v[28:31]
    ds_read_b128 v[88:91], v8 offset:32768
    ds_read_b128 v[92:95], v8 offset:33792
    v_rcp_f32 v56, v32
    s_nop 0
    v_pk_mul_f32 v[24:25], v[24:25], v[56:57] op_sel_hi:[1,0]
    v_pk_mul_f32 v[26:27], v[26:27], v[56:57] op_sel_hi:[1,0]
    v_cvt_pk_bf16_f32 v60, v24, v25
    v_cvt_pk_bf16_f32 v61, v26, v27
    ds_write_b64 v9, v[60:61] offset:0
    v_pk_mul_f32 v[28:29], v[28:29], v[56:57] op_sel_hi:[1,0]
    v_pk_mul_f32 v[30:31], v[30:31], v[56:57] op_sel_hi:[1,0]
    v_cvt_pk_bf16_f32 v62, v28, v29
    v_cvt_pk_bf16_f32 v63, v30, v31
    ds_write_b64 v9, v[62:63] offset:8
    v_subrev_u32 v57, s46, v32
    v_cmp_le_u32 vcc, s47, v57
    v_mfma_f32_16x16x16_bf16 v[24:27], v[22:23], v[20:21], 0
    v_mfma_f32_16x16x16_bf16 v[28:31], v[22:23], v[20:21], 0
    v_mfma_f32_16x16x16_bf16 v[32:35], v[22:23], v[20:21], 0
    v_mfma_f32_16x16x16_bf16 v[36:39], v[22:23], v[20:21], 0
    s_cbranch_vccnz L_S1_fallback
L_S1_fbdone:
    s_waitcnt lgkmcnt(0)
    s_barrier
    ds_read_b128 v[120:123], v0
    ds_read_b128 v[124:127], v0 offset:1024
    s_add_u32 s30, s30, 1
    v_mfma_f32_16x16x16_bf16 v[40:43], v[22:23], v[20:21], 0
    v_mov_b32 v68, s30
    v_mfma_f32_16x16x16_bf16 v[44:47], v[22:23], v[20:21], 0
    v_mfma_f32_16x16x16_bf16 v[48:51], v[22:23], v[20:21], 0
    v_mfma_f32_16x16x16_bf16 v[52:55], v[22:23], v[20:21], 0
    s_waitcnt lgkmcnt(1)
    v_smfmac_f32_16x16x64_bf16 v[24:27], v[120:123], v[192:199], v13
    s_waitcnt lgkmcnt(0)
    ds_read_b128 v[96:99], v8 offset:2048
    v_smfmac_f32_16x16x64_bf16 v[24:27], v[124:127], v[200:207], v13
    ds_read_b128 v[100:103], v8 offset:3072
    v_smfmac_f32_16x16x64_bf16 v[28:31], v[120:123], v[208:215], v13
    ds_read_b128 v[104:107], v8 offset:34816
    v_smfmac_f32_16x16x64_bf16 v[28:31], v[124:127], v[216:223], v13
    ds_read_b128 v[108:111], v8 offset:35840
    v_add_f32 v24, v24, v25
    v_smfmac_f32_16x16x64_bf16 v[32:35], v[120:123], v[224:231], v13
    ds_read_b128 v[56:59], v8 offset:4096
    v_add_f32 v26, v26, v27
    v_cvt_pk_bf16_f32 v24, v24, v26
    v_smfmac_f32_16x16x64_bf16 v[32:35], v[124:127], v[232:239], v13
    ds_read_b128 v[60:63], v8 offset:5120
    v_and_or_b32 v24, v24, -2, s38
    v_add_f32 v28, v28, v29
    v_smfmac_f32_16x16x64_bf16 v[36:39], v[120:123], v[240:247], v13
    ds_read_b128 v[72:75], v8 offset:36864
    v_add_f32 v30, v30, v31
    v_cvt_pk_bf16_f32 v25, v28, v30
    v_smfmac_f32_16x16x64_bf16 v[36:39], v[124:127], v[248:255], v13
    buffer_store_dword v68, v6, s[4:7], s23 offen sc1
    ds_read_b128 v[76:79], v8 offset:37888
    v_add_f32 v32, v32, v33
    v_smfmac_f32_16x16x64_bf16 v[40:43], v[120:123], v[80:87], v13
    ds_read_b128 v[80:83], v8 offset:6144
    v_add_f32 v34, v34, v35
    v_cvt_pk_bf16_f32 v26, v32, v34
    v_smfmac_f32_16x16x64_bf16 v[40:43], v[124:127], v[88:95], v13
    s_waitcnt lgkmcnt(7)
    ds_read_b128 v[84:87], v8 offset:7168
    ds_read_b128 v[88:91], v8 offset:38912
    v_add_f32 v36, v36, v37
    v_smfmac_f32_16x16x64_bf16 v[44:47], v[120:123], v[96:103], v13
    s_waitcnt lgkmcnt(7)
    ds_read_b128 v[92:95], v8 offset:39936
    v_add_f32 v38, v38, v39
    v_cvt_pk_bf16_f32 v27, v36, v38
    v_smfmac_f32_16x16x64_bf16 v[44:47], v[124:127], v[104:111], v13
    s_waitcnt lgkmcnt(6)
    buffer_store_dwordx4 v[24:27], v11, s[4:7], s32 offen sc1
    v_add_f32 v40, v40, v41
    v_xor_b32 v8, 0x10000, v8
    v_smfmac_f32_16x16x64_bf16 v[48:51], v[120:123], v[56:63], v13
    s_waitcnt lgkmcnt(4)
    v_add_f32 v42, v42, v43
    v_cvt_pk_bf16_f32 v40, v40, v42
    v_smfmac_f32_16x16x64_bf16 v[48:51], v[124:127], v[72:79], v13
    s_waitcnt lgkmcnt(2)
    v_and_or_b32 v40, v40, -2, s38
    v_add_f32 v44, v44, v45
    v_smfmac_f32_16x16x64_bf16 v[52:55], v[120:123], v[80:87], v13
    s_waitcnt lgkmcnt(0)
    buffer_load_dword v69, v6, s[4:7], s29 offen sc1
    v_add_f32 v46, v46, v47
    v_cvt_pk_bf16_f32 v41, v44, v46
    v_smfmac_f32_16x16x64_bf16 v[52:55], v[124:127], v[88:95], v13
    v_add_f32 v48, v48, v49
    v_add_f32 v50, v50, v51
    v_cvt_pk_bf16_f32 v42, v48, v50
    buffer_load_dword v70, v6, s[4:7], s29 offen sc1
    s_nop 3
    v_add_f32 v52, v52, v53
    v_add_f32 v54, v54, v55
    v_cvt_pk_bf16_f32 v43, v52, v54
    buffer_store_dwordx4 v[40:43], v11, s[4:7], s33 offen sc1
    s_cmp_lg_u32 s17, 0
    s_cbranch_scc1 L_S1_others
    buffer_load_dword v71, v6, s[4:7], s29 offen sc1
    v_cndmask_b32 v56, 0, v14, s[48:49]
    v_cndmask_b32 v57, 0, v14, s[50:51]
    v_cndmask_b32 v58, 0, v14, s[52:53]
    v_cndmask_b32 v59, 0, v14, s[54:55]
    v_mov_b32 v120, v64
    v_mov_b32 v121, v65
    v_mov_b32 v122, v66
    v_mov_b32 v123, v67
    v_mov_b32 v60, 0
    v_mov_b32 v61, 0
    v_mov_b32 v62, 0
    v_mov_b32 v63, 0
    v_mov_b32 v64, 0
    v_mov_b32 v65, 0
    v_mov_b32 v66, 0
    v_mov_b32 v67, 0
    buffer_load_dword v72, v6, s[4:7], s29 offen sc1
    s_waitcnt vmcnt(4)
    v_cmp_gt_u32 vcc, s30, v69
    s_cbranch_vccz L_S1_go
    buffer_load_dword v69, v6, s[4:7], s29 offen sc1
    s_waitcnt vmcnt(4)
    v_cmp_gt_u32 vcc, s30, v70
    s_cbranch_vccz L_S1_go
    buffer_load_dword v70, v6, s[4:7], s29 offen sc1
L_S1_hl:
    s_waitcnt vmcnt(3)
    v_cmp_gt_u32 vcc, s30, v71
    s_cbranch_vccz L_S1_go
    buffer_load_dword v71, v6, s[4:7], s29 offen sc1
    s_add_u32 s97, s97, 1
    s_waitcnt vmcnt(3)
    v_cmp_gt_u32 vcc, s30, v72
    s_cbranch_vccz L_S1_go
    buffer_load_dword v72, v6, s[4:7], s29 offen sc1
    s_add_u32 s97, s97, 1
    s_waitcnt vmcnt(3)
    v_cmp_gt_u32 vcc, s30, v69
    s_cbranch_vccz L_S1_go
    buffer_load_dword v69, v6, s[4:7], s29 offen sc1
    s_add_u32 s97, s97, 1
    s_waitcnt vmcnt(3)
    v_cmp_gt_u32 vcc, s30, v70
    s_cbranch_vccz L_S1_go
    buffer_load_dword v70, v6, s[4:7], s29 offen sc1
    s_add_u32 s97, s97, 1
    s_add_u32 s18, s18, 1
    s_cmp_gt_u32 s18, 200000
    s_cbranch_scc0 L_S1_hl
    s_branch L_abort
.p2align 5
L_S1_go:
    buffer_load_dwordx4 v[24:27], v0, s[4:7], s34 offen offset:0 sc1
    buffer_load_dwordx4 v[28:31], v0, s[4:7], s34 offen offset:1024 sc1
    buffer_load_dwordx4 v[32:35], v0, s[4:7], s34 offen offset:2048 sc1
    buffer_load_dwordx4 v[36:39], v0, s[4:7], s34 offen offset:3072 sc1
    buffer_load_dwordx4 v[40:43], v0, s[4:7], s35 offen offset:0 sc1
    buffer_load_dwordx4 v[44:47], v0, s[4:7], s35 offen offset:1024 sc1
    buffer_load_dwordx4 v[48:51], v0, s[4:7], s35 offen offset:2048 sc1
    buffer_load_dwordx4 v[52:55], v0, s[4:7], s35 offen offset:3072 sc1
L_S1_h2:
    s_waitcnt vmcnt(7)
    v_mfma_f32_16x16x32_bf16 v[72:75], v[24:27], v[56:59], 0
    s_waitcnt vmcnt(6)
    v_xor_b32 v76, s38, v24
    v_mfma_f32_16x16x32_bf16 v[72:75], v[28:31], v[56:59], v[72:75]
    s_waitcnt vmcnt(5)
    v_bitop3_b32 v76, v76, v28, s38 bitop3:0xf6
    v_mfma_f32_16x16x32_bf16 v[72:75], v[32:35], v[56:59], v[72:75]
    s_waitcnt vmcnt(4)
    v_bitop3_b32 v76, v76, v32, s38 bitop3:0xf6
    v_mfma_f32_16x16x32_bf16 v[72:75], v[36:39], v[56:59], v[72:75]
    s_waitcnt vmcnt(3)
    v_bitop3_b32 v76, v76, v36, s38 bitop3:0xf6
    v_mfma_f32_16x16x32_bf16 v[72:75], v[40:43], v[56:59], v[72:75]
    s_waitcnt vmcnt(2)
    v_bitop3_b32 v76, v76, v40, s38 bitop3:0xf6
    v_mfma_f32_16x16x32_bf16 v[72:75], v[44:47], v[56:59], v[72:75]
    s_waitcnt vmcnt(1)
    v_bitop3_b32 v76, v76, v44, s38 bitop3:0xf6
    v_mfma_f32_16x16x32_bf16 v[72:75], v[48:51], v[56:59], v[72:75]
    s_waitcnt vmcnt(0)
    v_bitop3_b32 v76, v76, v48, s38 bitop3:0xf6
    v_mfma_f32_16x16x32_bf16 v[72:75], v[52:55], v[56:59], v[72:75]
    v_bitop3_b32 v76, v76, v52, s38 bitop3:0xf6
    v_and_b32 v76, 1, v76
    v_cmp_ne_u32 vcc, 0, v76
    v_mov_b32 v76, -1
    v_mov_b32 v77, -1
    s_nop 2
    v_cvt_pk_bf16_f32 v78, v72, v73
    v_cvt_pk_bf16_f32 v79, v74, v75
    s_cbranch_vccnz L_S1_h2r
L_S1_pubit:
    buffer_store_dwordx2 v[78:79], v12, s[4:7], s36 offen sc1
    buffer_store_dwordx2 v[76:77], v12, s[4:7], s37 offen sc1
    ds_read_b128 v[80:83], v8 offset:0
    ds_read_b128 v[84:87], v8 offset:1024
    ds_read_b128 v[88:91], v8 offset:2048
    ds_read_b128 v[92:95], v8 offset:3072
    ds_read_b128 v[96:99], v8 offset:32768
    ds_read_b128 v[100:103], v8 offset:33792
    ds_read_b128 v[104:107], v8 offset:34816
    ds_read_b128 v[108:111], v8 offset:35840
    v_mov_b32 v60, 0
    v_mov_b32 v61, 0
    v_mov_b32 v62, 0
    v_mov_b32 v63, 0
    v_mov_b32 v64, 0
    v_mov_b32 v65, 0
    v_mov_b32 v66, 0
    v_mov_b32 v67, 0
    s_waitcnt vmcnt(63)
    v_readfirstlane_b32 s44, v15
    s_nop 0
    s_lshr_b32 s19, s44, 16
    s_and_b32 s44, s44, 0xffff
    s_min_u32 s44, s44, s19
    s_add_u32 s19, s30, 2
    s_min_u32 s19, s19, 64
    s_cmp_ge_u32 s44, s19
    s_cbranch_scc0 L_S1_av0_slow
L_S1_av0_ok:
    v_mov_b32 v56, 0
    v_mov_b32 v57, 0
    v_mov_b32 v58, 0
    v_mov_b32 v59, 0
    v_mov_b32 v72, 0
    v_mov_b32 v73, 0
    v_mov_b32 v74, 0
    v_mov_b32 v75, 0
    v_mov_b32 v76, 0
    v_mov_b32 v77, 0
    v_mov_b32 v78, 0
    v_mov_b32 v79, 0
    s_branch L_S1_join
.p2align 5
L_S1_others:
    v_mov_b32 v56, 0
    v_mov_b32 v57, 0
    v_mov_b32 v58, 0
    v_mov_b32 v59, 0
    v_mov_b32 v72, 0
    v_mov_b32 v73, 0
    v_mov_b32 v74, 0
    v_mov_b32 v75, 0
    v_mov_b32 v76, 0
    v_mov_b32 v77, 0
    v_mov_b32 v78, 0
    v_mov_b32 v79, 0
    ds_read_b128 v[80:83], v8 offset:0
    ds_read_b128 v[84:87], v8 offset:1024
    ds_read_b128 v[88:91], v8 offset:2048
    ds_read_b128 v[92:95], v8 offset:3072
    ds_read_b128 v[96:99], v8 offset:32768
    ds_read_b128 v[100:103], v8 offset:33792
    ds_read_b128 v[104:107], v8 offset:34816
    ds_read_b128 v[108:111], v8 offset:35840
    v_mov_b32 v120, v64
    v_mov_b32 v121, v65
    v_mov_b32 v122, v66
    v_mov_b32 v123, v67
    v_mov_b32 v60, 0
    v_mov_b32 v61, 0
    v_mov_b32 v62, 0
    v_mov_b32 v63, 0
    v_mov_b32 v64, 0
    v_mov_b32 v65, 0
    v_mov_b32 v66, 0
    v_mov_b32 v67, 0
    s_cmp_lg_u32 s17, 1
    s_cbranch_scc1 L_S1_av2_ok
    s_waitcnt vmcnt(4)
    v_readfirstlane_b32 s44, v15
    s_nop 0
    s_lshr_b32 s19, s44, 16
    s_and_b32 s44, s44, 0xffff
    s_min_u32 s44, s44, s19
    s_add_u32 s19, s30, 2
    s_min_u32 s19, s19, 64
    s_cmp_ge_u32 s44, s19
    s_cbranch_scc0 L_S1_av2_slow
L_S1_av2_ok:
L_S1_join:
    s_barrier
    buffer_load_dwordx4 v[24:27], v1, s[4:7], s31 offen sc1
    buffer_load_dwordx4 v[28:31], v1, s[4:7], s31 offen offset:1024 sc1
    s_waitcnt vmcnt(2)
    v_mov_b32 v68, 0
    v_mov_b32 v69, 0
    v_mov_b32 v70, 0
    v_mov_b32 v71, 0
    s_waitcnt lgkmcnt(0)
    s_branch L_S0_h1
L_S0_h1retry:
    s_mov_b64 exec, vcc
    buffer_load_dwordx4 v[24:27], v1, s[4:7], s31 offen sc1
    buffer_load_dwordx4 v[28:31], v1, s[4:7], s31 offen offset:1024 sc1
    s_mov_b64 exec, -1
    s_add_u32 s18, s18, 1
    s_cmp_gt_u32 s18, 200000
    s_cbranch_scc1 L_abort
    s_add_u32 s95, s95, 1
    s_nop 2
    v_mov_b32 v56, 0
    v_mov_b32 v57, 0
    v_mov_b32 v58, 0
    v_mov_b32 v59, 0
    v_mov_b32 v60, 0
    v_mov_b32 v61, 0
    v_mov_b32 v62, 0
    v_mov_b32 v63, 0
    s_branch L_S0_h1
L_S0_h2r:
    s_mov_b64 exec, vcc
    buffer_load_dwordx4 v[24:27], v0, s[4:7], s34 offen offset:0 sc1
    buffer_load_dwordx4 v[28:31], v0, s[4:7], s34 offen offset:1024 sc1
    buffer_load_dwordx4 v[32:35], v0, s[4:7], s34 offen offset:2048 sc1
    buffer_load_dwordx4 v[36:39], v0, s[4:7], s34 offen offset:3072 sc1
    buffer_load_dwordx4 v[40:43], v0, s[4:7], s35 offen offset:0 sc1
    buffer_load_dwordx4 v[44:47], v0, s[4:7], s35 offen offset:1024 sc1
    buffer_load_dwordx4 v[48:51], v0, s[4:7], s35 offen offset:2048 sc1
    buffer_load_dwordx4 v[52:55], v0, s[4:7], s35 offen offset:3072 sc1
    s_mov_b64 exec, -1
    s_add_u32 s18, s18, 1
    s_cmp_gt_u32 s18, 200000
    s_cbranch_scc1 L_abort
    s_add_u32 s96, s96, 1
    s_branch L_S0_h2
L_S0_av0_slow:
    buffer_load_dword v15, off, s[4:7], s42 sc1
    s_add_u32 s18, s18, 1
    s_cmp_gt_u32 s18, 200000
    s_cbranch_scc1 L_abort
    s_waitcnt vmcnt(0)
    v_readfirstlane_b32 s44, v15
    s_nop 0
    s_lshr_b32 s20, s44, 16
    s_and_b32 s44, s44, 0xffff
    s_min_u32 s44, s44, s20
    s_cmp_ge_u32 s44, s19
    s_cbranch_scc0 L_S0_av0_slow
    s_branch L_S0_av0_ok
L_S0_av2_slow:
    buffer_load_dword v15, off, s[4:7], s42 sc1
    s_add_u32 s18, s18, 1
    s_cmp_gt_u32 s18, 200000
    s_cbranch_scc1 L_abort
    s_waitcnt vmcnt(0)
    v_readfirstlane_b32 s44, v15
    s_nop 0
    s_lshr_b32 s20, s44, 16
    s_and_b32 s44, s44, 0xffff
    s_min_u32 s44, s44, s20
    s_cmp_ge_u32 s44, s19
    s_cbranch_scc0 L_S0_av2_slow
    s_branch L_S0_av2_ok
L_S0_fallback:
    s_nop 7
    s_nop 3
    s_waitcnt lgkmcnt(0)
    ds_read_b64_tr_b16 v[80:81], v7 offset:0
    ds_read_b64_tr_b16 v[82:83], v7 offset:512
    ds_read_b64_tr_b16 v[84:85], v7 offset:1024
    ds_read_b64_tr_b16 v[86:87], v7 offset:1536
    ds_read_b64_tr_b16 v[88:89], v7 offset:2048
    ds_read_b64_tr_b16 v[90:91], v7 offset:2560
    ds_read_b64_tr_b16 v[92:93], v7 offset:3072
    ds_read_b64_tr_b16 v[94:95], v7 offset:3584
    ds_read_b128 v[96:99], v0 offset:8192
    s_waitcnt lgkmcnt(0)
    ds_read_b128 v[100:103], v0 offset:9216
    ds_read_b128 v[104:107], v0 offset:10240
    ds_read_b128 v[108:111], v0 offset:11264
    v_mfma_f32_16x16x32_bf16 v[72:75], v[96:99], v[80:83], 0
    s_waitcnt lgkmcnt(2)
    v_mfma_f32_16x16x32_bf16 v[72:75], v[100:103], v[84:87], v[72:75]
    s_waitcnt lgkmcnt(1)
    v_mfma_f32_16x16x32_bf16 v[72:75], v[104:107], v[88:91], v[72:75]
    s_waitcnt lgkmcnt(0)
    v_mfma_f32_16x16x32_bf16 v[72:75], v[108:111], v[92:95], v[72:75]
    s_nop 7
    ds_read_b128 v[96:99], v0 offset:12288
    s_waitcnt lgkmcnt(0)
    ds_read_b128 v[100:103], v0 offset:13312
    ds_read_b128 v[104:107], v0 offset:14336
    ds_read_b128 v[108:111], v0 offset:15360
    v_mfma_f32_16x16x32_bf16 v[76:79], v[96:99], v[80:83], 0
    s_waitcnt lgkmcnt(2)
    v_mfma_f32_16x16x32_bf16 v[76:79], v[100:103], v[84:87], v[76:79]
    s_waitcnt lgkmcnt(1)
    v_mfma_f32_16x16x32_bf16 v[76:79], v[104:107], v[88:91], v[76:79]
    s_waitcnt lgkmcnt(0)
    v_mfma_f32_16x16x32_bf16 v[76:79], v[108:111], v[92:95], v[76:79]
    s_nop 7
    ds_read_b64_tr_b16 v[96:97], v7 offset:4096
    ds_read_b64_tr_b16 v[98:99], v7 offset:4608
    ds_read_b64_tr_b16 v[100:101], v7 offset:5120
    ds_read_b64_tr_b16 v[102:103], v7 offset:5632
    ds_read_b64_tr_b16 v[104:105], v7 offset:6144
    s_waitcnt lgkmcnt(3)
    ds_read_b64_tr_b16 v[106:107], v7 offset:6656
    ds_read_b64_tr_b16 v[108:109], v7 offset:7168
    ds_read_b64_tr_b16 v[110:111], v7 offset:7680
    v_mfma_f32_16x16x32_bf16 v[68:71], v[96:99], v[80:83], 0
    s_waitcnt lgkmcnt(4)
    v_mfma_f32_16x16x32_bf16 v[68:71], v[100:103], v[84:87], v[68:71]
    s_waitcnt lgkmcnt(2)
    v_mfma_f32_16x16x32_bf16 v[68:71], v[104:107], v[88:91], v[68:71]
    s_waitcnt lgkmcnt(0)
    v_mfma_f32_16x16x32_bf16 v[68:71], v[108:111], v[92:95], v[68:71]
    s_nop 7
    v_mul_f32 v68, s45, v68
    v_mul_f32 v69, s45, v69
    v_max3_f32 v70, v68, v69, v72
    v_max3_f32 v70, v70, v73, v74
    v_max3_f32 v70, v70, v75, v76
    v_max3_f32 v70, v70, v77, v78
    v_max_f32 v70, v70, v79
    v_mov_b32 v71, v70
    s_nop 1
    v_permlane16_swap_b32 v70, v71
    v_max_f32 v70, v70, v71
    v_mov_b32 v71, v70
    s_nop 1
    v_permlane32_swap_b32 v70, v71
    v_max_f32 v70, v70, v71
    v_sub_f32 v72, v72, v70
    v_exp_f32 v72, v72
    v_sub_f32 v73, v73, v70
    v_exp_f32 v73, v73
    v_sub_f32 v74, v74, v70
    v_exp_f32 v74, v74
    v_sub_f32 v75, v75, v70
    v_exp_f32 v75, v75
    v_sub_f32 v76, v76, v70
    v_exp_f32 v76, v76
    v_sub_f32 v77, v77, v70
    v_exp_f32 v77, v77
    v_sub_f32 v78, v78, v70
    v_exp_f32 v78, v78
    v_sub_f32 v79, v79, v70
    v_exp_f32 v79, v79
    v_sub_f32 v68, v68, v70
    v_exp_f32 v68, v68
    v_sub_f32 v69, v69, v70
    v_exp_f32 v69, v69
    v_cvt_pk_bf16_f32 v56, v72, v73
    v_cvt_pk_bf16_f32 v57, v74, v75
    v_cvt_pk_bf16_f32 v58, v76, v77
    v_cvt_pk_bf16_f32 v59, v78, v79
    v_cvt_pk_bf16_f32 v20, v68, v69
    v_cvt_pk_bf16_f32 v23, v68, v69
    v_mfma_f32_16x16x32_bf16 v[32:35], v[16:19], v[56:59], 0
    v_mfma_f32_16x16x32_bf16 v[24:27], v[112:115], v[56:59], 0
    v_mfma_f32_16x16x32_bf16 v[28:31], v[116:119], v[56:59], 0
    v_mfma_f32_16x16x16_bf16 v[32:35], v[16:17], v[20:21], v[32:35]
    v_mfma_f32_16x16x16_bf16 v[24:27], v[66:67], v[20:21], v[24:27]
    v_mfma_f32_16x16x16_bf16 v[28:31], v[66:67], v[22:23], v[28:31]
    ds_read_b128 v[80:83], v8 offset:0
    ds_read_b128 v[84:87], v8 offset:1024
    ds_read_b128 v[88:91], v8 offset:32768
    ds_read_b128 v[92:95], v8 offset:33792
    ds_read_b128 v[96:99], v8 offset:2048
    ds_read_b128 v[100:103], v8 offset:3072
    ds_read_b128 v[104:107], v8 offset:34816
    ds_read_b128 v[108:111], v8 offset:35840
    v_rcp_f32 v56, v32
    s_nop 0
    v_mul_f32 v24, v24, v56
    v_mul_f32 v25, v25, v56
    v_mul_f32 v26, v26, v56
    v_mul_f32 v27, v27, v56
    v_mul_f32 v28, v28, v56
    v_mul_f32 v29, v29, v56
    v_mul_f32 v30, v30, v56
    v_mul_f32 v31, v31, v56
    v_cvt_pk_bf16_f32 v60, v24, v25
    v_cvt_pk_bf16_f32 v61, v26, v27
    v_cvt_pk_bf16_f32 v62, v28, v29
    v_cvt_pk_bf16_f32 v63, v30, v31
    ds_write_b128 v9, v[60:63]
    v_mov_b32 v24, 0
    v_mov_b32 v25, 0
    v_mov_b32 v26, 0
    v_mov_b32 v27, 0
    v_mov_b32 v28, 0
    v_mov_b32 v29, 0
    v_mov_b32 v30, 0
    v_mov_b32 v31, 0
    v_mov_b32 v32, 0
    v_mov_b32 v33, 0
    v_mov_b32 v34, 0
    v_mov_b32 v35, 0
    v_mov_b32 v36, 0
    v_mov_b32 v37, 0
    v_mov_b32 v38, 0
    v_mov_b32 v39, 0
    s_waitcnt lgkmcnt(0)
    s_nop 1
    s_branch L_S0_fbdone
L_S1_h1retry:
    s_mov_b64 exec, vcc
    buffer_load_dwordx4 v[24:27], v1, s[4:7], s31 offen sc1
    buffer_load_dwordx4 v[28:31], v1, s[4:7], s31 offen offset:1024 sc1
    s_mov_b64 exec, -1
    s_add_u32 s18, s18, 1
    s_cmp_gt_u32 s18, 200000
    s_cbranch_scc1 L_abort
    s_add_u32 s95, s95, 1
    s_nop 2
    v_mov_b32 v56, 0
    v_mov_b32 v57, 0
    v_mov_b32 v58, 0
    v_mov_b32 v59, 0
    v_mov_b32 v60, 0
    v_mov_b32 v61, 0
    v_mov_b32 v62, 0
    v_mov_b32 v63, 0
    s_branch L_S1_h1
L_S1_h2r:
    s_mov_b64 exec, vcc
    buffer_load_dwordx4 v[24:27], v0, s[4:7], s34 offen offset:0 sc1
    buffer_load_dwordx4 v[28:31], v0, s[4:7], s34 offen offset:1024 sc1
    buffer_load_dwordx4 v[32:35], v0, s[4:7], s34 offen offset:2048 sc1
    buffer_load_dwordx4 v[36:39], v0, s[4:7], s34 offen offset:3072 sc1
    buffer_load_dwordx4 v[40:43], v0, s[4:7], s35 offen offset:0 sc1
    buffer_load_dwordx4 v[44:47], v0, s[4:7], s35 offen offset:1024 sc1
    buffer_load_dwordx4 v[48:51], v0, s[4:7], s35 offen offset:2048 sc1
    buffer_load_dwordx4 v[52:55], v0, s[4:7], s35 offen offset:3072 sc1
    s_mov_b64 exec, -1
    s_add_u32 s18, s18, 1
    s_cmp_gt_u32 s18, 200000
    s_cbranch_scc1 L_abort
    s_add_u32 s96, s96, 1
    s_branch L_S1_h2
L_S1_av0_slow:
    buffer_load_dword v15, off, s[4:7], s42 sc1
    s_add_u32 s18, s18, 1
    s_cmp_gt_u32 s18, 200000
    s_cbranch_scc1 L_abort
    s_waitcnt vmcnt(0)
    v_readfirstlane_b32 s44, v15
    s_nop 0
    s_lshr_b32 s20, s44, 16
    s_and_b32 s44, s44, 0xffff
    s_min_u32 s44, s44, s20
    s_cmp_ge_u32 s44, s19
    s_cbranch_scc0 L_S1_av0_slow
    s_branch L_S1_av0_ok
L_S1_av2_slow:
    buffer_load_dword v15, off, s[4:7], s42 sc1
    s_add_u32 s18, s18, 1
    s_cmp_gt_u32 s18, 200000
    s_cbranch_scc1 L_abort
    s_waitcnt vmcnt(0)
    v_readfirstlane_b32 s44, v15
    s_nop 0
    s_lshr_b32 s20, s44, 16
    s_and_b32 s44, s44, 0xffff
    s_min_u32 s44, s44, s20
    s_cmp_ge_u32 s44, s19
    s_cbranch_scc0 L_S1_av2_slow
    s_branch L_S1_av2_ok
L_S1_fallback:
    s_nop 7
    s_nop 3
    s_waitcnt lgkmcnt(0)
    ds_read_b64_tr_b16 v[80:81], v7 offset:0
    ds_read_b64_tr_b16 v[82:83], v7 offset:512
    ds_read_b64_tr_b16 v[84:85], v7 offset:1024
    ds_read_b64_tr_b16 v[86:87], v7 offset:1536
    ds_read_b64_tr_b16 v[88:89], v7 offset:2048
    ds_read_b64_tr_b16 v[90:91], v7 offset:2560
    ds_read_b64_tr_b16 v[92:93], v7 offset:3072
    ds_read_b64_tr_b16 v[94:95], v7 offset:3584
    ds_read_b128 v[96:99], v0 offset:16384
    s_waitcnt lgkmcnt(0)
    ds_read_b128 v[100:103], v0 offset:17408
    ds_read_b128 v[104:107], v0 offset:18432
    ds_read_b128 v[108:111], v0 offset:19456
    v_mfma_f32_16x16x32_bf16 v[72:75], v[96:99], v[80:83], 0
    s_waitcnt lgkmcnt(2)
    v_mfma_f32_16x16x32_bf16 v[72:75], v[100:103], v[84:87], v[72:75]
    s_waitcnt lgkmcnt(1)
    v_mfma_f32_16x16x32_bf16 v[72:75], v[104:107], v[88:91], v[72:75]
    s_waitcnt lgkmcnt(0)
    v_mfma_f32_16x16x32_bf16 v[72:75], v[108:111], v[92:95], v[72:75]
    s_nop 7
    ds_read_b128 v[96:99], v0 offset:20480
    s_waitcnt lgkmcnt(0)
    ds_read_b128 v[100:103], v0 offset:21504
    ds_read_b128 v[104:107], v0 offset:22528
    ds_read_b128 v[108:111], v0 offset:23552
    v_mfma_f32_16x16x32_bf16 v[76:79], v[96:99], v[80:83], 0
    s_waitcnt lgkmcnt(2)
    v_mfma_f32_16x16x32_bf16 v[76:79], v[100:103], v[84:87], v[76:79]
    s_waitcnt lgkmcnt(1)
    v_mfma_f32_16x16x32_bf16 v[76:79], v[104:107], v[88:91], v[76:79]
    s_waitcnt lgkmcnt(0)
    v_mfma_f32_16x16x32_bf16 v[76:79], v[108:111], v[92:95], v[76:79]
    s_nop 7
    ds_read_b64_tr_b16 v[96:97], v7 offset:4096
    ds_read_b64_tr_b16 v[98:99], v7 offset:4608
    ds_read_b64_tr_b16 v[100:101], v7 offset:5120
    ds_read_b64_tr_b16 v[102:103], v7 offset:5632
    ds_read_b64_tr_b16 v[104:105], v7 offset:6144
    s_waitcnt lgkmcnt(3)
    ds_read_b64_tr_b16 v[106:107], v7 offset:6656
    ds_read_b64_tr_b16 v[108:109], v7 offset:7168
    ds_read_b64_tr_b16 v[110:111], v7 offset:7680
    v_mfma_f32_16x16x32_bf16 v[68:71], v[96:99], v[80:83], 0
    s_waitcnt lgkmcnt(4)
    v_mfma_f32_16x16x32_bf16 v[68:71], v[100:103], v[84:87], v[68:71]
    s_waitcnt lgkmcnt(2)
    v_mfma_f32_16x16x32_bf16 v[68:71], v[104:107], v[88:91], v[68:71]
    s_waitcnt lgkmcnt(0)
    v_mfma_f32_16x16x32_bf16 v[68:71], v[108:111], v[92:95], v[68:71]
    s_nop 7
    v_mul_f32 v68, s45, v68
    v_mul_f32 v69, s45, v69
    v_max3_f32 v70, v68, v69, v72
    v_max3_f32 v70, v70, v73, v74
    v_max3_f32 v70, v70, v75, v76
    v_max3_f32 v70, v70, v77, v78
    v_max_f32 v70, v70, v79
    v_mov_b32 v71, v70
    s_nop 1
    v_permlane16_swap_b32 v70, v71
    v_max_f32 v70, v70, v71
    v_mov_b32 v71, v70
    s_nop 1
    v_permlane32_swap_b32 v70, v71
    v_max_f32 v70, v70, v71
    v_sub_f32 v72, v72, v70
    v_exp_f32 v72, v72
    v_sub_f32 v73, v73, v70
    v_exp_f32 v73, v73
    v_sub_f32 v74, v74, v70
    v_exp_f32 v74, v74
    v_sub_f32 v75, v75, v70
    v_exp_f32 v75, v75
    v_sub_f32 v76, v76, v70
    v_exp_f32 v76, v76
    v_sub_f32 v77, v77, v70
    v_exp_f32 v77, v77
    v_sub_f32 v78, v78, v70
    v_exp_f32 v78, v78
    v_sub_f32 v79, v79, v70
    v_exp_f32 v79, v79
    v_sub_f32 v68, v68, v70
    v_exp_f32 v68, v68
    v_sub_f32 v69, v69, v70
    v_exp_f32 v69, v69
    v_cvt_pk_bf16_f32 v56, v72, v73
    v_cvt_pk_bf16_f32 v57, v74, v75
    v_cvt_pk_bf16_f32 v58, v76, v77
    v_cvt_pk_bf16_f32 v59, v78, v79
    v_cvt_pk_bf16_f32 v20, v68, v69
    v_cvt_pk_bf16_f32 v23, v68, v69
    v_mfma_f32_16x16x32_bf16 v[32:35], v[16:19], v[56:59], 0
    v_mfma_f32_16x16x32_bf16 v[24:27], v[120:123], v[56:59], 0
    v_mfma_f32_16x16x32_bf16 v[28:31], v[124:127], v[56:59], 0
    v_mfma_f32_16x16x16_bf16 v[32:35], v[16:17], v[20:21], v[32:35]
    v_mfma_f32_16x16x16_bf16 v[24:27], v[66:67], v[20:21], v[24:27]
    v_mfma_f32_16x16x16_bf16 v[28:31], v[66:67], v[22:23], v[28:31]
    ds_read_b128 v[80:83], v8 offset:0
    ds_read_b128 v[84:87], v8 offset:1024
    ds_read_b128 v[88:91], v8 offset:32768
    ds_read_b128 v[92:95], v8 offset:33792
    ds_read_b128 v[96:99], v8 offset:2048
    ds_read_b128 v[100:103], v8 offset:3072
    ds_read_b128 v[104:107], v8 offset:34816
    ds_read_b128 v[108:111], v8 offset:35840
    v_rcp_f32 v56, v32
    s_nop 0
    v_mul_f32 v24, v24, v56
    v_mul_f32 v25, v25, v56
    v_mul_f32 v26, v26, v56
    v_mul_f32 v27, v27, v56
    v_mul_f32 v28, v28, v56
    v_mul_f32 v29, v29, v56
    v_mul_f32 v30, v30, v56
    v_mul_f32 v31, v31, v56
    v_cvt_pk_bf16_f32 v60, v24, v25
    v_cvt_pk_bf16_f32 v61, v26, v27
    v_cvt_pk_bf16_f32 v62, v28, v29
    v_cvt_pk_bf16_f32 v63, v30, v31
    ds_write_b128 v9, v[60:63]
    v_mov_b32 v24, 0
    v_mov_b32 v25, 0
    v_mov_b32 v26, 0
    v_mov_b32 v27, 0
    v_mov_b32 v28, 0
    v_mov_b32 v29, 0
    v_mov_b32 v30, 0
    v_mov_b32 v31, 0
    v_mov_b32 v32, 0
    v_mov_b32 v33, 0
    v_mov_b32 v34, 0
    v_mov_b32 v35, 0
    v_mov_b32 v36, 0
    v_mov_b32 v37, 0
    v_mov_b32 v38, 0
    v_mov_b32 v39, 0
    s_waitcnt lgkmcnt(0)
    s_nop 1
    s_branch L_S1_fbdone
L_ch_av_slow:
    buffer_load_dword v15, off, s[4:7], s42 sc1
    s_add_u32 s18, s18, 1
    s_cmp_gt_u32 s18, 200000
    s_cbranch_scc1 L_abort
    s_waitcnt vmcnt(0)
    v_readfirstlane_b32 s44, v15
    s_nop 0
    s_lshr_b32 s20, s44, 16
    s_and_b32 s44, s44, 0xffff
    s_min_u32 s44, s44, s20
    s_cmp_ge_u32 s44, s19
    s_cbranch_scc0 L_ch_av_slow
    s_branch L_ch_av_ok
L_last:
    buffer_load_dwordx4 v[24:27], v1, s[4:7], s31 offen sc1
    buffer_load_dwordx4 v[28:31], v1, s[4:7], s31 offen offset:1024 sc1
    s_waitcnt vmcnt(2)
    v_mov_b32 v68, 0
    v_mov_b32 v69, 0
    v_mov_b32 v70, 0
    v_mov_b32 v71, 0
L_last_h1:
    s_waitcnt vmcnt(0) lgkmcnt(0)
    ds_write_b128 v1, v[24:27]
    v_max3_u32 v23, v25, v27, v29
    v_max_u32 v23, v23, v31
    v_cmp_eq_u32 vcc, -1, v23
    ds_write_b128 v1, v[28:31] offset:1024
    s_cbranch_vccz L_last_ok
    s_mov_b64 exec, vcc
    buffer_load_dwordx4 v[24:27], v1, s[4:7], s31 offen sc1
    buffer_load_dwordx4 v[28:31], v1, s[4:7], s31 offen offset:1024 sc1
    s_mov_b64 exec, -1
    s_add_u32 s18, s18, 1
    s_cmp_gt_u32 s18, 200000
    s_cbranch_scc0 L_last_h1
    s_branch L_abort
L_last_ok:
    v_smfmac_f32_16x16x64_bf16 v[72:75], v[24:27], v[80:87], v13
    v_smfmac_f32_16x16x64_bf16 v[76:79], v[24:27], v[88:95], v13
    v_mov_b32 v20, 62
    v_smfmac_f32_16x16x64_bf16 v[72:75], v[28:31], v[96:103], v13
    v_smfmac_f32_16x16x64_bf16 v[76:79], v[28:31], v[104:111], v13
    s_waitcnt lgkmcnt(0)
    s_barrier
    ds_read_b128 v[32:35], v2 offset:0
    v_smfmac_f32_16x16x64_bf16 v[64:67], v[24:27], a[128:135], v13
    ds_read_b128 v[36:39], v2 offset:1024
    buffer_store_dword v20, v10, s[4:7], s43 offen sc1
    v_smfmac_f32_16x16x64_bf16 v[68:71], v[24:27], a[136:143], v13
    ds_read_b128 v[40:43], v3 offset:0
    v_smfmac_f32_16x16x64_bf16 v[64:67], v[28:31], a[144:151], v13
    ds_read_b128 v[44:47], v3 offset:1024
    v_smfmac_f32_16x16x64_bf16 v[68:71], v[28:31], a[152:159], v13
    s_waitcnt lgkmcnt(3)
    ds_read_b128 v[48:51], v4 offset:0
    v_smfmac_f32_16x16x64_bf16 v[64:67], v[32:35], a[160:167], v13
    ds_read_b128 v[52:55], v4 offset:1024
    v_smfmac_f32_16x16x64_bf16 v[68:71], v[32:35], a[168:175], v13
    s_waitcnt lgkmcnt(4)
    buffer_store_dwordx4 v[112:115], v0, s[4:7], s41 offen sc1
    v_smfmac_f32_16x16x64_bf16 v[64:67], v[36:39], a[176:183], v13
    s_add_u32 s41, s41, 131072
    ds_read_b128 v[80:83], v8 offset:4096
    v_smfmac_f32_16x16x64_bf16 v[68:71], v[36:39], a[184:191], v13
    s_waitcnt lgkmcnt(4)
    ds_read_b128 v[84:87], v8 offset:5120
    v_smfmac_f32_16x16x64_bf16 v[64:67], v[40:43], a[192:199], v13
    ds_read_b128 v[88:91], v8 offset:6144
    v_smfmac_f32_16x16x64_bf16 v[68:71], v[40:43], a[200:207], v13
    s_waitcnt lgkmcnt(5)
    ds_read_b128 v[92:95], v8 offset:7168
    v_smfmac_f32_16x16x64_bf16 v[64:67], v[44:47], a[208:215], v13
    ds_read_b128 v[96:99], v8 offset:36864
    v_smfmac_f32_16x16x64_bf16 v[68:71], v[44:47], a[216:223], v13
    s_waitcnt lgkmcnt(6)
    ds_read_b128 v[100:103], v8 offset:37888
    v_smfmac_f32_16x16x64_bf16 v[64:67], v[48:51], a[224:231], v13
    ds_read_b128 v[104:107], v8 offset:38912
    v_smfmac_f32_16x16x64_bf16 v[68:71], v[48:51], a[232:239], v13
    s_waitcnt lgkmcnt(7)
    ds_read_b128 v[108:111], v8 offset:39936
    v_smfmac_f32_16x16x64_bf16 v[64:67], v[52:55], a[240:247], v13
    v_smfmac_f32_16x16x64_bf16 v[68:71], v[52:55], a[248:255], v13
    v_smfmac_f32_16x16x64_bf16 v[72:75], v[40:43], v[128:135], v13
    v_smfmac_f32_16x16x64_bf16 v[76:79], v[40:43], v[136:143], v13
    v_smfmac_f32_16x16x64_bf16 v[72:75], v[44:47], v[144:151], v13
    v_add_f32 v64, v64, v65
    v_smfmac_f32_16x16x64_bf16 v[76:79], v[44:47], v[152:159], v13
    v_add_f32 v66, v66, v67
    v_smfmac_f32_16x16x64_bf16 v[72:75], v[48:51], v[160:167], v13
    v_cvt_pk_bf16_f32 v64, v64, v66
    v_smfmac_f32_16x16x64_bf16 v[76:79], v[48:51], v[168:175], v13
    v_add_f32 v68, v68, v69
    v_smfmac_f32_16x16x64_bf16 v[72:75], v[52:55], v[176:183], v13
    v_add_f32 v70, v70, v71
    v_smfmac_f32_16x16x64_bf16 v[76:79], v[52:55], v[184:191], v13
    s_waitcnt lgkmcnt(6)
    v_cvt_pk_bf16_f32 v65, v68, v70
    v_smfmac_f32_16x16x64_bf16 v[72:75], v[32:35], v[80:87], v13
    s_waitcnt lgkmcnt(4)
    v_smfmac_f32_16x16x64_bf16 v[76:79], v[32:35], v[88:95], v13
    s_waitcnt lgkmcnt(2)
    v_smfmac_f32_16x16x64_bf16 v[72:75], v[36:39], v[96:103], v13
    s_waitcnt lgkmcnt(0)
    v_smfmac_f32_16x16x64_bf16 v[76:79], v[36:39], v[104:111], v13
    s_nop 3
    v_add_f32 v72, v72, v73
    v_add_f32 v74, v74, v75
    v_cvt_pk_bf16_f32 v66, v72, v74
    s_nop 0
    v_add_f32 v76, v76, v77
    v_add_f32 v78, v78, v79
    v_cvt_pk_bf16_f32 v67, v76, v78
    buffer_store_dwordx4 v[64:67], v0, s[4:7], s41 offen sc1
    s_nop 1
    s_endpgm
L_chain_end:
L_role_mix:
    s_load_dwordx2 s[24:25], s[0:1], 112
    s_waitcnt lgkmcnt(0)
    s_mov_b32 s4, s24
    s_and_b32 s5, s25, 0xffff
    s_mov_b32 s6, 0x10000000
    s_mov_b32 s7, 0x20000
    s_load_dwordx2 s[24:25], s[0:1], 104
    s_waitcnt lgkmcnt(0)
    s_mov_b32 s12, s24
    s_and_b32 s13, s25, 0xffff
    s_mov_b32 s14, 0x100
    s_mov_b32 s15, 0x20000
    s_mul_i32 s16, s16, 3
    s_add_u32 s16, s16, s27
    s_sub_u32 s16, s16, 5
    s_lshr_b32 s19, s16, 5
    s_and_b32 s16, s16, 31
    s_cmp_eq_u32 s19, 1
    s_cbranch_scc1 L_role_pv
    s_cmp_eq_u32 s19, 2
    s_cbranch_scc1 L_role_fg
    v_and_b32 v127, 63, v0
    v_lshrrev_b32 v126, 6, v0
    s_nop 0
    v_readfirstlane_b32 s17, v126
    v_lshlrev_b32 v0, 4, v127
    v_bfe_u32 v1, v127, 4, 2
    v_and_b32 v126, 15, v127
    v_xor_b32 v1, v1, v126
    v_lshlrev_b32 v1, 4, v1
    v_lshl_add_u32 v1, v126, 10, v1
    v_bfe_u32 v2, v127, 4, 2
    v_add_u32 v2, 4, v2
    v_and_b32 v126, 15, v127
    v_xor_b32 v2, v2, v126
    v_lshlrev_b32 v2, 4, v2
    v_lshl_add_u32 v2, v126, 10, v2
    v_bfe_u32 v3, v127, 4, 2
    v_add_u32 v3, 8, v3
    v_and_b32 v126, 15, v127
    v_xor_b32 v3, v3, v126
    v_lshlrev_b32 v3, 4, v3
    v_lshl_add_u32 v3, v126, 10, v3
    v_bfe_u32 v4, v127, 4, 2
    v_add_u32 v4, 12, v4
    v_and_b32 v126, 15, v127
    v_xor_b32 v4, v4, v126
    v_lshlrev_b32 v4, 4, v4
    v_lshl_add_u32 v4, v126, 10, v4
    s_and_b32 s19, s17, 1
    s_lshl_b32 s19, s19, 7
    v_xor_b32 v5, s19, v0
    s_lshl_b32 s19, s17, 10
    v_add_u32 v8, s19, v0
    s_load_dwordx2 s[24:25], s[0:1], 0
    s_waitcnt lgkmcnt(0)
    s_mov_b32 s32, s24
    s_and_b32 s33, s25, 0xffff
    s_mov_b32 s34, 0x200000
    s_mov_b32 s35, 0x20000
    s_lshl_b32 s40, s16, 7
    s_add_u32 s40, s40, 0
    v_mov_b32 v6, 0
    buffer_store_short v6, off, s[4:7], s40 sc1
    s_load_dwordx2 s[24:25], s[0:1], 24
    s_waitcnt lgkmcnt(0)
    s_mov_b32 s68, s24
    s_and_b32 s69, s25, 0xffff
    s_mov_b32 s70, 0x400000
    s_mov_b32 s71, 0x20000
    s_mov_b32 s30, 0
    v_bfe_u32 v123, v127, 5, 1
    v_lshlrev_b32 v123, 15, v123
    v_bfe_u32 v126, v127, 4, 1
    v_lshlrev_b32 v126, 16, v126
    v_add_u32 v123, v123, v126
    v_bfe_u32 v126, v127, 3, 1
    v_lshlrev_b32 v126, 14, v126
    v_add_u32 v123, v123, v126
    v_bfe_u32 v126, v127, 2, 1
    v_lshlrev_b32 v126, 13, v126
    v_add_u32 v123, v123, v126
    v_bfe_u32 v126, v127, 0, 1
    v_lshlrev_b32 v126, 4, v126
    v_add_u32 v123, v123, v126
    v_lshrrev_b32 v126, 3, v127
    v_xor_b32 v126, v126, v127
    v_and_b32 v126, 2, v126
    v_lshl_add_u32 v123, v126, 4, v123
    v_bfe_u32 v125, v127, 5, 1
    v_lshlrev_b32 v125, 10, v125
    v_bfe_u32 v126, v127, 4, 1
    v_mul_u32_u24 v126, 288, v126
    v_add_u32 v125, v125, v126
    v_bfe_u32 v126, v127, 3, 1
    v_lshlrev_b32 v126, 7, v126
    v_add_u32 v125, v125, v126
    v_bfe_u32 v126, v127, 2, 1
    v_lshlrev_b32 v126, 6, v126
    v_add_u32 v125, v125, v126
    v_bfe_u32 v126, v127, 0, 2
    v_lshlrev_b32 v126, 3, v126
    v_add_u32 v125, v125, v126
    s_lshl_b32 s22, s17, 15
    v_add_u32 v125, s22, v125
    v_xor_b32 v124, 32, v125
    s_add_u32 m0, s22, 0
    s_lshl_b32 s19, s16, 8
    s_lshl_b32 s20, s17, 6
    s_add_u32 s19, s19, s20
    buffer_load_dwordx4 v123, s[68:71], s19 offen offset:0  lds
    s_add_u32 s19, s19, 130048
    buffer_load_dwordx4 v123, s[68:71], s19 offen offset:1024  lds
    s_add_u32 s19, s19, 130048
    buffer_load_dwordx4 v123, s[68:71], s19 offen offset:2048  lds
    s_add_u32 s19, s19, 130048
    buffer_load_dwordx4 v123, s[68:71], s19 offen offset:3072  lds
    s_add_u32 m0, s22, 4096
    s_lshl_b32 s19, s16, 8
    s_lshl_b32 s20, s17, 6
    s_add_u32 s19, s19, s20
    s_add_u32 s19, s19, 524288
    buffer_load_dwordx4 v123, s[68:71], s19 offen offset:0  lds
    s_add_u32 s19, s19, 130048
    buffer_load_dwordx4 v123, s[68:71], s19 offen offset:1024  lds
    s_add_u32 s19, s19, 130048
    buffer_load_dwordx4 v123, s[68:71], s19 offen offset:2048  lds
    s_add_u32 s19, s19, 130048
    buffer_load_dwordx4 v123, s[68:71], s19 offen offset:3072  lds
    s_add_u32 m0, s22, 8192
    s_lshl_b32 s19, s16, 8
    s_lshl_b32 s20, s17, 6
    s_add_u32 s19, s19, s20
    s_add_u32 s19, s19, 1048576
    buffer_load_dwordx4 v123, s[68:71], s19 offen offset:0  lds
    s_add_u32 s19, s19, 130048
    buffer_load_dwordx4 v123, s[68:71], s19 offen offset:1024  lds
    s_add_u32 s19, s19, 130048
    buffer_load_dwordx4 v123, s[68:71], s19 offen offset:2048  lds
    s_add_u32 s19, s19, 130048
    buffer_load_dwordx4 v123, s[68:71], s19 offen offset:3072  lds
    s_add_u32 m0, s22, 12288
    s_lshl_b32 s19, s16, 8
    s_lshl_b32 s20, s17, 6
    s_add_u32 s19, s19, s20
    s_add_u32 s19, s19, 1572864
    buffer_load_dwordx4 v123, s[68:71], s19 offen offset:0  lds
    s_add_u32 s19, s19, 130048
    buffer_load_dwordx4 v123, s[68:71], s19 offen offset:1024  lds
    s_add_u32 s19, s19, 130048
    buffer_load_dwordx4 v123, s[68:71], s19 offen offset:2048  lds
    s_add_u32 s19, s19, 130048
    buffer_load_dwordx4 v123, s[68:71], s19 offen offset:3072  lds
    s_add_u32 m0, s22, 16384
    s_lshl_b32 s19, s16, 8
    s_lshl_b32 s20, s17, 6
    s_add_u32 s19, s19, s20
    s_add_u32 s19, s19, 2097152
    buffer_load_dwordx4 v123, s[68:71], s19 offen offset:0  lds
    s_add_u32 s19, s19, 130048
    buffer_load_dwordx4 v123, s[68:71], s19 offen offset:1024  lds
    s_add_u32 s19, s19, 130048
    buffer_load_dwordx4 v123, s[68:71], s19 offen offset:2048  lds
    s_add_u32 s19, s19, 130048
    buffer_load_dwordx4 v123, s[68:71], s19 offen offset:3072  lds
    s_add_u32 m0, s22, 20480
    s_lshl_b32 s19, s16, 8
    s_lshl_b32 s20, s17, 6
    s_add_u32 s19, s19, s20
    s_add_u32 s19, s19, 2621440
    buffer_load_dwordx4 v123, s[68:71], s19 offen offset:0  lds
    s_add_u32 s19, s19, 130048
    buffer_load_dwordx4 v123, s[68:71], s19 offen offset:1024  lds
    s_add_u32 s19, s19, 130048
    buffer_load_dwordx4 v123, s[68:71], s19 offen offset:2048  lds
    s_add_u32 s19, s19, 130048
    buffer_load_dwordx4 v123, s[68:71], s19 offen offset:3072  lds
    s_add_u32 m0, s22, 24576
    s_lshl_b32 s19, s16, 8
    s_lshl_b32 s20, s17, 6
    s_add_u32 s19, s19, s20
    s_add_u32 s19, s19, 3145728
    buffer_load_dwordx4 v123, s[68:71], s19 offen offset:0  lds
    s_add_u32 s19, s19, 130048
    buffer_load_dwordx4 v123, s[68:71], s19 offen offset:1024  lds
    s_add_u32 s19, s19, 130048
    buffer_load_dwordx4 v123, s[68:71], s19 offen offset:2048  lds
    s_add_u32 s19, s19, 130048
    buffer_load_dwordx4 v123, s[68:71], s19 offen offset:3072  lds
    s_add_u32 m0, s22, 28672
    s_lshl_b32 s19, s16, 8
    s_lshl_b32 s20, s17, 6
    s_add_u32 s19, s19, s20
    s_add_u32 s19, s19, 3670016
    buffer_load_dwordx4 v123, s[68:71], s19 offen offset:0  lds
    s_add_u32 s19, s19, 130048
    buffer_load_dwordx4 v123, s[68:71], s19 offen offset:1024  lds
    s_add_u32 s19, s19, 130048
    buffer_load_dwordx4 v123, s[68:71], s19 offen offset:2048  lds
    s_add_u32 s19, s19, 130048
    buffer_load_dwordx4 v123, s[68:71], s19 offen offset:3072  lds
    s_waitcnt vmcnt(28)
    s_barrier
    s_cmp_lg_u32 s17, 0
    s_cbranch_scc1 L_pk_noreg
    s_mul_i32 s19, s28, s28
    s_lshl_b32 s19, s19, 18
    s_lshl_b32 s20, s28, 9
    s_add_u32 s19, s19, s20
    s_add_u32 s19, s19, 1
    s_lshl_b32 s20, s27, 2
    s_mov_b64 exec, 1
    v_mov_b32 v7, s19
    buffer_atomic_add v7, off, s[12:15], s20
    s_mov_b64 exec, -1
L_pk_noreg:
    ds_read_b64_tr_b16 v[128:129], v125 offset:0
    ds_read_b64_tr_b16 v[130:131], v125 offset:512
    ds_read_b64_tr_b16 v[132:133], v125 offset:2048
    ds_read_b64_tr_b16 v[134:135], v125 offset:2560
    ds_read_b64_tr_b16 v[192:193], v124 offset:0
    ds_read_b64_tr_b16 v[194:195], v124 offset:512
    ds_read_b64_tr_b16 v[196:197], v124 offset:2048
    ds_read_b64_tr_b16 v[198:199], v124 offset:2560
    s_waitcnt lgkmcnt(0)
    s_waitcnt vmcnt(24)
    ds_read_b64_tr_b16 v[136:137], v125 offset:4096
    ds_read_b64_tr_b16 v[138:139], v125 offset:4608
    ds_read_b64_tr_b16 v[140:141], v125 offset:6144
    ds_read_b64_tr_b16 v[142:143], v125 offset:6656
    ds_read_b64_tr_b16 v[200:201], v124 offset:4096
    ds_read_b64_tr_b16 v[202:203], v124 offset:4608
    ds_read_b64_tr_b16 v[204:205], v124 offset:6144
    ds_read_b64_tr_b16 v[206:207], v124 offset:6656
    s_waitcnt lgkmcnt(0)
    s_waitcnt vmcnt(20)
    ds_read_b64_tr_b16 v[144:145], v125 offset:8192
    ds_read_b64_tr_b16 v[146:147], v125 offset:8704
    ds_read_b64_tr_b16 v[148:149], v125 offset:10240
    ds_read_b64_tr_b16 v[150:151], v125 offset:10752
    ds_read_b64_tr_b16 v[208:209], v124 offset:8192
    ds_read_b64_tr_b16 v[210:211], v124 offset:8704
    ds_read_b64_tr_b16 v[212:213], v124 offset:10240
    ds_read_b64_tr_b16 v[214:215], v124 offset:10752
    s_waitcnt lgkmcnt(0)
    s_waitcnt vmcnt(16)
    ds_read_b64_tr_b16 v[152:153], v125 offset:12288
    ds_read_b64_tr_b16 v[154:155], v125 offset:12800
    ds_read_b64_tr_b16 v[156:157], v125 offset:14336
    ds_read_b64_tr_b16 v[158:159], v125 offset:14848
    ds_read_b64_tr_b16 v[216:217], v124 offset:12288
    ds_read_b64_tr_b16 v[218:219], v124 offset:12800
    ds_read_b64_tr_b16 v[220:221], v124 offset:14336
    ds_read_b64_tr_b16 v[222:223], v124 offset:14848
    s_waitcnt lgkmcnt(0)
    s_waitcnt vmcnt(12)
    ds_read_b64_tr_b16 v[160:161], v125 offset:16384
    ds_read_b64_tr_b16 v[162:163], v125 offset:16896
    ds_read_b64_tr_b16 v[164:165], v125 offset:18432
    ds_read_b64_tr_b16 v[166:167], v125 offset:18944
    ds_read_b64_tr_b16 v[224:225], v124 offset:16384
    ds_read_b64_tr_b16 v[226:227], v124 offset:16896
    ds_read_b64_tr_b16 v[228:229], v124 offset:18432
    ds_read_b64_tr_b16 v[230:231], v124 offset:18944
    s_waitcnt lgkmcnt(0)
    s_waitcnt vmcnt(8)
    ds_read_b64_tr_b16 v[168:169], v125 offset:20480
    ds_read_b64_tr_b16 v[170:171], v125 offset:20992
    ds_read_b64_tr_b16 v[172:173], v125 offset:22528
    ds_read_b64_tr_b16 v[174:175], v125 offset:23040
    ds_read_b64_tr_b16 v[232:233], v124 offset:20480
    ds_read_b64_tr_b16 v[234:235], v124 offset:20992
    ds_read_b64_tr_b16 v[236:237], v124 offset:22528
    ds_read_b64_tr_b16 v[238:239], v124 offset:23040
    s_waitcnt lgkmcnt(0)
    s_waitcnt vmcnt(4)
    ds_read_b64_tr_b16 v[176:177], v125 offset:24576
    ds_read_b64_tr_b16 v[178:179], v125 offset:25088
    ds_read_b64_tr_b16 v[180:181], v125 offset:26624
    ds_read_b64_tr_b16 v[182:183], v125 offset:27136
    ds_read_b64_tr_b16 v[240:241], v124 offset:24576
    ds_read_b64_tr_b16 v[242:243], v124 offset:25088
    ds_read_b64_tr_b16 v[244:245], v124 offset:26624
    ds_read_b64_tr_b16 v[246:247], v124 offset:27136
    s_waitcnt lgkmcnt(0)
    s_waitcnt vmcnt(0)
    ds_read_b64_tr_b16 v[184:185], v125 offset:28672
    ds_read_b64_tr_b16 v[186:187], v125 offset:29184
    ds_read_b64_tr_b16 v[188:189], v125 offset:30720
    ds_read_b64_tr_b16 v[190:191], v125 offset:31232
    ds_read_b64_tr_b16 v[248:249], v124 offset:28672
    ds_read_b64_tr_b16 v[250:251], v124 offset:29184
    ds_read_b64_tr_b16 v[252:253], v124 offset:30720
    ds_read_b64_tr_b16 v[254:255], v124 offset:31232
    s_waitcnt lgkmcnt(0)
    s_barrier
    s_lshl_b32 s31, s30, 15
    s_lshl_b32 s36, s17, 13
    s_add_u32 s31, s31, s36
    s_add_u32 m0, s36, 0
    v_xor_b32 v6, 0, v5
    buffer_load_dwordx4 v6, s[32:35], s31 offen offset:0 lds
    v_xor_b32 v7, 16, v5
    buffer_load_dwordx4 v7, s[32:35], s31 offen offset:1024 lds
    v_xor_b32 v6, 32, v5
    buffer_load_dwordx4 v6, s[32:35], s31 offen offset:2048 lds
    v_xor_b32 v7, 48, v5
    buffer_load_dwordx4 v7, s[32:35], s31 offen offset:3072 lds
    s_add_u32 m0, s36, 4096
    s_add_u32 s31, s31, 4096
    v_xor_b32 v6, 64, v5
    buffer_load_dwordx4 v6, s[32:35], s31 offen offset:0 lds
    v_xor_b32 v7, 80, v5
    buffer_load_dwordx4 v7, s[32:35], s31 offen offset:1024 lds
    v_xor_b32 v6, 96, v5
    buffer_load_dwordx4 v6, s[32:35], s31 offen offset:2048 lds
    v_xor_b32 v7, 112, v5
    buffer_load_dwordx4 v7, s[32:35], s31 offen offset:3072 lds
    s_mov_b32 s44, 0x3e0293ee
    s_lshl_b32 s19, s16, 13
    s_add_u32 s41, s19, 16777216
    s_waitcnt vmcnt(0)
L_pk_loop:
    s_waitcnt vmcnt(2)
    s_barrier
    s_add_u32 s21, s30, 1
    s_min_u32 s21, s21, 63
    ds_read_b128 v[16:19], v1 offset:0
    s_waitcnt lgkmcnt(0)
    ds_read_b128 v[20:23], v1 offset:16384
    v_mfma_f32_16x16x32_bf16 v[32:35], v[128:131], v[16:19], 0
    s_waitcnt lgkmcnt(0)
    ds_read_b128 v[24:27], v2 offset:0
    v_mfma_f32_16x16x32_bf16 v[40:43], v[128:131], v[20:23], 0
    ds_read_b128 v[28:31], v2 offset:16384
    v_mfma_f32_16x16x32_bf16 v[36:39], v[192:195], v[16:19], 0
    s_lshl_b32 s31, s21, 15
    s_lshl_b32 s36, s17, 13
    s_add_u32 s31, s31, s36
    s_add_u32 s36, s36, 32768
    v_mfma_f32_16x16x32_bf16 v[44:47], v[192:195], v[20:23], 0
    s_waitcnt lgkmcnt(1)
    v_mfma_f32_16x16x32_bf16 v[32:35], v[132:135], v[24:27], v[32:35]
    s_waitcnt lgkmcnt(0)
    ds_read_b128 v[16:19], v3 offset:0
    v_mfma_f32_16x16x32_bf16 v[40:43], v[132:135], v[28:31], v[40:43]
    ds_read_b128 v[20:23], v3 offset:16384
    v_mfma_f32_16x16x32_bf16 v[36:39], v[196:199], v[24:27], v[36:39]
    s_add_u32 m0, s36, 0
    v_xor_b32 v6, 0, v5
    buffer_load_dwordx4 v6, s[32:35], s31 offen offset:0 lds
    v_mfma_f32_16x16x32_bf16 v[44:47], v[196:199], v[28:31], v[44:47]
    s_waitcnt lgkmcnt(1)
    v_mfma_f32_16x16x32_bf16 v[32:35], v[136:139], v[16:19], v[32:35]
    s_waitcnt lgkmcnt(0)
    ds_read_b128 v[24:27], v4 offset:0
    v_mfma_f32_16x16x32_bf16 v[40:43], v[136:139], v[20:23], v[40:43]
    ds_read_b128 v[28:31], v4 offset:16384
    v_mfma_f32_16x16x32_bf16 v[36:39], v[200:203], v[16:19], v[36:39]
    v_xor_b32 v7, 16, v5
    buffer_load_dwordx4 v7, s[32:35], s31 offen offset:1024 lds
    v_mfma_f32_16x16x32_bf16 v[44:47], v[200:203], v[20:23], v[44:47]
    s_waitcnt lgkmcnt(1)
    v_mfma_f32_16x16x32_bf16 v[32:35], v[140:143], v[24:27], v[32:35]
    s_waitcnt lgkmcnt(0)
    ds_read_b128 v[16:19], v1 offset:256
    v_mfma_f32_16x16x32_bf16 v[40:43], v[140:143], v[28:31], v[40:43]
    ds_read_b128 v[20:23], v1 offset:16640
    v_mfma_f32_16x16x32_bf16 v[36:39], v[204:207], v[24:27], v[36:39]
    v_xor_b32 v6, 32, v5
    buffer_load_dwordx4 v6, s[32:35], s31 offen offset:2048 lds
    v_mfma_f32_16x16x32_bf16 v[44:47], v[204:207], v[28:31], v[44:47]
    s_waitcnt lgkmcnt(1)
    v_mfma_f32_16x16x32_bf16 v[32:35], v[144:147], v[16:19], v[32:35]
    s_waitcnt lgkmcnt(0)
    ds_read_b128 v[24:27], v2 offset:256
    v_mfma_f32_16x16x32_bf16 v[40:43], v[144:147], v[20:23], v[40:43]
    ds_read_b128 v[28:31], v2 offset:16640
    v_mfma_f32_16x16x32_bf16 v[36:39], v[208:211], v[16:19], v[36:39]
    v_xor_b32 v7, 48, v5
    buffer_load_dwordx4 v7, s[32:35], s31 offen offset:3072 lds
    v_mfma_f32_16x16x32_bf16 v[44:47], v[208:211], v[20:23], v[44:47]
    s_waitcnt lgkmcnt(1)
    v_mfma_f32_16x16x32_bf16 v[32:35], v[148:151], v[24:27], v[32:35]
    s_waitcnt lgkmcnt(0)
    ds_read_b128 v[16:19], v3 offset:256
    v_mfma_f32_16x16x32_bf16 v[40:43], v[148:151], v[28:31], v[40:43]
    ds_read_b128 v[20:23], v3 offset:16640
    v_mfma_f32_16x16x32_bf16 v[36:39], v[212:215], v[24:27], v[36:39]
    s_add_u32 m0, s36, 4096
    s_add_u32 s31, s31, 4096
    v_xor_b32 v6, 64, v5
    buffer_load_dwordx4 v6, s[32:35], s31 offen offset:0 lds
    v_mfma_f32_16x16x32_bf16 v[44:47], v[212:215], v[28:31], v[44:47]
    s_waitcnt lgkmcnt(1)
    v_mfma_f32_16x16x32_bf16 v[32:35], v[152:155], v[16:19], v[32:35]
    s_waitcnt lgkmcnt(0)
    ds_read_b128 v[24:27], v4 offset:256
    v_mfma_f32_16x16x32_bf16 v[40:43], v[152:155], v[20:23], v[40:43]
    ds_read_b128 v[28:31], v4 offset:16640
    v_mfma_f32_16x16x32_bf16 v[36:39], v[216:219], v[16:19], v[36:39]
    v_xor_b32 v7, 80, v5
    buffer_load_dwordx4 v7, s[32:35], s31 offen offset:1024 lds
    v_mfma_f32_16x16x32_bf16 v[44:47], v[216:219], v[20:23], v[44:47]
    s_waitcnt lgkmcnt(1)
    v_mfma_f32_16x16x32_bf16 v[32:35], v[156:159], v[24:27], v[32:35]
    s_waitcnt lgkmcnt(0)
    ds_read_b128 v[16:19], v1 offset:512
    v_mfma_f32_16x16x32_bf16 v[40:43], v[156:159], v[28:31], v[40:43]
    ds_read_b128 v[20:23], v1 offset:16896
    v_mfma_f32_16x16x32_bf16 v[36:39], v[220:223], v[24:27], v[36:39]
    v_xor_b32 v6, 96, v5
    buffer_load_dwordx4 v6, s[32:35], s31 offen offset:2048 lds
    v_mfma_f32_16x16x32_bf16 v[44:47], v[220:223], v[28:31], v[44:47]
    s_waitcnt lgkmcnt(1)
    v_mfma_f32_16x16x32_bf16 v[32:35], v[160:163], v[16:19], v[32:35]
    s_waitcnt lgkmcnt(0)
    ds_read_b128 v[24:27], v2 offset:512
    v_mfma_f32_16x16x32_bf16 v[40:43], v[160:163], v[20:23], v[40:43]
    ds_read_b128 v[28:31], v2 offset:16896
    v_mfma_f32_16x16x32_bf16 v[36:39], v[224:227], v[16:19], v[36:39]
    v_xor_b32 v7, 112, v5
    buffer_load_dwordx4 v7, s[32:35], s31 offen offset:3072 lds
    v_mfma_f32_16x16x32_bf16 v[44:47], v[224:227], v[20:23], v[44:47]
    s_waitcnt lgkmcnt(1)
    v_mfma_f32_16x16x32_bf16 v[32:35], v[164:167], v[24:27], v[32:35]
    s_waitcnt lgkmcnt(0)
    ds_read_b128 v[16:19], v3 offset:512
    v_mfma_f32_16x16x32_bf16 v[40:43], v[164:167], v[28:31], v[40:43]
    ds_read_b128 v[20:23], v3 offset:16896
    v_mfma_f32_16x16x32_bf16 v[36:39], v[228:231], v[24:27], v[36:39]
    v_mfma_f32_16x16x32_bf16 v[44:47], v[228:231], v[28:31], v[44:47]
    s_waitcnt lgkmcnt(1)
    v_mfma_f32_16x16x32_bf16 v[32:35], v[168:171], v[16:19], v[32:35]
    s_waitcnt lgkmcnt(0)
    ds_read_b128 v[24:27], v4 offset:512
    v_mfma_f32_16x16x32_bf16 v[40:43], v[168:171], v[20:23], v[40:43]
    ds_read_b128 v[28:31], v4 offset:16896
    v_mfma_f32_16x16x32_bf16 v[36:39], v[232:235], v[16:19], v[36:39]
    v_mfma_f32_16x16x32_bf16 v[44:47], v[232:235], v[20:23], v[44:47]
    s_waitcnt lgkmcnt(1)
    v_mfma_f32_16x16x32_bf16 v[32:35], v[172:175], v[24:27], v[32:35]
    s_waitcnt lgkmcnt(0)
    ds_read_b128 v[16:19], v1 offset:768
    v_mfma_f32_16x16x32_bf16 v[40:43], v[172:175], v[28:31], v[40:43]
    ds_read_b128 v[20:23], v1 offset:17152
    v_mfma_f32_16x16x32_bf16 v[36:39], v[236:239], v[24:27], v[36:39]
    v_mfma_f32_16x16x32_bf16 v[44:47], v[236:239], v[28:31], v[44:47]
    s_waitcnt lgkmcnt(1)
    v_mfma_f32_16x16x32_bf16 v[32:35], v[176:179], v[16:19], v[32:35]
    s_waitcnt lgkmcnt(0)
    ds_read_b128 v[24:27], v2 offset:768
    v_mfma_f32_16x16x32_bf16 v[40:43], v[176:179], v[20:23], v[40:43]
    ds_read_b128 v[28:31], v2 offset:17152
    v_mfma_f32_16x16x32_bf16 v[36:39], v[240:243], v[16:19], v[36:39]
    v_mfma_f32_16x16x32_bf16 v[44:47], v[240:243], v[20:23], v[44:47]
    s_waitcnt lgkmcnt(1)
    v_mfma_f32_16x16x32_bf16 v[32:35], v[180:183], v[24:27], v[32:35]
    s_waitcnt lgkmcnt(0)
    ds_read_b128 v[16:19], v3 offset:768
    v_mfma_f32_16x16x32_bf16 v[40:43], v[180:183], v[28:31], v[40:43]
    ds_read_b128 v[20:23], v3 offset:17152
    v_mfma_f32_16x16x32_bf16 v[36:39], v[244:247], v[24:27], v[36:39]
    v_mfma_f32_16x16x32_bf16 v[44:47], v[244:247], v[28:31], v[44:47]
    s_waitcnt lgkmcnt(1)
    v_mfma_f32_16x16x32_bf16 v[32:35], v[184:187], v[16:19], v[32:35]
    s_waitcnt lgkmcnt(0)
    ds_read_b128 v[24:27], v4 offset:768
    v_mfma_f32_16x16x32_bf16 v[40:43], v[184:187], v[20:23], v[40:43]
    ds_read_b128 v[28:31], v4 offset:17152
    v_mfma_f32_16x16x32_bf16 v[36:39], v[248:251], v[16:19], v[36:39]
    v_mfma_f32_16x16x32_bf16 v[44:47], v[248:251], v[20:23], v[44:47]
    s_waitcnt lgkmcnt(1)
    v_mfma_f32_16x16x32_bf16 v[32:35], v[188:191], v[24:27], v[32:35]
    s_waitcnt lgkmcnt(0)
    v_mfma_f32_16x16x32_bf16 v[40:43], v[188:191], v[28:31], v[40:43]
    v_mfma_f32_16x16x32_bf16 v[36:39], v[252:255], v[24:27], v[36:39]
    v_mfma_f32_16x16x32_bf16 v[44:47], v[252:255], v[28:31], v[44:47]
    s_waitcnt vmcnt(8)
    s_barrier
    s_cmp_lg_u32 s17, 0
    s_cbranch_scc1 L_pk_nf0
    s_mov_b64 exec, 1
    v_mov_b32 v6, s30
    buffer_store_short v6, off, s[4:7], s40 sc1
    s_mov_b64 exec, -1
L_pk_nf0:
    v_mul_f32 v32, s44, v32
    v_mul_f32 v33, s44, v33
    v_mul_f32 v34, s44, v34
    v_mul_f32 v35, s44, v35
    v_mul_f32 v36, s44, v36
    v_mul_f32 v37, s44, v37
    v_mul_f32 v38, s44, v38
    v_mul_f32 v39, s44, v39
    v_cvt_pk_bf16_f32 v32, v32, v33
    v_cvt_pk_bf16_f32 v33, v34, v35
    v_cvt_pk_bf16_f32 v34, v36, v37
    v_cvt_pk_bf16_f32 v35, v38, v39
    buffer_store_dwordx4 v[32:35], v8, s[4:7], s41 offen sc1
    v_mul_f32 v40, s44, v40
    v_mul_f32 v41, s44, v41
    v_mul_f32 v42, s44, v42
    v_mul_f32 v43, s44, v43
    v_mul_f32 v44, s44, v44
    v_mul_f32 v45, s44, v45
    v_mul_f32 v46, s44, v46
    v_mul_f32 v47, s44, v47
    v_cvt_pk_bf16_f32 v40, v40, v41
    v_cvt_pk_bf16_f32 v41, v42, v43
    v_cvt_pk_bf16_f32 v42, v44, v45
    v_cvt_pk_bf16_f32 v43, v46, v47
    s_add_u32 s19, s41, 4096
    buffer_store_dwordx4 v[40:43], v8, s[4:7], s19 offen sc1
    s_add_u32 s41, s41, 262144
    s_add_u32 s30, s30, 1
    s_waitcnt vmcnt(2)
    s_barrier
    s_add_u32 s21, s30, 1
    s_min_u32 s21, s21, 63
    ds_read_b128 v[16:19], v1 offset:32768
    s_waitcnt lgkmcnt(0)
    ds_read_b128 v[20:23], v1 offset:49152
    v_mfma_f32_16x16x32_bf16 v[32:35], v[128:131], v[16:19], 0
    s_waitcnt lgkmcnt(0)
    ds_read_b128 v[24:27], v2 offset:32768
    v_mfma_f32_16x16x32_bf16 v[40:43], v[128:131], v[20:23], 0
    ds_read_b128 v[28:31], v2 offset:49152
    v_mfma_f32_16x16x32_bf16 v[36:39], v[192:195], v[16:19], 0
    s_lshl_b32 s31, s21, 15
    s_lshl_b32 s36, s17, 13
    s_add_u32 s31, s31, s36
    v_mfma_f32_16x16x32_bf16 v[44:47], v[192:195], v[20:23], 0
    s_waitcnt lgkmcnt(1)
    v_mfma_f32_16x16x32_bf16 v[32:35], v[132:135], v[24:27], v[32:35]
    s_waitcnt lgkmcnt(0)
    ds_read_b128 v[16:19], v3 offset:32768
    v_mfma_f32_16x16x32_bf16 v[40:43], v[132:135], v[28:31], v[40:43]
    ds_read_b128 v[20:23], v3 offset:49152
    v_mfma_f32_16x16x32_bf16 v[36:39], v[196:199], v[24:27], v[36:39]
    s_add_u32 m0, s36, 0
    v_xor_b32 v6, 0, v5
    buffer_load_dwordx4 v6, s[32:35], s31 offen offset:0 lds
    v_mfma_f32_16x16x32_bf16 v[44:47], v[196:199], v[28:31], v[44:47]
    s_waitcnt lgkmcnt(1)
    v_mfma_f32_16x16x32_bf16 v[32:35], v[136:139], v[16:19], v[32:35]
    s_waitcnt lgkmcnt(0)
    ds_read_b128 v[24:27], v4 offset:32768
    v_mfma_f32_16x16x32_bf16 v[40:43], v[136:139], v[20:23], v[40:43]
    ds_read_b128 v[28:31], v4 offset:49152
    v_mfma_f32_16x16x32_bf16 v[36:39], v[200:203], v[16:19], v[36:39]
    v_xor_b32 v7, 16, v5
    buffer_load_dwordx4 v7, s[32:35], s31 offen offset:1024 lds
    v_mfma_f32_16x16x32_bf16 v[44:47], v[200:203], v[20:23], v[44:47]
    s_waitcnt lgkmcnt(1)
    v_mfma_f32_16x16x32_bf16 v[32:35], v[140:143], v[24:27], v[32:35]
    s_waitcnt lgkmcnt(0)
    ds_read_b128 v[16:19], v1 offset:33024
    v_mfma_f32_16x16x32_bf16 v[40:43], v[140:143], v[28:31], v[40:43]
    ds_read_b128 v[20:23], v1 offset:49408
    v_mfma_f32_16x16x32_bf16 v[36:39], v[204:207], v[24:27], v[36:39]
    v_xor_b32 v6, 32, v5
    buffer_load_dwordx4 v6, s[32:35], s31 offen offset:2048 lds
    v_mfma_f32_16x16x32_bf16 v[44:47], v[204:207], v[28:31], v[44:47]
    s_waitcnt lgkmcnt(1)
    v_mfma_f32_16x16x32_bf16 v[32:35], v[144:147], v[16:19], v[32:35]
    s_waitcnt lgkmcnt(0)
    ds_read_b128 v[24:27], v2 offset:33024
    v_mfma_f32_16x16x32_bf16 v[40:43], v[144:147], v[20:23], v[40:43]
    ds_read_b128 v[28:31], v2 offset:49408
    v_mfma_f32_16x16x32_bf16 v[36:39], v[208:211], v[16:19], v[36:39]
    v_xor_b32 v7, 48, v5
    buffer_load_dwordx4 v7, s[32:35], s31 offen offset:3072 lds
    v_mfma_f32_16x16x32_bf16 v[44:47], v[208:211], v[20:23], v[44:47]
    s_waitcnt lgkmcnt(1)
    v_mfma_f32_16x16x32_bf16 v[32:35], v[148:151], v[24:27], v[32:35]
    s_waitcnt lgkmcnt(0)
    ds_read_b128 v[16:19], v3 offset:33024
    v_mfma_f32_16x16x32_bf16 v[40:43], v[148:151], v[28:31], v[40:43]
    ds_read_b128 v[20:23], v3 offset:49408
    v_mfma_f32_16x16x32_bf16 v[36:39], v[212:215], v[24:27], v[36:39]
    s_add_u32 m0, s36, 4096
    s_add_u32 s31, s31, 4096
    v_xor_b32 v6, 64, v5
    buffer_load_dwordx4 v6, s[32:35], s31 offen offset:0 lds
    v_mfma_f32_16x16x32_bf16 v[44:47], v[212:215], v[28:31], v[44:47]
    s_waitcnt lgkmcnt(1)
    v_mfma_f32_16x16x32_bf16 v[32:35], v[152:155], v[16:19], v[32:35]
    s_waitcnt lgkmcnt(0)
    ds_read_b128 v[24:27], v4 offset:33024
    v_mfma_f32_16x16x32_bf16 v[40:43], v[152:155], v[20:23], v[40:43]
    ds_read_b128 v[28:31], v4 offset:49408
    v_mfma_f32_16x16x32_bf16 v[36:39], v[216:219], v[16:19], v[36:39]
    v_xor_b32 v7, 80, v5
    buffer_load_dwordx4 v7, s[32:35], s31 offen offset:1024 lds
    v_mfma_f32_16x16x32_bf16 v[44:47], v[216:219], v[20:23], v[44:47]
    s_waitcnt lgkmcnt(1)
    v_mfma_f32_16x16x32_bf16 v[32:35], v[156:159], v[24:27], v[32:35]
    s_waitcnt lgkmcnt(0)
    ds_read_b128 v[16:19], v1 offset:33280
    v_mfma_f32_16x16x32_bf16 v[40:43], v[156:159], v[28:31], v[40:43]
    ds_read_b128 v[20:23], v1 offset:49664
    v_mfma_f32_16x16x32_bf16 v[36:39], v[220:223], v[24:27], v[36:39]
    v_xor_b32 v6, 96, v5
    buffer_load_dwordx4 v6, s[32:35], s31 offen offset:2048 lds
    v_mfma_f32_16x16x32_bf16 v[44:47], v[220:223], v[28:31], v[44:47]
    s_waitcnt lgkmcnt(1)
    v_mfma_f32_16x16x32_bf16 v[32:35], v[160:163], v[16:19], v[32:35]
    s_waitcnt lgkmcnt(0)
    ds_read_b128 v[24:27], v2 offset:33280
    v_mfma_f32_16x16x32_bf16 v[40:43], v[160:163], v[20:23], v[40:43]
    ds_read_b128 v[28:31], v2 offset:49664
    v_mfma_f32_16x16x32_bf16 v[36:39], v[224:227], v[16:19], v[36:39]
    v_xor_b32 v7, 112, v5
    buffer_load_dwordx4 v7, s[32:35], s31 offen offset:3072 lds
    v_mfma_f32_16x16x32_bf16 v[44:47], v[224:227], v[20:23], v[44:47]
    s_waitcnt lgkmcnt(1)
    v_mfma_f32_16x16x32_bf16 v[32:35], v[164:167], v[24:27], v[32:35]
    s_waitcnt lgkmcnt(0)
    ds_read_b128 v[16:19], v3 offset:33280
    v_mfma_f32_16x16x32_bf16 v[40:43], v[164:167], v[28:31], v[40:43]
    ds_read_b128 v[20:23], v3 offset:49664
    v_mfma_f32_16x16x32_bf16 v[36:39], v[228:231], v[24:27], v[36:39]
    v_mfma_f32_16x16x32_bf16 v[44:47], v[228:231], v[28:31], v[44:47]
    s_waitcnt lgkmcnt(1)
    v_mfma_f32_16x16x32_bf16 v[32:35], v[168:171], v[16:19], v[32:35]
    s_waitcnt lgkmcnt(0)
    ds_read_b128 v[24:27], v4 offset:33280
    v_mfma_f32_16x16x32_bf16 v[40:43], v[168:171], v[20:23], v[40:43]
    ds_read_b128 v[28:31], v4 offset:49664
    v_mfma_f32_16x16x32_bf16 v[36:39], v[232:235], v[16:19], v[36:39]
    v_mfma_f32_16x16x32_bf16 v[44:47], v[232:235], v[20:23], v[44:47]
    s_waitcnt lgkmcnt(1)
    v_mfma_f32_16x16x32_bf16 v[32:35], v[172:175], v[24:27], v[32:35]
    s_waitcnt lgkmcnt(0)
    ds_read_b128 v[16:19], v1 offset:33536
    v_mfma_f32_16x16x32_bf16 v[40:43], v[172:175], v[28:31], v[40:43]
    ds_read_b128 v[20:23], v1 offset:49920
    v_mfma_f32_16x16x32_bf16 v[36:39], v[236:239], v[24:27], v[36:39]
    v_mfma_f32_16x16x32_bf16 v[44:47], v[236:239], v[28:31], v[44:47]
    s_waitcnt lgkmcnt(1)
    v_mfma_f32_16x16x32_bf16 v[32:35], v[176:179], v[16:19], v[32:35]
    s_waitcnt lgkmcnt(0)
    ds_read_b128 v[24:27], v2 offset:33536
    v_mfma_f32_16x16x32_bf16 v[40:43], v[176:179], v[20:23], v[40:43]
    ds_read_b128 v[28:31], v2 offset:49920
    v_mfma_f32_16x16x32_bf16 v[36:39], v[240:243], v[16:19], v[36:39]
    v_mfma_f32_16x16x32_bf16 v[44:47], v[240:243], v[20:23], v[44:47]
    s_waitcnt lgkmcnt(1)
    v_mfma_f32_16x16x32_bf16 v[32:35], v[180:183], v[24:27], v[32:35]
    s_waitcnt lgkmcnt(0)
    ds_read_b128 v[16:19], v3 offset:33536
    v_mfma_f32_16x16x32_bf16 v[40:43], v[180:183], v[28:31], v[40:43]
    ds_read_b128 v[20:23], v3 offset:49920
    v_mfma_f32_16x16x32_bf16 v[36:39], v[244:247], v[24:27], v[36:39]
    v_mfma_f32_16x16x32_bf16 v[44:47], v[244:247], v[28:31], v[44:47]
    s_waitcnt lgkmcnt(1)
    v_mfma_f32_16x16x32_bf16 v[32:35], v[184:187], v[16:19], v[32:35]
    s_waitcnt lgkmcnt(0)
    ds_read_b128 v[24:27], v4 offset:33536
    v_mfma_f32_16x16x32_bf16 v[40:43], v[184:187], v[20:23], v[40:43]
    ds_read_b128 v[28:31], v4 offset:49920
    v_mfma_f32_16x16x32_bf16 v[36:39], v[248:251], v[16:19], v[36:39]
    v_mfma_f32_16x16x32_bf16 v[44:47], v[248:251], v[20:23], v[44:47]
    s_waitcnt lgkmcnt(1)
    v_mfma_f32_16x16x32_bf16 v[32:35], v[188:191], v[24:27], v[32:35]
    s_waitcnt lgkmcnt(0)
    v_mfma_f32_16x16x32_bf16 v[40:43], v[188:191], v[28:31], v[40:43]
    v_mfma_f32_16x16x32_bf16 v[36:39], v[252:255], v[24:27], v[36:39]
    v_mfma_f32_16x16x32_bf16 v[44:47], v[252:255], v[28:31], v[44:47]
    s_waitcnt vmcnt(8)
    s_barrier
    s_cmp_lg_u32 s17, 0
    s_cbranch_scc1 L_pk_nf1
    s_mov_b64 exec, 1
    v_mov_b32 v6, s30
    buffer_store_short v6, off, s[4:7], s40 sc1
    s_mov_b64 exec, -1
L_pk_nf1:
    v_mul_f32 v32, s44, v32
    v_mul_f32 v33, s44, v33
    v_mul_f32 v34, s44, v34
    v_mul_f32 v35, s44, v35
    v_mul_f32 v36, s44, v36
    v_mul_f32 v37, s44, v37
    v_mul_f32 v38, s44, v38
    v_mul_f32 v39, s44, v39
    v_cvt_pk_bf16_f32 v32, v32, v33
    v_cvt_pk_bf16_f32 v33, v34, v35
    v_cvt_pk_bf16_f32 v34, v36, v37
    v_cvt_pk_bf16_f32 v35, v38, v39
    buffer_store_dwordx4 v[32:35], v8, s[4:7], s41 offen sc1
    v_mul_f32 v40, s44, v40
    v_mul_f32 v41, s44, v41
    v_mul_f32 v42, s44, v42
    v_mul_f32 v43, s44, v43
    v_mul_f32 v44, s44, v44
    v_mul_f32 v45, s44, v45
    v_mul_f32 v46, s44, v46
    v_mul_f32 v47, s44, v47
    v_cvt_pk_bf16_f32 v40, v40, v41
    v_cvt_pk_bf16_f32 v41, v42, v43
    v_cvt_pk_bf16_f32 v42, v44, v45
    v_cvt_pk_bf16_f32 v43, v46, v47
    s_add_u32 s19, s41, 4096
    buffer_store_dwordx4 v[40:43], v8, s[4:7], s19 offen sc1
    s_add_u32 s41, s41, 262144
    s_add_u32 s30, s30, 1
    s_cmp_lt_u32 s30, 64
    s_cbranch_scc1 L_pk_loop
    s_waitcnt vmcnt(0)
    s_barrier
    s_cmp_lg_u32 s17, 0
    s_cbranch_scc1 L_pk_nfe
    s_mov_b64 exec, 1
    v_mov_b32 v6, s30
    buffer_store_short v6, off, s[4:7], s40 sc1
    s_mov_b64 exec, -1
L_pk_nfe:
    s_branch L_done
L_role_pv:
    v_and_b32 v127, 63, v0
    v_lshrrev_b32 v126, 6, v0
    s_nop 0
    v_readfirstlane_b32 s17, v126
    v_lshlrev_b32 v0, 4, v127
    v_bfe_u32 v1, v127, 4, 2
    v_and_b32 v126, 15, v127
    v_xor_b32 v1, v1, v126
    v_lshlrev_b32 v1, 4, v1
    v_lshl_add_u32 v1, v126, 10, v1
    v_bfe_u32 v2, v127, 4, 2
    v_add_u32 v2, 4, v2
    v_and_b32 v126, 15, v127
    v_xor_b32 v2, v2, v126
    v_lshlrev_b32 v2, 4, v2
    v_lshl_add_u32 v2, v126, 10, v2
    v_bfe_u32 v3, v127, 4, 2
    v_add_u32 v3, 8, v3
    v_and_b32 v126, 15, v127
    v_xor_b32 v3, v3, v126
    v_lshlrev_b32 v3, 4, v3
    v_lshl_add_u32 v3, v126, 10, v3
    v_bfe_u32 v4, v127, 4, 2
    v_add_u32 v4, 12, v4
    v_and_b32 v126, 15, v127
    v_xor_b32 v4, v4, v126
    v_lshlrev_b32 v4, 4, v4
    v_lshl_add_u32 v4, v126, 10, v4
    s_and_b32 s19, s17, 1
    s_lshl_b32 s19, s19, 7
    v_xor_b32 v5, s19, v0
    s_lshl_b32 s19, s17, 10
    v_add_u32 v8, s19, v0
    s_load_dwordx2 s[24:25], s[0:1], 0
    s_waitcnt lgkmcnt(0)
    s_mov_b32 s32, s24
    s_and_b32 s33, s25, 0xffff
    s_mov_b32 s34, 0x200000
    s_mov_b32 s35, 0x20000
    s_lshl_b32 s40, s16, 7
    s_add_u32 s40, s40, 2
    v_mov_b32 v6, 0
    buffer_store_short v6, off, s[4:7], s40 sc1
    s_load_dwordx2 s[24:25], s[0:1], 32
    s_waitcnt lgkmcnt(0)
    s_mov_b32 s68, s24
    s_and_b32 s69, s25, 0xffff
    s_mov_b32 s70, 0x400000
    s_mov_b32 s71, 0x20000
    s_mov_b32 s30, 0
    v_bfe_u32 v123, v127, 5, 1
    v_lshlrev_b32 v123, 15, v123
    v_bfe_u32 v126, v127, 4, 1
    v_lshlrev_b32 v126, 16, v126
    v_add_u32 v123, v123, v126
    v_bfe_u32 v126, v127, 3, 1
    v_lshlrev_b32 v126, 14, v126
    v_add_u32 v123, v123, v126
    v_bfe_u32 v126, v127, 2, 1
    v_lshlrev_b32 v126, 13, v126
    v_add_u32 v123, v123, v126
    v_bfe_u32 v126, v127, 0, 1
    v_lshlrev_b32 v126, 4, v126
    v_add_u32 v123, v123, v126
    v_lshrrev_b32 v126, 3, v127
    v_xor_b32 v126, v126, v127
    v_and_b32 v126, 2, v126
    v_lshl_add_u32 v123, v126, 4, v123
    v_bfe_u32 v125, v127, 5, 1
    v_lshlrev_b32 v125, 10, v125
    v_bfe_u32 v126, v127, 4, 1
    v_mul_u32_u24 v126, 288, v126
    v_add_u32 v125, v125, v126
    v_bfe_u32 v126, v127, 3, 1
    v_lshlrev_b32 v126, 7, v126
    v_add_u32 v125, v125, v126
    v_bfe_u32 v126, v127, 2, 1
    v_lshlrev_b32 v126, 6, v126
    v_add_u32 v125, v125, v126
    v_bfe_u32 v126, v127, 0, 2
    v_lshlrev_b32 v126, 3, v126
    v_add_u32 v125, v125, v126
    s_lshl_b32 s22, s17, 15
    v_add_u32 v125, s22, v125
    v_xor_b32 v124, 32, v125
    s_add_u32 m0, s22, 0
    s_lshl_b32 s19, s16, 8
    s_lshl_b32 s20, s17, 6
    s_add_u32 s19, s19, s20
    buffer_load_dwordx4 v123, s[68:71], s19 offen offset:0  lds
    s_add_u32 s19, s19, 130048
    buffer_load_dwordx4 v123, s[68:71], s19 offen offset:1024  lds
    s_add_u32 s19, s19, 130048
    buffer_load_dwordx4 v123, s[68:71], s19 offen offset:2048  lds
    s_add_u32 s19, s19, 130048
    buffer_load_dwordx4 v123, s[68:71], s19 offen offset:3072  lds
    s_add_u32 m0, s22, 4096
    s_lshl_b32 s19, s16, 8
    s_lshl_b32 s20, s17, 6
    s_add_u32 s19, s19, s20
    s_add_u32 s19, s19, 524288
    buffer_load_dwordx4 v123, s[68:71], s19 offen offset:0  lds
    s_add_u32 s19, s19, 130048
    buffer_load_dwordx4 v123, s[68:71], s19 offen offset:1024  lds
    s_add_u32 s19, s19, 130048
    buffer_load_dwordx4 v123, s[68:71], s19 offen offset:2048  lds
    s_add_u32 s19, s19, 130048
    buffer_load_dwordx4 v123, s[68:71], s19 offen offset:3072  lds
    s_add_u32 m0, s22, 8192
    s_lshl_b32 s19, s16, 8
    s_lshl_b32 s20, s17, 6
    s_add_u32 s19, s19, s20
    s_add_u32 s19, s19, 1048576
    buffer_load_dwordx4 v123, s[68:71], s19 offen offset:0  lds
    s_add_u32 s19, s19, 130048
    buffer_load_dwordx4 v123, s[68:71], s19 offen offset:1024  lds
    s_add_u32 s19, s19, 130048
    buffer_load_dwordx4 v123, s[68:71], s19 offen offset:2048  lds
    s_add_u32 s19, s19, 130048
    buffer_load_dwordx4 v123, s[68:71], s19 offen offset:3072  lds
    s_add_u32 m0, s22, 12288
    s_lshl_b32 s19, s16, 8
    s_lshl_b32 s20, s17, 6
    s_add_u32 s19, s19, s20
    s_add_u32 s19, s19, 1572864
    buffer_load_dwordx4 v123, s[68:71], s19 offen offset:0  lds
    s_add_u32 s19, s19, 130048
    buffer_load_dwordx4 v123, s[68:71], s19 offen offset:1024  lds
    s_add_u32 s19, s19, 130048
    buffer_load_dwordx4 v123, s[68:71], s19 offen offset:2048  lds
    s_add_u32 s19, s19, 130048
    buffer_load_dwordx4 v123, s[68:71], s19 offen offset:3072  lds
    s_add_u32 m0, s22, 16384
    s_lshl_b32 s19, s16, 8
    s_lshl_b32 s20, s17, 6
    s_add_u32 s19, s19, s20
    s_add_u32 s19, s19, 2097152
    buffer_load_dwordx4 v123, s[68:71], s19 offen offset:0  lds
    s_add_u32 s19, s19, 130048
    buffer_load_dwordx4 v123, s[68:71], s19 offen offset:1024  lds
    s_add_u32 s19, s19, 130048
    buffer_load_dwordx4 v123, s[68:71], s19 offen offset:2048  lds
    s_add_u32 s19, s19, 130048
    buffer_load_dwordx4 v123, s[68:71], s19 offen offset:3072  lds
    s_add_u32 m0, s22, 20480
    s_lshl_b32 s19, s16, 8
    s_lshl_b32 s20, s17, 6
    s_add_u32 s19, s19, s20
    s_add_u32 s19, s19, 2621440
    buffer_load_dwordx4 v123, s[68:71], s19 offen offset:0  lds
    s_add_u32 s19, s19, 130048
    buffer_load_dwordx4 v123, s[68:71], s19 offen offset:1024  lds
    s_add_u32 s19, s19, 130048
    buffer_load_dwordx4 v123, s[68:71], s19 offen offset:2048  lds
    s_add_u32 s19, s19, 130048
    buffer_load_dwordx4 v123, s[68:71], s19 offen offset:3072  lds
    s_add_u32 m0, s22, 24576
    s_lshl_b32 s19, s16, 8
    s_lshl_b32 s20, s17, 6
    s_add_u32 s19, s19, s20
    s_add_u32 s19, s19, 3145728
    buffer_load_dwordx4 v123, s[68:71], s19 offen offset:0  lds
    s_add_u32 s19, s19, 130048
    buffer_load_dwordx4 v123, s[68:71], s19 offen offset:1024  lds
    s_add_u32 s19, s19, 130048
    buffer_load_dwordx4 v123, s[68:71], s19 offen offset:2048  lds
    s_add_u32 s19, s19, 130048
    buffer_load_dwordx4 v123, s[68:71], s19 offen offset:3072  lds
    s_add_u32 m0, s22, 28672
    s_lshl_b32 s19, s16, 8
    s_lshl_b32 s20, s17, 6
    s_add_u32 s19, s19, s20
    s_add_u32 s19, s19, 3670016
    buffer_load_dwordx4 v123, s[68:71], s19 offen offset:0  lds
    s_add_u32 s19, s19, 130048
    buffer_load_dwordx4 v123, s[68:71], s19 offen offset:1024  lds
    s_add_u32 s19, s19, 130048
    buffer_load_dwordx4 v123, s[68:71], s19 offen offset:2048  lds
    s_add_u32 s19, s19, 130048
    buffer_load_dwordx4 v123, s[68:71], s19 offen offset:3072  lds
    s_waitcnt vmcnt(28)
    s_barrier
    s_cmp_lg_u32 s17, 0
    s_cbranch_scc1 L_pv_noreg
    s_mul_i32 s19, s28, s28
    s_lshl_b32 s19, s19, 18
    s_lshl_b32 s20, s28, 9
    s_add_u32 s19, s19, s20
    s_add_u32 s19, s19, 1
    s_lshl_b32 s20, s27, 2
    s_mov_b64 exec, 1
    v_mov_b32 v7, s19
    buffer_atomic_add v7, off, s[12:15], s20
    s_mov_b64 exec, -1
L_pv_noreg:
    ds_read_b64_tr_b16 v[128:129], v125 offset:0
    ds_read_b64_tr_b16 v[130:131], v125 offset:512
    ds_read_b64_tr_b16 v[132:133], v125 offset:2048
    ds_read_b64_tr_b16 v[134:135], v125 offset:2560
    ds_read_b64_tr_b16 v[192:193], v124 offset:0
    ds_read_b64_tr_b16 v[194:195], v124 offset:512
    ds_read_b64_tr_b16 v[196:197], v124 offset:2048
    ds_read_b64_tr_b16 v[198:199], v124 offset:2560
    s_waitcnt lgkmcnt(0)
    s_waitcnt vmcnt(24)
    ds_read_b64_tr_b16 v[136:137], v125 offset:4096
    ds_read_b64_tr_b16 v[138:139], v125 offset:4608
    ds_read_b64_tr_b16 v[140:141], v125 offset:6144
    ds_read_b64_tr_b16 v[142:143], v125 offset:6656
    ds_read_b64_tr_b16 v[200:201], v124 offset:4096
    ds_read_b64_tr_b16 v[202:203], v124 offset:4608
    ds_read_b64_tr_b16 v[204:205], v124 offset:6144
    ds_read_b64_tr_b16 v[206:207], v124 offset:6656
    s_waitcnt lgkmcnt(0)
    s_waitcnt vmcnt(20)
    ds_read_b64_tr_b16 v[144:145], v125 offset:8192
    ds_read_b64_tr_b16 v[146:147], v125 offset:8704
    ds_read_b64_tr_b16 v[148:149], v125 offset:10240
    ds_read_b64_tr_b16 v[150:151], v125 offset:10752
    ds_read_b64_tr_b16 v[208:209], v124 offset:8192
    ds_read_b64_tr_b16 v[210:211], v124 offset:8704
    ds_read_b64_tr_b16 v[212:213], v124 offset:10240
    ds_read_b64_tr_b16 v[214:215], v124 offset:10752
    s_waitcnt lgkmcnt(0)
    s_waitcnt vmcnt(16)
    ds_read_b64_tr_b16 v[152:153], v125 offset:12288
    ds_read_b64_tr_b16 v[154:155], v125 offset:12800
    ds_read_b64_tr_b16 v[156:157], v125 offset:14336
    ds_read_b64_tr_b16 v[158:159], v125 offset:14848
    ds_read_b64_tr_b16 v[216:217], v124 offset:12288
    ds_read_b64_tr_b16 v[218:219], v124 offset:12800
    ds_read_b64_tr_b16 v[220:221], v124 offset:14336
    ds_read_b64_tr_b16 v[222:223], v124 offset:14848
    s_waitcnt lgkmcnt(0)
    s_waitcnt vmcnt(12)
    ds_read_b64_tr_b16 v[160:161], v125 offset:16384
    ds_read_b64_tr_b16 v[162:163], v125 offset:16896
    ds_read_b64_tr_b16 v[164:165], v125 offset:18432
    ds_read_b64_tr_b16 v[166:167], v125 offset:18944
    ds_read_b64_tr_b16 v[224:225], v124 offset:16384
    ds_read_b64_tr_b16 v[226:227], v124 offset:16896
    ds_read_b64_tr_b16 v[228:229], v124 offset:18432
    ds_read_b64_tr_b16 v[230:231], v124 offset:18944
    s_waitcnt lgkmcnt(0)
    s_waitcnt vmcnt(8)
    ds_read_b64_tr_b16 v[168:169], v125 offset:20480
    ds_read_b64_tr_b16 v[170:171], v125 offset:20992
    ds_read_b64_tr_b16 v[172:173], v125 offset:22528
    ds_read_b64_tr_b16 v[174:175], v125 offset:23040
    ds_read_b64_tr_b16 v[232:233], v124 offset:20480
    ds_read_b64_tr_b16 v[234:235], v124 offset:20992
    ds_read_b64_tr_b16 v[236:237], v124 offset:22528
    ds_read_b64_tr_b16 v[238:239], v124 offset:23040
    s_waitcnt lgkmcnt(0)
    s_waitcnt vmcnt(4)
    ds_read_b64_tr_b16 v[176:177], v125 offset:24576
    ds_read_b64_tr_b16 v[178:179], v125 offset:25088
    ds_read_b64_tr_b16 v[180:181], v125 offset:26624
    ds_read_b64_tr_b16 v[182:183], v125 offset:27136
    ds_read_b64_tr_b16 v[240:241], v124 offset:24576
    ds_read_b64_tr_b16 v[242:243], v124 offset:25088
    ds_read_b64_tr_b16 v[244:245], v124 offset:26624
    ds_read_b64_tr_b16 v[246:247], v124 offset:27136
    s_waitcnt lgkmcnt(0)
    s_waitcnt vmcnt(0)
    ds_read_b64_tr_b16 v[184:185], v125 offset:28672
    ds_read_b64_tr_b16 v[186:187], v125 offset:29184
    ds_read_b64_tr_b16 v[188:189], v125 offset:30720
    ds_read_b64_tr_b16 v[190:191], v125 offset:31232
    ds_read_b64_tr_b16 v[248:249], v124 offset:28672
    ds_read_b64_tr_b16 v[250:251], v124 offset:29184
    ds_read_b64_tr_b16 v[252:253], v124 offset:30720
    ds_read_b64_tr_b16 v[254:255], v124 offset:31232
    s_waitcnt lgkmcnt(0)
    s_barrier
    s_lshl_b32 s31, s30, 15
    s_lshl_b32 s36, s17, 13
    s_add_u32 s31, s31, s36
    s_add_u32 m0, s36, 0
    v_xor_b32 v6, 0, v5
    buffer_load_dwordx4 v6, s[32:35], s31 offen offset:0 lds
    v_xor_b32 v7, 16, v5
    buffer_load_dwordx4 v7, s[32:35], s31 offen offset:1024 lds
    v_xor_b32 v6, 32, v5
    buffer_load_dwordx4 v6, s[32:35], s31 offen offset:2048 lds
    v_xor_b32 v7, 48, v5
    buffer_load_dwordx4 v7, s[32:35], s31 offen offset:3072 lds
    s_add_u32 m0, s36, 4096
    s_add_u32 s31, s31, 4096
    v_xor_b32 v6, 64, v5
    buffer_load_dwordx4 v6, s[32:35], s31 offen offset:0 lds
    v_xor_b32 v7, 80, v5
    buffer_load_dwordx4 v7, s[32:35], s31 offen offset:1024 lds
    v_xor_b32 v6, 96, v5
    buffer_load_dwordx4 v6, s[32:35], s31 offen offset:2048 lds
    v_xor_b32 v7, 112, v5
    buffer_load_dwordx4 v7, s[32:35], s31 offen offset:3072 lds
    s_mov_b32 s44, 0x3e0293ee
    s_lshl_b32 s19, s16, 13
    s_lshl_b32 s20, s17, 10
    s_add_u32 s19, s19, s20
    s_add_u32 s41, s19, 33554432
    s_waitcnt vmcnt(0)
L_pv_loop:
    s_waitcnt vmcnt(2)
    s_barrier
    s_add_u32 s21, s30, 1
    s_min_u32 s21, s21, 63
    ds_read_b128 v[16:19], v1 offset:0
    s_waitcnt lgkmcnt(0)
    ds_read_b128 v[20:23], v1 offset:16384
    v_mfma_f32_16x16x32_bf16 v[32:35], v[16:19], v[128:131], 0
    s_waitcnt lgkmcnt(0)
    ds_read_b128 v[24:27], v2 offset:0
    v_mfma_f32_16x16x32_bf16 v[36:39], v[20:23], v[128:131], 0
    ds_read_b128 v[28:31], v2 offset:16384
    v_mfma_f32_16x16x32_bf16 v[40:43], v[16:19], v[192:195], 0
    s_lshl_b32 s31, s21, 15
    s_lshl_b32 s36, s17, 13
    s_add_u32 s31, s31, s36
    s_add_u32 s36, s36, 32768
    v_mfma_f32_16x16x32_bf16 v[44:47], v[20:23], v[192:195], 0
    s_waitcnt lgkmcnt(1)
    v_mfma_f32_16x16x32_bf16 v[32:35], v[24:27], v[132:135], v[32:35]
    s_waitcnt lgkmcnt(0)
    ds_read_b128 v[16:19], v3 offset:0
    v_mfma_f32_16x16x32_bf16 v[36:39], v[28:31], v[132:135], v[36:39]
    ds_read_b128 v[20:23], v3 offset:16384
    v_mfma_f32_16x16x32_bf16 v[40:43], v[24:27], v[196:199], v[40:43]
    s_add_u32 m0, s36, 0
    v_xor_b32 v6, 0, v5
    buffer_load_dwordx4 v6, s[32:35], s31 offen offset:0 lds
    v_mfma_f32_16x16x32_bf16 v[44:47], v[28:31], v[196:199], v[44:47]
    s_waitcnt lgkmcnt(1)
    v_mfma_f32_16x16x32_bf16 v[32:35], v[16:19], v[136:139], v[32:35]
    s_waitcnt lgkmcnt(0)
    ds_read_b128 v[24:27], v4 offset:0
    v_mfma_f32_16x16x32_bf16 v[36:39], v[20:23], v[136:139], v[36:39]
    ds_read_b128 v[28:31], v4 offset:16384
    v_mfma_f32_16x16x32_bf16 v[40:43], v[16:19], v[200:203], v[40:43]
    v_xor_b32 v7, 16, v5
    buffer_load_dwordx4 v7, s[32:35], s31 offen offset:1024 lds
    v_mfma_f32_16x16x32_bf16 v[44:47], v[20:23], v[200:203], v[44:47]
    s_waitcnt lgkmcnt(1)
    v_mfma_f32_16x16x32_bf16 v[32:35], v[24:27], v[140:143], v[32:35]
    s_waitcnt lgkmcnt(0)
    ds_read_b128 v[16:19], v1 offset:256
    v_mfma_f32_16x16x32_bf16 v[36:39], v[28:31], v[140:143], v[36:39]
    ds_read_b128 v[20:23], v1 offset:16640
    v_mfma_f32_16x16x32_bf16 v[40:43], v[24:27], v[204:207], v[40:43]
    v_xor_b32 v6, 32, v5
    buffer_load_dwordx4 v6, s[32:35], s31 offen offset:2048 lds
    v_mfma_f32_16x16x32_bf16 v[44:47], v[28:31], v[204:207], v[44:47]
    s_waitcnt lgkmcnt(1)
    v_mfma_f32_16x16x32_bf16 v[32:35], v[16:19], v[144:147], v[32:35]
    s_waitcnt lgkmcnt(0)
    ds_read_b128 v[24:27], v2 offset:256
    v_mfma_f32_16x16x32_bf16 v[36:39], v[20:23], v[144:147], v[36:39]
    ds_read_b128 v[28:31], v2 offset:16640
    v_mfma_f32_16x16x32_bf16 v[40:43], v[16:19], v[208:211], v[40:43]
    v_xor_b32 v7, 48, v5
    buffer_load_dwordx4 v7, s[32:35], s31 offen offset:3072 lds
    v_mfma_f32_16x16x32_bf16 v[44:47], v[20:23], v[208:211], v[44:47]
    s_waitcnt lgkmcnt(1)
    v_mfma_f32_16x16x32_bf16 v[32:35], v[24:27], v[148:151], v[32:35]
    s_waitcnt lgkmcnt(0)
    ds_read_b128 v[16:19], v3 offset:256
    v_mfma_f32_16x16x32_bf16 v[36:39], v[28:31], v[148:151], v[36:39]
    ds_read_b128 v[20:23], v3 offset:16640
    v_mfma_f32_16x16x32_bf16 v[40:43], v[24:27], v[212:215], v[40:43]
    s_add_u32 m0, s36, 4096
    s_add_u32 s31, s31, 4096
    v_xor_b32 v6, 64, v5
    buffer_load_dwordx4 v6, s[32:35], s31 offen offset:0 lds
    v_mfma_f32_16x16x32_bf16 v[44:47], v[28:31], v[212:215], v[44:47]
    s_waitcnt lgkmcnt(1)
    v_mfma_f32_16x16x32_bf16 v[32:35], v[16:19], v[152:155], v[32:35]
    s_waitcnt lgkmcnt(0)
    ds_read_b128 v[24:27], v4 offset:256
    v_mfma_f32_16x16x32_bf16 v[36:39], v[20:23], v[152:155], v[36:39]
    ds_read_b128 v[28:31], v4 offset:16640
    v_mfma_f32_16x16x32_bf16 v[40:43], v[16:19], v[216:219], v[40:43]
    v_xor_b32 v7, 80, v5
    buffer_load_dwordx4 v7, s[32:35], s31 offen offset:1024 lds
    v_mfma_f32_16x16x32_bf16 v[44:47], v[20:23], v[216:219], v[44:47]
    s_waitcnt lgkmcnt(1)
    v_mfma_f32_16x16x32_bf16 v[32:35], v[24:27], v[156:159], v[32:35]
    s_waitcnt lgkmcnt(0)
    ds_read_b128 v[16:19], v1 offset:512
    v_mfma_f32_16x16x32_bf16 v[36:39], v[28:31], v[156:159], v[36:39]
    ds_read_b128 v[20:23], v1 offset:16896
    v_mfma_f32_16x16x32_bf16 v[40:43], v[24:27], v[220:223], v[40:43]
    v_xor_b32 v6, 96, v5
    buffer_load_dwordx4 v6, s[32:35], s31 offen offset:2048 lds
    v_mfma_f32_16x16x32_bf16 v[44:47], v[28:31], v[220:223], v[44:47]
    s_waitcnt lgkmcnt(1)
    v_mfma_f32_16x16x32_bf16 v[32:35], v[16:19], v[160:163], v[32:35]
    s_waitcnt lgkmcnt(0)
    ds_read_b128 v[24:27], v2 offset:512
    v_mfma_f32_16x16x32_bf16 v[36:39], v[20:23], v[160:163], v[36:39]
    ds_read_b128 v[28:31], v2 offset:16896
    v_mfma_f32_16x16x32_bf16 v[40:43], v[16:19], v[224:227], v[40:43]
    v_xor_b32 v7, 112, v5
    buffer_load_dwordx4 v7, s[32:35], s31 offen offset:3072 lds
    v_mfma_f32_16x16x32_bf16 v[44:47], v[20:23], v[224:227], v[44:47]
    s_waitcnt lgkmcnt(1)
    v_mfma_f32_16x16x32_bf16 v[32:35], v[24:27], v[164:167], v[32:35]
    s_waitcnt lgkmcnt(0)
    ds_read_b128 v[16:19], v3 offset:512
    v_mfma_f32_16x16x32_bf16 v[36:39], v[28:31], v[164:167], v[36:39]
    ds_read_b128 v[20:23], v3 offset:16896
    v_mfma_f32_16x16x32_bf16 v[40:43], v[24:27], v[228:231], v[40:43]
    v_mfma_f32_16x16x32_bf16 v[44:47], v[28:31], v[228:231], v[44:47]
    s_waitcnt lgkmcnt(1)
    v_mfma_f32_16x16x32_bf16 v[32:35], v[16:19], v[168:171], v[32:35]
    s_waitcnt lgkmcnt(0)
    ds_read_b128 v[24:27], v4 offset:512
    v_mfma_f32_16x16x32_bf16 v[36:39], v[20:23], v[168:171], v[36:39]
    ds_read_b128 v[28:31], v4 offset:16896
    v_mfma_f32_16x16x32_bf16 v[40:43], v[16:19], v[232:235], v[40:43]
    v_mfma_f32_16x16x32_bf16 v[44:47], v[20:23], v[232:235], v[44:47]
    s_waitcnt lgkmcnt(1)
    v_mfma_f32_16x16x32_bf16 v[32:35], v[24:27], v[172:175], v[32:35]
    s_waitcnt lgkmcnt(0)
    ds_read_b128 v[16:19], v1 offset:768
    v_mfma_f32_16x16x32_bf16 v[36:39], v[28:31], v[172:175], v[36:39]
    ds_read_b128 v[20:23], v1 offset:17152
    v_mfma_f32_16x16x32_bf16 v[40:43], v[24:27], v[236:239], v[40:43]
    v_mfma_f32_16x16x32_bf16 v[44:47], v[28:31], v[236:239], v[44:47]
    s_waitcnt lgkmcnt(1)
    v_mfma_f32_16x16x32_bf16 v[32:35], v[16:19], v[176:179], v[32:35]
    s_waitcnt lgkmcnt(0)
    ds_read_b128 v[24:27], v2 offset:768
    v_mfma_f32_16x16x32_bf16 v[36:39], v[20:23], v[176:179], v[36:39]
    ds_read_b128 v[28:31], v2 offset:17152
    v_mfma_f32_16x16x32_bf16 v[40:43], v[16:19], v[240:243], v[40:43]
    v_mfma_f32_16x16x32_bf16 v[44:47], v[20:23], v[240:243], v[44:47]
    s_waitcnt lgkmcnt(1)
    v_mfma_f32_16x16x32_bf16 v[32:35], v[24:27], v[180:183], v[32:35]
    s_waitcnt lgkmcnt(0)
    ds_read_b128 v[16:19], v3 offset:768
    v_mfma_f32_16x16x32_bf16 v[36:39], v[28:31], v[180:183], v[36:39]
    ds_read_b128 v[20:23], v3 offset:17152
    v_mfma_f32_16x16x32_bf16 v[40:43], v[24:27], v[244:247], v[40:43]
    v_mfma_f32_16x16x32_bf16 v[44:47], v[28:31], v[244:247], v[44:47]
    s_waitcnt lgkmcnt(1)
    v_mfma_f32_16x16x32_bf16 v[32:35], v[16:19], v[184:187], v[32:35]
    s_waitcnt lgkmcnt(0)
    ds_read_b128 v[24:27], v4 offset:768
    v_mfma_f32_16x16x32_bf16 v[36:39], v[20:23], v[184:187], v[36:39]
    ds_read_b128 v[28:31], v4 offset:17152
    v_mfma_f32_16x16x32_bf16 v[40:43], v[16:19], v[248:251], v[40:43]
    v_mfma_f32_16x16x32_bf16 v[44:47], v[20:23], v[248:251], v[44:47]
    s_waitcnt lgkmcnt(1)
    v_mfma_f32_16x16x32_bf16 v[32:35], v[24:27], v[188:191], v[32:35]
    s_waitcnt lgkmcnt(0)
    v_mfma_f32_16x16x32_bf16 v[36:39], v[28:31], v[188:191], v[36:39]
    v_mfma_f32_16x16x32_bf16 v[40:43], v[24:27], v[252:255], v[40:43]
    v_mfma_f32_16x16x32_bf16 v[44:47], v[28:31], v[252:255], v[44:47]
    s_waitcnt vmcnt(8)
    s_barrier
    s_cmp_lg_u32 s17, 0
    s_cbranch_scc1 L_pv_nf0
    s_mov_b64 exec, 1
    v_mov_b32 v6, s30
    buffer_store_short v6, off, s[4:7], s40 sc1
    s_mov_b64 exec, -1
L_pv_nf0:
    v_cvt_pk_bf16_f32 v32, v32, v33
    v_cvt_pk_bf16_f32 v33, v34, v35
    v_cvt_pk_bf16_f32 v34, v36, v37
    v_cvt_pk_bf16_f32 v35, v38, v39
    buffer_store_dwordx4 v[32:35], v8, s[4:7], s41 offen offset:0 sc1
    v_cvt_pk_bf16_f32 v40, v40, v41
    v_cvt_pk_bf16_f32 v41, v42, v43
    v_cvt_pk_bf16_f32 v42, v44, v45
    v_cvt_pk_bf16_f32 v43, v46, v47
    buffer_store_dwordx4 v[40:43], v8, s[4:7], s41 offen offset:1024 sc1
    s_add_u32 s41, s41, 262144
    s_add_u32 s30, s30, 1
    s_waitcnt vmcnt(2)
    s_barrier
    s_add_u32 s21, s30, 1
    s_min_u32 s21, s21, 63
    ds_read_b128 v[16:19], v1 offset:32768
    s_waitcnt lgkmcnt(0)
    ds_read_b128 v[20:23], v1 offset:49152
    v_mfma_f32_16x16x32_bf16 v[32:35], v[16:19], v[128:131], 0
    s_waitcnt lgkmcnt(0)
    ds_read_b128 v[24:27], v2 offset:32768
    v_mfma_f32_16x16x32_bf16 v[36:39], v[20:23], v[128:131], 0
    ds_read_b128 v[28:31], v2 offset:49152
    v_mfma_f32_16x16x32_bf16 v[40:43], v[16:19], v[192:195], 0
    s_lshl_b32 s31, s21, 15
    s_lshl_b32 s36, s17, 13
    s_add_u32 s31, s31, s36
    v_mfma_f32_16x16x32_bf16 v[44:47], v[20:23], v[192:195], 0
    s_waitcnt lgkmcnt(1)
    v_mfma_f32_16x16x32_bf16 v[32:35], v[24:27], v[132:135], v[32:35]
    s_waitcnt lgkmcnt(0)
    ds_read_b128 v[16:19], v3 offset:32768
    v_mfma_f32_16x16x32_bf16 v[36:39], v[28:31], v[132:135], v[36:39]
    ds_read_b128 v[20:23], v3 offset:49152
    v_mfma_f32_16x16x32_bf16 v[40:43], v[24:27], v[196:199], v[40:43]
    s_add_u32 m0, s36, 0
    v_xor_b32 v6, 0, v5
    buffer_load_dwordx4 v6, s[32:35], s31 offen offset:0 lds
    v_mfma_f32_16x16x32_bf16 v[44:47], v[28:31], v[196:199], v[44:47]
    s_waitcnt lgkmcnt(1)
    v_mfma_f32_16x16x32_bf16 v[32:35], v[16:19], v[136:139], v[32:35]
    s_waitcnt lgkmcnt(0)
    ds_read_b128 v[24:27], v4 offset:32768
    v_mfma_f32_16x16x32_bf16 v[36:39], v[20:23], v[136:139], v[36:39]
    ds_read_b128 v[28:31], v4 offset:49152
    v_mfma_f32_16x16x32_bf16 v[40:43], v[16:19], v[200:203], v[40:43]
    v_xor_b32 v7, 16, v5
    buffer_load_dwordx4 v7, s[32:35], s31 offen offset:1024 lds
    v_mfma_f32_16x16x32_bf16 v[44:47], v[20:23], v[200:203], v[44:47]
    s_waitcnt lgkmcnt(1)
    v_mfma_f32_16x16x32_bf16 v[32:35], v[24:27], v[140:143], v[32:35]
    s_waitcnt lgkmcnt(0)
    ds_read_b128 v[16:19], v1 offset:33024
    v_mfma_f32_16x16x32_bf16 v[36:39], v[28:31], v[140:143], v[36:39]
    ds_read_b128 v[20:23], v1 offset:49408
    v_mfma_f32_16x16x32_bf16 v[40:43], v[24:27], v[204:207], v[40:43]
    v_xor_b32 v6, 32, v5
    buffer_load_dwordx4 v6, s[32:35], s31 offen offset:2048 lds
    v_mfma_f32_16x16x32_bf16 v[44:47], v[28:31], v[204:207], v[44:47]
    s_waitcnt lgkmcnt(1)
    v_mfma_f32_16x16x32_bf16 v[32:35], v[16:19], v[144:147], v[32:35]
    s_waitcnt lgkmcnt(0)
    ds_read_b128 v[24:27], v2 offset:33024
    v_mfma_f32_16x16x32_bf16 v[36:39], v[20:23], v[144:147], v[36:39]
    ds_read_b128 v[28:31], v2 offset:49408
    v_mfma_f32_16x16x32_bf16 v[40:43], v[16:19], v[208:211], v[40:43]
    v_xor_b32 v7, 48, v5
    buffer_load_dwordx4 v7, s[32:35], s31 offen offset:3072 lds
    v_mfma_f32_16x16x32_bf16 v[44:47], v[20:23], v[208:211], v[44:47]
    s_waitcnt lgkmcnt(1)
    v_mfma_f32_16x16x32_bf16 v[32:35], v[24:27], v[148:151], v[32:35]
    s_waitcnt lgkmcnt(0)
    ds_read_b128 v[16:19], v3 offset:33024
    v_mfma_f32_16x16x32_bf16 v[36:39], v[28:31], v[148:151], v[36:39]
    ds_read_b128 v[20:23], v3 offset:49408
    v_mfma_f32_16x16x32_bf16 v[40:43], v[24:27], v[212:215], v[40:43]
    s_add_u32 m0, s36, 4096
    s_add_u32 s31, s31, 4096
    v_xor_b32 v6, 64, v5
    buffer_load_dwordx4 v6, s[32:35], s31 offen offset:0 lds
    v_mfma_f32_16x16x32_bf16 v[44:47], v[28:31], v[212:215], v[44:47]
    s_waitcnt lgkmcnt(1)
    v_mfma_f32_16x16x32_bf16 v[32:35], v[16:19], v[152:155], v[32:35]
    s_waitcnt lgkmcnt(0)
    ds_read_b128 v[24:27], v4 offset:33024
    v_mfma_f32_16x16x32_bf16 v[36:39], v[20:23], v[152:155], v[36:39]
    ds_read_b128 v[28:31], v4 offset:49408
    v_mfma_f32_16x16x32_bf16 v[40:43], v[16:19], v[216:219], v[40:43]
    v_xor_b32 v7, 80, v5
    buffer_load_dwordx4 v7, s[32:35], s31 offen offset:1024 lds
    v_mfma_f32_16x16x32_bf16 v[44:47], v[20:23], v[216:219], v[44:47]
    s_waitcnt lgkmcnt(1)
    v_mfma_f32_16x16x32_bf16 v[32:35], v[24:27], v[156:159], v[32:35]
    s_waitcnt lgkmcnt(0)
    ds_read_b128 v[16:19], v1 offset:33280
    v_mfma_f32_16x16x32_bf16 v[36:39], v[28:31], v[156:159], v[36:39]
    ds_read_b128 v[20:23], v1 offset:49664
    v_mfma_f32_16x16x32_bf16 v[40:43], v[24:27], v[220:223], v[40:43]
    v_xor_b32 v6, 96, v5
    buffer_load_dwordx4 v6, s[32:35], s31 offen offset:2048 lds
    v_mfma_f32_16x16x32_bf16 v[44:47], v[28:31], v[220:223], v[44:47]
    s_waitcnt lgkmcnt(1)
    v_mfma_f32_16x16x32_bf16 v[32:35], v[16:19], v[160:163], v[32:35]
    s_waitcnt lgkmcnt(0)
    ds_read_b128 v[24:27], v2 offset:33280
    v_mfma_f32_16x16x32_bf16 v[36:39], v[20:23], v[160:163], v[36:39]
    ds_read_b128 v[28:31], v2 offset:49664
    v_mfma_f32_16x16x32_bf16 v[40:43], v[16:19], v[224:227], v[40:43]
    v_xor_b32 v7, 112, v5
    buffer_load_dwordx4 v7, s[32:35], s31 offen offset:3072 lds
    v_mfma_f32_16x16x32_bf16 v[44:47], v[20:23], v[224:227], v[44:47]
    s_waitcnt lgkmcnt(1)
    v_mfma_f32_16x16x32_bf16 v[32:35], v[24:27], v[164:167], v[32:35]
    s_waitcnt lgkmcnt(0)
    ds_read_b128 v[16:19], v3 offset:33280
    v_mfma_f32_16x16x32_bf16 v[36:39], v[28:31], v[164:167], v[36:39]
    ds_read_b128 v[20:23], v3 offset:49664
    v_mfma_f32_16x16x32_bf16 v[40:43], v[24:27], v[228:231], v[40:43]
    v_mfma_f32_16x16x32_bf16 v[44:47], v[28:31], v[228:231], v[44:47]
    s_waitcnt lgkmcnt(1)
    v_mfma_f32_16x16x32_bf16 v[32:35], v[16:19], v[168:171], v[32:35]
    s_waitcnt lgkmcnt(0)
    ds_read_b128 v[24:27], v4 offset:33280
    v_mfma_f32_16x16x32_bf16 v[36:39], v[20:23], v[168:171], v[36:39]
    ds_read_b128 v[28:31], v4 offset:49664
    v_mfma_f32_16x16x32_bf16 v[40:43], v[16:19], v[232:235], v[40:43]
    v_mfma_f32_16x16x32_bf16 v[44:47], v[20:23], v[232:235], v[44:47]
    s_waitcnt lgkmcnt(1)
    v_mfma_f32_16x16x32_bf16 v[32:35], v[24:27], v[172:175], v[32:35]
    s_waitcnt lgkmcnt(0)
    ds_read_b128 v[16:19], v1 offset:33536
    v_mfma_f32_16x16x32_bf16 v[36:39], v[28:31], v[172:175], v[36:39]
    ds_read_b128 v[20:23], v1 offset:49920
    v_mfma_f32_16x16x32_bf16 v[40:43], v[24:27], v[236:239], v[40:43]
    v_mfma_f32_16x16x32_bf16 v[44:47], v[28:31], v[236:239], v[44:47]
    s_waitcnt lgkmcnt(1)
    v_mfma_f32_16x16x32_bf16 v[32:35], v[16:19], v[176:179], v[32:35]
    s_waitcnt lgkmcnt(0)
    ds_read_b128 v[24:27], v2 offset:33536
    v_mfma_f32_16x16x32_bf16 v[36:39], v[20:23], v[176:179], v[36:39]
    ds_read_b128 v[28:31], v2 offset:49920
    v_mfma_f32_16x16x32_bf16 v[40:43], v[16:19], v[240:243], v[40:43]
    v_mfma_f32_16x16x32_bf16 v[44:47], v[20:23], v[240:243], v[44:47]
    s_waitcnt lgkmcnt(1)
    v_mfma_f32_16x16x32_bf16 v[32:35], v[24:27], v[180:183], v[32:35]
    s_waitcnt lgkmcnt(0)
    ds_read_b128 v[16:19], v3 offset:33536
    v_mfma_f32_16x16x32_bf16 v[36:39], v[28:31], v[180:183], v[36:39]
    ds_read_b128 v[20:23], v3 offset:49920
    v_mfma_f32_16x16x32_bf16 v[40:43], v[24:27], v[244:247], v[40:43]
    v_mfma_f32_16x16x32_bf16 v[44:47], v[28:31], v[244:247], v[44:47]
    s_waitcnt lgkmcnt(1)
    v_mfma_f32_16x16x32_bf16 v[32:35], v[16:19], v[184:187], v[32:35]
    s_waitcnt lgkmcnt(0)
    ds_read_b128 v[24:27], v4 offset:33536
    v_mfma_f32_16x16x32_bf16 v[36:39], v[20:23], v[184:187], v[36:39]
    ds_read_b128 v[28:31], v4 offset:49920
    v_mfma_f32_16x16x32_bf16 v[40:43], v[16:19], v[248:251], v[40:43]
    v_mfma_f32_16x16x32_bf16 v[44:47], v[20:23], v[248:251], v[44:47]
    s_waitcnt lgkmcnt(1)
    v_mfma_f32_16x16x32_bf16 v[32:35], v[24:27], v[188:191], v[32:35]
    s_waitcnt lgkmcnt(0)
    v_mfma_f32_16x16x32_bf16 v[36:39], v[28:31], v[188:191], v[36:39]
    v_mfma_f32_16x16x32_bf16 v[40:43], v[24:27], v[252:255], v[40:43]
    v_mfma_f32_16x16x32_bf16 v[44:47], v[28:31], v[252:255], v[44:47]
    s_waitcnt vmcnt(8)
    s_barrier
    s_cmp_lg_u32 s17, 0
    s_cbranch_scc1 L_pv_nf1
    s_mov_b64 exec, 1
    v_mov_b32 v6, s30
    buffer_store_short v6, off, s[4:7], s40 sc1
    s_mov_b64 exec, -1
L_pv_nf1:
    v_cvt_pk_bf16_f32 v32, v32, v33
    v_cvt_pk_bf16_f32 v33, v34, v35
    v_cvt_pk_bf16_f32 v34, v36, v37
    v_cvt_pk_bf16_f32 v35, v38, v39
    buffer_store_dwordx4 v[32:35], v8, s[4:7], s41 offen offset:0 sc1
    v_cvt_pk_bf16_f32 v40, v40, v41
    v_cvt_pk_bf16_f32 v41, v42, v43
    v_cvt_pk_bf16_f32 v42, v44, v45
    v_cvt_pk_bf16_f32 v43, v46, v47
    buffer_store_dwordx4 v[40:43], v8, s[4:7], s41 offen offset:1024 sc1
    s_add_u32 s41, s41, 262144
    s_add_u32 s30, s30, 1
    s_cmp_lt_u32 s30, 64
    s_cbranch_scc1 L_pv_loop
    s_waitcnt vmcnt(0)
    s_barrier
    s_cmp_lg_u32 s17, 0
    s_cbranch_scc1 L_pv_nfe
    s_mov_b64 exec, 1
    v_mov_b32 v6, s30
    buffer_store_short v6, off, s[4:7], s40 sc1
    s_mov_b64 exec, -1
L_pv_nfe:
    s_branch L_done
L_role_fg:
    s_cmp_ge_u32 s16, 28
    s_cbranch_scc1 L_role_g
    v_and_b32 v127, 63, v0
    v_lshrrev_b32 v126, 6, v0
    s_nop 0
    v_readfirstlane_b32 s17, v126
    v_lshlrev_b32 v0, 4, v127
    v_bfe_u32 v1, v127, 4, 2
    v_and_b32 v126, 15, v127
    v_xor_b32 v1, v1, v126
    v_lshlrev_b32 v1, 4, v1
    v_lshl_add_u32 v1, v126, 10, v1
    v_bfe_u32 v2, v127, 4, 2
    v_add_u32 v2, 4, v2
    v_and_b32 v126, 15, v127
    v_xor_b32 v2, v2, v126
    v_lshlrev_b32 v2, 4, v2
    v_lshl_add_u32 v2, v126, 10, v2
    v_bfe_u32 v3, v127, 4, 2
    v_add_u32 v3, 8, v3
    v_and_b32 v126, 15, v127
    v_xor_b32 v3, v3, v126
    v_lshlrev_b32 v3, 4, v3
    v_lshl_add_u32 v3, v126, 10, v3
    v_bfe_u32 v4, v127, 4, 2
    v_add_u32 v4, 12, v4
    v_and_b32 v126, 15, v127
    v_xor_b32 v4, v4, v126
    v_lshlrev_b32 v4, 4, v4
    v_lshl_add_u32 v4, v126, 10, v4
    s_and_b32 s19, s17, 1
    s_lshl_b32 s19, s19, 7
    v_xor_b32 v5, s19, v0
    s_lshl_b32 s19, s17, 10
    v_add_u32 v8, s19, v0
    s_load_dwordx2 s[24:25], s[0:1], 0
    s_waitcnt lgkmcnt(0)
    s_mov_b32 s32, s24
    s_and_b32 s33, s25, 0xffff
    s_mov_b32 s34, 0x200000
    s_mov_b32 s35, 0x20000
    s_lshl_b32 s40, s16, 7
    s_add_u32 s40, s40, 12288
    v_mov_b32 v6, 0
    buffer_store_dword v6, off, s[4:7], s40 sc1
    s_cmp_ge_u32 s16, 14
    s_cselect_b32 s46, 1, 0
    s_cselect_b32 s19, 14, 0
    s_sub_u32 s45, s16, s19
    s_waitcnt vmcnt(0)
    s_barrier
    s_cmp_lg_u32 s17, 0
    s_cbranch_scc1 L_f_noreg
    s_mul_i32 s19, s28, s28
    s_lshl_b32 s19, s19, 18
    s_lshl_b32 s20, s28, 9
    s_add_u32 s19, s19, s20
    s_add_u32 s19, s19, 1
    s_lshl_b32 s20, s27, 2
    s_mov_b64 exec, 1
    v_mov_b32 v7, s19
    buffer_atomic_add v7, off, s[12:15], s20
    s_mov_b64 exec, -1
L_f_noreg:
    s_load_dwordx2 s[24:25], s[0:1], 64
    s_waitcnt lgkmcnt(0)
    s_mov_b32 s68, s24
    s_and_b32 s69, s25, 0xffff
    s_mov_b32 s70, 0x1c0000
    s_mov_b32 s71, 0x20000
    s_load_dwordx2 s[24:25], s[0:1], 72
    s_waitcnt lgkmcnt(0)
    s_mov_b32 s72, s24
    s_and_b32 s73, s25, 0xffff
    s_mov_b32 s74, 0x1c0000
    s_mov_b32 s75, 0x20000
    s_load_dwordx2 s[24:25], s[0:1], 80
    s_waitcnt lgkmcnt(0)
    s_mov_b32 s76, s24
    s_and_b32 s77, s25, 0xffff
    s_mov_b32 s78, 0x1c0000
    s_mov_b32 s79, 0x20000
    v_bfe_u32 v123, v127, 5, 1
    v_mul_u32_u24 v123, 14336, v123
    v_bfe_u32 v126, v127, 4, 1
    v_mul_u32_u24 v126, 28672, v126
    v_add_u32 v123, v123, v126
    v_bfe_u32 v126, v127, 3, 1
    v_mul_u32_u24 v126, 7168, v126
    v_add_u32 v123, v123, v126
    v_bfe_u32 v126, v127, 2, 1
    v_mul_u32_u24 v126, 3584, v126
    v_add_u32 v123, v123, v126
    v_bfe_u32 v126, v127, 0, 1
    v_lshlrev_b32 v126, 4, v126
    v_add_u32 v123, v123, v126
    v_lshrrev_b32 v126, 3, v127
    v_xor_b32 v126, v126, v127
    v_and_b32 v126, 2, v126
    v_lshl_add_u32 v123, v126, 4, v123
    v_bfe_u32 v122, v127, 5, 1
    v_lshlrev_b32 v122, 14, v122
    v_bfe_u32 v126, v127, 4, 1
    v_lshlrev_b32 v126, 12, v126
    v_add_u32 v122, v122, v126
    v_bfe_u32 v126, v127, 3, 1
    v_lshlrev_b32 v126, 11, v126
    v_add_u32 v122, v122, v126
    v_bfe_u32 v126, v127, 2, 1
    v_lshlrev_b32 v126, 10, v126
    v_add_u32 v122, v122, v126
    v_bfe_u32 v126, v127, 0, 1
    v_lshlrev_b32 v126, 4, v126
    v_add_u32 v122, v122, v126
    v_lshrrev_b32 v126, 3, v127
    v_xor_b32 v126, v126, v127
    v_and_b32 v126, 2, v126
    v_lshl_add_u32 v122, v126, 4, v122
    v_bfe_u32 v125, v127, 5, 1
    v_lshlrev_b32 v125, 10, v125
    v_bfe_u32 v126, v127, 4, 1
    v_mul_u32_u24 v126, 288, v126
    v_add_u32 v125, v125, v126
    v_bfe_u32 v126, v127, 3, 1
    v_lshlrev_b32 v126, 7, v126
    v_add_u32 v125, v125, v126
    v_bfe_u32 v126, v127, 2, 1
    v_lshlrev_b32 v126, 6, v126
    v_add_u32 v125, v125, v126
    v_bfe_u32 v126, v127, 0, 2
    v_lshlrev_b32 v126, 3, v126
    v_add_u32 v125, v125, v126
    s_lshl_b32 s22, s17, 15
    v_add_u32 v125, s22, v125
    v_xor_b32 v124, 32, v125
    s_add_u32 m0, s22, 0
    s_lshl_b32 s19, s45, 8
    s_lshl_b32 s20, s17, 6
    s_add_u32 s19, s19, s20
    buffer_load_dwordx4 v123, s[68:71], s19 offen offset:0  lds
    s_add_u32 s19, s19, 56320
    buffer_load_dwordx4 v123, s[68:71], s19 offen offset:1024  lds
    s_add_u32 s19, s19, 56320
    buffer_load_dwordx4 v123, s[68:71], s19 offen offset:2048  lds
    s_add_u32 s19, s19, 56320
    buffer_load_dwordx4 v123, s[68:71], s19 offen offset:3072  lds
    s_add_u32 m0, s22, 4096
    s_lshl_b32 s19, s45, 8
    s_lshl_b32 s20, s17, 6
    s_add_u32 s19, s19, s20
    s_add_u32 s19, s19, 229376
    buffer_load_dwordx4 v123, s[68:71], s19 offen offset:0  lds
    s_add_u32 s19, s19, 56320
    buffer_load_dwordx4 v123, s[68:71], s19 offen offset:1024  lds
    s_add_u32 s19, s19, 56320
    buffer_load_dwordx4 v123, s[68:71], s19 offen offset:2048  lds
    s_add_u32 s19, s19, 56320
    buffer_load_dwordx4 v123, s[68:71], s19 offen offset:3072  lds
    s_add_u32 m0, s22, 8192
    s_lshl_b32 s19, s45, 8
    s_lshl_b32 s20, s17, 6
    s_add_u32 s19, s19, s20
    s_add_u32 s19, s19, 458752
    buffer_load_dwordx4 v123, s[68:71], s19 offen offset:0  lds
    s_add_u32 s19, s19, 56320
    buffer_load_dwordx4 v123, s[68:71], s19 offen offset:1024  lds
    s_add_u32 s19, s19, 56320
    buffer_load_dwordx4 v123, s[68:71], s19 offen offset:2048  lds
    s_add_u32 s19, s19, 56320
    buffer_load_dwordx4 v123, s[68:71], s19 offen offset:3072  lds
    s_add_u32 m0, s22, 12288
    s_lshl_b32 s19, s45, 8
    s_lshl_b32 s20, s17, 6
    s_add_u32 s19, s19, s20
    s_add_u32 s19, s19, 688128
    buffer_load_dwordx4 v123, s[68:71], s19 offen offset:0  lds
    s_add_u32 s19, s19, 56320
    buffer_load_dwordx4 v123, s[68:71], s19 offen offset:1024  lds
    s_add_u32 s19, s19, 56320
    buffer_load_dwordx4 v123, s[68:71], s19 offen offset:2048  lds
    s_add_u32 s19, s19, 56320
    buffer_load_dwordx4 v123, s[68:71], s19 offen offset:3072  lds
    s_add_u32 m0, s22, 16384
    s_lshl_b32 s19, s45, 8
    s_lshl_b32 s20, s17, 6
    s_add_u32 s19, s19, s20
    s_add_u32 s19, s19, 917504
    buffer_load_dwordx4 v123, s[68:71], s19 offen offset:0  lds
    s_add_u32 s19, s19, 56320
    buffer_load_dwordx4 v123, s[68:71], s19 offen offset:1024  lds
    s_add_u32 s19, s19, 56320
    buffer_load_dwordx4 v123, s[68:71], s19 offen offset:2048  lds
    s_add_u32 s19, s19, 56320
    buffer_load_dwordx4 v123, s[68:71], s19 offen offset:3072  lds
    s_add_u32 m0, s22, 20480
    s_lshl_b32 s19, s45, 8
    s_lshl_b32 s20, s17, 6
    s_add_u32 s19, s19, s20
    s_add_u32 s19, s19, 1146880
    buffer_load_dwordx4 v123, s[68:71], s19 offen offset:0  lds
    s_add_u32 s19, s19, 56320
    buffer_load_dwordx4 v123, s[68:71], s19 offen offset:1024  lds
    s_add_u32 s19, s19, 56320
    buffer_load_dwordx4 v123, s[68:71], s19 offen offset:2048  lds
    s_add_u32 s19, s19, 56320
    buffer_load_dwordx4 v123, s[68:71], s19 offen offset:3072  lds
    s_add_u32 m0, s22, 24576
    s_lshl_b32 s19, s45, 8
    s_lshl_b32 s20, s17, 6
    s_add_u32 s19, s19, s20
    s_add_u32 s19, s19, 1376256
    buffer_load_dwordx4 v123, s[68:71], s19 offen offset:0  lds
    s_add_u32 s19, s19, 56320
    buffer_load_dwordx4 v123, s[68:71], s19 offen offset:1024  lds
    s_add_u32 s19, s19, 56320
    buffer_load_dwordx4 v123, s[68:71], s19 offen offset:2048  lds
    s_add_u32 s19, s19, 56320
    buffer_load_dwordx4 v123, s[68:71], s19 offen offset:3072  lds
    s_add_u32 m0, s22, 28672
    s_lshl_b32 s19, s45, 8
    s_lshl_b32 s20, s17, 6
    s_add_u32 s19, s19, s20
    s_add_u32 s19, s19, 1605632
    buffer_load_dwordx4 v123, s[68:71], s19 offen offset:0  lds
    s_add_u32 s19, s19, 56320
    buffer_load_dwordx4 v123, s[68:71], s19 offen offset:1024  lds
    s_add_u32 s19, s19, 56320
    buffer_load_dwordx4 v123, s[68:71], s19 offen offset:2048  lds
    s_add_u32 s19, s19, 56320
    buffer_load_dwordx4 v123, s[68:71], s19 offen offset:3072  lds
    s_waitcnt vmcnt(28)
    ds_read_b64_tr_b16 a[0:1], v125 offset:0
    ds_read_b64_tr_b16 a[2:3], v125 offset:512
    ds_read_b64_tr_b16 a[4:5], v125 offset:2048
    ds_read_b64_tr_b16 a[6:7], v125 offset:2560
    ds_read_b64_tr_b16 a[64:65], v124 offset:0
    ds_read_b64_tr_b16 a[66:67], v124 offset:512
    ds_read_b64_tr_b16 a[68:69], v124 offset:2048
    ds_read_b64_tr_b16 a[70:71], v124 offset:2560
    s_waitcnt lgkmcnt(0)
    s_add_u32 m0, s22, 0
    s_lshl_b32 s19, s45, 8
    s_lshl_b32 s20, s17, 6
    s_add_u32 s19, s19, s20
    buffer_load_dwordx4 v123, s[72:75], s19 offen offset:0  lds
    s_add_u32 s19, s19, 56320
    buffer_load_dwordx4 v123, s[72:75], s19 offen offset:1024  lds
    s_add_u32 s19, s19, 56320
    buffer_load_dwordx4 v123, s[72:75], s19 offen offset:2048  lds
    s_add_u32 s19, s19, 56320
    buffer_load_dwordx4 v123, s[72:75], s19 offen offset:3072  lds
    s_waitcnt vmcnt(28)
    ds_read_b64_tr_b16 a[8:9], v125 offset:4096
    ds_read_b64_tr_b16 a[10:11], v125 offset:4608
    ds_read_b64_tr_b16 a[12:13], v125 offset:6144
    ds_read_b64_tr_b16 a[14:15], v125 offset:6656
    ds_read_b64_tr_b16 a[72:73], v124 offset:4096
    ds_read_b64_tr_b16 a[74:75], v124 offset:4608
    ds_read_b64_tr_b16 a[76:77], v124 offset:6144
    ds_read_b64_tr_b16 a[78:79], v124 offset:6656
    s_waitcnt lgkmcnt(0)
    s_add_u32 m0, s22, 4096
    s_lshl_b32 s19, s45, 8
    s_lshl_b32 s20, s17, 6
    s_add_u32 s19, s19, s20
    s_add_u32 s19, s19, 229376
    buffer_load_dwordx4 v123, s[72:75], s19 offen offset:0  lds
    s_add_u32 s19, s19, 56320
    buffer_load_dwordx4 v123, s[72:75], s19 offen offset:1024  lds
    s_add_u32 s19, s19, 56320
    buffer_load_dwordx4 v123, s[72:75], s19 offen offset:2048  lds
    s_add_u32 s19, s19, 56320
    buffer_load_dwordx4 v123, s[72:75], s19 offen offset:3072  lds
    s_waitcnt vmcnt(28)
    ds_read_b64_tr_b16 a[16:17], v125 offset:8192
    ds_read_b64_tr_b16 a[18:19], v125 offset:8704
    ds_read_b64_tr_b16 a[20:21], v125 offset:10240
    ds_read_b64_tr_b16 a[22:23], v125 offset:10752
    ds_read_b64_tr_b16 a[80:81], v124 offset:8192
    ds_read_b64_tr_b16 a[82:83], v124 offset:8704
    ds_read_b64_tr_b16 a[84:85], v124 offset:10240
    ds_read_b64_tr_b16 a[86:87], v124 offset:10752
    s_waitcnt lgkmcnt(0)
    s_add_u32 m0, s22, 8192
    s_lshl_b32 s19, s45, 8
    s_lshl_b32 s20, s17, 6
    s_add_u32 s19, s19, s20
    s_add_u32 s19, s19, 458752
    buffer_load_dwordx4 v123, s[72:75], s19 offen offset:0  lds
    s_add_u32 s19, s19, 56320
    buffer_load_dwordx4 v123, s[72:75], s19 offen offset:1024  lds
    s_add_u32 s19, s19, 56320
    buffer_load_dwordx4 v123, s[72:75], s19 offen offset:2048  lds
    s_add_u32 s19, s19, 56320
    buffer_load_dwordx4 v123, s[72:75], s19 offen offset:3072  lds
    s_waitcnt vmcnt(28)
    ds_read_b64_tr_b16 a[24:25], v125 offset:12288
    ds_read_b64_tr_b16 a[26:27], v125 offset:12800
    ds_read_b64_tr_b16 a[28:29], v125 offset:14336
    ds_read_b64_tr_b16 a[30:31], v125 offset:14848
    ds_read_b64_tr_b16 a[88:89], v124 offset:12288
    ds_read_b64_tr_b16 a[90:91], v124 offset:12800
    ds_read_b64_tr_b16 a[92:93], v124 offset:14336
    ds_read_b64_tr_b16 a[94:95], v124 offset:14848
    s_waitcnt lgkmcnt(0)
    s_add_u32 m0, s22, 12288
    s_lshl_b32 s19, s45, 8
    s_lshl_b32 s20, s17, 6
    s_add_u32 s19, s19, s20
    s_add_u32 s19, s19, 688128
    buffer_load_dwordx4 v123, s[72:75], s19 offen offset:0  lds
    s_add_u32 s19, s19, 56320
    buffer_load_dwordx4 v123, s[72:75], s19 offen offset:1024  lds
    s_add_u32 s19, s19, 56320
    buffer_load_dwordx4 v123, s[72:75], s19 offen offset:2048  lds
    s_add_u32 s19, s19, 56320
    buffer_load_dwordx4 v123, s[72:75], s19 offen offset:3072  lds
    s_waitcnt vmcnt(28)
    ds_read_b64_tr_b16 a[32:33], v125 offset:16384
    ds_read_b64_tr_b16 a[34:35], v125 offset:16896
    ds_read_b64_tr_b16 a[36:37], v125 offset:18432
    ds_read_b64_tr_b16 a[38:39], v125 offset:18944
    ds_read_b64_tr_b16 a[96:97], v124 offset:16384
    ds_read_b64_tr_b16 a[98:99], v124 offset:16896
    ds_read_b64_tr_b16 a[100:101], v124 offset:18432
    ds_read_b64_tr_b16 a[102:103], v124 offset:18944
    s_waitcnt lgkmcnt(0)
    s_add_u32 m0, s22, 16384
    s_lshl_b32 s19, s45, 8
    s_lshl_b32 s20, s17, 6
    s_add_u32 s19, s19, s20
    s_add_u32 s19, s19, 917504
    buffer_load_dwordx4 v123, s[72:75], s19 offen offset:0  lds
    s_add_u32 s19, s19, 56320
    buffer_load_dwordx4 v123, s[72:75], s19 offen offset:1024  lds
    s_add_u32 s19, s19, 56320
    buffer_load_dwordx4 v123, s[72:75], s19 offen offset:2048  lds
    s_add_u32 s19, s19, 56320
    buffer_load_dwordx4 v123, s[72:75], s19 offen offset:3072  lds
    s_waitcnt vmcnt(28)
    ds_read_b64_tr_b16 a[40:41], v125 offset:20480
    ds_read_b64_tr_b16 a[42:43], v125 offset:20992
    ds_read_b64_tr_b16 a[44:45], v125 offset:22528
    ds_read_b64_tr_b16 a[46:47], v125 offset:23040
    ds_read_b64_tr_b16 a[104:105], v124 offset:20480
    ds_read_b64_tr_b16 a[106:107], v124 offset:20992
    ds_read_b64_tr_b16 a[108:109], v124 offset:22528
    ds_read_b64_tr_b16 a[110:111], v124 offset:23040
    s_waitcnt lgkmcnt(0)
    s_add_u32 m0, s22, 20480
    s_lshl_b32 s19, s45, 8
    s_lshl_b32 s20, s17, 6
    s_add_u32 s19, s19, s20
    s_add_u32 s19, s19, 1146880
    buffer_load_dwordx4 v123, s[72:75], s19 offen offset:0  lds
    s_add_u32 s19, s19, 56320
    buffer_load_dwordx4 v123, s[72:75], s19 offen offset:1024  lds
    s_add_u32 s19, s19, 56320
    buffer_load_dwordx4 v123, s[72:75], s19 offen offset:2048  lds
    s_add_u32 s19, s19, 56320
    buffer_load_dwordx4 v123, s[72:75], s19 offen offset:3072  lds
    s_waitcnt vmcnt(28)
    ds_read_b64_tr_b16 a[48:49], v125 offset:24576
    ds_read_b64_tr_b16 a[50:51], v125 offset:25088
    ds_read_b64_tr_b16 a[52:53], v125 offset:26624
    ds_read_b64_tr_b16 a[54:55], v125 offset:27136
    ds_read_b64_tr_b16 a[112:113], v124 offset:24576
    ds_read_b64_tr_b16 a[114:115], v124 offset:25088
    ds_read_b64_tr_b16 a[116:117], v124 offset:26624
    ds_read_b64_tr_b16 a[118:119], v124 offset:27136
    s_waitcnt lgkmcnt(0)
    s_add_u32 m0, s22, 24576
    s_lshl_b32 s19, s45, 8
    s_lshl_b32 s20, s17, 6
    s_add_u32 s19, s19, s20
    s_add_u32 s19, s19, 1376256
    buffer_load_dwordx4 v123, s[72:75], s19 offen offset:0  lds
    s_add_u32 s19, s19, 56320
    buffer_load_dwordx4 v123, s[72:75], s19 offen offset:1024  lds
    s_add_u32 s19, s19, 56320
    buffer_load_dwordx4 v123, s[72:75], s19 offen offset:2048  lds
    s_add_u32 s19, s19, 56320
    buffer_load_dwordx4 v123, s[72:75], s19 offen offset:3072  lds
    s_waitcnt vmcnt(28)
    ds_read_b64_tr_b16 a[56:57], v125 offset:28672
    ds_read_b64_tr_b16 a[58:59], v125 offset:29184
    ds_read_b64_tr_b16 a[60:61], v125 offset:30720
    ds_read_b64_tr_b16 a[62:63], v125 offset:31232
    ds_read_b64_tr_b16 a[120:121], v124 offset:28672
    ds_read_b64_tr_b16 a[122:123], v124 offset:29184
    ds_read_b64_tr_b16 a[124:125], v124 offset:30720
    ds_read_b64_tr_b16 a[126:127], v124 offset:31232
    s_waitcnt lgkmcnt(0)
    s_add_u32 m0, s22, 28672
    s_lshl_b32 s19, s45, 8
    s_lshl_b32 s20, s17, 6
    s_add_u32 s19, s19, s20
    s_add_u32 s19, s19, 1605632
    buffer_load_dwordx4 v123, s[72:75], s19 offen offset:0  lds
    s_add_u32 s19, s19, 56320
    buffer_load_dwordx4 v123, s[72:75], s19 offen offset:1024  lds
    s_add_u32 s19, s19, 56320
    buffer_load_dwordx4 v123, s[72:75], s19 offen offset:2048  lds
    s_add_u32 s19, s19, 56320
    buffer_load_dwordx4 v123, s[72:75], s19 offen offset:3072  lds
    s_waitcnt vmcnt(28)
    ds_read_b64_tr_b16 a[128:129], v125 offset:0
    ds_read_b64_tr_b16 a[130:131], v125 offset:512
    ds_read_b64_tr_b16 a[132:133], v125 offset:2048
    ds_read_b64_tr_b16 a[134:135], v125 offset:2560
    ds_read_b64_tr_b16 a[192:193], v124 offset:0
    ds_read_b64_tr_b16 a[194:195], v124 offset:512
    ds_read_b64_tr_b16 a[196:197], v124 offset:2048
    ds_read_b64_tr_b16 a[198:199], v124 offset:2560
    s_waitcnt lgkmcnt(0)
    s_add_u32 m0, s22, 0
    s_lshl_b32 s19, s45, 17
    s_lshl_b32 s20, s17, 8
    s_add_u32 s19, s19, s20
    s_add_u32 s19, s19, 0
    buffer_load_dwordx4 v122, s[76:79], s19 offen offset:0  lds
    s_add_u32 s19, s19, 7168
    buffer_load_dwordx4 v122, s[76:79], s19 offen offset:1024  lds
    s_add_u32 s19, s19, 23552
    buffer_load_dwordx4 v122, s[76:79], s19 offen offset:2048  lds
    s_add_u32 s19, s19, 7168
    buffer_load_dwordx4 v122, s[76:79], s19 offen offset:3072  lds
    s_waitcnt vmcnt(28)
    ds_read_b64_tr_b16 a[136:137], v125 offset:4096
    ds_read_b64_tr_b16 a[138:139], v125 offset:4608
    ds_read_b64_tr_b16 a[140:141], v125 offset:6144
    ds_read_b64_tr_b16 a[142:143], v125 offset:6656
    ds_read_b64_tr_b16 a[200:201], v124 offset:4096
    ds_read_b64_tr_b16 a[202:203], v124 offset:4608
    ds_read_b64_tr_b16 a[204:205], v124 offset:6144
    ds_read_b64_tr_b16 a[206:207], v124 offset:6656
    s_waitcnt lgkmcnt(0)
    s_add_u32 m0, s22, 4096
    s_lshl_b32 s19, s45, 17
    s_lshl_b32 s20, s17, 8
    s_add_u32 s19, s19, s20
    s_add_u32 s19, s19, 65536
    buffer_load_dwordx4 v122, s[76:79], s19 offen offset:0  lds
    s_add_u32 s19, s19, 7168
    buffer_load_dwordx4 v122, s[76:79], s19 offen offset:1024  lds
    s_add_u32 s19, s19, 23552
    buffer_load_dwordx4 v122, s[76:79], s19 offen offset:2048  lds
    s_add_u32 s19, s19, 7168
    buffer_load_dwordx4 v122, s[76:79], s19 offen offset:3072  lds
    s_waitcnt vmcnt(28)
    ds_read_b64_tr_b16 a[144:145], v125 offset:8192
    ds_read_b64_tr_b16 a[146:147], v125 offset:8704
    ds_read_b64_tr_b16 a[148:149], v125 offset:10240
    ds_read_b64_tr_b16 a[150:151], v125 offset:10752
    ds_read_b64_tr_b16 a[208:209], v124 offset:8192
    ds_read_b64_tr_b16 a[210:211], v124 offset:8704
    ds_read_b64_tr_b16 a[212:213], v124 offset:10240
    ds_read_b64_tr_b16 a[214:215], v124 offset:10752
    s_waitcnt lgkmcnt(0)
    s_add_u32 m0, s22, 8192
    s_lshl_b32 s19, s45, 17
    s_lshl_b32 s20, s17, 8
    s_add_u32 s19, s19, s20
    s_add_u32 s19, s19, 64
    buffer_load_dwordx4 v122, s[76:79], s19 offen offset:0  lds
    s_add_u32 s19, s19, 7168
    buffer_load_dwordx4 v122, s[76:79], s19 offen offset:1024  lds
    s_add_u32 s19, s19, 23552
    buffer_load_dwordx4 v122, s[76:79], s19 offen offset:2048  lds
    s_add_u32 s19, s19, 7168
    buffer_load_dwordx4 v122, s[76:79], s19 offen offset:3072  lds
    s_waitcnt vmcnt(28)
    ds_read_b64_tr_b16 a[152:153], v125 offset:12288
    ds_read_b64_tr_b16 a[154:155], v125 offset:12800
    ds_read_b64_tr_b16 a[156:157], v125 offset:14336
    ds_read_b64_tr_b16 a[158:159], v125 offset:14848
    ds_read_b64_tr_b16 a[216:217], v124 offset:12288
    ds_read_b64_tr_b16 a[218:219], v124 offset:12800
    ds_read_b64_tr_b16 a[220:221], v124 offset:14336
    ds_read_b64_tr_b16 a[222:223], v124 offset:14848
    s_waitcnt lgkmcnt(0)
    s_add_u32 m0, s22, 12288
    s_lshl_b32 s19, s45, 17
    s_lshl_b32 s20, s17, 8
    s_add_u32 s19, s19, s20
    s_add_u32 s19, s19, 65600
    buffer_load_dwordx4 v122, s[76:79], s19 offen offset:0  lds
    s_add_u32 s19, s19, 7168
    buffer_load_dwordx4 v122, s[76:79], s19 offen offset:1024  lds
    s_add_u32 s19, s19, 23552
    buffer_load_dwordx4 v122, s[76:79], s19 offen offset:2048  lds
    s_add_u32 s19, s19, 7168
    buffer_load_dwordx4 v122, s[76:79], s19 offen offset:3072  lds
    s_waitcnt vmcnt(28)
    ds_read_b64_tr_b16 a[160:161], v125 offset:16384
    ds_read_b64_tr_b16 a[162:163], v125 offset:16896
    ds_read_b64_tr_b16 a[164:165], v125 offset:18432
    ds_read_b64_tr_b16 a[166:167], v125 offset:18944
    ds_read_b64_tr_b16 a[224:225], v124 offset:16384
    ds_read_b64_tr_b16 a[226:227], v124 offset:16896
    ds_read_b64_tr_b16 a[228:229], v124 offset:18432
    ds_read_b64_tr_b16 a[230:231], v124 offset:18944
    s_waitcnt lgkmcnt(0)
    s_add_u32 m0, s22, 16384
    s_lshl_b32 s19, s45, 17
    s_lshl_b32 s20, s17, 8
    s_add_u32 s19, s19, s20
    s_add_u32 s19, s19, 128
    buffer_load_dwordx4 v122, s[76:79], s19 offen offset:0  lds
    s_add_u32 s19, s19, 7168
    buffer_load_dwordx4 v122, s[76:79], s19 offen offset:1024  lds
    s_add_u32 s19, s19, 23552
    buffer_load_dwordx4 v122, s[76:79], s19 offen offset:2048  lds
    s_add_u32 s19, s19, 7168
    buffer_load_dwordx4 v122, s[76:79], s19 offen offset:3072  lds
    s_waitcnt vmcnt(28)
    ds_read_b64_tr_b16 a[168:169], v125 offset:20480
    ds_read_b64_tr_b16 a[170:171], v125 offset:20992
    ds_read_b64_tr_b16 a[172:173], v125 offset:22528
    ds_read_b64_tr_b16 a[174:175], v125 offset:23040
    ds_read_b64_tr_b16 a[232:233], v124 offset:20480
    ds_read_b64_tr_b16 a[234:235], v124 offset:20992
    ds_read_b64_tr_b16 a[236:237], v124 offset:22528
    ds_read_b64_tr_b16 a[238:239], v124 offset:23040
    s_waitcnt lgkmcnt(0)
    s_add_u32 m0, s22, 20480
    s_lshl_b32 s19, s45, 17
    s_lshl_b32 s20, s17, 8
    s_add_u32 s19, s19, s20
    s_add_u32 s19, s19, 65664
    buffer_load_dwordx4 v122, s[76:79], s19 offen offset:0  lds
    s_add_u32 s19, s19, 7168
    buffer_load_dwordx4 v122, s[76:79], s19 offen offset:1024  lds
    s_add_u32 s19, s19, 23552
    buffer_load_dwordx4 v122, s[76:79], s19 offen offset:2048  lds
    s_add_u32 s19, s19, 7168
    buffer_load_dwordx4 v122, s[76:79], s19 offen offset:3072  lds
    s_waitcnt vmcnt(28)
    ds_read_b64_tr_b16 a[176:177], v125 offset:24576
    ds_read_b64_tr_b16 a[178:179], v125 offset:25088
    ds_read_b64_tr_b16 a[180:181], v125 offset:26624
    ds_read_b64_tr_b16 a[182:183], v125 offset:27136
    ds_read_b64_tr_b16 a[240:241], v124 offset:24576
    ds_read_b64_tr_b16 a[242:243], v124 offset:25088
    ds_read_b64_tr_b16 a[244:245], v124 offset:26624
    ds_read_b64_tr_b16 a[246:247], v124 offset:27136
    s_waitcnt lgkmcnt(0)
    s_add_u32 m0, s22, 24576
    s_lshl_b32 s19, s45, 17
    s_lshl_b32 s20, s17, 8
    s_add_u32 s19, s19, s20
    s_add_u32 s19, s19, 192
    buffer_load_dwordx4 v122, s[76:79], s19 offen offset:0  lds
    s_add_u32 s19, s19, 7168
    buffer_load_dwordx4 v122, s[76:79], s19 offen offset:1024  lds
    s_add_u32 s19, s19, 23552
    buffer_load_dwordx4 v122, s[76:79], s19 offen offset:2048  lds
    s_add_u32 s19, s19, 7168
    buffer_load_dwordx4 v122, s[76:79], s19 offen offset:3072  lds
    s_waitcnt vmcnt(28)
    ds_read_b64_tr_b16 a[184:185], v125 offset:28672
    ds_read_b64_tr_b16 a[186:187], v125 offset:29184
    ds_read_b64_tr_b16 a[188:189], v125 offset:30720
    ds_read_b64_tr_b16 a[190:191], v125 offset:31232
    ds_read_b64_tr_b16 a[248:249], v124 offset:28672
    ds_read_b64_tr_b16 a[250:251], v124 offset:29184
    ds_read_b64_tr_b16 a[252:253], v124 offset:30720
    ds_read_b64_tr_b16 a[254:255], v124 offset:31232
    s_waitcnt lgkmcnt(0)
    s_add_u32 m0, s22, 28672
    s_lshl_b32 s19, s45, 17
    s_lshl_b32 s20, s17, 8
    s_add_u32 s19, s19, s20
    s_add_u32 s19, s19, 65728
    buffer_load_dwordx4 v122, s[76:79], s19 offen offset:0  lds
    s_add_u32 s19, s19, 7168
    buffer_load_dwordx4 v122, s[76:79], s19 offen offset:1024  lds
    s_add_u32 s19, s19, 23552
    buffer_load_dwordx4 v122, s[76:79], s19 offen offset:2048  lds
    s_add_u32 s19, s19, 7168
    buffer_load_dwordx4 v122, s[76:79], s19 offen offset:3072  lds
    s_waitcnt vmcnt(28)
    ds_read_b64_tr_b16 v[128:129], v125 offset:0
    ds_read_b64_tr_b16 v[130:131], v125 offset:512
    ds_read_b64_tr_b16 v[132:133], v125 offset:2048
    ds_read_b64_tr_b16 v[134:135], v125 offset:2560
    ds_read_b64_tr_b16 v[144:145], v124 offset:0
    ds_read_b64_tr_b16 v[146:147], v124 offset:512
    ds_read_b64_tr_b16 v[148:149], v124 offset:2048
    ds_read_b64_tr_b16 v[150:151], v124 offset:2560
    s_waitcnt lgkmcnt(0)
    s_waitcnt vmcnt(24)
    ds_read_b64_tr_b16 v[136:137], v125 offset:4096
    ds_read_b64_tr_b16 v[138:139], v125 offset:4608
    ds_read_b64_tr_b16 v[140:141], v125 offset:6144
    ds_read_b64_tr_b16 v[142:143], v125 offset:6656
    ds_read_b64_tr_b16 v[152:153], v124 offset:4096
    ds_read_b64_tr_b16 v[154:155], v124 offset:4608
    ds_read_b64_tr_b16 v[156:157], v124 offset:6144
    ds_read_b64_tr_b16 v[158:159], v124 offset:6656
    s_waitcnt lgkmcnt(0)
    s_waitcnt vmcnt(20)
    ds_read_b64_tr_b16 v[160:161], v125 offset:8192
    ds_read_b64_tr_b16 v[162:163], v125 offset:8704
    ds_read_b64_tr_b16 v[164:165], v125 offset:10240
    ds_read_b64_tr_b16 v[166:167], v125 offset:10752
    ds_read_b64_tr_b16 v[176:177], v124 offset:8192
    ds_read_b64_tr_b16 v[178:179], v124 offset:8704
    ds_read_b64_tr_b16 v[180:181], v124 offset:10240
    ds_read_b64_tr_b16 v[182:183], v124 offset:10752
    s_waitcnt lgkmcnt(0)
    s_waitcnt vmcnt(16)
    ds_read_b64_tr_b16 v[168:169], v125 offset:12288
    ds_read_b64_tr_b16 v[170:171], v125 offset:12800
    ds_read_b64_tr_b16 v[172:173], v125 offset:14336
    ds_read_b64_tr_b16 v[174:175], v125 offset:14848
    ds_read_b64_tr_b16 v[184:185], v124 offset:12288
    ds_read_b64_tr_b16 v[186:187], v124 offset:12800
    ds_read_b64_tr_b16 v[188:189], v124 offset:14336
    ds_read_b64_tr_b16 v[190:191], v124 offset:14848
    s_waitcnt lgkmcnt(0)
    s_waitcnt vmcnt(12)
    ds_read_b64_tr_b16 v[192:193], v125 offset:16384
    ds_read_b64_tr_b16 v[194:195], v125 offset:16896
    ds_read_b64_tr_b16 v[196:197], v125 offset:18432
    ds_read_b64_tr_b16 v[198:199], v125 offset:18944
    ds_read_b64_tr_b16 v[208:209], v124 offset:16384
    ds_read_b64_tr_b16 v[210:211], v124 offset:16896
    ds_read_b64_tr_b16 v[212:213], v124 offset:18432
    ds_read_b64_tr_b16 v[214:215], v124 offset:18944
    s_waitcnt lgkmcnt(0)
    s_waitcnt vmcnt(8)
    ds_read_b64_tr_b16 v[200:201], v125 offset:20480
    ds_read_b64_tr_b16 v[202:203], v125 offset:20992
    ds_read_b64_tr_b16 v[204:205], v125 offset:22528
    ds_read_b64_tr_b16 v[206:207], v125 offset:23040
    ds_read_b64_tr_b16 v[216:217], v124 offset:20480
    ds_read_b64_tr_b16 v[218:219], v124 offset:20992
    ds_read_b64_tr_b16 v[220:221], v124 offset:22528
    ds_read_b64_tr_b16 v[222:223], v124 offset:23040
    s_waitcnt lgkmcnt(0)
    s_waitcnt vmcnt(4)
    ds_read_b64_tr_b16 v[224:225], v125 offset:24576
    ds_read_b64_tr_b16 v[226:227], v125 offset:25088
    ds_read_b64_tr_b16 v[228:229], v125 offset:26624
    ds_read_b64_tr_b16 v[230:231], v125 offset:27136
    ds_read_b64_tr_b16 v[240:241], v124 offset:24576
    ds_read_b64_tr_b16 v[242:243], v124 offset:25088
    ds_read_b64_tr_b16 v[244:245], v124 offset:26624
    ds_read_b64_tr_b16 v[246:247], v124 offset:27136
    s_waitcnt lgkmcnt(0)
    s_waitcnt vmcnt(0)
    ds_read_b64_tr_b16 v[232:233], v125 offset:28672
    ds_read_b64_tr_b16 v[234:235], v125 offset:29184
    ds_read_b64_tr_b16 v[236:237], v125 offset:30720
    ds_read_b64_tr_b16 v[238:239], v125 offset:31232
    ds_read_b64_tr_b16 v[248:249], v124 offset:28672
    ds_read_b64_tr_b16 v[250:251], v124 offset:29184
    ds_read_b64_tr_b16 v[252:253], v124 offset:30720
    ds_read_b64_tr_b16 v[254:255], v124 offset:31232
    s_waitcnt lgkmcnt(0)
    s_barrier
    s_mov_b32 s47, 0xbdd2d3e8
    s_mov_b32 s48, 0xc0135761
    s_lshl_b32 s41, s46, 19
    s_lshl_b32 s19, s17, 17
    s_add_u32 s41, s41, s19
    s_lshl_b32 s19, s45, 10
    s_add_u32 s41, s41, s19
    s_add_u32 s41, s41, 67108864
    s_mov_b32 s30, s46
    s_mov_b32 s43, -1
    v_mov_b32 v9, s48
    v_add_u32 v10, 65536, v8
    v_add_u32 v11, 65536, v0
    s_lshl_b32 s31, s30, 15
    s_lshl_b32 s36, s17, 13
    s_add_u32 s31, s31, s36
    s_add_u32 m0, s36, 0
    v_xor_b32 v6, 0, v5
    buffer_load_dwordx4 v6, s[32:35], s31 offen offset:0 lds
    v_xor_b32 v7, 16, v5
    buffer_load_dwordx4 v7, s[32:35], s31 offen offset:1024 lds
    v_xor_b32 v6, 32, v5
    buffer_load_dwordx4 v6, s[32:35], s31 offen offset:2048 lds
    v_xor_b32 v7, 48, v5
    buffer_load_dwordx4 v7, s[32:35], s31 offen offset:3072 lds
    s_add_u32 m0, s36, 4096
    s_add_u32 s31, s31, 4096
    v_xor_b32 v6, 64, v5
    buffer_load_dwordx4 v6, s[32:35], s31 offen offset:0 lds
    v_xor_b32 v7, 80, v5
    buffer_load_dwordx4 v7, s[32:35], s31 offen offset:1024 lds
    v_xor_b32 v6, 96, v5
    buffer_load_dwordx4 v6, s[32:35], s31 offen offset:2048 lds
    v_xor_b32 v7, 112, v5
    buffer_load_dwordx4 v7, s[32:35], s31 offen offset:3072 lds
    s_waitcnt vmcnt(0)
L_f_loop:
    s_waitcnt vmcnt(8)
    s_barrier
    s_add_u32 s21, s30, 2
    s_min_u32 s21, s21, 63
    s_max_i32 s22, s43, 0
    s_cmp_lg_u32 s17, 0
    s_cbranch_scc1 L_f_nf0
    s_mov_b64 exec, 1
    v_mov_b32 v6, s22
    buffer_store_dword v6, off, s[4:7], s40 sc1
    s_mov_b64 exec, -1
L_f_nf0:
    s_add_u32 s43, s43, 1
    ds_read_b128 v[16:19], v1 offset:0
    s_waitcnt lgkmcnt(0)
    ds_read_b128 v[20:23], v1 offset:16384
    v_mfma_f32_16x16x32_bf16 v[32:35], a[0:3], v[16:19], 0
    s_waitcnt lgkmcnt(0)
    ds_read_b128 v[24:27], v2 offset:0
    v_mfma_f32_16x16x32_bf16 v[40:43], a[0:3], v[20:23], 0
    ds_read_b128 v[28:31], v2 offset:16384
    v_mfma_f32_16x16x32_bf16 v[36:39], a[64:67], v[16:19], 0
    v_mfma_f32_16x16x32_bf16 v[44:47], a[64:67], v[20:23], 0
    s_lshl_b32 s31, s21, 15
    s_lshl_b32 s36, s17, 13
    s_add_u32 s31, s31, s36
    s_add_u32 s36, s36, 32768
    v_mfma_f32_16x16x32_bf16 v[48:51], a[128:131], v[16:19], 0
    v_mfma_f32_16x16x32_bf16 v[56:59], a[128:131], v[20:23], 0
    v_mfma_f32_16x16x32_bf16 v[52:55], a[192:195], v[16:19], 0
    v_mfma_f32_16x16x32_bf16 v[60:63], a[192:195], v[20:23], 0
    s_waitcnt lgkmcnt(1)
    v_mfma_f32_16x16x32_bf16 v[32:35], a[4:7], v[24:27], v[32:35]
    s_waitcnt lgkmcnt(0)
    ds_read_b128 v[16:19], v3 offset:0
    v_mfma_f32_16x16x32_bf16 v[40:43], a[4:7], v[28:31], v[40:43]
    ds_read_b128 v[20:23], v3 offset:16384
    v_mfma_f32_16x16x32_bf16 v[36:39], a[68:71], v[24:27], v[36:39]
    v_mfma_f32_16x16x32_bf16 v[44:47], a[68:71], v[28:31], v[44:47]
    s_add_u32 m0, s36, 0
    v_xor_b32 v6, 0, v5
    buffer_load_dwordx4 v6, s[32:35], s31 offen offset:0 lds
    v_mfma_f32_16x16x32_bf16 v[48:51], a[132:135], v[24:27], v[48:51]
    v_mfma_f32_16x16x32_bf16 v[56:59], a[132:135], v[28:31], v[56:59]
    v_mfma_f32_16x16x32_bf16 v[52:55], a[196:199], v[24:27], v[52:55]
    v_mfma_f32_16x16x32_bf16 v[60:63], a[196:199], v[28:31], v[60:63]
    s_waitcnt lgkmcnt(1)
    v_mfma_f32_16x16x32_bf16 v[32:35], a[8:11], v[16:19], v[32:35]
    s_waitcnt lgkmcnt(0)
    ds_read_b128 v[24:27], v4 offset:0
    v_mfma_f32_16x16x32_bf16 v[40:43], a[8:11], v[20:23], v[40:43]
    ds_read_b128 v[28:31], v4 offset:16384
    v_mfma_f32_16x16x32_bf16 v[36:39], a[72:75], v[16:19], v[36:39]
    v_mfma_f32_16x16x32_bf16 v[44:47], a[72:75], v[20:23], v[44:47]
    v_xor_b32 v7, 16, v5
    buffer_load_dwordx4 v7, s[32:35], s31 offen offset:1024 lds
    v_mfma_f32_16x16x32_bf16 v[48:51], a[136:139], v[16:19], v[48:51]
    v_mfma_f32_16x16x32_bf16 v[56:59], a[136:139], v[20:23], v[56:59]
    v_mfma_f32_16x16x32_bf16 v[52:55], a[200:203], v[16:19], v[52:55]
    v_mfma_f32_16x16x32_bf16 v[60:63], a[200:203], v[20:23], v[60:63]
    s_waitcnt lgkmcnt(1)
    v_mfma_f32_16x16x32_bf16 v[32:35], a[12:15], v[24:27], v[32:35]
    s_waitcnt lgkmcnt(0)
    ds_read_b128 v[16:19], v1 offset:256
    v_mfma_f32_16x16x32_bf16 v[40:43], a[12:15], v[28:31], v[40:43]
    ds_read_b128 v[20:23], v1 offset:16640
    v_mfma_f32_16x16x32_bf16 v[36:39], a[76:79], v[24:27], v[36:39]
    v_mfma_f32_16x16x32_bf16 v[44:47], a[76:79], v[28:31], v[44:47]
    v_xor_b32 v6, 32, v5
    buffer_load_dwordx4 v6, s[32:35], s31 offen offset:2048 lds
    v_mfma_f32_16x16x32_bf16 v[48:51], a[140:143], v[24:27], v[48:51]
    v_mfma_f32_16x16x32_bf16 v[56:59], a[140:143], v[28:31], v[56:59]
    v_mfma_f32_16x16x32_bf16 v[52:55], a[204:207], v[24:27], v[52:55]
    v_mfma_f32_16x16x32_bf16 v[60:63], a[204:207], v[28:31], v[60:63]
    s_waitcnt lgkmcnt(1)
    v_mfma_f32_16x16x32_bf16 v[32:35], a[16:19], v[16:19], v[32:35]
    s_waitcnt lgkmcnt(0)
    ds_read_b128 v[24:27], v2 offset:256
    v_mfma_f32_16x16x32_bf16 v[40:43], a[16:19], v[20:23], v[40:43]
    ds_read_b128 v[28:31], v2 offset:16640
    v_mfma_f32_16x16x32_bf16 v[36:39], a[80:83], v[16:19], v[36:39]
    v_mfma_f32_16x16x32_bf16 v[44:47], a[80:83], v[20:23], v[44:47]
    v_xor_b32 v7, 48, v5
    buffer_load_dwordx4 v7, s[32:35], s31 offen offset:3072 lds
    v_mfma_f32_16x16x32_bf16 v[48:51], a[144:147], v[16:19], v[48:51]
    v_mfma_f32_16x16x32_bf16 v[56:59], a[144:147], v[20:23], v[56:59]
    v_mfma_f32_16x16x32_bf16 v[52:55], a[208:211], v[16:19], v[52:55]
    v_mfma_f32_16x16x32_bf16 v[60:63], a[208:211], v[20:23], v[60:63]
    s_waitcnt lgkmcnt(1)
    v_mfma_f32_16x16x32_bf16 v[32:35], a[20:23], v[24:27], v[32:35]
    s_waitcnt lgkmcnt(0)
    ds_read_b128 v[16:19], v3 offset:256
    v_mfma_f32_16x16x32_bf16 v[40:43], a[20:23], v[28:31], v[40:43]
    ds_read_b128 v[20:23], v3 offset:16640
    v_mfma_f32_16x16x32_bf16 v[36:39], a[84:87], v[24:27], v[36:39]
    v_mfma_f32_16x16x32_bf16 v[44:47], a[84:87], v[28:31], v[44:47]
    s_add_u32 m0, s36, 4096
    s_add_u32 s31, s31, 4096
    v_xor_b32 v6, 64, v5
    buffer_load_dwordx4 v6, s[32:35], s31 offen offset:0 lds
    v_mfma_f32_16x16x32_bf16 v[48:51], a[148:151], v[24:27], v[48:51]
    v_mfma_f32_16x16x32_bf16 v[56:59], a[148:151], v[28:31], v[56:59]
    v_mfma_f32_16x16x32_bf16 v[52:55], a[212:215], v[24:27], v[52:55]
    v_mfma_f32_16x16x32_bf16 v[60:63], a[212:215], v[28:31], v[60:63]
    s_waitcnt lgkmcnt(1)
    v_mfma_f32_16x16x32_bf16 v[32:35], a[24:27], v[16:19], v[32:35]
    s_waitcnt lgkmcnt(0)
    ds_read_b128 v[24:27], v4 offset:256
    v_mfma_f32_16x16x32_bf16 v[40:43], a[24:27], v[20:23], v[40:43]
    ds_read_b128 v[28:31], v4 offset:16640
    v_mfma_f32_16x16x32_bf16 v[36:39], a[88:91], v[16:19], v[36:39]
    v_mfma_f32_16x16x32_bf16 v[44:47], a[88:91], v[20:23], v[44:47]
    v_xor_b32 v7, 80, v5
    buffer_load_dwordx4 v7, s[32:35], s31 offen offset:1024 lds
    v_mfma_f32_16x16x32_bf16 v[48:51], a[152:155], v[16:19], v[48:51]
    v_mfma_f32_16x16x32_bf16 v[56:59], a[152:155], v[20:23], v[56:59]
    v_mfma_f32_16x16x32_bf16 v[52:55], a[216:219], v[16:19], v[52:55]
    v_mfma_f32_16x16x32_bf16 v[60:63], a[216:219], v[20:23], v[60:63]
    s_waitcnt lgkmcnt(1)
    v_mfma_f32_16x16x32_bf16 v[32:35], a[28:31], v[24:27], v[32:35]
    s_waitcnt lgkmcnt(0)
    ds_read_b128 v[16:19], v1 offset:512
    v_mfma_f32_16x16x32_bf16 v[40:43], a[28:31], v[28:31], v[40:43]
    ds_read_b128 v[20:23], v1 offset:16896
    v_mfma_f32_16x16x32_bf16 v[36:39], a[92:95], v[24:27], v[36:39]
    v_mfma_f32_16x16x32_bf16 v[44:47], a[92:95], v[28:31], v[44:47]
    v_xor_b32 v6, 96, v5
    buffer_load_dwordx4 v6, s[32:35], s31 offen offset:2048 lds
    v_mfma_f32_16x16x32_bf16 v[48:51], a[156:159], v[24:27], v[48:51]
    v_mfma_f32_16x16x32_bf16 v[56:59], a[156:159], v[28:31], v[56:59]
    v_mfma_f32_16x16x32_bf16 v[52:55], a[220:223], v[24:27], v[52:55]
    v_mfma_f32_16x16x32_bf16 v[60:63], a[220:223], v[28:31], v[60:63]
    s_waitcnt lgkmcnt(1)
    v_mfma_f32_16x16x32_bf16 v[32:35], a[32:35], v[16:19], v[32:35]
    s_waitcnt lgkmcnt(0)
    ds_read_b128 v[24:27], v2 offset:512
    v_mfma_f32_16x16x32_bf16 v[40:43], a[32:35], v[20:23], v[40:43]
    ds_read_b128 v[28:31], v2 offset:16896
    v_mfma_f32_16x16x32_bf16 v[36:39], a[96:99], v[16:19], v[36:39]
    v_mfma_f32_16x16x32_bf16 v[44:47], a[96:99], v[20:23], v[44:47]
    v_xor_b32 v7, 112, v5
    buffer_load_dwordx4 v7, s[32:35], s31 offen offset:3072 lds
    v_mfma_f32_16x16x32_bf16 v[48:51], a[160:163], v[16:19], v[48:51]
    v_mfma_f32_16x16x32_bf16 v[56:59], a[160:163], v[20:23], v[56:59]
    v_mfma_f32_16x16x32_bf16 v[52:55], a[224:227], v[16:19], v[52:55]
    v_mfma_f32_16x16x32_bf16 v[60:63], a[224:227], v[20:23], v[60:63]
    s_waitcnt lgkmcnt(1)
    v_mfma_f32_16x16x32_bf16 v[32:35], a[36:39], v[24:27], v[32:35]
    s_waitcnt lgkmcnt(0)
    ds_read_b128 v[16:19], v3 offset:512
    v_mfma_f32_16x16x32_bf16 v[40:43], a[36:39], v[28:31], v[40:43]
    ds_read_b128 v[20:23], v3 offset:16896
    v_mfma_f32_16x16x32_bf16 v[36:39], a[100:103], v[24:27], v[36:39]
    v_mfma_f32_16x16x32_bf16 v[44:47], a[100:103], v[28:31], v[44:47]
    v_mfma_f32_16x16x32_bf16 v[48:51], a[164:167], v[24:27], v[48:51]
    v_mfma_f32_16x16x32_bf16 v[56:59], a[164:167], v[28:31], v[56:59]
    v_mfma_f32_16x16x32_bf16 v[52:55], a[228:231], v[24:27], v[52:55]
    v_mfma_f32_16x16x32_bf16 v[60:63], a[228:231], v[28:31], v[60:63]
    s_waitcnt lgkmcnt(1)
    v_mfma_f32_16x16x32_bf16 v[32:35], a[40:43], v[16:19], v[32:35]
    s_waitcnt lgkmcnt(0)
    ds_read_b128 v[24:27], v4 offset:512
    v_mfma_f32_16x16x32_bf16 v[40:43], a[40:43], v[20:23], v[40:43]
    ds_read_b128 v[28:31], v4 offset:16896
    v_mfma_f32_16x16x32_bf16 v[36:39], a[104:107], v[16:19], v[36:39]
    v_mfma_f32_16x16x32_bf16 v[44:47], a[104:107], v[20:23], v[44:47]
    v_mfma_f32_16x16x32_bf16 v[48:51], a[168:171], v[16:19], v[48:51]
    v_mfma_f32_16x16x32_bf16 v[56:59], a[168:171], v[20:23], v[56:59]
    v_mfma_f32_16x16x32_bf16 v[52:55], a[232:235], v[16:19], v[52:55]
    v_mfma_f32_16x16x32_bf16 v[60:63], a[232:235], v[20:23], v[60:63]
    s_waitcnt lgkmcnt(1)
    v_mfma_f32_16x16x32_bf16 v[32:35], a[44:47], v[24:27], v[32:35]
    s_waitcnt lgkmcnt(0)
    ds_read_b128 v[16:19], v1 offset:768
    v_mfma_f32_16x16x32_bf16 v[40:43], a[44:47], v[28:31], v[40:43]
    ds_read_b128 v[20:23], v1 offset:17152
    v_mfma_f32_16x16x32_bf16 v[36:39], a[108:111], v[24:27], v[36:39]
    v_mfma_f32_16x16x32_bf16 v[44:47], a[108:111], v[28:31], v[44:47]
    v_mfma_f32_16x16x32_bf16 v[48:51], a[172:175], v[24:27], v[48:51]
    v_mfma_f32_16x16x32_bf16 v[56:59], a[172:175], v[28:31], v[56:59]
    v_mfma_f32_16x16x32_bf16 v[52:55], a[236:239], v[24:27], v[52:55]
    v_mfma_f32_16x16x32_bf16 v[60:63], a[236:239], v[28:31], v[60:63]
    s_waitcnt lgkmcnt(1)
    v_mfma_f32_16x16x32_bf16 v[32:35], a[48:51], v[16:19], v[32:35]
    s_waitcnt lgkmcnt(0)
    ds_read_b128 v[24:27], v2 offset:768
    v_mfma_f32_16x16x32_bf16 v[40:43], a[48:51], v[20:23], v[40:43]
    ds_read_b128 v[28:31], v2 offset:17152
    v_mfma_f32_16x16x32_bf16 v[36:39], a[112:115], v[16:19], v[36:39]
    v_mfma_f32_16x16x32_bf16 v[44:47], a[112:115], v[20:23], v[44:47]
    v_mfma_f32_16x16x32_bf16 v[48:51], a[176:179], v[16:19], v[48:51]
    v_mfma_f32_16x16x32_bf16 v[56:59], a[176:179], v[20:23], v[56:59]
    v_mfma_f32_16x16x32_bf16 v[52:55], a[240:243], v[16:19], v[52:55]
    v_mfma_f32_16x16x32_bf16 v[60:63], a[240:243], v[20:23], v[60:63]
    s_waitcnt lgkmcnt(1)
    v_mfma_f32_16x16x32_bf16 v[32:35], a[52:55], v[24:27], v[32:35]
    s_waitcnt lgkmcnt(0)
    ds_read_b128 v[16:19], v3 offset:768
    v_mfma_f32_16x16x32_bf16 v[40:43], a[52:55], v[28:31], v[40:43]
    ds_read_b128 v[20:23], v3 offset:17152
    v_mfma_f32_16x16x32_bf16 v[36:39], a[116:119], v[24:27], v[36:39]
    v_mfma_f32_16x16x32_bf16 v[44:47], a[116:119], v[28:31], v[44:47]
    v_mfma_f32_16x16x32_bf16 v[48:51], a[180:183], v[24:27], v[48:51]
    v_mfma_f32_16x16x32_bf16 v[56:59], a[180:183], v[28:31], v[56:59]
    v_mfma_f32_16x16x32_bf16 v[52:55], a[244:247], v[24:27], v[52:55]
    v_mfma_f32_16x16x32_bf16 v[60:63], a[244:247], v[28:31], v[60:63]
    s_waitcnt lgkmcnt(1)
    v_mfma_f32_16x16x32_bf16 v[32:35], a[56:59], v[16:19], v[32:35]
    s_waitcnt lgkmcnt(0)
    ds_read_b128 v[24:27], v4 offset:768
    v_mfma_f32_16x16x32_bf16 v[40:43], a[56:59], v[20:23], v[40:43]
    ds_read_b128 v[28:31], v4 offset:17152
    v_mfma_f32_16x16x32_bf16 v[36:39], a[120:123], v[16:19], v[36:39]
    v_mfma_f32_16x16x32_bf16 v[44:47], a[120:123], v[20:23], v[44:47]
    v_mfma_f32_16x16x32_bf16 v[48:51], a[184:187], v[16:19], v[48:51]
    v_mfma_f32_16x16x32_bf16 v[56:59], a[184:187], v[20:23], v[56:59]
    v_mfma_f32_16x16x32_bf16 v[52:55], a[248:251], v[16:19], v[52:55]
    v_mfma_f32_16x16x32_bf16 v[60:63], a[248:251], v[20:23], v[60:63]
    s_waitcnt lgkmcnt(1)
    v_mfma_f32_16x16x32_bf16 v[32:35], a[60:63], v[24:27], v[32:35]
    s_waitcnt lgkmcnt(0)
    v_mfma_f32_16x16x32_bf16 v[40:43], a[60:63], v[28:31], v[40:43]
    v_mfma_f32_16x16x32_bf16 v[36:39], a[124:127], v[24:27], v[36:39]
    v_mfma_f32_16x16x32_bf16 v[44:47], a[124:127], v[28:31], v[44:47]
    v_mfma_f32_16x16x32_bf16 v[48:51], a[188:191], v[24:27], v[48:51]
    v_mfma_f32_16x16x32_bf16 v[56:59], a[188:191], v[28:31], v[56:59]
    v_mfma_f32_16x16x32_bf16 v[52:55], a[252:255], v[24:27], v[52:55]
    v_mfma_f32_16x16x32_bf16 v[60:63], a[252:255], v[28:31], v[60:63]
    v_cvt_pk_bf16_f32 v112, v32, v33
    v_cvt_pk_bf16_f32 v113, v34, v35
    v_cvt_pk_bf16_f32 v114, v36, v37
    v_cvt_pk_bf16_f32 v115, v38, v39
    v_cvt_pk_bf16_f32 v116, v48, v49
    v_cvt_pk_bf16_f32 v117, v50, v51
    v_cvt_pk_bf16_f32 v118, v52, v53
    v_cvt_pk_bf16_f32 v119, v54, v55
    v_lshlrev_b32 v32, 16, v112
    v_and_b32 v33, 0xffff0000, v112
    v_lshlrev_b32 v48, 16, v116
    v_and_b32 v49, 0xffff0000, v116
    v_lshlrev_b32 v34, 16, v113
    v_and_b32 v35, 0xffff0000, v113
    v_lshlrev_b32 v50, 16, v117
    v_and_b32 v51, 0xffff0000, v117
    v_lshlrev_b32 v36, 16, v114
    v_and_b32 v37, 0xffff0000, v114
    v_lshlrev_b32 v52, 16, v118
    v_and_b32 v53, 0xffff0000, v118
    v_lshlrev_b32 v38, 16, v115
    v_and_b32 v39, 0xffff0000, v115
    v_lshlrev_b32 v54, 16, v119
    v_and_b32 v55, 0xffff0000, v119
    v_mul_f32 v112, v32, v32
    v_mul_f32 v113, v33, v33
    v_mul_f32 v114, v34, v34
    v_mul_f32 v115, v35, v35
    v_mul_f32 v116, v36, v36
    v_mul_f32 v117, v37, v37
    v_mul_f32 v118, v38, v38
    v_mul_f32 v119, v39, v39
    v_fma_f32 v112, v112, s47, v9
    v_fma_f32 v113, v113, s47, v9
    v_fma_f32 v114, v114, s47, v9
    v_fma_f32 v115, v115, s47, v9
    v_fma_f32 v116, v116, s47, v9
    v_fma_f32 v117, v117, s47, v9
    v_fma_f32 v118, v118, s47, v9
    v_fma_f32 v119, v119, s47, v9
    v_mul_f32 v112, v112, v32
    v_mul_f32 v113, v113, v33
    v_mul_f32 v114, v114, v34
    v_mul_f32 v115, v115, v35
    v_mul_f32 v116, v116, v36
    v_mul_f32 v117, v117, v37
    v_mul_f32 v118, v118, v38
    v_mul_f32 v119, v119, v39
    v_exp_f32 v112, v112
    v_exp_f32 v113, v113
    v_exp_f32 v114, v114
    v_exp_f32 v115, v115
    v_exp_f32 v116, v116
    v_exp_f32 v117, v117
    v_exp_f32 v118, v118
    v_exp_f32 v119, v119
    v_add_f32 v112, 1.0, v112
    v_add_f32 v113, 1.0, v113
    v_add_f32 v114, 1.0, v114
    v_add_f32 v115, 1.0, v115
    v_add_f32 v116, 1.0, v116
    v_add_f32 v117, 1.0, v117
    v_add_f32 v118, 1.0, v118
    v_add_f32 v119, 1.0, v119
    v_rcp_f32 v112, v112
    v_rcp_f32 v113, v113
    v_rcp_f32 v114, v114
    v_rcp_f32 v115, v115
    v_rcp_f32 v116, v116
    v_rcp_f32 v117, v117
    v_rcp_f32 v118, v118
    v_rcp_f32 v119, v119
    v_mul_f32 v32, v32, v112
    v_mul_f32 v33, v33, v113
    v_mul_f32 v34, v34, v114
    v_mul_f32 v35, v35, v115
    v_mul_f32 v36, v36, v116
    v_mul_f32 v37, v37, v117
    v_mul_f32 v38, v38, v118
    v_mul_f32 v39, v39, v119
    v_cvt_pk_bf16_f32 v112, v32, v33
    v_cvt_pk_bf16_f32 v113, v34, v35
    v_cvt_pk_bf16_f32 v114, v36, v37
    v_cvt_pk_bf16_f32 v115, v38, v39
    v_lshlrev_b32 v32, 16, v112
    v_and_b32 v33, 0xffff0000, v112
    v_lshlrev_b32 v34, 16, v113
    v_and_b32 v35, 0xffff0000, v113
    v_lshlrev_b32 v36, 16, v114
    v_and_b32 v37, 0xffff0000, v114
    v_lshlrev_b32 v38, 16, v115
    v_and_b32 v39, 0xffff0000, v115
    v_mul_f32 v32, v32, v48
    v_mul_f32 v33, v33, v49
    v_mul_f32 v34, v34, v50
    v_mul_f32 v35, v35, v51
    v_mul_f32 v36, v36, v52
    v_mul_f32 v37, v37, v53
    v_mul_f32 v38, v38, v54
    v_mul_f32 v39, v39, v55
    v_cvt_pk_bf16_f32 v32, v32, v33
    v_cvt_pk_bf16_f32 v33, v34, v35
    v_cvt_pk_bf16_f32 v34, v36, v37
    v_cvt_pk_bf16_f32 v35, v38, v39
    ds_write_b128 v10, v[32:35] offset:0
    v_cvt_pk_bf16_f32 v112, v40, v41
    v_cvt_pk_bf16_f32 v113, v42, v43
    v_cvt_pk_bf16_f32 v114, v44, v45
    v_cvt_pk_bf16_f32 v115, v46, v47
    v_cvt_pk_bf16_f32 v116, v56, v57
    v_cvt_pk_bf16_f32 v117, v58, v59
    v_cvt_pk_bf16_f32 v118, v60, v61
    v_cvt_pk_bf16_f32 v119, v62, v63
    v_lshlrev_b32 v40, 16, v112
    v_and_b32 v41, 0xffff0000, v112
    v_lshlrev_b32 v56, 16, v116
    v_and_b32 v57, 0xffff0000, v116
    v_lshlrev_b32 v42, 16, v113
    v_and_b32 v43, 0xffff0000, v113
    v_lshlrev_b32 v58, 16, v117
    v_and_b32 v59, 0xffff0000, v117
    v_lshlrev_b32 v44, 16, v114
    v_and_b32 v45, 0xffff0000, v114
    v_lshlrev_b32 v60, 16, v118
    v_and_b32 v61, 0xffff0000, v118
    v_lshlrev_b32 v46, 16, v115
    v_and_b32 v47, 0xffff0000, v115
    v_lshlrev_b32 v62, 16, v119
    v_and_b32 v63, 0xffff0000, v119
    v_mul_f32 v112, v40, v40
    v_mul_f32 v113, v41, v41
    v_mul_f32 v114, v42, v42
    v_mul_f32 v115, v43, v43
    v_mul_f32 v116, v44, v44
    v_mul_f32 v117, v45, v45
    v_mul_f32 v118, v46, v46
    v_mul_f32 v119, v47, v47
    v_fma_f32 v112, v112, s47, v9
    v_fma_f32 v113, v113, s47, v9
    v_fma_f32 v114, v114, s47, v9
    v_fma_f32 v115, v115, s47, v9
    v_fma_f32 v116, v116, s47, v9
    v_fma_f32 v117, v117, s47, v9
    v_fma_f32 v118, v118, s47, v9
    v_fma_f32 v119, v119, s47, v9
    v_mul_f32 v112, v112, v40
    v_mul_f32 v113, v113, v41
    v_mul_f32 v114, v114, v42
    v_mul_f32 v115, v115, v43
    v_mul_f32 v116, v116, v44
    v_mul_f32 v117, v117, v45
    v_mul_f32 v118, v118, v46
    v_mul_f32 v119, v119, v47
    v_exp_f32 v112, v112
    v_exp_f32 v113, v113
    v_exp_f32 v114, v114
    v_exp_f32 v115, v115
    v_exp_f32 v116, v116
    v_exp_f32 v117, v117
    v_exp_f32 v118, v118
    v_exp_f32 v119, v119
    v_add_f32 v112, 1.0, v112
    v_add_f32 v113, 1.0, v113
    v_add_f32 v114, 1.0, v114
    v_add_f32 v115, 1.0, v115
    v_add_f32 v116, 1.0, v116
    v_add_f32 v117, 1.0, v117
    v_add_f32 v118, 1.0, v118
    v_add_f32 v119, 1.0, v119
    v_rcp_f32 v112, v112
    v_rcp_f32 v113, v113
    v_rcp_f32 v114, v114
    v_rcp_f32 v115, v115
    v_rcp_f32 v116, v116
    v_rcp_f32 v117, v117
    v_rcp_f32 v118, v118
    v_rcp_f32 v119, v119
    v_mul_f32 v40, v40, v112
    v_mul_f32 v41, v41, v113
    v_mul_f32 v42, v42, v114
    v_mul_f32 v43, v43, v115
    v_mul_f32 v44, v44, v116
    v_mul_f32 v45, v45, v117
    v_mul_f32 v46, v46, v118
    v_mul_f32 v47, v47, v119
    v_cvt_pk_bf16_f32 v112, v40, v41
    v_cvt_pk_bf16_f32 v113, v42, v43
    v_cvt_pk_bf16_f32 v114, v44, v45
    v_cvt_pk_bf16_f32 v115, v46, v47
    v_lshlrev_b32 v40, 16, v112
    v_and_b32 v41, 0xffff0000, v112
    v_lshlrev_b32 v42, 16, v113
    v_and_b32 v43, 0xffff0000, v113
    v_lshlrev_b32 v44, 16, v114
    v_and_b32 v45, 0xffff0000, v114
    v_lshlrev_b32 v46, 16, v115
    v_and_b32 v47, 0xffff0000, v115
    v_mul_f32 v40, v40, v56
    v_mul_f32 v41, v41, v57
    v_mul_f32 v42, v42, v58
    v_mul_f32 v43, v43, v59
    v_mul_f32 v44, v44, v60
    v_mul_f32 v45, v45, v61
    v_mul_f32 v46, v46, v62
    v_mul_f32 v47, v47, v63
    v_cvt_pk_bf16_f32 v40, v40, v41
    v_cvt_pk_bf16_f32 v41, v42, v43
    v_cvt_pk_bf16_f32 v42, v44, v45
    v_cvt_pk_bf16_f32 v43, v46, v47
    ds_write_b128 v10, v[40:43] offset:4096
    s_waitcnt lgkmcnt(0)
    s_barrier
    ds_read_b128 v[64:67], v11 offset:0
    ds_read_b128 v[68:71], v11 offset:1024
    ds_read_b128 v[72:75], v11 offset:2048
    ds_read_b128 v[76:79], v11 offset:3072
    ds_read_b128 v[80:83], v11 offset:4096
    s_waitcnt lgkmcnt(4)
    ds_read_b128 v[84:87], v11 offset:5120
    ds_read_b128 v[88:91], v11 offset:6144
    ds_read_b128 v[92:95], v11 offset:7168
    v_mfma_f32_16x16x32_bf16 v[96:99], v[64:67], v[128:131], 0
    s_waitcnt lgkmcnt(3)
    v_mfma_f32_16x16x32_bf16 v[100:103], v[80:83], v[128:131], 0
    v_mfma_f32_16x16x32_bf16 v[96:99], v[68:71], v[132:135], v[96:99]
    s_waitcnt lgkmcnt(2)
    v_mfma_f32_16x16x32_bf16 v[100:103], v[84:87], v[132:135], v[100:103]
    v_mfma_f32_16x16x32_bf16 v[96:99], v[72:75], v[136:139], v[96:99]
    s_waitcnt lgkmcnt(1)
    v_mfma_f32_16x16x32_bf16 v[100:103], v[88:91], v[136:139], v[100:103]
    v_mfma_f32_16x16x32_bf16 v[96:99], v[76:79], v[140:143], v[96:99]
    s_waitcnt lgkmcnt(0)
    v_mfma_f32_16x16x32_bf16 v[100:103], v[92:95], v[140:143], v[100:103]
    v_mfma_f32_16x16x32_bf16 v[104:107], v[64:67], v[144:147], 0
    v_mfma_f32_16x16x32_bf16 v[108:111], v[80:83], v[144:147], 0
    v_mfma_f32_16x16x32_bf16 v[104:107], v[68:71], v[148:151], v[104:107]
    v_cvt_pk_bf16_f32 v96, v96, v97
    v_mfma_f32_16x16x32_bf16 v[108:111], v[84:87], v[148:151], v[108:111]
    v_cvt_pk_bf16_f32 v97, v98, v99
    v_mfma_f32_16x16x32_bf16 v[104:107], v[72:75], v[152:155], v[104:107]
    v_cvt_pk_bf16_f32 v98, v100, v101
    v_mfma_f32_16x16x32_bf16 v[108:111], v[88:91], v[152:155], v[108:111]
    v_cvt_pk_bf16_f32 v99, v102, v103
    v_mfma_f32_16x16x32_bf16 v[104:107], v[76:79], v[156:159], v[104:107]
    s_add_u32 s19, s41, 0
    buffer_store_dwordx4 v[96:99], v0, s[4:7], s19 offen sc1
    v_mfma_f32_16x16x32_bf16 v[108:111], v[92:95], v[156:159], v[108:111]
    s_nop 0
    v_mfma_f32_16x16x32_bf16 v[96:99], v[64:67], v[160:163], 0
    v_mfma_f32_16x16x32_bf16 v[100:103], v[80:83], v[160:163], 0
    v_mfma_f32_16x16x32_bf16 v[96:99], v[68:71], v[164:167], v[96:99]
    v_cvt_pk_bf16_f32 v104, v104, v105
    v_mfma_f32_16x16x32_bf16 v[100:103], v[84:87], v[164:167], v[100:103]
    v_cvt_pk_bf16_f32 v105, v106, v107
    v_mfma_f32_16x16x32_bf16 v[96:99], v[72:75], v[168:171], v[96:99]
    v_cvt_pk_bf16_f32 v106, v108, v109
    v_mfma_f32_16x16x32_bf16 v[100:103], v[88:91], v[168:171], v[100:103]
    v_cvt_pk_bf16_f32 v107, v110, v111
    v_mfma_f32_16x16x32_bf16 v[96:99], v[76:79], v[172:175], v[96:99]
    s_add_u32 s19, s41, 16384
    buffer_store_dwordx4 v[104:107], v0, s[4:7], s19 offen sc1
    v_mfma_f32_16x16x32_bf16 v[100:103], v[92:95], v[172:175], v[100:103]
    s_nop 0
    v_mfma_f32_16x16x32_bf16 v[104:107], v[64:67], v[176:179], 0
    v_mfma_f32_16x16x32_bf16 v[108:111], v[80:83], v[176:179], 0
    v_mfma_f32_16x16x32_bf16 v[104:107], v[68:71], v[180:183], v[104:107]
    v_cvt_pk_bf16_f32 v96, v96, v97
    v_mfma_f32_16x16x32_bf16 v[108:111], v[84:87], v[180:183], v[108:111]
    v_cvt_pk_bf16_f32 v97, v98, v99
    v_mfma_f32_16x16x32_bf16 v[104:107], v[72:75], v[184:187], v[104:107]
    v_cvt_pk_bf16_f32 v98, v100, v101
    v_mfma_f32_16x16x32_bf16 v[108:111], v[88:91], v[184:187], v[108:111]
    v_cvt_pk_bf16_f32 v99, v102, v103
    v_mfma_f32_16x16x32_bf16 v[104:107], v[76:79], v[188:191], v[104:107]
    s_add_u32 s19, s41, 32768
    buffer_store_dwordx4 v[96:99], v0, s[4:7], s19 offen sc1
    v_mfma_f32_16x16x32_bf16 v[108:111], v[92:95], v[188:191], v[108:111]
    s_nop 0
    v_mfma_f32_16x16x32_bf16 v[96:99], v[64:67], v[192:195], 0
    v_mfma_f32_16x16x32_bf16 v[100:103], v[80:83], v[192:195], 0
    v_mfma_f32_16x16x32_bf16 v[96:99], v[68:71], v[196:199], v[96:99]
    v_cvt_pk_bf16_f32 v104, v104, v105
    v_mfma_f32_16x16x32_bf16 v[100:103], v[84:87], v[196:199], v[100:103]
    v_cvt_pk_bf16_f32 v105, v106, v107
    v_mfma_f32_16x16x32_bf16 v[96:99], v[72:75], v[200:203], v[96:99]
    v_cvt_pk_bf16_f32 v106, v108, v109
    v_mfma_f32_16x16x32_bf16 v[100:103], v[88:91], v[200:203], v[100:103]
    v_cvt_pk_bf16_f32 v107, v110, v111
    v_mfma_f32_16x16x32_bf16 v[96:99], v[76:79], v[204:207], v[96:99]
    s_add_u32 s19, s41, 49152
    buffer_store_dwordx4 v[104:107], v0, s[4:7], s19 offen sc1
    v_mfma_f32_16x16x32_bf16 v[100:103], v[92:95], v[204:207], v[100:103]
    s_nop 0
    v_mfma_f32_16x16x32_bf16 v[104:107], v[64:67], v[208:211], 0
    v_mfma_f32_16x16x32_bf16 v[108:111], v[80:83], v[208:211], 0
    v_mfma_f32_16x16x32_bf16 v[104:107], v[68:71], v[212:215], v[104:107]
    v_cvt_pk_bf16_f32 v96, v96, v97
    v_mfma_f32_16x16x32_bf16 v[108:111], v[84:87], v[212:215], v[108:111]
    v_cvt_pk_bf16_f32 v97, v98, v99
    v_mfma_f32_16x16x32_bf16 v[104:107], v[72:75], v[216:219], v[104:107]
    v_cvt_pk_bf16_f32 v98, v100, v101
    v_mfma_f32_16x16x32_bf16 v[108:111], v[88:91], v[216:219], v[108:111]
    v_cvt_pk_bf16_f32 v99, v102, v103
    v_mfma_f32_16x16x32_bf16 v[104:107], v[76:79], v[220:223], v[104:107]
    s_add_u32 s19, s41, 65536
    buffer_store_dwordx4 v[96:99], v0, s[4:7], s19 offen sc1
    v_mfma_f32_16x16x32_bf16 v[108:111], v[92:95], v[220:223], v[108:111]
    s_nop 0
    v_mfma_f32_16x16x32_bf16 v[96:99], v[64:67], v[224:227], 0
    v_mfma_f32_16x16x32_bf16 v[100:103], v[80:83], v[224:227], 0
    v_mfma_f32_16x16x32_bf16 v[96:99], v[68:71], v[228:231], v[96:99]
    v_cvt_pk_bf16_f32 v104, v104, v105
    v_mfma_f32_16x16x32_bf16 v[100:103], v[84:87], v[228:231], v[100:103]
    v_cvt_pk_bf16_f32 v105, v106, v107
    v_mfma_f32_16x16x32_bf16 v[96:99], v[72:75], v[232:235], v[96:99]
    v_cvt_pk_bf16_f32 v106, v108, v109
    v_mfma_f32_16x16x32_bf16 v[100:103], v[88:91], v[232:235], v[100:103]
    v_cvt_pk_bf16_f32 v107, v110, v111
    v_mfma_f32_16x16x32_bf16 v[96:99], v[76:79], v[236:239], v[96:99]
    s_add_u32 s19, s41, 81920
    buffer_store_dwordx4 v[104:107], v0, s[4:7], s19 offen sc1
    v_mfma_f32_16x16x32_bf16 v[100:103], v[92:95], v[236:239], v[100:103]
    s_nop 0
    v_mfma_f32_16x16x32_bf16 v[104:107], v[64:67], v[240:243], 0
    v_mfma_f32_16x16x32_bf16 v[108:111], v[80:83], v[240:243], 0
    v_mfma_f32_16x16x32_bf16 v[104:107], v[68:71], v[244:247], v[104:107]
    v_cvt_pk_bf16_f32 v96, v96, v97
    v_mfma_f32_16x16x32_bf16 v[108:111], v[84:87], v[244:247], v[108:111]
    v_cvt_pk_bf16_f32 v97, v98, v99
    v_mfma_f32_16x16x32_bf16 v[104:107], v[72:75], v[248:251], v[104:107]
    v_cvt_pk_bf16_f32 v98, v100, v101
    v_mfma_f32_16x16x32_bf16 v[108:111], v[88:91], v[248:251], v[108:111]
    v_cvt_pk_bf16_f32 v99, v102, v103
    v_mfma_f32_16x16x32_bf16 v[104:107], v[76:79], v[252:255], v[104:107]
    s_add_u32 s19, s41, 98304
    buffer_store_dwordx4 v[96:99], v0, s[4:7], s19 offen sc1
    v_mfma_f32_16x16x32_bf16 v[108:111], v[92:95], v[252:255], v[108:111]
    s_nop 3
    v_cvt_pk_bf16_f32 v104, v104, v105
    v_cvt_pk_bf16_f32 v105, v106, v107
    s_nop 1
    v_cvt_pk_bf16_f32 v106, v108, v109
    v_cvt_pk_bf16_f32 v107, v110, v111
    s_add_u32 s19, s41, 114688
    buffer_store_dwordx4 v[104:107], v0, s[4:7], s19 offen sc1
    s_add_u32 s41, s41, 1048576
    s_add_u32 s30, s30, 2
    s_waitcnt vmcnt(8)
    s_barrier
    s_add_u32 s21, s30, 2
    s_min_u32 s21, s21, 63
    s_max_i32 s22, s43, 0
    s_cmp_lg_u32 s17, 0
    s_cbranch_scc1 L_f_nf1
    s_mov_b64 exec, 1
    v_mov_b32 v6, s22
    buffer_store_dword v6, off, s[4:7], s40 sc1
    s_mov_b64 exec, -1
L_f_nf1:
    s_add_u32 s43, s43, 1
    ds_read_b128 v[16:19], v1 offset:32768
    s_waitcnt lgkmcnt(0)
    ds_read_b128 v[20:23], v1 offset:49152
    v_mfma_f32_16x16x32_bf16 v[32:35], a[0:3], v[16:19], 0
    s_waitcnt lgkmcnt(0)
    ds_read_b128 v[24:27], v2 offset:32768
    v_mfma_f32_16x16x32_bf16 v[40:43], a[0:3], v[20:23], 0
    ds_read_b128 v[28:31], v2 offset:49152
    v_mfma_f32_16x16x32_bf16 v[36:39], a[64:67], v[16:19], 0
    v_mfma_f32_16x16x32_bf16 v[44:47], a[64:67], v[20:23], 0
    s_lshl_b32 s31, s21, 15
    s_lshl_b32 s36, s17, 13
    s_add_u32 s31, s31, s36
    v_mfma_f32_16x16x32_bf16 v[48:51], a[128:131], v[16:19], 0
    v_mfma_f32_16x16x32_bf16 v[56:59], a[128:131], v[20:23], 0
    v_mfma_f32_16x16x32_bf16 v[52:55], a[192:195], v[16:19], 0
    v_mfma_f32_16x16x32_bf16 v[60:63], a[192:195], v[20:23], 0
    s_waitcnt lgkmcnt(1)
    v_mfma_f32_16x16x32_bf16 v[32:35], a[4:7], v[24:27], v[32:35]
    s_waitcnt lgkmcnt(0)
    ds_read_b128 v[16:19], v3 offset:32768
    v_mfma_f32_16x16x32_bf16 v[40:43], a[4:7], v[28:31], v[40:43]
    ds_read_b128 v[20:23], v3 offset:49152
    v_mfma_f32_16x16x32_bf16 v[36:39], a[68:71], v[24:27], v[36:39]
    v_mfma_f32_16x16x32_bf16 v[44:47], a[68:71], v[28:31], v[44:47]
    s_add_u32 m0, s36, 0
    v_xor_b32 v6, 0, v5
    buffer_load_dwordx4 v6, s[32:35], s31 offen offset:0 lds
    v_mfma_f32_16x16x32_bf16 v[48:51], a[132:135], v[24:27], v[48:51]
    v_mfma_f32_16x16x32_bf16 v[56:59], a[132:135], v[28:31], v[56:59]
    v_mfma_f32_16x16x32_bf16 v[52:55], a[196:199], v[24:27], v[52:55]
    v_mfma_f32_16x16x32_bf16 v[60:63], a[196:199], v[28:31], v[60:63]
    s_waitcnt lgkmcnt(1)
    v_mfma_f32_16x16x32_bf16 v[32:35], a[8:11], v[16:19], v[32:35]
    s_waitcnt lgkmcnt(0)
    ds_read_b128 v[24:27], v4 offset:32768
    v_mfma_f32_16x16x32_bf16 v[40:43], a[8:11], v[20:23], v[40:43]
    ds_read_b128 v[28:31], v4 offset:49152
    v_mfma_f32_16x16x32_bf16 v[36:39], a[72:75], v[16:19], v[36:39]
    v_mfma_f32_16x16x32_bf16 v[44:47], a[72:75], v[20:23], v[44:47]
    v_xor_b32 v7, 16, v5
    buffer_load_dwordx4 v7, s[32:35], s31 offen offset:1024 lds
    v_mfma_f32_16x16x32_bf16 v[48:51], a[136:139], v[16:19], v[48:51]
    v_mfma_f32_16x16x32_bf16 v[56:59], a[136:139], v[20:23], v[56:59]
    v_mfma_f32_16x16x32_bf16 v[52:55], a[200:203], v[16:19], v[52:55]
    v_mfma_f32_16x16x32_bf16 v[60:63], a[200:203], v[20:23], v[60:63]
    s_waitcnt lgkmcnt(1)
    v_mfma_f32_16x16x32_bf16 v[32:35], a[12:15], v[24:27], v[32:35]
    s_waitcnt lgkmcnt(0)
    ds_read_b128 v[16:19], v1 offset:33024
    v_mfma_f32_16x16x32_bf16 v[40:43], a[12:15], v[28:31], v[40:43]
    ds_read_b128 v[20:23], v1 offset:49408
    v_mfma_f32_16x16x32_bf16 v[36:39], a[76:79], v[24:27], v[36:39]
    v_mfma_f32_16x16x32_bf16 v[44:47], a[76:79], v[28:31], v[44:47]
    v_xor_b32 v6, 32, v5
    buffer_load_dwordx4 v6, s[32:35], s31 offen offset:2048 lds
    v_mfma_f32_16x16x32_bf16 v[48:51], a[140:143], v[24:27], v[48:51]
    v_mfma_f32_16x16x32_bf16 v[56:59], a[140:143], v[28:31], v[56:59]
    v_mfma_f32_16x16x32_bf16 v[52:55], a[204:207], v[24:27], v[52:55]
    v_mfma_f32_16x16x32_bf16 v[60:63], a[204:207], v[28:31], v[60:63]
    s_waitcnt lgkmcnt(1)
    v_mfma_f32_16x16x32_bf16 v[32:35], a[16:19], v[16:19], v[32:35]
    s_waitcnt lgkmcnt(0)
    ds_read_b128 v[24:27], v2 offset:33024
    v_mfma_f32_16x16x32_bf16 v[40:43], a[16:19], v[20:23], v[40:43]
    ds_read_b128 v[28:31], v2 offset:49408
    v_mfma_f32_16x16x32_bf16 v[36:39], a[80:83], v[16:19], v[36:39]
    v_mfma_f32_16x16x32_bf16 v[44:47], a[80:83], v[20:23], v[44:47]
    v_xor_b32 v7, 48, v5
    buffer_load_dwordx4 v7, s[32:35], s31 offen offset:3072 lds
    v_mfma_f32_16x16x32_bf16 v[48:51], a[144:147], v[16:19], v[48:51]
    v_mfma_f32_16x16x32_bf16 v[56:59], a[144:147], v[20:23], v[56:59]
    v_mfma_f32_16x16x32_bf16 v[52:55], a[208:211], v[16:19], v[52:55]
    v_mfma_f32_16x16x32_bf16 v[60:63], a[208:211], v[20:23], v[60:63]
    s_waitcnt lgkmcnt(1)
    v_mfma_f32_16x16x32_bf16 v[32:35], a[20:23], v[24:27], v[32:35]
    s_waitcnt lgkmcnt(0)
    ds_read_b128 v[16:19], v3 offset:33024
    v_mfma_f32_16x16x32_bf16 v[40:43], a[20:23], v[28:31], v[40:43]
    ds_read_b128 v[20:23], v3 offset:49408
    v_mfma_f32_16x16x32_bf16 v[36:39], a[84:87], v[24:27], v[36:39]
    v_mfma_f32_16x16x32_bf16 v[44:47], a[84:87], v[28:31], v[44:47]
    s_add_u32 m0, s36, 4096
    s_add_u32 s31, s31, 4096
    v_xor_b32 v6, 64, v5
    buffer_load_dwordx4 v6, s[32:35], s31 offen offset:0 lds
    v_mfma_f32_16x16x32_bf16 v[48:51], a[148:151], v[24:27], v[48:51]
    v_mfma_f32_16x16x32_bf16 v[56:59], a[148:151], v[28:31], v[56:59]
    v_mfma_f32_16x16x32_bf16 v[52:55], a[212:215], v[24:27], v[52:55]
    v_mfma_f32_16x16x32_bf16 v[60:63], a[212:215], v[28:31], v[60:63]
    s_waitcnt lgkmcnt(1)
    v_mfma_f32_16x16x32_bf16 v[32:35], a[24:27], v[16:19], v[32:35]
    s_waitcnt lgkmcnt(0)
    ds_read_b128 v[24:27], v4 offset:33024
    v_mfma_f32_16x16x32_bf16 v[40:43], a[24:27], v[20:23], v[40:43]
    ds_read_b128 v[28:31], v4 offset:49408
    v_mfma_f32_16x16x32_bf16 v[36:39], a[88:91], v[16:19], v[36:39]
    v_mfma_f32_16x16x32_bf16 v[44:47], a[88:91], v[20:23], v[44:47]
    v_xor_b32 v7, 80, v5
    buffer_load_dwordx4 v7, s[32:35], s31 offen offset:1024 lds
    v_mfma_f32_16x16x32_bf16 v[48:51], a[152:155], v[16:19], v[48:51]
    v_mfma_f32_16x16x32_bf16 v[56:59], a[152:155], v[20:23], v[56:59]
    v_mfma_f32_16x16x32_bf16 v[52:55], a[216:219], v[16:19], v[52:55]
    v_mfma_f32_16x16x32_bf16 v[60:63], a[216:219], v[20:23], v[60:63]
    s_waitcnt lgkmcnt(1)
    v_mfma_f32_16x16x32_bf16 v[32:35], a[28:31], v[24:27], v[32:35]
    s_waitcnt lgkmcnt(0)
    ds_read_b128 v[16:19], v1 offset:33280
    v_mfma_f32_16x16x32_bf16 v[40:43], a[28:31], v[28:31], v[40:43]
    ds_read_b128 v[20:23], v1 offset:49664
    v_mfma_f32_16x16x32_bf16 v[36:39], a[92:95], v[24:27], v[36:39]
    v_mfma_f32_16x16x32_bf16 v[44:47], a[92:95], v[28:31], v[44:47]
    v_xor_b32 v6, 96, v5
    buffer_load_dwordx4 v6, s[32:35], s31 offen offset:2048 lds
    v_mfma_f32_16x16x32_bf16 v[48:51], a[156:159], v[24:27], v[48:51]
    v_mfma_f32_16x16x32_bf16 v[56:59], a[156:159], v[28:31], v[56:59]
    v_mfma_f32_16x16x32_bf16 v[52:55], a[220:223], v[24:27], v[52:55]
    v_mfma_f32_16x16x32_bf16 v[60:63], a[220:223], v[28:31], v[60:63]
    s_waitcnt lgkmcnt(1)
    v_mfma_f32_16x16x32_bf16 v[32:35], a[32:35], v[16:19], v[32:35]
    s_waitcnt lgkmcnt(0)
    ds_read_b128 v[24:27], v2 offset:33280
    v_mfma_f32_16x16x32_bf16 v[40:43], a[32:35], v[20:23], v[40:43]
    ds_read_b128 v[28:31], v2 offset:49664
    v_mfma_f32_16x16x32_bf16 v[36:39], a[96:99], v[16:19], v[36:39]
    v_mfma_f32_16x16x32_bf16 v[44:47], a[96:99], v[20:23], v[44:47]
    v_xor_b32 v7, 112, v5
    buffer_load_dwordx4 v7, s[32:35], s31 offen offset:3072 lds
    v_mfma_f32_16x16x32_bf16 v[48:51], a[160:163], v[16:19], v[48:51]
    v_mfma_f32_16x16x32_bf16 v[56:59], a[160:163], v[20:23], v[56:59]
    v_mfma_f32_16x16x32_bf16 v[52:55], a[224:227], v[16:19], v[52:55]
    v_mfma_f32_16x16x32_bf16 v[60:63], a[224:227], v[20:23], v[60:63]
    s_waitcnt lgkmcnt(1)
    v_mfma_f32_16x16x32_bf16 v[32:35], a[36:39], v[24:27], v[32:35]
    s_waitcnt lgkmcnt(0)
    ds_read_b128 v[16:19], v3 offset:33280
    v_mfma_f32_16x16x32_bf16 v[40:43], a[36:39], v[28:31], v[40:43]
    ds_read_b128 v[20:23], v3 offset:49664
    v_mfma_f32_16x16x32_bf16 v[36:39], a[100:103], v[24:27], v[36:39]
    v_mfma_f32_16x16x32_bf16 v[44:47], a[100:103], v[28:31], v[44:47]
    v_mfma_f32_16x16x32_bf16 v[48:51], a[164:167], v[24:27], v[48:51]
    v_mfma_f32_16x16x32_bf16 v[56:59], a[164:167], v[28:31], v[56:59]
    v_mfma_f32_16x16x32_bf16 v[52:55], a[228:231], v[24:27], v[52:55]
    v_mfma_f32_16x16x32_bf16 v[60:63], a[228:231], v[28:31], v[60:63]
    s_waitcnt lgkmcnt(1)
    v_mfma_f32_16x16x32_bf16 v[32:35], a[40:43], v[16:19], v[32:35]
    s_waitcnt lgkmcnt(0)
    ds_read_b128 v[24:27], v4 offset:33280
    v_mfma_f32_16x16x32_bf16 v[40:43], a[40:43], v[20:23], v[40:43]
    ds_read_b128 v[28:31], v4 offset:49664
    v_mfma_f32_16x16x32_bf16 v[36:39], a[104:107], v[16:19], v[36:39]
    v_mfma_f32_16x16x32_bf16 v[44:47], a[104:107], v[20:23], v[44:47]
    v_mfma_f32_16x16x32_bf16 v[48:51], a[168:171], v[16:19], v[48:51]
    v_mfma_f32_16x16x32_bf16 v[56:59], a[168:171], v[20:23], v[56:59]
    v_mfma_f32_16x16x32_bf16 v[52:55], a[232:235], v[16:19], v[52:55]
    v_mfma_f32_16x16x32_bf16 v[60:63], a[232:235], v[20:23], v[60:63]
    s_waitcnt lgkmcnt(1)
    v_mfma_f32_16x16x32_bf16 v[32:35], a[44:47], v[24:27], v[32:35]
    s_waitcnt lgkmcnt(0)
    ds_read_b128 v[16:19], v1 offset:33536
    v_mfma_f32_16x16x32_bf16 v[40:43], a[44:47], v[28:31], v[40:43]
    ds_read_b128 v[20:23], v1 offset:49920
    v_mfma_f32_16x16x32_bf16 v[36:39], a[108:111], v[24:27], v[36:39]
    v_mfma_f32_16x16x32_bf16 v[44:47], a[108:111], v[28:31], v[44:47]
    v_mfma_f32_16x16x32_bf16 v[48:51], a[172:175], v[24:27], v[48:51]
    v_mfma_f32_16x16x32_bf16 v[56:59], a[172:175], v[28:31], v[56:59]
    v_mfma_f32_16x16x32_bf16 v[52:55], a[236:239], v[24:27], v[52:55]
    v_mfma_f32_16x16x32_bf16 v[60:63], a[236:239], v[28:31], v[60:63]
    s_waitcnt lgkmcnt(1)
    v_mfma_f32_16x16x32_bf16 v[32:35], a[48:51], v[16:19], v[32:35]
    s_waitcnt lgkmcnt(0)
    ds_read_b128 v[24:27], v2 offset:33536
    v_mfma_f32_16x16x32_bf16 v[40:43], a[48:51], v[20:23], v[40:43]
    ds_read_b128 v[28:31], v2 offset:49920
    v_mfma_f32_16x16x32_bf16 v[36:39], a[112:115], v[16:19], v[36:39]
    v_mfma_f32_16x16x32_bf16 v[44:47], a[112:115], v[20:23], v[44:47]
    v_mfma_f32_16x16x32_bf16 v[48:51], a[176:179], v[16:19], v[48:51]
    v_mfma_f32_16x16x32_bf16 v[56:59], a[176:179], v[20:23], v[56:59]
    v_mfma_f32_16x16x32_bf16 v[52:55], a[240:243], v[16:19], v[52:55]
    v_mfma_f32_16x16x32_bf16 v[60:63], a[240:243], v[20:23], v[60:63]
    s_waitcnt lgkmcnt(1)
    v_mfma_f32_16x16x32_bf16 v[32:35], a[52:55], v[24:27], v[32:35]
    s_waitcnt lgkmcnt(0)
    ds_read_b128 v[16:19], v3 offset:33536
    v_mfma_f32_16x16x32_bf16 v[40:43], a[52:55], v[28:31], v[40:43]
    ds_read_b128 v[20:23], v3 offset:49920
    v_mfma_f32_16x16x32_bf16 v[36:39], a[116:119], v[24:27], v[36:39]
    v_mfma_f32_16x16x32_bf16 v[44:47], a[116:119], v[28:31], v[44:47]
    v_mfma_f32_16x16x32_bf16 v[48:51], a[180:183], v[24:27], v[48:51]
    v_mfma_f32_16x16x32_bf16 v[56:59], a[180:183], v[28:31], v[56:59]
    v_mfma_f32_16x16x32_bf16 v[52:55], a[244:247], v[24:27], v[52:55]
    v_mfma_f32_16x16x32_bf16 v[60:63], a[244:247], v[28:31], v[60:63]
    s_waitcnt lgkmcnt(1)
    v_mfma_f32_16x16x32_bf16 v[32:35], a[56:59], v[16:19], v[32:35]
    s_waitcnt lgkmcnt(0)
    ds_read_b128 v[24:27], v4 offset:33536
    v_mfma_f32_16x16x32_bf16 v[40:43], a[56:59], v[20:23], v[40:43]
    ds_read_b128 v[28:31], v4 offset:49920
    v_mfma_f32_16x16x32_bf16 v[36:39], a[120:123], v[16:19], v[36:39]
    v_mfma_f32_16x16x32_bf16 v[44:47], a[120:123], v[20:23], v[44:47]
    v_mfma_f32_16x16x32_bf16 v[48:51], a[184:187], v[16:19], v[48:51]
    v_mfma_f32_16x16x32_bf16 v[56:59], a[184:187], v[20:23], v[56:59]
    v_mfma_f32_16x16x32_bf16 v[52:55], a[248:251], v[16:19], v[52:55]
    v_mfma_f32_16x16x32_bf16 v[60:63], a[248:251], v[20:23], v[60:63]
    s_waitcnt lgkmcnt(1)
    v_mfma_f32_16x16x32_bf16 v[32:35], a[60:63], v[24:27], v[32:35]
    s_waitcnt lgkmcnt(0)
    v_mfma_f32_16x16x32_bf16 v[40:43], a[60:63], v[28:31], v[40:43]
    v_mfma_f32_16x16x32_bf16 v[36:39], a[124:127], v[24:27], v[36:39]
    v_mfma_f32_16x16x32_bf16 v[44:47], a[124:127], v[28:31], v[44:47]
    v_mfma_f32_16x16x32_bf16 v[48:51], a[188:191], v[24:27], v[48:51]
    v_mfma_f32_16x16x32_bf16 v[56:59], a[188:191], v[28:31], v[56:59]
    v_mfma_f32_16x16x32_bf16 v[52:55], a[252:255], v[24:27], v[52:55]
    v_mfma_f32_16x16x32_bf16 v[60:63], a[252:255], v[28:31], v[60:63]
    v_cvt_pk_bf16_f32 v112, v32, v33
    v_cvt_pk_bf16_f32 v113, v34, v35
    v_cvt_pk_bf16_f32 v114, v36, v37
    v_cvt_pk_bf16_f32 v115, v38, v39
    v_cvt_pk_bf16_f32 v116, v48, v49
    v_cvt_pk_bf16_f32 v117, v50, v51
    v_cvt_pk_bf16_f32 v118, v52, v53
    v_cvt_pk_bf16_f32 v119, v54, v55
    v_lshlrev_b32 v32, 16, v112
    v_and_b32 v33, 0xffff0000, v112
    v_lshlrev_b32 v48, 16, v116
    v_and_b32 v49, 0xffff0000, v116
    v_lshlrev_b32 v34, 16, v113
    v_and_b32 v35, 0xffff0000, v113
    v_lshlrev_b32 v50, 16, v117
    v_and_b32 v51, 0xffff0000, v117
    v_lshlrev_b32 v36, 16, v114
    v_and_b32 v37, 0xffff0000, v114
    v_lshlrev_b32 v52, 16, v118
    v_and_b32 v53, 0xffff0000, v118
    v_lshlrev_b32 v38, 16, v115
    v_and_b32 v39, 0xffff0000, v115
    v_lshlrev_b32 v54, 16, v119
    v_and_b32 v55, 0xffff0000, v119
    v_mul_f32 v112, v32, v32
    v_mul_f32 v113, v33, v33
    v_mul_f32 v114, v34, v34
    v_mul_f32 v115, v35, v35
    v_mul_f32 v116, v36, v36
    v_mul_f32 v117, v37, v37
    v_mul_f32 v118, v38, v38
    v_mul_f32 v119, v39, v39
    v_fma_f32 v112, v112, s47, v9
    v_fma_f32 v113, v113, s47, v9
    v_fma_f32 v114, v114, s47, v9
    v_fma_f32 v115, v115, s47, v9
    v_fma_f32 v116, v116, s47, v9
    v_fma_f32 v117, v117, s47, v9
    v_fma_f32 v118, v118, s47, v9
    v_fma_f32 v119, v119, s47, v9
    v_mul_f32 v112, v112, v32
    v_mul_f32 v113, v113, v33
    v_mul_f32 v114, v114, v34
    v_mul_f32 v115, v115, v35
    v_mul_f32 v116, v116, v36
    v_mul_f32 v117, v117, v37
    v_mul_f32 v118, v118, v38
    v_mul_f32 v119, v119, v39
    v_exp_f32 v112, v112
    v_exp_f32 v113, v113
    v_exp_f32 v114, v114
    v_exp_f32 v115, v115
    v_exp_f32 v116, v116
    v_exp_f32 v117, v117
    v_exp_f32 v118, v118
    v_exp_f32 v119, v119
    v_add_f32 v112, 1.0, v112
    v_add_f32 v113, 1.0, v113
    v_add_f32 v114, 1.0, v114
    v_add_f32 v115, 1.0, v115
    v_add_f32 v116, 1.0, v116
    v_add_f32 v117, 1.0, v117
    v_add_f32 v118, 1.0, v118
    v_add_f32 v119, 1.0, v119
    v_rcp_f32 v112, v112
    v_rcp_f32 v113, v113
    v_rcp_f32 v114, v114
    v_rcp_f32 v115, v115
    v_rcp_f32 v116, v116
    v_rcp_f32 v117, v117
    v_rcp_f32 v118, v118
    v_rcp_f32 v119, v119
    v_mul_f32 v32, v32, v112
    v_mul_f32 v33, v33, v113
    v_mul_f32 v34, v34, v114
    v_mul_f32 v35, v35, v115
    v_mul_f32 v36, v36, v116
    v_mul_f32 v37, v37, v117
    v_mul_f32 v38, v38, v118
    v_mul_f32 v39, v39, v119
    v_cvt_pk_bf16_f32 v112, v32, v33
    v_cvt_pk_bf16_f32 v113, v34, v35
    v_cvt_pk_bf16_f32 v114, v36, v37
    v_cvt_pk_bf16_f32 v115, v38, v39
    v_lshlrev_b32 v32, 16, v112
    v_and_b32 v33, 0xffff0000, v112
    v_lshlrev_b32 v34, 16, v113
    v_and_b32 v35, 0xffff0000, v113
    v_lshlrev_b32 v36, 16, v114
    v_and_b32 v37, 0xffff0000, v114
    v_lshlrev_b32 v38, 16, v115
    v_and_b32 v39, 0xffff0000, v115
    v_mul_f32 v32, v32, v48
    v_mul_f32 v33, v33, v49
    v_mul_f32 v34, v34, v50
    v_mul_f32 v35, v35, v51
    v_mul_f32 v36, v36, v52
    v_mul_f32 v37, v37, v53
    v_mul_f32 v38, v38, v54
    v_mul_f32 v39, v39, v55
    v_cvt_pk_bf16_f32 v32, v32, v33
    v_cvt_pk_bf16_f32 v33, v34, v35
    v_cvt_pk_bf16_f32 v34, v36, v37
    v_cvt_pk_bf16_f32 v35, v38, v39
    ds_write_b128 v10, v[32:35] offset:0
    v_cvt_pk_bf16_f32 v112, v40, v41
    v_cvt_pk_bf16_f32 v113, v42, v43
    v_cvt_pk_bf16_f32 v114, v44, v45
    v_cvt_pk_bf16_f32 v115, v46, v47
    v_cvt_pk_bf16_f32 v116, v56, v57
    v_cvt_pk_bf16_f32 v117, v58, v59
    v_cvt_pk_bf16_f32 v118, v60, v61
    v_cvt_pk_bf16_f32 v119, v62, v63
    v_lshlrev_b32 v40, 16, v112
    v_and_b32 v41, 0xffff0000, v112
    v_lshlrev_b32 v56, 16, v116
    v_and_b32 v57, 0xffff0000, v116
    v_lshlrev_b32 v42, 16, v113
    v_and_b32 v43, 0xffff0000, v113
    v_lshlrev_b32 v58, 16, v117
    v_and_b32 v59, 0xffff0000, v117
    v_lshlrev_b32 v44, 16, v114
    v_and_b32 v45, 0xffff0000, v114
    v_lshlrev_b32 v60, 16, v118
    v_and_b32 v61, 0xffff0000, v118
    v_lshlrev_b32 v46, 16, v115
    v_and_b32 v47, 0xffff0000, v115
    v_lshlrev_b32 v62, 16, v119
    v_and_b32 v63, 0xffff0000, v119
    v_mul_f32 v112, v40, v40
    v_mul_f32 v113, v41, v41
    v_mul_f32 v114, v42, v42
    v_mul_f32 v115, v43, v43
    v_mul_f32 v116, v44, v44
    v_mul_f32 v117, v45, v45
    v_mul_f32 v118, v46, v46
    v_mul_f32 v119, v47, v47
    v_fma_f32 v112, v112, s47, v9
    v_fma_f32 v113, v113, s47, v9
    v_fma_f32 v114, v114, s47, v9
    v_fma_f32 v115, v115, s47, v9
    v_fma_f32 v116, v116, s47, v9
    v_fma_f32 v117, v117, s47, v9
    v_fma_f32 v118, v118, s47, v9
    v_fma_f32 v119, v119, s47, v9
    v_mul_f32 v112, v112, v40
    v_mul_f32 v113, v113, v41
    v_mul_f32 v114, v114, v42
    v_mul_f32 v115, v115, v43
    v_mul_f32 v116, v116, v44
    v_mul_f32 v117, v117, v45
    v_mul_f32 v118, v118, v46
    v_mul_f32 v119, v119, v47
    v_exp_f32 v112, v112
    v_exp_f32 v113, v113
    v_exp_f32 v114, v114
    v_exp_f32 v115, v115
    v_exp_f32 v116, v116
    v_exp_f32 v117, v117
    v_exp_f32 v118, v118
    v_exp_f32 v119, v119
    v_add_f32 v112, 1.0, v112
    v_add_f32 v113, 1.0, v113
    v_add_f32 v114, 1.0, v114
    v_add_f32 v115, 1.0, v115
    v_add_f32 v116, 1.0, v116
    v_add_f32 v117, 1.0, v117
    v_add_f32 v118, 1.0, v118
    v_add_f32 v119, 1.0, v119
    v_rcp_f32 v112, v112
    v_rcp_f32 v113, v113
    v_rcp_f32 v114, v114
    v_rcp_f32 v115, v115
    v_rcp_f32 v116, v116
    v_rcp_f32 v117, v117
    v_rcp_f32 v118, v118
    v_rcp_f32 v119, v119
    v_mul_f32 v40, v40, v112
    v_mul_f32 v41, v41, v113
    v_mul_f32 v42, v42, v114
    v_mul_f32 v43, v43, v115
    v_mul_f32 v44, v44, v116
    v_mul_f32 v45, v45, v117
    v_mul_f32 v46, v46, v118
    v_mul_f32 v47, v47, v119
    v_cvt_pk_bf16_f32 v112, v40, v41
    v_cvt_pk_bf16_f32 v113, v42, v43
    v_cvt_pk_bf16_f32 v114, v44, v45
    v_cvt_pk_bf16_f32 v115, v46, v47
    v_lshlrev_b32 v40, 16, v112
    v_and_b32 v41, 0xffff0000, v112
    v_lshlrev_b32 v42, 16, v113
    v_and_b32 v43, 0xffff0000, v113
    v_lshlrev_b32 v44, 16, v114
    v_and_b32 v45, 0xffff0000, v114
    v_lshlrev_b32 v46, 16, v115
    v_and_b32 v47, 0xffff0000, v115
    v_mul_f32 v40, v40, v56
    v_mul_f32 v41, v41, v57
    v_mul_f32 v42, v42, v58
    v_mul_f32 v43, v43, v59
    v_mul_f32 v44, v44, v60
    v_mul_f32 v45, v45, v61
    v_mul_f32 v46, v46, v62
    v_mul_f32 v47, v47, v63
    v_cvt_pk_bf16_f32 v40, v40, v41
    v_cvt_pk_bf16_f32 v41, v42, v43
    v_cvt_pk_bf16_f32 v42, v44, v45
    v_cvt_pk_bf16_f32 v43, v46, v47
    ds_write_b128 v10, v[40:43] offset:4096
    s_waitcnt lgkmcnt(0)
    s_barrier
    ds_read_b128 v[64:67], v11 offset:0
    ds_read_b128 v[68:71], v11 offset:1024
    ds_read_b128 v[72:75], v11 offset:2048
    ds_read_b128 v[76:79], v11 offset:3072
    ds_read_b128 v[80:83], v11 offset:4096
    s_waitcnt lgkmcnt(4)
    ds_read_b128 v[84:87], v11 offset:5120
    ds_read_b128 v[88:91], v11 offset:6144
    ds_read_b128 v[92:95], v11 offset:7168
    v_mfma_f32_16x16x32_bf16 v[96:99], v[64:67], v[128:131], 0
    s_waitcnt lgkmcnt(3)
    v_mfma_f32_16x16x32_bf16 v[100:103], v[80:83], v[128:131], 0
    v_mfma_f32_16x16x32_bf16 v[96:99], v[68:71], v[132:135], v[96:99]
    s_waitcnt lgkmcnt(2)
    v_mfma_f32_16x16x32_bf16 v[100:103], v[84:87], v[132:135], v[100:103]
    v_mfma_f32_16x16x32_bf16 v[96:99], v[72:75], v[136:139], v[96:99]
    s_waitcnt lgkmcnt(1)
    v_mfma_f32_16x16x32_bf16 v[100:103], v[88:91], v[136:139], v[100:103]
    v_mfma_f32_16x16x32_bf16 v[96:99], v[76:79], v[140:143], v[96:99]
    s_waitcnt lgkmcnt(0)
    v_mfma_f32_16x16x32_bf16 v[100:103], v[92:95], v[140:143], v[100:103]
    v_mfma_f32_16x16x32_bf16 v[104:107], v[64:67], v[144:147], 0
    v_mfma_f32_16x16x32_bf16 v[108:111], v[80:83], v[144:147], 0
    v_mfma_f32_16x16x32_bf16 v[104:107], v[68:71], v[148:151], v[104:107]
    v_cvt_pk_bf16_f32 v96, v96, v97
    v_mfma_f32_16x16x32_bf16 v[108:111], v[84:87], v[148:151], v[108:111]
    v_cvt_pk_bf16_f32 v97, v98, v99
    v_mfma_f32_16x16x32_bf16 v[104:107], v[72:75], v[152:155], v[104:107]
    v_cvt_pk_bf16_f32 v98, v100, v101
    v_mfma_f32_16x16x32_bf16 v[108:111], v[88:91], v[152:155], v[108:111]
    v_cvt_pk_bf16_f32 v99, v102, v103
    v_mfma_f32_16x16x32_bf16 v[104:107], v[76:79], v[156:159], v[104:107]
    s_add_u32 s19, s41, 0
    buffer_store_dwordx4 v[96:99], v0, s[4:7], s19 offen sc1
    v_mfma_f32_16x16x32_bf16 v[108:111], v[92:95], v[156:159], v[108:111]
    s_nop 0
    v_mfma_f32_16x16x32_bf16 v[96:99], v[64:67], v[160:163], 0
    v_mfma_f32_16x16x32_bf16 v[100:103], v[80:83], v[160:163], 0
    v_mfma_f32_16x16x32_bf16 v[96:99], v[68:71], v[164:167], v[96:99]
    v_cvt_pk_bf16_f32 v104, v104, v105
    v_mfma_f32_16x16x32_bf16 v[100:103], v[84:87], v[164:167], v[100:103]
    v_cvt_pk_bf16_f32 v105, v106, v107
    v_mfma_f32_16x16x32_bf16 v[96:99], v[72:75], v[168:171], v[96:99]
    v_cvt_pk_bf16_f32 v106, v108, v109
    v_mfma_f32_16x16x32_bf16 v[100:103], v[88:91], v[168:171], v[100:103]
    v_cvt_pk_bf16_f32 v107, v110, v111
    v_mfma_f32_16x16x32_bf16 v[96:99], v[76:79], v[172:175], v[96:99]
    s_add_u32 s19, s41, 16384
    buffer_store_dwordx4 v[104:107], v0, s[4:7], s19 offen sc1
    v_mfma_f32_16x16x32_bf16 v[100:103], v[92:95], v[172:175], v[100:103]
    s_nop 0
    v_mfma_f32_16x16x32_bf16 v[104:107], v[64:67], v[176:179], 0
    v_mfma_f32_16x16x32_bf16 v[108:111], v[80:83], v[176:179], 0
    v_mfma_f32_16x16x32_bf16 v[104:107], v[68:71], v[180:183], v[104:107]
    v_cvt_pk_bf16_f32 v96, v96, v97
    v_mfma_f32_16x16x32_bf16 v[108:111], v[84:87], v[180:183], v[108:111]
    v_cvt_pk_bf16_f32 v97, v98, v99
    v_mfma_f32_16x16x32_bf16 v[104:107], v[72:75], v[184:187], v[104:107]
    v_cvt_pk_bf16_f32 v98, v100, v101
    v_mfma_f32_16x16x32_bf16 v[108:111], v[88:91], v[184:187], v[108:111]
    v_cvt_pk_bf16_f32 v99, v102, v103
    v_mfma_f32_16x16x32_bf16 v[104:107], v[76:79], v[188:191], v[104:107]
    s_add_u32 s19, s41, 32768
    buffer_store_dwordx4 v[96:99], v0, s[4:7], s19 offen sc1
    v_mfma_f32_16x16x32_bf16 v[108:111], v[92:95], v[188:191], v[108:111]
    s_nop 0
    v_mfma_f32_16x16x32_bf16 v[96:99], v[64:67], v[192:195], 0
    v_mfma_f32_16x16x32_bf16 v[100:103], v[80:83], v[192:195], 0
    v_mfma_f32_16x16x32_bf16 v[96:99], v[68:71], v[196:199], v[96:99]
    v_cvt_pk_bf16_f32 v104, v104, v105
    v_mfma_f32_16x16x32_bf16 v[100:103], v[84:87], v[196:199], v[100:103]
    v_cvt_pk_bf16_f32 v105, v106, v107
    v_mfma_f32_16x16x32_bf16 v[96:99], v[72:75], v[200:203], v[96:99]
    v_cvt_pk_bf16_f32 v106, v108, v109
    v_mfma_f32_16x16x32_bf16 v[100:103], v[88:91], v[200:203], v[100:103]
    v_cvt_pk_bf16_f32 v107, v110, v111
    v_mfma_f32_16x16x32_bf16 v[96:99], v[76:79], v[204:207], v[96:99]
    s_add_u32 s19, s41, 49152
    buffer_store_dwordx4 v[104:107], v0, s[4:7], s19 offen sc1
    v_mfma_f32_16x16x32_bf16 v[100:103], v[92:95], v[204:207], v[100:103]
    s_nop 0
    v_mfma_f32_16x16x32_bf16 v[104:107], v[64:67], v[208:211], 0
    v_mfma_f32_16x16x32_bf16 v[108:111], v[80:83], v[208:211], 0
    v_mfma_f32_16x16x32_bf16 v[104:107], v[68:71], v[212:215], v[104:107]
    v_cvt_pk_bf16_f32 v96, v96, v97
    v_mfma_f32_16x16x32_bf16 v[108:111], v[84:87], v[212:215], v[108:111]
    v_cvt_pk_bf16_f32 v97, v98, v99
    v_mfma_f32_16x16x32_bf16 v[104:107], v[72:75], v[216:219], v[104:107]
    v_cvt_pk_bf16_f32 v98, v100, v101
    v_mfma_f32_16x16x32_bf16 v[108:111], v[88:91], v[216:219], v[108:111]
    v_cvt_pk_bf16_f32 v99, v102, v103
    v_mfma_f32_16x16x32_bf16 v[104:107], v[76:79], v[220:223], v[104:107]
    s_add_u32 s19, s41, 65536
    buffer_store_dwordx4 v[96:99], v0, s[4:7], s19 offen sc1
    v_mfma_f32_16x16x32_bf16 v[108:111], v[92:95], v[220:223], v[108:111]
    s_nop 0
    v_mfma_f32_16x16x32_bf16 v[96:99], v[64:67], v[224:227], 0
    v_mfma_f32_16x16x32_bf16 v[100:103], v[80:83], v[224:227], 0
    v_mfma_f32_16x16x32_bf16 v[96:99], v[68:71], v[228:231], v[96:99]
    v_cvt_pk_bf16_f32 v104, v104, v105
    v_mfma_f32_16x16x32_bf16 v[100:103], v[84:87], v[228:231], v[100:103]
    v_cvt_pk_bf16_f32 v105, v106, v107
    v_mfma_f32_16x16x32_bf16 v[96:99], v[72:75], v[232:235], v[96:99]
    v_cvt_pk_bf16_f32 v106, v108, v109
    v_mfma_f32_16x16x32_bf16 v[100:103], v[88:91], v[232:235], v[100:103]
    v_cvt_pk_bf16_f32 v107, v110, v111
    v_mfma_f32_16x16x32_bf16 v[96:99], v[76:79], v[236:239], v[96:99]
    s_add_u32 s19, s41, 81920
    buffer_store_dwordx4 v[104:107], v0, s[4:7], s19 offen sc1
    v_mfma_f32_16x16x32_bf16 v[100:103], v[92:95], v[236:239], v[100:103]
    s_nop 0
    v_mfma_f32_16x16x32_bf16 v[104:107], v[64:67], v[240:243], 0
    v_mfma_f32_16x16x32_bf16 v[108:111], v[80:83], v[240:243], 0
    v_mfma_f32_16x16x32_bf16 v[104:107], v[68:71], v[244:247], v[104:107]
    v_cvt_pk_bf16_f32 v96, v96, v97
    v_mfma_f32_16x16x32_bf16 v[108:111], v[84:87], v[244:247], v[108:111]
    v_cvt_pk_bf16_f32 v97, v98, v99
    v_mfma_f32_16x16x32_bf16 v[104:107], v[72:75], v[248:251], v[104:107]
    v_cvt_pk_bf16_f32 v98, v100, v101
    v_mfma_f32_16x16x32_bf16 v[108:111], v[88:91], v[248:251], v[108:111]
    v_cvt_pk_bf16_f32 v99, v102, v103
    v_mfma_f32_16x16x32_bf16 v[104:107], v[76:79], v[252:255], v[104:107]
    s_add_u32 s19, s41, 98304
    buffer_store_dwordx4 v[96:99], v0, s[4:7], s19 offen sc1
    v_mfma_f32_16x16x32_bf16 v[108:111], v[92:95], v[252:255], v[108:111]
    s_nop 3
    v_cvt_pk_bf16_f32 v104, v104, v105
    v_cvt_pk_bf16_f32 v105, v106, v107
    s_nop 1
    v_cvt_pk_bf16_f32 v106, v108, v109
    v_cvt_pk_bf16_f32 v107, v110, v111
    s_add_u32 s19, s41, 114688
    buffer_store_dwordx4 v[104:107], v0, s[4:7], s19 offen sc1
    s_add_u32 s41, s41, 1048576
    s_add_u32 s30, s30, 2
    s_cmp_lt_u32 s30, 64
    s_cbranch_scc1 L_f_loop
    s_waitcnt vmcnt(0)
    s_barrier
    s_mov_b32 s21, 32
    s_cmp_lg_u32 s17, 0
    s_cbranch_scc1 L_f_nfe
    s_mov_b64 exec, 1
    v_mov_b32 v6, s21
    buffer_store_dword v6, off, s[4:7], s40 sc1
    s_mov_b64 exec, -1
L_f_nfe:
    s_branch L_done
L_role_g:
    v_lshrrev_b32 v1, 6, v0
    s_nop 0
    v_readfirstlane_b32 s17, v1
    s_nop 0
    s_cmp_lg_u32 s17, 0
    s_cbranch_scc1 L_g_noreg
    s_mul_i32 s19, s28, s28
    s_lshl_b32 s19, s19, 18
    s_lshl_b32 s20, s28, 9
    s_add_u32 s19, s19, s20
    s_add_u32 s19, s19, 1
    s_lshl_b32 s20, s27, 2
    s_mov_b64 exec, 1
    v_mov_b32 v2, s19
    buffer_atomic_add v2, off, s[12:15], s20
    s_mov_b64 exec, -1
L_g_noreg:
    s_branch L_done
L_role_c:
    s_load_dwordx2 s[24:25], s[0:1], 112
    s_waitcnt lgkmcnt(0)
    s_mov_b32 s4, s24
    s_and_b32 s5, s25, 0xffff
    s_mov_b32 s6, 0x10000000
    s_mov_b32 s7, 0x20000
    s_load_dwordx2 s[24:25], s[0:1], 104
    s_waitcnt lgkmcnt(0)
    s_mov_b32 s12, s24
    s_and_b32 s13, s25, 0xffff
    s_mov_b32 s14, 0x100
    s_mov_b32 s15, 0x20000
    v_and_b32 v127, 63, v0
    v_lshrrev_b32 v126, 6, v0
    s_nop 0
    v_readfirstlane_b32 s17, v126
    v_lshlrev_b32 v0, 4, v127
    v_bfe_u32 v1, v127, 4, 2
    v_and_b32 v126, 15, v127
    v_xor_b32 v1, v1, v126
    v_lshlrev_b32 v1, 4, v1
    v_lshl_add_u32 v1, v126, 10, v1
    v_bfe_u32 v2, v127, 4, 2
    v_add_u32 v2, 4, v2
    v_and_b32 v126, 15, v127
    v_xor_b32 v2, v2, v126
    v_lshlrev_b32 v2, 4, v2
    v_lshl_add_u32 v2, v126, 10, v2
    v_bfe_u32 v3, v127, 4, 2
    v_add_u32 v3, 8, v3
    v_and_b32 v126, 15, v127
    v_xor_b32 v3, v3, v126
    v_lshlrev_b32 v3, 4, v3
    v_lshl_add_u32 v3, v126, 10, v3
    v_bfe_u32 v4, v127, 4, 2
    v_add_u32 v4, 12, v4
    v_and_b32 v126, 15, v127
    v_xor_b32 v4, v4, v126
    v_lshlrev_b32 v4, 4, v4
    v_lshl_add_u32 v4, v126, 10, v4
    s_and_b32 s19, s17, 1
    s_lshl_b32 s19, s19, 7
    v_xor_b32 v5, s19, v0
    s_lshl_b32 s19, s17, 10
    v_add_u32 v8, s19, v0
    s_load_dwordx2 s[24:25], s[0:1], 0
    s_waitcnt lgkmcnt(0)
    s_mov_b32 s32, s24
    s_and_b32 s33, s25, 0xffff
    s_mov_b32 s34, 0x200000
    s_mov_b32 s35, 0x20000
    s_sub_u32 s45, s27, 1
    s_lshl_b32 s21, s45, 5
    s_add_u32 s21, s21, s16
    v_mov_b32 v16, -1
    v_mov_b32 v17, -1
    v_mov_b32 v18, -1
    v_mov_b32 v19, -1
    v_mov_b32 v20, 0
    s_lshl_b32 s19, s21, 12
    s_add_u32 s19, s19, 1048576
    buffer_store_dwordx4 v[16:19], v8, s[4:7], s19 offen sc1
    s_mul_i32 s19, s21, 5120
    s_add_u32 s19, s19, 59113472
    buffer_store_dwordx4 v[16:19], v8, s[4:7], s19 offen sc1
    s_add_u32 s19, s19, 4096
    s_cmp_lt_u32 s17, 1
    s_cselect_b32 s19, s19, 268435456
    buffer_store_dwordx4 v[16:19], v8, s[4:7], s19 offen sc1
    s_cmp_ge_u32 s21, 8
    s_cbranch_scc1 L_c_noarm
    s_lshl_b32 s19, s21, 12
    s_add_u32 s19, s19, 262144
    buffer_store_dwordx4 v[16:19], v8, s[4:7], s19 offen sc1
    s_cmp_lg_u32 s21, 0
    s_cbranch_scc1 L_c_noarm
    v_mov_b32 v21, 0
    v_mov_b32 v22, 0
    v_mov_b32 v23, 0
    s_mov_b32 s19, 196608
    buffer_store_dwordx4 v[20:23], v8, s[4:7], s19 offen sc1
    s_mov_b32 s19, 200704
    buffer_store_dwordx4 v[20:23], v8, s[4:7], s19 offen sc1
    s_mov_b32 s19, 8192
    buffer_store_dwordx4 v[20:23], v8, s[4:7], s19 offen sc1
L_c_noarm:
    s_load_dwordx2 s[24:25], s[0:1], 88
    s_waitcnt lgkmcnt(0)
    s_mov_b32 s76, s24
    s_and_b32 s77, s25, 0xffff
    s_mov_b32 s78, 0x400
    s_mov_b32 s79, 0x20000
    s_lshl_b32 s19, s21, 2
    s_add_u32 s19, s19, s17
    s_lshl_b32 s20, s19, 12
    buffer_load_dwordx4 v[40:43], v0, s[76:79], 0 offen
    buffer_load_dwordx4 v[48:51], v0, s[32:35], s20 offen offset:0
    buffer_load_dwordx4 v[52:55], v0, s[32:35], s20 offen offset:1024
    buffer_load_dwordx4 v[56:59], v0, s[32:35], s20 offen offset:2048
    buffer_load_dwordx4 v[60:63], v0, s[32:35], s20 offen offset:3072
    s_waitcnt vmcnt(4)
    v_lshlrev_b32 v32, 16, v40
    v_and_b32 v33, 0xffff0000, v40
    v_lshlrev_b32 v34, 16, v41
    v_and_b32 v35, 0xffff0000, v41
    v_lshlrev_b32 v36, 16, v42
    v_and_b32 v37, 0xffff0000, v42
    v_lshlrev_b32 v38, 16, v43
    v_and_b32 v39, 0xffff0000, v43
    s_waitcnt vmcnt(3)
    v_lshlrev_b32 v40, 16, v48
    v_and_b32 v41, 0xffff0000, v48
    v_lshlrev_b32 v42, 16, v49
    v_and_b32 v43, 0xffff0000, v49
    v_lshlrev_b32 v44, 16, v50
    v_and_b32 v45, 0xffff0000, v50
    v_lshlrev_b32 v46, 16, v51
    v_and_b32 v47, 0xffff0000, v51
    v_mul_f32 v40, v40, v32
    v_mul_f32 v41, v41, v33
    v_mul_f32 v42, v42, v34
    v_mul_f32 v43, v43, v35
    v_mul_f32 v44, v44, v36
    v_mul_f32 v45, v45, v37
    v_mul_f32 v46, v46, v38
    v_mul_f32 v47, v47, v39
    v_cvt_pk_bf16_f32 v48, v40, v41
    v_cvt_pk_bf16_f32 v49, v42, v43
    v_cvt_pk_bf16_f32 v50, v44, v45
    v_cvt_pk_bf16_f32 v51, v46, v47
    v_lshlrev_b32 v40, 16, v48
    v_and_b32 v41, 0xffff0000, v48
    v_lshlrev_b32 v42, 16, v49
    v_and_b32 v43, 0xffff0000, v49
    v_lshlrev_b32 v44, 16, v50
    v_and_b32 v45, 0xffff0000, v50
    v_lshlrev_b32 v46, 16, v51
    v_and_b32 v47, 0xffff0000, v51
    v_add_f32 v40, v40, v44
    v_add_f32 v41, v41, v45
    v_add_f32 v42, v42, v46
    v_add_f32 v43, v43, v47
    v_add_f32 v40, v40, v42
    v_add_f32 v41, v41, v43
    v_add_f32 v40, v40, v41
    s_nop 1
    v_add_f32_dpp v40, v40, v40 row_ror:1 row_mask:0xf bank_mask:0xf
    s_nop 1
    v_add_f32_dpp v40, v40, v40 row_ror:2 row_mask:0xf bank_mask:0xf
    s_nop 1
    v_add_f32_dpp v40, v40, v40 row_ror:4 row_mask:0xf bank_mask:0xf
    s_nop 1
    v_add_f32_dpp v40, v40, v40 row_ror:8 row_mask:0xf bank_mask:0xf
    v_mov_b32 v41, v40
    s_nop 1
    v_permlane16_swap_b32 v40, v41
    v_add_f32 v40, v40, v41
    v_mov_b32 v41, v40
    s_nop 1
    v_permlane32_swap_b32 v40, v41
    v_add_f32 v40, v40, v41
    v_mov_b32 v64, v40
    s_waitcnt vmcnt(2)
    v_lshlrev_b32 v40, 16, v52
    v_and_b32 v41, 0xffff0000, v52
    v_lshlrev_b32 v42, 16, v53
    v_and_b32 v43, 0xffff0000, v53
    v_lshlrev_b32 v44, 16, v54
    v_and_b32 v45, 0xffff0000, v54
    v_lshlrev_b32 v46, 16, v55
    v_and_b32 v47, 0xffff0000, v55
    v_mul_f32 v40, v40, v32
    v_mul_f32 v41, v41, v33
    v_mul_f32 v42, v42, v34
    v_mul_f32 v43, v43, v35
    v_mul_f32 v44, v44, v36
    v_mul_f32 v45, v45, v37
    v_mul_f32 v46, v46, v38
    v_mul_f32 v47, v47, v39
    v_cvt_pk_bf16_f32 v52, v40, v41
    v_cvt_pk_bf16_f32 v53, v42, v43
    v_cvt_pk_bf16_f32 v54, v44, v45
    v_cvt_pk_bf16_f32 v55, v46, v47
    v_lshlrev_b32 v40, 16, v52
    v_and_b32 v41, 0xffff0000, v52
    v_lshlrev_b32 v42, 16, v53
    v_and_b32 v43, 0xffff0000, v53
    v_lshlrev_b32 v44, 16, v54
    v_and_b32 v45, 0xffff0000, v54
    v_lshlrev_b32 v46, 16, v55
    v_and_b32 v47, 0xffff0000, v55
    v_add_f32 v40, v40, v44
    v_add_f32 v41, v41, v45
    v_add_f32 v42, v42, v46
    v_add_f32 v43, v43, v47
    v_add_f32 v40, v40, v42
    v_add_f32 v41, v41, v43
    v_add_f32 v40, v40, v41
    s_nop 1
    v_add_f32_dpp v40, v40, v40 row_ror:1 row_mask:0xf bank_mask:0xf
    s_nop 1
    v_add_f32_dpp v40, v40, v40 row_ror:2 row_mask:0xf bank_mask:0xf
    s_nop 1
    v_add_f32_dpp v40, v40, v40 row_ror:4 row_mask:0xf bank_mask:0xf
    s_nop 1
    v_add_f32_dpp v40, v40, v40 row_ror:8 row_mask:0xf bank_mask:0xf
    v_mov_b32 v41, v40
    s_nop 1
    v_permlane16_swap_b32 v40, v41
    v_add_f32 v40, v40, v41
    v_mov_b32 v41, v40
    s_nop 1
    v_permlane32_swap_b32 v40, v41
    v_add_f32 v40, v40, v41
    v_cmp_eq_u32 vcc, 1, v127
    s_nop 1
    v_cndmask_b32 v64, v64, v40, vcc
    s_waitcnt vmcnt(1)
    v_lshlrev_b32 v40, 16, v56
    v_and_b32 v41, 0xffff0000, v56
    v_lshlrev_b32 v42, 16, v57
    v_and_b32 v43, 0xffff0000, v57
    v_lshlrev_b32 v44, 16, v58
    v_and_b32 v45, 0xffff0000, v58
    v_lshlrev_b32 v46, 16, v59
    v_and_b32 v47, 0xffff0000, v59
    v_mul_f32 v40, v40, v32
    v_mul_f32 v41, v41, v33
    v_mul_f32 v42, v42, v34
    v_mul_f32 v43, v43, v35
    v_mul_f32 v44, v44, v36
    v_mul_f32 v45, v45, v37
    v_mul_f32 v46, v46, v38
    v_mul_f32 v47, v47, v39
    v_cvt_pk_bf16_f32 v56, v40, v41
    v_cvt_pk_bf16_f32 v57, v42, v43
    v_cvt_pk_bf16_f32 v58, v44, v45
    v_cvt_pk_bf16_f32 v59, v46, v47
    v_lshlrev_b32 v40, 16, v56
    v_and_b32 v41, 0xffff0000, v56
    v_lshlrev_b32 v42, 16, v57
    v_and_b32 v43, 0xffff0000, v57
    v_lshlrev_b32 v44, 16, v58
    v_and_b32 v45, 0xffff0000, v58
    v_lshlrev_b32 v46, 16, v59
    v_and_b32 v47, 0xffff0000, v59
    v_add_f32 v40, v40, v44
    v_add_f32 v41, v41, v45
    v_add_f32 v42, v42, v46
    v_add_f32 v43, v43, v47
    v_add_f32 v40, v40, v42
    v_add_f32 v41, v41, v43
    v_add_f32 v40, v40, v41
    s_nop 1
    v_add_f32_dpp v40, v40, v40 row_ror:1 row_mask:0xf bank_mask:0xf
    s_nop 1
    v_add_f32_dpp v40, v40, v40 row_ror:2 row_mask:0xf bank_mask:0xf
    s_nop 1
    v_add_f32_dpp v40, v40, v40 row_ror:4 row_mask:0xf bank_mask:0xf
    s_nop 1
    v_add_f32_dpp v40, v40, v40 row_ror:8 row_mask:0xf bank_mask:0xf
    v_mov_b32 v41, v40
    s_nop 1
    v_permlane16_swap_b32 v40, v41
    v_add_f32 v40, v40, v41
    v_mov_b32 v41, v40
    s_nop 1
    v_permlane32_swap_b32 v40, v41
    v_add_f32 v40, v40, v41
    v_cmp_eq_u32 vcc, 2, v127
    s_nop 1
    v_cndmask_b32 v64, v64, v40, vcc
    s_waitcnt vmcnt(0)
    v_lshlrev_b32 v40, 16, v60
    v_and_b32 v41, 0xffff0000, v60
    v_lshlrev_b32 v42, 16, v61
    v_and_b32 v43, 0xffff0000, v61
    v_lshlrev_b32 v44, 16, v62
    v_and_b32 v45, 0xffff0000, v62
    v_lshlrev_b32 v46, 16, v63
    v_and_b32 v47, 0xffff0000, v63
    v_mul_f32 v40, v40, v32
    v_mul_f32 v41, v41, v33
    v_mul_f32 v42, v42, v34
    v_mul_f32 v43, v43, v35
    v_mul_f32 v44, v44, v36
    v_mul_f32 v45, v45, v37
    v_mul_f32 v46, v46, v38
    v_mul_f32 v47, v47, v39
    v_cvt_pk_bf16_f32 v60, v40, v41
    v_cvt_pk_bf16_f32 v61, v42, v43
    v_cvt_pk_bf16_f32 v62, v44, v45
    v_cvt_pk_bf16_f32 v63, v46, v47
    v_lshlrev_b32 v40, 16, v60
    v_and_b32 v41, 0xffff0000, v60
    v_lshlrev_b32 v42, 16, v61
    v_and_b32 v43, 0xffff0000, v61
    v_lshlrev_b32 v44, 16, v62
    v_and_b32 v45, 0xffff0000, v62
    v_lshlrev_b32 v46, 16, v63
    v_and_b32 v47, 0xffff0000, v63
    v_add_f32 v40, v40, v44
    v_add_f32 v41, v41, v45
    v_add_f32 v42, v42, v46
    v_add_f32 v43, v43, v47
    v_add_f32 v40, v40, v42
    v_add_f32 v41, v41, v43
    v_add_f32 v40, v40, v41
    s_nop 1
    v_add_f32_dpp v40, v40, v40 row_ror:1 row_mask:0xf bank_mask:0xf
    s_nop 1
    v_add_f32_dpp v40, v40, v40 row_ror:2 row_mask:0xf bank_mask:0xf
    s_nop 1
    v_add_f32_dpp v40, v40, v40 row_ror:4 row_mask:0xf bank_mask:0xf
    s_nop 1
    v_add_f32_dpp v40, v40, v40 row_ror:8 row_mask:0xf bank_mask:0xf
    v_mov_b32 v41, v40
    s_nop 1
    v_permlane16_swap_b32 v40, v41
    v_add_f32 v40, v40, v41
    v_mov_b32 v41, v40
    s_nop 1
    v_permlane32_swap_b32 v40, v41
    v_add_f32 v40, v40, v41
    v_cmp_eq_u32 vcc, 3, v127
    s_nop 1
    v_cndmask_b32 v64, v64, v40, vcc
    v_cvt_pk_bf16_f32 v64, v64, v64
    v_and_b32 v64, 0xffff0000, v64
    v_mul_f32 v64, 0xbfb8aa3b, v64
    v_exp_f32 v64, v64
    s_nop 0
    v_add_f32 v64, 1.0, v64
    v_rcp_f32 v64, v64
    s_nop 0
    v_cvt_pk_bf16_f32 v64, v64, v64
    v_and_b32 v64, 0xffff0000, v64
    v_bfe_u32 v40, v127, 0, 2
    v_lshlrev_b32 v40, 2, v40
    v_bfe_u32 v41, v127, 2, 1
    v_lshlrev_b32 v41, 28, v41
    v_add_u32 v40, v40, v41
    v_bfe_u32 v41, v127, 3, 1
    v_lshlrev_b32 v41, 28, v41
    v_add_u32 v40, v40, v41
    v_bfe_u32 v41, v127, 4, 1
    v_lshlrev_b32 v41, 28, v41
    v_add_u32 v40, v40, v41
    v_bfe_u32 v41, v127, 5, 1
    v_lshlrev_b32 v41, 28, v41
    v_add_u32 v40, v40, v41
    s_lshl_b32 s19, s19, 4
    s_add_u32 s19, s19, 327680
    buffer_store_dword v64, v40, s[4:7], s19 offen sc1
    s_waitcnt vmcnt(0)
    s_barrier
    s_cmp_lg_u32 s17, 0
    s_cbranch_scc1 L_c_noreg
    s_mul_i32 s19, s28, s28
    s_lshl_b32 s19, s19, 18
    s_lshl_b32 s20, s28, 9
    s_add_u32 s19, s19, s20
    s_add_u32 s19, s19, 1
    s_lshl_b32 s20, s27, 2
    s_mov_b64 exec, 1
    v_mov_b32 v7, s19
    buffer_atomic_add v7, off, s[12:15], s20
    s_mov_b64 exec, -1
L_c_noreg:
    s_load_dwordx2 s[24:25], s[0:1], 16
    s_waitcnt lgkmcnt(0)
    s_mov_b32 s68, s24
    s_and_b32 s69, s25, 0xffff
    s_mov_b32 s70, 0x400000
    s_mov_b32 s71, 0x20000
    s_load_dwordx2 s[24:25], s[0:1], 40
    s_waitcnt lgkmcnt(0)
    s_mov_b32 s72, s24
    s_and_b32 s73, s25, 0xffff
    s_mov_b32 s74, 0x400000
    s_mov_b32 s75, 0x20000
    v_bfe_u32 v123, v127, 5, 1
    v_lshlrev_b32 v123, 15, v123
    v_bfe_u32 v126, v127, 4, 1
    v_lshlrev_b32 v126, 16, v126
    v_add_u32 v123, v123, v126
    v_bfe_u32 v126, v127, 3, 1
    v_lshlrev_b32 v126, 14, v126
    v_add_u32 v123, v123, v126
    v_bfe_u32 v126, v127, 2, 1
    v_lshlrev_b32 v126, 13, v126
    v_add_u32 v123, v123, v126
    v_bfe_u32 v126, v127, 0, 1
    v_lshlrev_b32 v126, 4, v126
    v_add_u32 v123, v123, v126
    v_lshrrev_b32 v126, 3, v127
    v_xor_b32 v126, v126, v127
    v_and_b32 v126, 2, v126
    v_lshl_add_u32 v123, v126, 4, v123
    v_bfe_u32 v122, v127, 5, 1
    v_lshlrev_b32 v122, 14, v122
    v_bfe_u32 v126, v127, 4, 1
    v_lshlrev_b32 v126, 12, v126
    v_add_u32 v122, v122, v126
    v_bfe_u32 v126, v127, 3, 1
    v_lshlrev_b32 v126, 11, v126
    v_add_u32 v122, v122, v126
    v_bfe_u32 v126, v127, 2, 1
    v_lshlrev_b32 v126, 10, v126
    v_add_u32 v122, v122, v126
    v_bfe_u32 v126, v127, 0, 1
    v_lshlrev_b32 v126, 4, v126
    v_add_u32 v122, v122, v126
    v_lshrrev_b32 v126, 3, v127
    v_xor_b32 v126, v126, v127
    v_and_b32 v126, 2, v126
    v_lshl_add_u32 v122, v126, 4, v122
    v_bfe_u32 v125, v127, 5, 1
    v_lshlrev_b32 v125, 10, v125
    v_bfe_u32 v126, v127, 4, 1
    v_mul_u32_u24 v126, 288, v126
    v_add_u32 v125, v125, v126
    v_bfe_u32 v126, v127, 3, 1
    v_lshlrev_b32 v126, 7, v126
    v_add_u32 v125, v125, v126
    v_bfe_u32 v126, v127, 2, 1
    v_lshlrev_b32 v126, 6, v126
    v_add_u32 v125, v125, v126
    v_bfe_u32 v126, v127, 0, 2
    v_lshlrev_b32 v126, 3, v126
    v_add_u32 v125, v125, v126
    s_lshl_b32 s22, s17, 15
    v_add_u32 v125, s22, v125
    v_xor_b32 v124, 32, v125
    s_add_u32 m0, s22, 0
    s_lshl_b32 s19, s16, 8
    s_lshl_b32 s20, s17, 6
    s_add_u32 s19, s19, s20
    buffer_load_dwordx4 v123, s[68:71], s19 offen offset:0  lds
    s_add_u32 s19, s19, 130048
    buffer_load_dwordx4 v123, s[68:71], s19 offen offset:1024  lds
    s_add_u32 s19, s19, 130048
    buffer_load_dwordx4 v123, s[68:71], s19 offen offset:2048  lds
    s_add_u32 s19, s19, 130048
    buffer_load_dwordx4 v123, s[68:71], s19 offen offset:3072  lds
    s_add_u32 m0, s22, 4096
    s_lshl_b32 s19, s16, 8
    s_lshl_b32 s20, s17, 6
    s_add_u32 s19, s19, s20
    s_add_u32 s19, s19, 524288
    buffer_load_dwordx4 v123, s[68:71], s19 offen offset:0  lds
    s_add_u32 s19, s19, 130048
    buffer_load_dwordx4 v123, s[68:71], s19 offen offset:1024  lds
    s_add_u32 s19, s19, 130048
    buffer_load_dwordx4 v123, s[68:71], s19 offen offset:2048  lds
    s_add_u32 s19, s19, 130048
    buffer_load_dwordx4 v123, s[68:71], s19 offen offset:3072  lds
    s_add_u32 m0, s22, 8192
    s_lshl_b32 s19, s16, 8
    s_lshl_b32 s20, s17, 6
    s_add_u32 s19, s19, s20
    s_add_u32 s19, s19, 1048576
    buffer_load_dwordx4 v123, s[68:71], s19 offen offset:0  lds
    s_add_u32 s19, s19, 130048
    buffer_load_dwordx4 v123, s[68:71], s19 offen offset:1024  lds
    s_add_u32 s19, s19, 130048
    buffer_load_dwordx4 v123, s[68:71], s19 offen offset:2048  lds
    s_add_u32 s19, s19, 130048
    buffer_load_dwordx4 v123, s[68:71], s19 offen offset:3072  lds
    s_add_u32 m0, s22, 12288
    s_lshl_b32 s19, s16, 8
    s_lshl_b32 s20, s17, 6
    s_add_u32 s19, s19, s20
    s_add_u32 s19, s19, 1572864
    buffer_load_dwordx4 v123, s[68:71], s19 offen offset:0  lds
    s_add_u32 s19, s19, 130048
    buffer_load_dwordx4 v123, s[68:71], s19 offen offset:1024  lds
    s_add_u32 s19, s19, 130048
    buffer_load_dwordx4 v123, s[68:71], s19 offen offset:2048  lds
    s_add_u32 s19, s19, 130048
    buffer_load_dwordx4 v123, s[68:71], s19 offen offset:3072  lds
    s_add_u32 m0, s22, 16384
    s_lshl_b32 s19, s16, 8
    s_lshl_b32 s20, s17, 6
    s_add_u32 s19, s19, s20
    s_add_u32 s19, s19, 2097152
    buffer_load_dwordx4 v123, s[68:71], s19 offen offset:0  lds
    s_add_u32 s19, s19, 130048
    buffer_load_dwordx4 v123, s[68:71], s19 offen offset:1024  lds
    s_add_u32 s19, s19, 130048
    buffer_load_dwordx4 v123, s[68:71], s19 offen offset:2048  lds
    s_add_u32 s19, s19, 130048
    buffer_load_dwordx4 v123, s[68:71], s19 offen offset:3072  lds
    s_add_u32 m0, s22, 20480
    s_lshl_b32 s19, s16, 8
    s_lshl_b32 s20, s17, 6
    s_add_u32 s19, s19, s20
    s_add_u32 s19, s19, 2621440
    buffer_load_dwordx4 v123, s[68:71], s19 offen offset:0  lds
    s_add_u32 s19, s19, 130048
    buffer_load_dwordx4 v123, s[68:71], s19 offen offset:1024  lds
    s_add_u32 s19, s19, 130048
    buffer_load_dwordx4 v123, s[68:71], s19 offen offset:2048  lds
    s_add_u32 s19, s19, 130048
    buffer_load_dwordx4 v123, s[68:71], s19 offen offset:3072  lds
    s_add_u32 m0, s22, 24576
    s_lshl_b32 s19, s16, 8
    s_lshl_b32 s20, s17, 6
    s_add_u32 s19, s19, s20
    s_add_u32 s19, s19, 3145728
    buffer_load_dwordx4 v123, s[68:71], s19 offen offset:0  lds
    s_add_u32 s19, s19, 130048
    buffer_load_dwordx4 v123, s[68:71], s19 offen offset:1024  lds
    s_add_u32 s19, s19, 130048
    buffer_load_dwordx4 v123, s[68:71], s19 offen offset:2048  lds
    s_add_u32 s19, s19, 130048
    buffer_load_dwordx4 v123, s[68:71], s19 offen offset:3072  lds
    s_add_u32 m0, s22, 28672
    s_lshl_b32 s19, s16, 8
    s_lshl_b32 s20, s17, 6
    s_add_u32 s19, s19, s20
    s_add_u32 s19, s19, 3670016
    buffer_load_dwordx4 v123, s[68:71], s19 offen offset:0  lds
    s_add_u32 s19, s19, 130048
    buffer_load_dwordx4 v123, s[68:71], s19 offen offset:1024  lds
    s_add_u32 s19, s19, 130048
    buffer_load_dwordx4 v123, s[68:71], s19 offen offset:2048  lds
    s_add_u32 s19, s19, 130048
    buffer_load_dwordx4 v123, s[68:71], s19 offen offset:3072  lds
    s_waitcnt vmcnt(28)
    ds_read_b64_tr_b16 a[0:1], v125 offset:0
    ds_read_b64_tr_b16 a[2:3], v125 offset:512
    ds_read_b64_tr_b16 a[4:5], v125 offset:2048
    ds_read_b64_tr_b16 a[6:7], v125 offset:2560
    ds_read_b64_tr_b16 a[64:65], v124 offset:0
    ds_read_b64_tr_b16 a[66:67], v124 offset:512
    ds_read_b64_tr_b16 a[68:69], v124 offset:2048
    ds_read_b64_tr_b16 a[70:71], v124 offset:2560
    s_waitcnt lgkmcnt(0)
    s_add_u32 m0, s22, 0
    s_lshl_b32 s19, s16, 17
    s_lshl_b32 s20, s17, 8
    s_add_u32 s19, s19, s20
    s_add_u32 s19, s19, 0
    buffer_load_dwordx4 v122, s[72:75], s19 offen offset:0  lds
    s_add_u32 s19, s19, 7168
    buffer_load_dwordx4 v122, s[72:75], s19 offen offset:1024  lds
    s_add_u32 s19, s19, 23552
    buffer_load_dwordx4 v122, s[72:75], s19 offen offset:2048  lds
    s_add_u32 s19, s19, 7168
    buffer_load_dwordx4 v122, s[72:75], s19 offen offset:3072  lds
    s_waitcnt vmcnt(28)
    ds_read_b64_tr_b16 a[8:9], v125 offset:4096
    ds_read_b64_tr_b16 a[10:11], v125 offset:4608
    ds_read_b64_tr_b16 a[12:13], v125 offset:6144
    ds_read_b64_tr_b16 a[14:15], v125 offset:6656
    ds_read_b64_tr_b16 a[72:73], v124 offset:4096
    ds_read_b64_tr_b16 a[74:75], v124 offset:4608
    ds_read_b64_tr_b16 a[76:77], v124 offset:6144
    ds_read_b64_tr_b16 a[78:79], v124 offset:6656
    s_waitcnt lgkmcnt(0)
    s_add_u32 m0, s22, 4096
    s_lshl_b32 s19, s16, 17
    s_lshl_b32 s20, s17, 8
    s_add_u32 s19, s19, s20
    s_add_u32 s19, s19, 65536
    buffer_load_dwordx4 v122, s[72:75], s19 offen offset:0  lds
    s_add_u32 s19, s19, 7168
    buffer_load_dwordx4 v122, s[72:75], s19 offen offset:1024  lds
    s_add_u32 s19, s19, 23552
    buffer_load_dwordx4 v122, s[72:75], s19 offen offset:2048  lds
    s_add_u32 s19, s19, 7168
    buffer_load_dwordx4 v122, s[72:75], s19 offen offset:3072  lds
    s_waitcnt vmcnt(28)
    ds_read_b64_tr_b16 a[16:17], v125 offset:8192
    ds_read_b64_tr_b16 a[18:19], v125 offset:8704
    ds_read_b64_tr_b16 a[20:21], v125 offset:10240
    ds_read_b64_tr_b16 a[22:23], v125 offset:10752
    ds_read_b64_tr_b16 a[80:81], v124 offset:8192
    ds_read_b64_tr_b16 a[82:83], v124 offset:8704
    ds_read_b64_tr_b16 a[84:85], v124 offset:10240
    ds_read_b64_tr_b16 a[86:87], v124 offset:10752
    s_waitcnt lgkmcnt(0)
    s_add_u32 m0, s22, 8192
    s_lshl_b32 s19, s16, 17
    s_lshl_b32 s20, s17, 8
    s_add_u32 s19, s19, s20
    s_add_u32 s19, s19, 64
    buffer_load_dwordx4 v122, s[72:75], s19 offen offset:0  lds
    s_add_u32 s19, s19, 7168
    buffer_load_dwordx4 v122, s[72:75], s19 offen offset:1024  lds
    s_add_u32 s19, s19, 23552
    buffer_load_dwordx4 v122, s[72:75], s19 offen offset:2048  lds
    s_add_u32 s19, s19, 7168
    buffer_load_dwordx4 v122, s[72:75], s19 offen offset:3072  lds
    s_waitcnt vmcnt(28)
    ds_read_b64_tr_b16 a[24:25], v125 offset:12288
    ds_read_b64_tr_b16 a[26:27], v125 offset:12800
    ds_read_b64_tr_b16 a[28:29], v125 offset:14336
    ds_read_b64_tr_b16 a[30:31], v125 offset:14848
    ds_read_b64_tr_b16 a[88:89], v124 offset:12288
    ds_read_b64_tr_b16 a[90:91], v124 offset:12800
    ds_read_b64_tr_b16 a[92:93], v124 offset:14336
    ds_read_b64_tr_b16 a[94:95], v124 offset:14848
    s_waitcnt lgkmcnt(0)
    s_add_u32 m0, s22, 12288
    s_lshl_b32 s19, s16, 17
    s_lshl_b32 s20, s17, 8
    s_add_u32 s19, s19, s20
    s_add_u32 s19, s19, 65600
    buffer_load_dwordx4 v122, s[72:75], s19 offen offset:0  lds
    s_add_u32 s19, s19, 7168
    buffer_load_dwordx4 v122, s[72:75], s19 offen offset:1024  lds
    s_add_u32 s19, s19, 23552
    buffer_load_dwordx4 v122, s[72:75], s19 offen offset:2048  lds
    s_add_u32 s19, s19, 7168
    buffer_load_dwordx4 v122, s[72:75], s19 offen offset:3072  lds
    s_waitcnt vmcnt(28)
    ds_read_b64_tr_b16 a[32:33], v125 offset:16384
    ds_read_b64_tr_b16 a[34:35], v125 offset:16896
    ds_read_b64_tr_b16 a[36:37], v125 offset:18432
    ds_read_b64_tr_b16 a[38:39], v125 offset:18944
    ds_read_b64_tr_b16 a[96:97], v124 offset:16384
    ds_read_b64_tr_b16 a[98:99], v124 offset:16896
    ds_read_b64_tr_b16 a[100:101], v124 offset:18432
    ds_read_b64_tr_b16 a[102:103], v124 offset:18944
    s_waitcnt lgkmcnt(0)
    s_add_u32 m0, s22, 16384
    s_lshl_b32 s19, s16, 17
    s_lshl_b32 s20, s17, 8
    s_add_u32 s19, s19, s20
    s_add_u32 s19, s19, 128
    buffer_load_dwordx4 v122, s[72:75], s19 offen offset:0  lds
    s_add_u32 s19, s19, 7168
    buffer_load_dwordx4 v122, s[72:75], s19 offen offset:1024  lds
    s_add_u32 s19, s19, 23552
    buffer_load_dwordx4 v122, s[72:75], s19 offen offset:2048  lds
    s_add_u32 s19, s19, 7168
    buffer_load_dwordx4 v122, s[72:75], s19 offen offset:3072  lds
    s_waitcnt vmcnt(28)
    ds_read_b64_tr_b16 a[40:41], v125 offset:20480
    ds_read_b64_tr_b16 a[42:43], v125 offset:20992
    ds_read_b64_tr_b16 a[44:45], v125 offset:22528
    ds_read_b64_tr_b16 a[46:47], v125 offset:23040
    ds_read_b64_tr_b16 a[104:105], v124 offset:20480
    ds_read_b64_tr_b16 a[106:107], v124 offset:20992
    ds_read_b64_tr_b16 a[108:109], v124 offset:22528
    ds_read_b64_tr_b16 a[110:111], v124 offset:23040
    s_waitcnt lgkmcnt(0)
    s_add_u32 m0, s22, 20480
    s_lshl_b32 s19, s16, 17
    s_lshl_b32 s20, s17, 8
    s_add_u32 s19, s19, s20
    s_add_u32 s19, s19, 65664
    buffer_load_dwordx4 v122, s[72:75], s19 offen offset:0  lds
    s_add_u32 s19, s19, 7168
    buffer_load_dwordx4 v122, s[72:75], s19 offen offset:1024  lds
    s_add_u32 s19, s19, 23552
    buffer_load_dwordx4 v122, s[72:75], s19 offen offset:2048  lds
    s_add_u32 s19, s19, 7168
    buffer_load_dwordx4 v122, s[72:75], s19 offen offset:3072  lds
    s_waitcnt vmcnt(28)
    ds_read_b64_tr_b16 a[48:49], v125 offset:24576
    ds_read_b64_tr_b16 a[50:51], v125 offset:25088
    ds_read_b64_tr_b16 a[52:53], v125 offset:26624
    ds_read_b64_tr_b16 a[54:55], v125 offset:27136
    ds_read_b64_tr_b16 a[112:113], v124 offset:24576
    ds_read_b64_tr_b16 a[114:115], v124 offset:25088
    ds_read_b64_tr_b16 a[116:117], v124 offset:26624
    ds_read_b64_tr_b16 a[118:119], v124 offset:27136
    s_waitcnt lgkmcnt(0)
    s_add_u32 m0, s22, 24576
    s_lshl_b32 s19, s16, 17
    s_lshl_b32 s20, s17, 8
    s_add_u32 s19, s19, s20
    s_add_u32 s19, s19, 192
    buffer_load_dwordx4 v122, s[72:75], s19 offen offset:0  lds
    s_add_u32 s19, s19, 7168
    buffer_load_dwordx4 v122, s[72:75], s19 offen offset:1024  lds
    s_add_u32 s19, s19, 23552
    buffer_load_dwordx4 v122, s[72:75], s19 offen offset:2048  lds
    s_add_u32 s19, s19, 7168
    buffer_load_dwordx4 v122, s[72:75], s19 offen offset:3072  lds
    s_waitcnt vmcnt(28)
    ds_read_b64_tr_b16 a[56:57], v125 offset:28672
    ds_read_b64_tr_b16 a[58:59], v125 offset:29184
    ds_read_b64_tr_b16 a[60:61], v125 offset:30720
    ds_read_b64_tr_b16 a[62:63], v125 offset:31232
    ds_read_b64_tr_b16 a[120:121], v124 offset:28672
    ds_read_b64_tr_b16 a[122:123], v124 offset:29184
    ds_read_b64_tr_b16 a[124:125], v124 offset:30720
    ds_read_b64_tr_b16 a[126:127], v124 offset:31232
    s_waitcnt lgkmcnt(0)
    s_add_u32 m0, s22, 28672
    s_lshl_b32 s19, s16, 17
    s_lshl_b32 s20, s17, 8
    s_add_u32 s19, s19, s20
    s_add_u32 s19, s19, 65728
    buffer_load_dwordx4 v122, s[72:75], s19 offen offset:0  lds
    s_add_u32 s19, s19, 7168
    buffer_load_dwordx4 v122, s[72:75], s19 offen offset:1024  lds
    s_add_u32 s19, s19, 23552
    buffer_load_dwordx4 v122, s[72:75], s19 offen offset:2048  lds
    s_add_u32 s19, s19, 7168
    buffer_load_dwordx4 v122, s[72:75], s19 offen offset:3072  lds
    s_waitcnt vmcnt(28)
    ds_read_b64_tr_b16 a[128:129], v125 offset:0
    ds_read_b64_tr_b16 a[130:131], v125 offset:512
    ds_read_b64_tr_b16 a[132:133], v125 offset:2048
    ds_read_b64_tr_b16 a[134:135], v125 offset:2560
    ds_read_b64_tr_b16 a[144:145], v124 offset:0
    ds_read_b64_tr_b16 a[146:147], v124 offset:512
    ds_read_b64_tr_b16 a[148:149], v124 offset:2048
    ds_read_b64_tr_b16 a[150:151], v124 offset:2560
    s_waitcnt lgkmcnt(0)
    s_waitcnt vmcnt(24)
    ds_read_b64_tr_b16 a[136:137], v125 offset:4096
    ds_read_b64_tr_b16 a[138:139], v125 offset:4608
    ds_read_b64_tr_b16 a[140:141], v125 offset:6144
    ds_read_b64_tr_b16 a[142:143], v125 offset:6656
    ds_read_b64_tr_b16 a[152:153], v124 offset:4096
    ds_read_b64_tr_b16 a[154:155], v124 offset:4608
    ds_read_b64_tr_b16 a[156:157], v124 offset:6144
    ds_read_b64_tr_b16 a[158:159], v124 offset:6656
    s_waitcnt lgkmcnt(0)
    s_waitcnt vmcnt(20)
    ds_read_b64_tr_b16 a[160:161], v125 offset:8192
    ds_read_b64_tr_b16 a[162:163], v125 offset:8704
    ds_read_b64_tr_b16 a[164:165], v125 offset:10240
    ds_read_b64_tr_b16 a[166:167], v125 offset:10752
    ds_read_b64_tr_b16 a[176:177], v124 offset:8192
    ds_read_b64_tr_b16 a[178:179], v124 offset:8704
    ds_read_b64_tr_b16 a[180:181], v124 offset:10240
    ds_read_b64_tr_b16 a[182:183], v124 offset:10752
    s_waitcnt lgkmcnt(0)
    s_waitcnt vmcnt(16)
    ds_read_b64_tr_b16 a[168:169], v125 offset:12288
    ds_read_b64_tr_b16 a[170:171], v125 offset:12800
    ds_read_b64_tr_b16 a[172:173], v125 offset:14336
    ds_read_b64_tr_b16 a[174:175], v125 offset:14848
    ds_read_b64_tr_b16 a[184:185], v124 offset:12288
    ds_read_b64_tr_b16 a[186:187], v124 offset:12800
    ds_read_b64_tr_b16 a[188:189], v124 offset:14336
    ds_read_b64_tr_b16 a[190:191], v124 offset:14848
    s_waitcnt lgkmcnt(0)
    s_waitcnt vmcnt(12)
    ds_read_b64_tr_b16 a[192:193], v125 offset:16384
    ds_read_b64_tr_b16 a[194:195], v125 offset:16896
    ds_read_b64_tr_b16 a[196:197], v125 offset:18432
    ds_read_b64_tr_b16 a[198:199], v125 offset:18944
    ds_read_b64_tr_b16 a[208:209], v124 offset:16384
    ds_read_b64_tr_b16 a[210:211], v124 offset:16896
    ds_read_b64_tr_b16 a[212:213], v124 offset:18432
    ds_read_b64_tr_b16 a[214:215], v124 offset:18944
    s_waitcnt lgkmcnt(0)
    s_waitcnt vmcnt(8)
    ds_read_b64_tr_b16 a[200:201], v125 offset:20480
    ds_read_b64_tr_b16 a[202:203], v125 offset:20992
    ds_read_b64_tr_b16 a[204:205], v125 offset:22528
    ds_read_b64_tr_b16 a[206:207], v125 offset:23040
    ds_read_b64_tr_b16 a[216:217], v124 offset:20480
    ds_read_b64_tr_b16 a[218:219], v124 offset:20992
    ds_read_b64_tr_b16 a[220:221], v124 offset:22528
    ds_read_b64_tr_b16 a[222:223], v124 offset:23040
    s_waitcnt lgkmcnt(0)
    s_waitcnt vmcnt(4)
    ds_read_b64_tr_b16 a[224:225], v125 offset:24576
    ds_read_b64_tr_b16 a[226:227], v125 offset:25088
    ds_read_b64_tr_b16 a[228:229], v125 offset:26624
    ds_read_b64_tr_b16 a[230:231], v125 offset:27136
    ds_read_b64_tr_b16 a[240:241], v124 offset:24576
    ds_read_b64_tr_b16 a[242:243], v124 offset:25088
    ds_read_b64_tr_b16 a[244:245], v124 offset:26624
    ds_read_b64_tr_b16 a[246:247], v124 offset:27136
    s_waitcnt lgkmcnt(0)
    s_waitcnt vmcnt(0)
    ds_read_b64_tr_b16 a[232:233], v125 offset:28672
    ds_read_b64_tr_b16 a[234:235], v125 offset:29184
    ds_read_b64_tr_b16 a[236:237], v125 offset:30720
    ds_read_b64_tr_b16 a[238:239], v125 offset:31232
    ds_read_b64_tr_b16 a[248:249], v124 offset:28672
    ds_read_b64_tr_b16 a[250:251], v124 offset:29184
    ds_read_b64_tr_b16 a[252:253], v124 offset:30720
    ds_read_b64_tr_b16 a[254:255], v124 offset:31232
    s_waitcnt lgkmcnt(0)
    s_barrier
    s_load_dwordx2 s[24:25], s[0:1], 96
    s_waitcnt lgkmcnt(0)
    s_mov_b32 s92, s24
    s_and_b32 s93, s25, 0xffff
    s_mov_b32 s94, 0x200000
    s_mov_b32 s95, 0x20000
    s_mov_b32 s44, 0x3e0293ee
    v_add_u32 v9, 65536, v8
    v_add_u32 v10, 65536, v0
    s_and_b32 s19, s17, 1
    s_lshr_b32 s20, s17, 1
    s_lshl_b32 s21, s19, 12
    v_add_u32 v11, s21, v10
    s_lshl_b32 s22, s20, 11
    v_add_u32 v14, s22, v11
    s_lshl_b32 s22, s20, 12
    v_add_u32 v21, s22, v0
    s_lshl_b32 s21, s19, 4
    v_and_b32 v6, 15, v127
    v_add_u32 v6, s21, v6
    v_bfe_u32 v7, v127, 4, 2
    v_lshlrev_b32 v7, 2, v7
    v_sub_u32 v6, v6, v7
    v_cmp_le_i32 s[60:61], 0, v6
    v_cmp_le_i32 s[62:63], 1, v6
    v_cmp_le_i32 s[64:65], 2, v6
    v_cmp_le_i32 s[66:67], 3, v6
    v_cmp_le_i32 s[68:69], 16, v6
    v_cmp_le_i32 s[70:71], 17, v6
    v_cmp_le_i32 s[72:73], 18, v6
    v_cmp_le_i32 s[74:75], 19, v6
    v_bfe_u32 v12, v127, 5, 1
    v_lshlrev_b32 v12, 3, v12
    v_bfe_u32 v126, v127, 0, 4
    v_add_u32 v12, v12, v126
    v_and_b32 v12, 15, v12
    v_and_b32 v126, 48, v127
    v_add_u32 v12, v12, v126
    v_lshlrev_b32 v12, 3, v12
    s_lshl_b32 s19, s17, 10
    s_add_u32 s19, s19, 81920
    v_add_u32 v12, s19, v12
    v_bfe_u32 v13, v127, 1, 1
    v_lshlrev_b32 v13, 3, v13
    v_bfe_u32 v126, v127, 2, 4
    v_add_u32 v13, v13, v126
    v_and_b32 v13, 15, v13
    v_and_b32 v126, 3, v127
    v_lshl_add_u32 v13, v126, 4, v13
    v_lshlrev_b32 v13, 3, v13
    v_add_u32 v13, 81920, v13
    v_mov_b32 v24, 0x3f803f80
    v_mov_b32 v28, 0
    v_mov_b32 v25, 0x3f803f80
    v_mov_b32 v29, 0
    v_mov_b32 v26, 0x3f803f80
    v_mov_b32 v30, 0
    v_mov_b32 v27, 0x3f803f80
    v_mov_b32 v31, 0
    v_add_u32 v6, 81920, v8
    ds_write_b128 v6, v[28:31]
    v_lshlrev_b32 v15, 7, v127
    v_lshlrev_b32 v22, 2, v127
    v_cmp_gt_u32 s[86:87], 32, v127
    s_lshl_b32 s19, s16, 7
    s_add_u32 s52, s19, 0
    s_mov_b32 s54, 12288
    s_mov_b64 s[84:85], 0
    s_bitset1_b64 s[84:85], 0
    v_bfe_u32 v16, v127, 4, 2
    v_lshlrev_b32 v16, 10, v16
    v_bfe_u32 v126, v127, 0, 4
    v_lshlrev_b32 v126, 4, v126
    v_add_u32 v16, v16, v126
    s_lshl_b32 s19, s17, 8
    v_add_u32 v16, s19, v16
    v_bfe_u32 v6, v127, 5, 1
    v_lshlrev_b32 v6, 28, v6
    v_add_u32 v17, v6, v16
    v_bfe_u32 v19, v127, 2, 1
    v_lshlrev_b32 v19, 4, v19
    v_bfe_u32 v126, v127, 0, 2
    v_add_u32 v19, v19, v126
    s_lshl_b32 s19, s17, 2
    v_add_u32 v19, s19, v19
    v_bfe_u32 v18, v127, 4, 2
    v_lshlrev_b32 v18, 3, v18
    v_bfe_u32 v126, v127, 3, 1
    v_lshlrev_b32 v126, 28, v126
    v_add_u32 v18, v18, v126
    v_lshl_add_u32 v18, v19, 10, v18
    v_lshlrev_b32 v19, 2, v19
    v_and_b32 v126, 1, v127
    v_cmp_eq_u32 vcc, 1, v126
    v_mov_b32 v20, 0x3f80
    v_mov_b32 v126, 0x3f800000
    v_cndmask_b32 v20, v20, v126, vcc
    v_bfe_u32 v126, v127, 1, 3
    v_cmp_eq_u32 s[76:77], 0, v126
    v_cmp_eq_u32 s[78:79], 1, v126
    v_cmp_eq_u32 s[80:81], 2, v126
    v_cmp_eq_u32 s[82:83], 3, v126
    s_lshl_b32 s19, s45, 21
    s_add_u32 s19, s19, 100663296
    s_lshl_b32 s20, s16, 10
    s_add_u32 s57, s19, s20
    s_lshl_b32 s20, s17, 18
    s_add_u32 s57, s57, s20
    s_lshl_b32 s20, s16, 15
    s_add_u32 s58, s19, s20
    s_mov_b32 s30, s45
    s_mov_b32 s43, 0
    s_mov_b32 s59, 0
    s_mov_b32 s90, 0
    s_and_b32 s19, s45, 1
    s_mul_i32 s19, s19, 14
    s_lshl_b64 s[88:89], 0x3fff, s19
    s_lshl_b32 s31, s30, 15
    s_lshl_b32 s36, s17, 13
    s_add_u32 s31, s31, s36
    s_add_u32 m0, s36, 0
    v_xor_b32 v6, 0, v5
    buffer_load_dwordx4 v6, s[32:35], s31 offen offset:0 lds
    v_xor_b32 v7, 16, v5
    buffer_load_dwordx4 v7, s[32:35], s31 offen offset:1024 lds
    v_xor_b32 v6, 32, v5
    buffer_load_dwordx4 v6, s[32:35], s31 offen offset:2048 lds
    v_xor_b32 v7, 48, v5
    buffer_load_dwordx4 v7, s[32:35], s31 offen offset:3072 lds
    s_add_u32 m0, s36, 4096
    s_add_u32 s31, s31, 4096
    v_xor_b32 v6, 64, v5
    buffer_load_dwordx4 v6, s[32:35], s31 offen offset:0 lds
    v_xor_b32 v7, 80, v5
    buffer_load_dwordx4 v7, s[32:35], s31 offen offset:1024 lds
    v_xor_b32 v6, 96, v5
    buffer_load_dwordx4 v6, s[32:35], s31 offen offset:2048 lds
    v_xor_b32 v7, 112, v5
    buffer_load_dwordx4 v7, s[32:35], s31 offen offset:3072 lds
    s_branch L_c_init2_first
L_c_init2:
    s_sleep 16
L_c_init2_first:
    buffer_load_dwordx4 v[232:235], off, s[12:15], 0 sc1
    buffer_load_dwordx4 v[236:239], off, s[12:15], 0 offset:16 sc1
    s_lshl_b32 s20, s27, 2
    buffer_load_dword v240, off, s[12:15], s20 sc1
    s_add_u32 s18, s18, 1
    s_cmp_gt_u32 s18, 200000
    s_cbranch_scc1 L_abort
    s_waitcnt vmcnt(0)
    v_readfirstlane_b32 s19, v232
    s_nop 0
    s_and_b32 s19, s19, 0x1ff
    s_cmp_ge_u32 s19, 32
    s_cbranch_scc0 L_c_init2
    v_readfirstlane_b32 s19, v233
    s_nop 0
    s_and_b32 s19, s19, 0x1ff
    s_cmp_ge_u32 s19, 32
    s_cbranch_scc0 L_c_init2
    v_readfirstlane_b32 s19, v234
    s_nop 0
    s_and_b32 s19, s19, 0x1ff
    s_cmp_ge_u32 s19, 32
    s_cbranch_scc0 L_c_init2
    v_readfirstlane_b32 s19, v235
    s_nop 0
    s_and_b32 s19, s19, 0x1ff
    s_cmp_ge_u32 s19, 32
    s_cbranch_scc0 L_c_init2
    v_readfirstlane_b32 s19, v236
    s_nop 0
    s_and_b32 s19, s19, 0x1ff
    s_cmp_ge_u32 s19, 32
    s_cbranch_scc0 L_c_init2
    v_readfirstlane_b32 s19, v237
    s_nop 0
    s_and_b32 s19, s19, 0x1ff
    s_cmp_ge_u32 s19, 32
    s_cbranch_scc0 L_c_init2
    v_readfirstlane_b32 s19, v238
    s_nop 0
    s_and_b32 s19, s19, 0x1ff
    s_cmp_ge_u32 s19, 32
    s_cbranch_scc0 L_c_init2
    v_readfirstlane_b32 s19, v239
    s_nop 0
    s_and_b32 s19, s19, 0x1ff
    s_cmp_ge_u32 s19, 32
    s_cbranch_scc0 L_c_init2
    v_readfirstlane_b32 s19, v240
    s_nop 0
    s_and_b32 s20, s19, 0x1ff
    s_cmp_ge_u32 s20, 32
    s_cbranch_scc0 L_c_init2
    s_mul_i32 s20, s28, s28
    s_lshl_b32 s20, s20, 18
    s_lshl_b32 s21, s28, 9
    s_add_u32 s20, s20, s21
    s_add_u32 s20, s20, 1
    s_lshl_b32 s20, s20, 5
    s_cmp_eq_u32 s19, s20
    s_cselect_b32 s26, 1, 0
    s_waitcnt lgkmcnt(0)
    s_cmp_eq_u32 s26, 1
    s_cbranch_scc0 L_cS_arm
L_cF_arm:
    v_mov_b32 v232, -1
    v_mov_b32 v233, -1
    v_mov_b32 v234, -1
    v_mov_b32 v235, -1
    s_add_u32 s19, s58, 0
    buffer_store_dwordx4 v[232:235], v8, s[4:7], s19 offen
    s_add_u32 s19, s19, 4096
    buffer_store_dwordx4 v[232:235], v8, s[4:7], s19 offen
    s_add_u32 s19, s19, 4096
    buffer_store_dwordx4 v[232:235], v8, s[4:7], s19 offen
    s_add_u32 s19, s19, 4096
    buffer_store_dwordx4 v[232:235], v8, s[4:7], s19 offen
    s_add_u32 s19, s19, 4096
    buffer_store_dwordx4 v[232:235], v8, s[4:7], s19 offen
    s_add_u32 s19, s19, 4096
    buffer_store_dwordx4 v[232:235], v8, s[4:7], s19 offen
    s_add_u32 s19, s19, 4096
    buffer_store_dwordx4 v[232:235], v8, s[4:7], s19 offen
    s_add_u32 s19, s19, 4096
    buffer_store_dwordx4 v[232:235], v8, s[4:7], s19 offen
    s_add_u32 s19, s58, 1048576
    buffer_store_dwordx4 v[232:235], v8, s[4:7], s19 offen
    s_add_u32 s19, s19, 4096
    buffer_store_dwordx4 v[232:235], v8, s[4:7], s19 offen
    s_add_u32 s19, s19, 4096
    buffer_store_dwordx4 v[232:235], v8, s[4:7], s19 offen
    s_add_u32 s19, s19, 4096
    buffer_store_dwordx4 v[232:235], v8, s[4:7], s19 offen
    s_add_u32 s19, s19, 4096
    buffer_store_dwordx4 v[232:235], v8, s[4:7], s19 offen
    s_add_u32 s19, s19, 4096
    buffer_store_dwordx4 v[232:235], v8, s[4:7], s19 offen
    s_add_u32 s19, s19, 4096
    buffer_store_dwordx4 v[232:235], v8, s[4:7], s19 offen
    s_add_u32 s19, s19, 4096
    buffer_store_dwordx4 v[232:235], v8, s[4:7], s19 offen
    s_waitcnt vmcnt(0)
    s_barrier
    s_cmp_lg_u32 s17, 0
    s_cbranch_scc1 L_cF_met
    s_lshl_b32 s20, s45, 2
    s_mov_b64 exec, 1
    v_mov_b32 v232, 1
    buffer_atomic_add v232, off, s[12:15], s20 offset:32
L_cF_meet:
    s_sleep 8
    buffer_load_dword v233, off, s[12:15], s20 offset:32 sc1
    s_add_u32 s18, s18, 1
    s_cmp_gt_u32 s18, 200000
    s_cbranch_scc1 L_abort
    s_waitcnt vmcnt(0)
    v_readfirstlane_b32 s19, v233
    s_nop 0
    s_cmp_ge_u32 s19, 32
    s_cbranch_scc0 L_cF_meet
    s_mov_b64 exec, -1
L_cF_met:
L_cF_loop:
    s_waitcnt vmcnt(0)
    s_barrier
    s_lshl_b32 s19, s30, 5
    s_add_u32 s19, s19, s16
    s_lshl_b32 s46, s19, 13
    s_lshl_b32 s47, s19, 12
    s_add_u32 s47, s47, 51380224
    s_add_u32 s51, s30, 1
    s_cmp_lg_u32 s17, 0
    s_cbranch_scc1 L_cF0_pp_ok
    s_cmp_ge_u32 s59, s51
    s_cbranch_scc1 L_cF0_pp_ok
    s_mov_b64 exec, s[84:85]
L_cF0_pp:
    buffer_load_dword v232, v15, s[4:7], s52 offen sc1
    s_add_u32 s18, s18, 1
    s_cmp_gt_u32 s18, 200000
    s_cbranch_scc1 L_abort
    s_waitcnt vmcnt(0)
    v_lshrrev_b32 v233, 16, v232
    v_and_b32 v232, 0xffff, v232
    v_min_u32 v232, v232, v233
    v_cmp_gt_u32 vcc, s51, v232
    s_cbranch_vccz L_cF0_pp_done
    s_sleep 4
    s_branch L_cF0_pp
L_cF0_pp_done:
    s_mov_b32 s59, s51
    s_add_u32 s19, s51, 4
    s_min_u32 s19, s19, 64
    v_cmp_gt_u32 vcc, s19, v232
    s_nop 0
    s_cmp_eq_u64 vcc, 0
    s_cselect_b32 s59, s19, s59
    s_add_u32 s19, s51, 8
    s_min_u32 s19, s19, 64
    v_cmp_gt_u32 vcc, s19, v232
    s_nop 0
    s_cmp_eq_u64 vcc, 0
    s_cselect_b32 s59, s19, s59
    s_add_u32 s19, s51, 16
    s_min_u32 s19, s19, 64
    v_cmp_gt_u32 vcc, s19, v232
    s_nop 0
    s_cmp_eq_u64 vcc, 0
    s_cselect_b32 s59, s19, s59
    s_mov_b64 exec, -1
L_cF0_pp_ok:
    s_barrier
    s_lshl_b32 s19, s17, 10
    s_add_u32 s20, s46, s19
    s_add_u32 s20, s20, 16777216
    s_lshl_b32 s19, s17, 11
    s_add_u32 m0, s19, 73728
    s_add_u32 s21, s46, 33554432
    buffer_load_dwordx4 v8, s[4:7], s20 offen offset:0 sc1 lds
    buffer_load_dwordx4 v8, s[4:7], s20 offen offset:1024 sc1 lds
    buffer_load_dwordx4 v[128:131], v21, s[4:7], s21 offen offset:0 sc1
    buffer_load_dwordx4 v[132:135], v21, s[4:7], s21 offen offset:1024 sc1
    buffer_load_dwordx4 v[136:139], v21, s[4:7], s21 offen offset:2048 sc1
    buffer_load_dwordx4 v[140:143], v21, s[4:7], s21 offen offset:3072 sc1
    v_cndmask_b32 v236, 0, v20, s[76:77]
    v_cndmask_b32 v237, 0, v20, s[78:79]
    v_cndmask_b32 v238, 0, v20, s[80:81]
    v_cndmask_b32 v239, 0, v20, s[82:83]
    s_lshr_b32 s21, s30, 1
    s_add_u32 s21, s21, 1
    s_cmp_lg_u32 s17, 0
    s_cbranch_scc1 L_cF0_pf_ok
    s_cmp_ge_u32 s90, s21
    s_cbranch_scc1 L_cF0_pf_ok
    s_mov_b64 exec, s[88:89]
L_cF0_pf:
    buffer_load_dword v232, v15, s[4:7], s54 offen sc1
    s_add_u32 s18, s18, 1
    s_cmp_gt_u32 s18, 200000
    s_cbranch_scc1 L_abort
    s_waitcnt vmcnt(0)
    v_cmp_gt_u32 vcc, s21, v232
    s_cbranch_vccz L_cF0_pf_done
    s_sleep 4
    s_branch L_cF0_pf
L_cF0_pf_done:
    s_mov_b32 s90, s21
    s_add_u32 s19, s21, 4
    s_min_u32 s19, s19, 32
    v_cmp_gt_u32 vcc, s19, v232
    s_nop 0
    s_cmp_eq_u64 vcc, 0
    s_cselect_b32 s90, s19, s90
    s_add_u32 s19, s21, 8
    s_min_u32 s19, s19, 32
    v_cmp_gt_u32 vcc, s19, v232
    s_nop 0
    s_cmp_eq_u64 vcc, 0
    s_cselect_b32 s90, s19, s90
    s_add_u32 s19, s21, 16
    s_min_u32 s19, s19, 32
    v_cmp_gt_u32 vcc, s19, v232
    s_nop 0
    s_cmp_eq_u64 vcc, 0
    s_cselect_b32 s90, s19, s90
    s_mov_b64 exec, -1
L_cF0_pf_ok:
    s_barrier
    s_lshl_b32 s50, s30, 19
    s_lshl_b32 s19, s16, 14
    s_add_u32 s50, s50, s19
    s_add_u32 s50, s50, 67108864
    buffer_load_dwordx4 v[184:187], v16, s[4:7], s50 offen sc1
    s_add_u32 s50, s50, 4096
    buffer_load_dwordx4 v[188:191], v16, s[4:7], s50 offen sc1
    s_add_u32 s50, s50, 4096
    buffer_load_dwordx4 v[192:195], v16, s[4:7], s50 offen sc1
    s_add_u32 s50, s50, 4096
    buffer_load_dwordx4 v[196:199], v17, s[4:7], s50 offen sc1
    s_lshl_b32 s56, s30, 7
    s_add_u32 s56, s56, 327680
    buffer_load_dword v235, v19, s[4:7], s56 offen sc1
    s_add_u32 s21, s30, 4
    s_min_u32 s21, s21, 63
    ds_read_b128 v[32:35], v1 offset:0
    s_waitcnt lgkmcnt(0)
    ds_read_b128 v[36:39], v1 offset:16384
    v_mfma_f32_16x16x32_bf16 v[48:51], a[0:3], v[32:35], 0
    s_waitcnt lgkmcnt(0)
    ds_read_b128 v[40:43], v2 offset:0
    v_mfma_f32_16x16x32_bf16 v[56:59], a[0:3], v[36:39], 0
    ds_read_b128 v[44:47], v2 offset:16384
    v_mfma_f32_16x16x32_bf16 v[52:55], a[64:67], v[32:35], 0
    s_lshl_b32 s31, s21, 15
    s_lshl_b32 s36, s17, 13
    s_add_u32 s31, s31, s36
    s_add_u32 s36, s36, 32768
    v_mfma_f32_16x16x32_bf16 v[60:63], a[64:67], v[36:39], 0
    s_waitcnt lgkmcnt(1)
    v_mfma_f32_16x16x32_bf16 v[48:51], a[4:7], v[40:43], v[48:51]
    s_waitcnt lgkmcnt(0)
    ds_read_b128 v[32:35], v3 offset:0
    v_mfma_f32_16x16x32_bf16 v[56:59], a[4:7], v[44:47], v[56:59]
    ds_read_b128 v[36:39], v3 offset:16384
    v_mfma_f32_16x16x32_bf16 v[52:55], a[68:71], v[40:43], v[52:55]
    s_add_u32 m0, s36, 0
    v_xor_b32 v6, 0, v5
    buffer_load_dwordx4 v6, s[32:35], s31 offen offset:0 lds
    v_mfma_f32_16x16x32_bf16 v[60:63], a[68:71], v[44:47], v[60:63]
    s_waitcnt lgkmcnt(1)
    v_mfma_f32_16x16x32_bf16 v[48:51], a[8:11], v[32:35], v[48:51]
    s_waitcnt lgkmcnt(0)
    ds_read_b128 v[40:43], v4 offset:0
    v_mfma_f32_16x16x32_bf16 v[56:59], a[8:11], v[36:39], v[56:59]
    ds_read_b128 v[44:47], v4 offset:16384
    v_mfma_f32_16x16x32_bf16 v[52:55], a[72:75], v[32:35], v[52:55]
    v_xor_b32 v7, 16, v5
    buffer_load_dwordx4 v7, s[32:35], s31 offen offset:1024 lds
    v_mfma_f32_16x16x32_bf16 v[60:63], a[72:75], v[36:39], v[60:63]
    s_waitcnt lgkmcnt(1)
    v_mfma_f32_16x16x32_bf16 v[48:51], a[12:15], v[40:43], v[48:51]
    s_waitcnt lgkmcnt(0)
    ds_read_b128 v[32:35], v1 offset:256
    v_mfma_f32_16x16x32_bf16 v[56:59], a[12:15], v[44:47], v[56:59]
    ds_read_b128 v[36:39], v1 offset:16640
    v_mfma_f32_16x16x32_bf16 v[52:55], a[76:79], v[40:43], v[52:55]
    v_xor_b32 v6, 32, v5
    buffer_load_dwordx4 v6, s[32:35], s31 offen offset:2048 lds
    v_mfma_f32_16x16x32_bf16 v[60:63], a[76:79], v[44:47], v[60:63]
    s_waitcnt lgkmcnt(1)
    v_mfma_f32_16x16x32_bf16 v[48:51], a[16:19], v[32:35], v[48:51]
    s_waitcnt lgkmcnt(0)
    ds_read_b128 v[40:43], v2 offset:256
    v_mfma_f32_16x16x32_bf16 v[56:59], a[16:19], v[36:39], v[56:59]
    ds_read_b128 v[44:47], v2 offset:16640
    v_mfma_f32_16x16x32_bf16 v[52:55], a[80:83], v[32:35], v[52:55]
    v_xor_b32 v7, 48, v5
    buffer_load_dwordx4 v7, s[32:35], s31 offen offset:3072 lds
    v_mfma_f32_16x16x32_bf16 v[60:63], a[80:83], v[36:39], v[60:63]
    s_waitcnt lgkmcnt(1)
    v_mfma_f32_16x16x32_bf16 v[48:51], a[20:23], v[40:43], v[48:51]
    s_waitcnt lgkmcnt(0)
    ds_read_b128 v[32:35], v3 offset:256
    v_mfma_f32_16x16x32_bf16 v[56:59], a[20:23], v[44:47], v[56:59]
    ds_read_b128 v[36:39], v3 offset:16640
    v_mfma_f32_16x16x32_bf16 v[52:55], a[84:87], v[40:43], v[52:55]
    s_add_u32 m0, s36, 4096
    s_add_u32 s31, s31, 4096
    v_xor_b32 v6, 64, v5
    buffer_load_dwordx4 v6, s[32:35], s31 offen offset:0 lds
    v_mfma_f32_16x16x32_bf16 v[60:63], a[84:87], v[44:47], v[60:63]
    s_waitcnt lgkmcnt(1)
    v_mfma_f32_16x16x32_bf16 v[48:51], a[24:27], v[32:35], v[48:51]
    s_waitcnt lgkmcnt(0)
    ds_read_b128 v[40:43], v4 offset:256
    v_mfma_f32_16x16x32_bf16 v[56:59], a[24:27], v[36:39], v[56:59]
    ds_read_b128 v[44:47], v4 offset:16640
    v_mfma_f32_16x16x32_bf16 v[52:55], a[88:91], v[32:35], v[52:55]
    v_xor_b32 v7, 80, v5
    buffer_load_dwordx4 v7, s[32:35], s31 offen offset:1024 lds
    v_mfma_f32_16x16x32_bf16 v[60:63], a[88:91], v[36:39], v[60:63]
    s_waitcnt lgkmcnt(1)
    v_mfma_f32_16x16x32_bf16 v[48:51], a[28:31], v[40:43], v[48:51]
    s_waitcnt lgkmcnt(0)
    ds_read_b128 v[32:35], v1 offset:512
    v_mfma_f32_16x16x32_bf16 v[56:59], a[28:31], v[44:47], v[56:59]
    ds_read_b128 v[36:39], v1 offset:16896
    v_mfma_f32_16x16x32_bf16 v[52:55], a[92:95], v[40:43], v[52:55]
    v_xor_b32 v6, 96, v5
    buffer_load_dwordx4 v6, s[32:35], s31 offen offset:2048 lds
    v_mfma_f32_16x16x32_bf16 v[60:63], a[92:95], v[44:47], v[60:63]
    s_waitcnt lgkmcnt(1)
    v_mfma_f32_16x16x32_bf16 v[48:51], a[32:35], v[32:35], v[48:51]
    s_waitcnt lgkmcnt(0)
    ds_read_b128 v[40:43], v2 offset:512
    v_mfma_f32_16x16x32_bf16 v[56:59], a[32:35], v[36:39], v[56:59]
    ds_read_b128 v[44:47], v2 offset:16896
    v_mfma_f32_16x16x32_bf16 v[52:55], a[96:99], v[32:35], v[52:55]
    v_xor_b32 v7, 112, v5
    buffer_load_dwordx4 v7, s[32:35], s31 offen offset:3072 lds
    v_mfma_f32_16x16x32_bf16 v[60:63], a[96:99], v[36:39], v[60:63]
    s_waitcnt lgkmcnt(1)
    v_mfma_f32_16x16x32_bf16 v[48:51], a[36:39], v[40:43], v[48:51]
    s_waitcnt lgkmcnt(0)
    ds_read_b128 v[32:35], v3 offset:512
    v_mfma_f32_16x16x32_bf16 v[56:59], a[36:39], v[44:47], v[56:59]
    ds_read_b128 v[36:39], v3 offset:16896
    v_mfma_f32_16x16x32_bf16 v[52:55], a[100:103], v[40:43], v[52:55]
    v_mfma_f32_16x16x32_bf16 v[60:63], a[100:103], v[44:47], v[60:63]
    s_waitcnt lgkmcnt(1)
    v_mfma_f32_16x16x32_bf16 v[48:51], a[40:43], v[32:35], v[48:51]
    s_waitcnt lgkmcnt(0)
    ds_read_b128 v[40:43], v4 offset:512
    v_mfma_f32_16x16x32_bf16 v[56:59], a[40:43], v[36:39], v[56:59]
    ds_read_b128 v[44:47], v4 offset:16896
    v_mfma_f32_16x16x32_bf16 v[52:55], a[104:107], v[32:35], v[52:55]
    v_mfma_f32_16x16x32_bf16 v[60:63], a[104:107], v[36:39], v[60:63]
    s_waitcnt lgkmcnt(1)
    v_mfma_f32_16x16x32_bf16 v[48:51], a[44:47], v[40:43], v[48:51]
    s_waitcnt lgkmcnt(0)
    ds_read_b128 v[32:35], v1 offset:768
    v_mfma_f32_16x16x32_bf16 v[56:59], a[44:47], v[44:47], v[56:59]
    ds_read_b128 v[36:39], v1 offset:17152
    v_mfma_f32_16x16x32_bf16 v[52:55], a[108:111], v[40:43], v[52:55]
    v_mfma_f32_16x16x32_bf16 v[60:63], a[108:111], v[44:47], v[60:63]
    s_waitcnt lgkmcnt(1)
    v_mfma_f32_16x16x32_bf16 v[48:51], a[48:51], v[32:35], v[48:51]
    s_waitcnt lgkmcnt(0)
    ds_read_b128 v[40:43], v2 offset:768
    v_mfma_f32_16x16x32_bf16 v[56:59], a[48:51], v[36:39], v[56:59]
    ds_read_b128 v[44:47], v2 offset:17152
    v_mfma_f32_16x16x32_bf16 v[52:55], a[112:115], v[32:35], v[52:55]
    v_mfma_f32_16x16x32_bf16 v[60:63], a[112:115], v[36:39], v[60:63]
    s_waitcnt lgkmcnt(1)
    v_mfma_f32_16x16x32_bf16 v[48:51], a[52:55], v[40:43], v[48:51]
    s_waitcnt lgkmcnt(0)
    ds_read_b128 v[32:35], v3 offset:768
    v_mfma_f32_16x16x32_bf16 v[56:59], a[52:55], v[44:47], v[56:59]
    ds_read_b128 v[36:39], v3 offset:17152
    v_mfma_f32_16x16x32_bf16 v[52:55], a[116:119], v[40:43], v[52:55]
    v_mfma_f32_16x16x32_bf16 v[60:63], a[116:119], v[44:47], v[60:63]
    s_waitcnt lgkmcnt(1)
    v_mfma_f32_16x16x32_bf16 v[48:51], a[56:59], v[32:35], v[48:51]
    s_waitcnt lgkmcnt(0)
    ds_read_b128 v[40:43], v4 offset:768
    v_mfma_f32_16x16x32_bf16 v[56:59], a[56:59], v[36:39], v[56:59]
    ds_read_b128 v[44:47], v4 offset:17152
    v_mfma_f32_16x16x32_bf16 v[52:55], a[120:123], v[32:35], v[52:55]
    v_mfma_f32_16x16x32_bf16 v[60:63], a[120:123], v[36:39], v[60:63]
    s_waitcnt lgkmcnt(1)
    v_mfma_f32_16x16x32_bf16 v[48:51], a[60:63], v[40:43], v[48:51]
    s_waitcnt lgkmcnt(0)
    v_mfma_f32_16x16x32_bf16 v[56:59], a[60:63], v[44:47], v[56:59]
    v_mfma_f32_16x16x32_bf16 v[52:55], a[124:127], v[40:43], v[52:55]
    v_mfma_f32_16x16x32_bf16 v[60:63], a[124:127], v[44:47], v[60:63]
    v_cvt_pk_bf16_f32 v48, v48, v49
    v_cvt_pk_bf16_f32 v49, v50, v51
    s_nop 1
    v_cvt_pk_bf16_f32 v50, v52, v53
    v_cvt_pk_bf16_f32 v51, v54, v55
    ds_write_b128 v9, v[48:51] offset:0
    v_cvt_pk_bf16_f32 v56, v56, v57
    v_cvt_pk_bf16_f32 v57, v58, v59
    v_cvt_pk_bf16_f32 v58, v60, v61
    v_cvt_pk_bf16_f32 v59, v62, v63
    ds_write_b128 v9, v[56:59] offset:4096
    s_waitcnt vmcnt(8)
    v_mfma_f32_16x16x32_bf16 v[244:247], v[184:187], v[236:239], 0
    v_mfma_f32_16x16x32_bf16 v[244:247], v[188:191], v[236:239], v[244:247]
    v_mfma_f32_16x16x32_bf16 v[244:247], v[192:195], v[236:239], v[244:247]
    v_mfma_f32_16x16x32_bf16 v[244:247], v[196:199], v[236:239], v[244:247]
    v_sub_f32 v232, 1.0, v235
    v_cvt_pk_bf16_f32 v232, v232, v232
    v_and_b32 v232, 0xffff0000, v232
    s_nop 4
    v_cvt_pk_bf16_f32 v244, v244, v245
    v_cvt_pk_bf16_f32 v246, v246, v247
    v_and_b32 v245, 0xffff0000, v244
    v_lshlrev_b32 v244, 16, v244
    v_and_b32 v247, 0xffff0000, v246
    v_lshlrev_b32 v246, 16, v246
    v_mul_f32 v244, v244, v232
    v_mul_f32 v245, v245, v232
    v_mul_f32 v246, v246, v232
    v_mul_f32 v247, v247, v232
    v_cvt_pk_bf16_f32 v244, v244, v245
    v_cvt_pk_bf16_f32 v246, v246, v247
    v_and_b32 v245, 0xffff0000, v244
    v_lshlrev_b32 v244, 16, v244
    v_and_b32 v247, 0xffff0000, v246
    v_lshlrev_b32 v246, 16, v246
    s_waitcnt lgkmcnt(0)
    s_barrier
    ds_read_b128 v[64:67], v11 offset:0
    ds_read_b128 v[68:71], v11 offset:1024
    ds_read_b128 v[72:75], v11 offset:2048
    ds_read_b128 v[76:79], v11 offset:3072
    ds_read_b128 v[80:83], v10 offset:8192
    ds_read_b128 v[84:87], v10 offset:9216
    ds_read_b128 v[88:91], v10 offset:10240
    ds_read_b128 v[92:95], v10 offset:11264
    ds_read_b128 v[96:99], v10 offset:12288
    s_waitcnt lgkmcnt(4)
    ds_read_b128 v[100:103], v10 offset:13312
    ds_read_b128 v[104:107], v10 offset:14336
    ds_read_b128 v[108:111], v10 offset:15360
    v_mfma_f32_16x16x32_bf16 v[152:155], v[80:83], v[64:67], 0
    s_waitcnt lgkmcnt(3)
    v_mfma_f32_16x16x32_bf16 v[156:159], v[96:99], v[64:67], 0
    v_mfma_f32_16x16x32_bf16 v[152:155], v[84:87], v[68:71], v[152:155]
    s_waitcnt lgkmcnt(2)
    v_mfma_f32_16x16x32_bf16 v[156:159], v[100:103], v[68:71], v[156:159]
    v_mfma_f32_16x16x32_bf16 v[152:155], v[88:91], v[72:75], v[152:155]
    s_waitcnt lgkmcnt(1)
    v_mfma_f32_16x16x32_bf16 v[156:159], v[104:107], v[72:75], v[156:159]
    v_mfma_f32_16x16x32_bf16 v[152:155], v[92:95], v[76:79], v[152:155]
    s_waitcnt lgkmcnt(0)
    v_mfma_f32_16x16x32_bf16 v[156:159], v[108:111], v[76:79], v[156:159]
    v_mov_b32 v232, 0xff800000
    s_nop 2
    v_cndmask_b32 v152, v232, v152, s[60:61]
    v_cndmask_b32 v153, v232, v153, s[62:63]
    v_cndmask_b32 v154, v232, v154, s[64:65]
    v_cndmask_b32 v155, v232, v155, s[66:67]
    v_cndmask_b32 v156, v232, v156, s[68:69]
    v_cndmask_b32 v157, v232, v157, s[70:71]
    v_cndmask_b32 v158, v232, v158, s[72:73]
    v_cndmask_b32 v159, v232, v159, s[74:75]
    v_max3_f32 v233, v152, v153, v154
    v_max3_f32 v233, v233, v155, v156
    v_max3_f32 v233, v233, v157, v158
    v_max_f32 v233, v233, v159
    v_mov_b32 v234, v233
    s_nop 1
    v_permlane16_swap_b32 v233, v234
    v_max_f32 v233, v233, v234
    v_mov_b32 v234, v233
    s_nop 1
    v_permlane32_swap_b32 v233, v234
    v_max_f32 v233, v233, v234
    v_sub_f32 v152, v152, v233
    v_sub_f32 v153, v153, v233
    v_sub_f32 v154, v154, v233
    v_sub_f32 v155, v155, v233
    v_sub_f32 v156, v156, v233
    v_sub_f32 v157, v157, v233
    v_sub_f32 v158, v158, v233
    v_sub_f32 v159, v159, v233
    v_exp_f32 v152, v152
    v_exp_f32 v153, v153
    v_exp_f32 v154, v154
    v_exp_f32 v155, v155
    v_exp_f32 v156, v156
    v_exp_f32 v157, v157
    v_exp_f32 v158, v158
    v_exp_f32 v159, v159
    v_cvt_pk_bf16_f32 v152, v152, v153
    v_cvt_pk_bf16_f32 v153, v154, v155
    v_cvt_pk_bf16_f32 v154, v156, v157
    v_cvt_pk_bf16_f32 v155, v158, v159
    s_nop 1
    v_mfma_f32_16x16x32_bf16 v[180:183], v[24:27], v[152:155], 0
    v_mfma_f32_16x16x32_bf16 v[164:167], v[128:131], v[152:155], 0
    v_mfma_f32_16x16x32_bf16 v[168:171], v[132:135], v[152:155], 0
    v_mfma_f32_16x16x32_bf16 v[172:175], v[136:139], v[152:155], 0
    v_mfma_f32_16x16x32_bf16 v[176:179], v[140:143], v[152:155], 0
    s_and_b32 s19, s43, 1
    s_lshl_b32 s19, s19, 20
    s_add_u32 s48, s57, s19
    s_add_u32 s49, s58, s19
    s_bfe_u32 s53, s43, 0x10001
    s_add_u32 s43, s43, 1
    s_min_u32 s19, s30, 62
    s_cmp_ge_u32 s30, 59
    s_cselect_b32 s51, s19, s51
    s_add_u32 s22, s52, 8192
    s_cmp_lg_u32 s17, 0
    s_cbranch_scc1 L_cF0_pa_ok
    s_mov_b64 exec, s[84:85]
L_cF0_pa:
    buffer_load_dword v234, v15, s[4:7], s22 offen sc1
    s_add_u32 s18, s18, 1
    s_cmp_gt_u32 s18, 200000
    s_cbranch_scc1 L_abort
    s_waitcnt vmcnt(0)
    v_cmp_gt_u32 vcc, s51, v234
    s_cbranch_vccz L_cF0_pa_done
    s_sleep 3
    s_branch L_cF0_pa
L_cF0_pa_done:
    s_mov_b64 exec, -1
L_cF0_pa_ok:
    s_barrier
    s_lshr_b32 s19, s17, 1
    s_lshl_b32 s19, s19, 11
    s_add_u32 s19, s19, s47
    s_branch L_cF0_km1
L_cF0_km:
    s_sleep 1
L_cF0_km1:
    buffer_load_dwordx2 v[148:149], v8, s[4:7], s47 offen sc1
    buffer_load_dwordx2 v[144:145], v0, s[4:7], s19 offen offset:8 sc1
    buffer_load_dwordx2 v[146:147], v0, s[4:7], s19 offen offset:1032 sc1
    s_add_u32 s18, s18, 1
    s_cmp_gt_u32 s18, 200000
    s_cbranch_scc1 L_abort
    s_waitcnt vmcnt(0)
    v_max3_u32 v234, v148, v144, v146
    v_cmp_eq_u32 vcc, -1, v234
    ds_write_b32 v12, v148
    ds_write_b32 v12, v149 offset:512
    s_cbranch_vccnz L_cF0_km
    s_waitcnt lgkmcnt(0)
    s_barrier
    ds_read_b64_tr_b16 v[112:113], v13 offset:0
    ds_read_b64_tr_b16 v[114:115], v13 offset:512
    ds_read_b64_tr_b16 v[116:117], v13 offset:1024
    ds_read_b64_tr_b16 v[118:119], v13 offset:1536
    ds_read_b64_tr_b16 v[120:121], v13 offset:2048
    s_waitcnt lgkmcnt(3)
    ds_read_b64_tr_b16 v[122:123], v13 offset:2560
    ds_read_b64_tr_b16 v[124:125], v13 offset:3072
    ds_read_b64_tr_b16 v[126:127], v13 offset:3584
    v_mfma_f32_16x16x32_bf16 v[160:163], v[112:115], v[64:67], 0
    s_waitcnt lgkmcnt(4)
    v_mfma_f32_16x16x32_bf16 v[160:163], v[116:119], v[68:71], v[160:163]
    s_waitcnt lgkmcnt(2)
    v_mfma_f32_16x16x32_bf16 v[160:163], v[120:123], v[72:75], v[160:163]
    s_waitcnt lgkmcnt(0)
    v_mfma_f32_16x16x32_bf16 v[160:163], v[124:127], v[76:79], v[160:163]
    s_nop 7
    v_mul_f32 v160, s44, v160
    v_mul_f32 v161, s44, v161
    v_max3_f32 v156, v233, v160, v161
    v_mov_b32 v234, v156
    s_nop 1
    v_permlane16_swap_b32 v156, v234
    v_max_f32 v156, v156, v234
    v_mov_b32 v234, v156
    s_nop 1
    v_permlane32_swap_b32 v156, v234
    v_max_f32 v156, v156, v234
    v_sub_f32 v157, v233, v156
    v_sub_f32 v160, v160, v156
    v_sub_f32 v161, v161, v156
    v_exp_f32 v157, v157
    v_exp_f32 v160, v160
    v_exp_f32 v161, v161
    s_nop 0
    v_cvt_pk_bf16_f32 v28, v160, v161
    v_cvt_pk_bf16_f32 v31, v160, v161
    s_nop 0
    v_mfma_f32_16x16x16_bf16 v[96:99], v[24:25], v[28:29], 0
    v_mfma_f32_16x16x16_bf16 v[80:83], v[144:145], v[28:29], 0
    v_mfma_f32_16x16x16_bf16 v[84:87], v[144:145], v[30:31], 0
    v_mfma_f32_16x16x16_bf16 v[88:91], v[146:147], v[28:29], 0
    v_mfma_f32_16x16x16_bf16 v[92:95], v[146:147], v[30:31], 0
    v_fma_f32 v180, v180, v157, v96
    v_rcp_f32 v234, v180
    v_fma_f32 v164, v164, v157, v80
    v_fma_f32 v165, v165, v157, v81
    v_fma_f32 v166, v166, v157, v82
    v_fma_f32 v167, v167, v157, v83
    v_fma_f32 v168, v168, v157, v84
    v_fma_f32 v169, v169, v157, v85
    v_fma_f32 v170, v170, v157, v86
    v_fma_f32 v171, v171, v157, v87
    v_fma_f32 v172, v172, v157, v88
    v_fma_f32 v173, v173, v157, v89
    v_fma_f32 v174, v174, v157, v90
    v_fma_f32 v175, v175, v157, v91
    v_fma_f32 v176, v176, v157, v92
    v_fma_f32 v177, v177, v157, v93
    v_fma_f32 v178, v178, v157, v94
    v_fma_f32 v179, v179, v157, v95
    v_pk_mul_f32 v[164:165], v[164:165], v[234:235] op_sel_hi:[1,0]
    v_pk_mul_f32 v[166:167], v[166:167], v[234:235] op_sel_hi:[1,0]
    v_pk_mul_f32 v[168:169], v[168:169], v[234:235] op_sel_hi:[1,0]
    v_pk_mul_f32 v[170:171], v[170:171], v[234:235] op_sel_hi:[1,0]
    v_pk_mul_f32 v[172:173], v[172:173], v[234:235] op_sel_hi:[1,0]
    v_pk_mul_f32 v[174:175], v[174:175], v[234:235] op_sel_hi:[1,0]
    v_pk_mul_f32 v[176:177], v[176:177], v[234:235] op_sel_hi:[1,0]
    v_pk_mul_f32 v[178:179], v[178:179], v[234:235] op_sel_hi:[1,0]
    v_cvt_pk_bf16_f32 v164, v164, v165
    v_cvt_pk_bf16_f32 v165, v166, v167
    v_cvt_pk_bf16_f32 v166, v168, v169
    v_cvt_pk_bf16_f32 v167, v170, v171
    v_cvt_pk_bf16_f32 v168, v172, v173
    v_cvt_pk_bf16_f32 v169, v174, v175
    v_cvt_pk_bf16_f32 v170, v176, v177
    v_cvt_pk_bf16_f32 v171, v178, v179
    ds_write_b128 v14, v[164:167] offset:0
    ds_write_b128 v14, v[168:171] offset:1024
    s_waitcnt lgkmcnt(0)
    s_barrier
    ds_read_b128 v[184:187], v10 offset:0
    ds_read_b128 v[188:191], v10 offset:1024
    ds_read_b128 v[192:195], v10 offset:2048
    ds_read_b128 v[196:199], v10 offset:3072
    ds_read_b128 v[200:203], v10 offset:4096
    s_waitcnt lgkmcnt(4)
    ds_read_b128 v[204:207], v10 offset:5120
    ds_read_b128 v[208:211], v10 offset:6144
    ds_read_b128 v[212:215], v10 offset:7168
    v_mfma_f32_16x16x32_bf16 v[216:219], v[184:187], a[128:131], 0
    s_waitcnt lgkmcnt(3)
    v_mfma_f32_16x16x32_bf16 v[220:223], v[200:203], a[128:131], 0
    v_mfma_f32_16x16x32_bf16 v[216:219], v[188:191], a[132:135], v[216:219]
    s_waitcnt lgkmcnt(2)
    v_mfma_f32_16x16x32_bf16 v[220:223], v[204:207], a[132:135], v[220:223]
    v_mfma_f32_16x16x32_bf16 v[216:219], v[192:195], a[136:139], v[216:219]
    s_waitcnt lgkmcnt(1)
    v_mfma_f32_16x16x32_bf16 v[220:223], v[208:211], a[136:139], v[220:223]
    v_mfma_f32_16x16x32_bf16 v[216:219], v[196:199], a[140:143], v[216:219]
    s_waitcnt lgkmcnt(0)
    v_mfma_f32_16x16x32_bf16 v[220:223], v[212:215], a[140:143], v[220:223]
    v_mfma_f32_16x16x32_bf16 v[224:227], v[184:187], a[144:147], 0
    v_mfma_f32_16x16x32_bf16 v[228:231], v[200:203], a[144:147], 0
    v_mfma_f32_16x16x32_bf16 v[224:227], v[188:191], a[148:151], v[224:227]
    v_cvt_pk_bf16_f32 v216, v216, v217
    v_mfma_f32_16x16x32_bf16 v[228:231], v[204:207], a[148:151], v[228:231]
    v_cvt_pk_bf16_f32 v217, v218, v219
    v_mfma_f32_16x16x32_bf16 v[224:227], v[192:195], a[152:155], v[224:227]
    v_cvt_pk_bf16_f32 v218, v220, v221
    v_mfma_f32_16x16x32_bf16 v[228:231], v[208:211], a[152:155], v[228:231]
    v_cvt_pk_bf16_f32 v219, v222, v223
    v_mfma_f32_16x16x32_bf16 v[224:227], v[196:199], a[156:159], v[224:227]
    v_and_or_b32 v216, v216, -2, s53
    s_add_u32 s19, s48, 0
    buffer_store_dwordx4 v[216:219], v0, s[4:7], s19 offen
    v_mfma_f32_16x16x32_bf16 v[228:231], v[212:215], a[156:159], v[228:231]
    s_nop 0
    v_mfma_f32_16x16x32_bf16 v[216:219], v[184:187], a[160:163], 0
    v_mfma_f32_16x16x32_bf16 v[220:223], v[200:203], a[160:163], 0
    v_mfma_f32_16x16x32_bf16 v[216:219], v[188:191], a[164:167], v[216:219]
    v_cvt_pk_bf16_f32 v224, v224, v225
    v_mfma_f32_16x16x32_bf16 v[220:223], v[204:207], a[164:167], v[220:223]
    v_cvt_pk_bf16_f32 v225, v226, v227
    v_mfma_f32_16x16x32_bf16 v[216:219], v[192:195], a[168:171], v[216:219]
    v_cvt_pk_bf16_f32 v226, v228, v229
    v_mfma_f32_16x16x32_bf16 v[220:223], v[208:211], a[168:171], v[220:223]
    v_cvt_pk_bf16_f32 v227, v230, v231
    v_mfma_f32_16x16x32_bf16 v[216:219], v[196:199], a[172:175], v[216:219]
    v_and_or_b32 v224, v224, -2, s53
    s_add_u32 s19, s48, 32768
    buffer_store_dwordx4 v[224:227], v0, s[4:7], s19 offen
    v_mfma_f32_16x16x32_bf16 v[220:223], v[212:215], a[172:175], v[220:223]
    s_nop 0
    v_mfma_f32_16x16x32_bf16 v[224:227], v[184:187], a[176:179], 0
    v_mfma_f32_16x16x32_bf16 v[228:231], v[200:203], a[176:179], 0
    v_mfma_f32_16x16x32_bf16 v[224:227], v[188:191], a[180:183], v[224:227]
    v_cvt_pk_bf16_f32 v216, v216, v217
    v_mfma_f32_16x16x32_bf16 v[228:231], v[204:207], a[180:183], v[228:231]
    v_cvt_pk_bf16_f32 v217, v218, v219
    v_mfma_f32_16x16x32_bf16 v[224:227], v[192:195], a[184:187], v[224:227]
    v_cvt_pk_bf16_f32 v218, v220, v221
    v_mfma_f32_16x16x32_bf16 v[228:231], v[208:211], a[184:187], v[228:231]
    v_cvt_pk_bf16_f32 v219, v222, v223
    v_mfma_f32_16x16x32_bf16 v[224:227], v[196:199], a[188:191], v[224:227]
    v_and_or_b32 v216, v216, -2, s53
    s_add_u32 s19, s48, 65536
    buffer_store_dwordx4 v[216:219], v0, s[4:7], s19 offen
    v_mfma_f32_16x16x32_bf16 v[228:231], v[212:215], a[188:191], v[228:231]
    s_nop 0
    v_mfma_f32_16x16x32_bf16 v[216:219], v[184:187], a[192:195], 0
    v_mfma_f32_16x16x32_bf16 v[220:223], v[200:203], a[192:195], 0
    v_mfma_f32_16x16x32_bf16 v[216:219], v[188:191], a[196:199], v[216:219]
    v_cvt_pk_bf16_f32 v224, v224, v225
    v_mfma_f32_16x16x32_bf16 v[220:223], v[204:207], a[196:199], v[220:223]
    v_cvt_pk_bf16_f32 v225, v226, v227
    v_mfma_f32_16x16x32_bf16 v[216:219], v[192:195], a[200:203], v[216:219]
    v_cvt_pk_bf16_f32 v226, v228, v229
    v_mfma_f32_16x16x32_bf16 v[220:223], v[208:211], a[200:203], v[220:223]
    v_cvt_pk_bf16_f32 v227, v230, v231
    v_mfma_f32_16x16x32_bf16 v[216:219], v[196:199], a[204:207], v[216:219]
    v_and_or_b32 v224, v224, -2, s53
    s_add_u32 s19, s48, 98304
    buffer_store_dwordx4 v[224:227], v0, s[4:7], s19 offen
    v_mfma_f32_16x16x32_bf16 v[220:223], v[212:215], a[204:207], v[220:223]
    s_nop 0
    v_mfma_f32_16x16x32_bf16 v[224:227], v[184:187], a[208:211], 0
    v_mfma_f32_16x16x32_bf16 v[228:231], v[200:203], a[208:211], 0
    v_mfma_f32_16x16x32_bf16 v[224:227], v[188:191], a[212:215], v[224:227]
    v_cvt_pk_bf16_f32 v216, v216, v217
    v_mfma_f32_16x16x32_bf16 v[228:231], v[204:207], a[212:215], v[228:231]
    v_cvt_pk_bf16_f32 v217, v218, v219
    v_mfma_f32_16x16x32_bf16 v[224:227], v[192:195], a[216:219], v[224:227]
    v_cvt_pk_bf16_f32 v218, v220, v221
    v_mfma_f32_16x16x32_bf16 v[228:231], v[208:211], a[216:219], v[228:231]
    v_cvt_pk_bf16_f32 v219, v222, v223
    v_mfma_f32_16x16x32_bf16 v[224:227], v[196:199], a[220:223], v[224:227]
    v_and_or_b32 v216, v216, -2, s53
    s_add_u32 s19, s48, 131072
    buffer_store_dwordx4 v[216:219], v0, s[4:7], s19 offen
    v_mfma_f32_16x16x32_bf16 v[228:231], v[212:215], a[220:223], v[228:231]
    s_nop 0
    v_mfma_f32_16x16x32_bf16 v[216:219], v[184:187], a[224:227], 0
    v_mfma_f32_16x16x32_bf16 v[220:223], v[200:203], a[224:227], 0
    v_mfma_f32_16x16x32_bf16 v[216:219], v[188:191], a[228:231], v[216:219]
    v_cvt_pk_bf16_f32 v224, v224, v225
    v_mfma_f32_16x16x32_bf16 v[220:223], v[204:207], a[228:231], v[220:223]
    v_cvt_pk_bf16_f32 v225, v226, v227
    v_mfma_f32_16x16x32_bf16 v[216:219], v[192:195], a[232:235], v[216:219]
    v_cvt_pk_bf16_f32 v226, v228, v229
    v_mfma_f32_16x16x32_bf16 v[220:223], v[208:211], a[232:235], v[220:223]
    v_cvt_pk_bf16_f32 v227, v230, v231
    v_mfma_f32_16x16x32_bf16 v[216:219], v[196:199], a[236:239], v[216:219]
    v_and_or_b32 v224, v224, -2, s53
    s_add_u32 s19, s48, 163840
    buffer_store_dwordx4 v[224:227], v0, s[4:7], s19 offen
    v_mfma_f32_16x16x32_bf16 v[220:223], v[212:215], a[236:239], v[220:223]
    s_nop 0
    v_mfma_f32_16x16x32_bf16 v[224:227], v[184:187], a[240:243], 0
    v_mfma_f32_16x16x32_bf16 v[228:231], v[200:203], a[240:243], 0
    v_mfma_f32_16x16x32_bf16 v[224:227], v[188:191], a[244:247], v[224:227]
    v_cvt_pk_bf16_f32 v216, v216, v217
    v_mfma_f32_16x16x32_bf16 v[228:231], v[204:207], a[244:247], v[228:231]
    v_cvt_pk_bf16_f32 v217, v218, v219
    v_mfma_f32_16x16x32_bf16 v[224:227], v[192:195], a[248:251], v[224:227]
    v_cvt_pk_bf16_f32 v218, v220, v221
    v_mfma_f32_16x16x32_bf16 v[228:231], v[208:211], a[248:251], v[228:231]
    v_cvt_pk_bf16_f32 v219, v222, v223
    v_mfma_f32_16x16x32_bf16 v[224:227], v[196:199], a[252:255], v[224:227]
    v_and_or_b32 v216, v216, -2, s53
    s_add_u32 s19, s48, 196608
    buffer_store_dwordx4 v[216:219], v0, s[4:7], s19 offen
    v_mfma_f32_16x16x32_bf16 v[228:231], v[212:215], a[252:255], v[228:231]
    s_nop 3
    v_cvt_pk_bf16_f32 v224, v224, v225
    v_cvt_pk_bf16_f32 v225, v226, v227
    s_nop 1
    v_cvt_pk_bf16_f32 v226, v228, v229
    v_cvt_pk_bf16_f32 v227, v230, v231
    v_and_or_b32 v224, v224, -2, s53
    s_add_u32 s19, s48, 229376
    buffer_store_dwordx4 v[224:227], v0, s[4:7], s19 offen
    s_waitcnt vmcnt(0)
L_cF0_in:
    s_mov_b32 s19, s49
    buffer_load_dwordx4 v[184:187], v16, s[4:7], s19 offen sc1
    s_add_u32 s19, s19, 4096
    buffer_load_dwordx4 v[188:191], v16, s[4:7], s19 offen sc1
    s_add_u32 s19, s19, 4096
    buffer_load_dwordx4 v[192:195], v16, s[4:7], s19 offen sc1
    s_add_u32 s19, s19, 4096
    buffer_load_dwordx4 v[196:199], v16, s[4:7], s19 offen sc1
    s_add_u32 s19, s19, 4096
    buffer_load_dwordx4 v[200:203], v16, s[4:7], s19 offen sc1
    s_add_u32 s19, s19, 4096
    buffer_load_dwordx4 v[204:207], v16, s[4:7], s19 offen sc1
    s_add_u32 s19, s19, 4096
    buffer_load_dwordx4 v[208:211], v16, s[4:7], s19 offen sc1
    s_add_u32 s19, s19, 4096
    buffer_load_dwordx4 v[212:215], v16, s[4:7], s19 offen sc1
    s_mov_b64 exec, -1
    s_add_u32 s18, s18, 1
    s_cmp_gt_u32 s18, 200000
    s_cbranch_scc1 L_abort
    s_waitcnt vmcnt(7)
    v_mfma_f32_16x16x32_bf16 v[240:243], v[184:187], v[236:239], 0
    s_waitcnt vmcnt(6)
    v_xor_b32 v234, s53, v184
    v_mfma_f32_16x16x32_bf16 v[240:243], v[188:191], v[236:239], v[240:243]
    s_waitcnt vmcnt(5)
    v_bitop3_b32 v234, v234, v188, s53 bitop3:0xf6
    v_mfma_f32_16x16x32_bf16 v[240:243], v[192:195], v[236:239], v[240:243]
    s_waitcnt vmcnt(4)
    v_bitop3_b32 v234, v234, v192, s53 bitop3:0xf6
    v_mfma_f32_16x16x32_bf16 v[240:243], v[196:199], v[236:239], v[240:243]
    s_waitcnt vmcnt(3)
    v_bitop3_b32 v234, v234, v196, s53 bitop3:0xf6
    v_mfma_f32_16x16x32_bf16 v[240:243], v[200:203], v[236:239], v[240:243]
    s_waitcnt vmcnt(2)
    v_bitop3_b32 v234, v234, v200, s53 bitop3:0xf6
    v_mfma_f32_16x16x32_bf16 v[240:243], v[204:207], v[236:239], v[240:243]
    s_waitcnt vmcnt(1)
    v_bitop3_b32 v234, v234, v204, s53 bitop3:0xf6
    v_mfma_f32_16x16x32_bf16 v[240:243], v[208:211], v[236:239], v[240:243]
    s_waitcnt vmcnt(0)
    v_bitop3_b32 v234, v234, v208, s53 bitop3:0xf6
    v_mfma_f32_16x16x32_bf16 v[240:243], v[212:215], v[236:239], v[240:243]
    v_bitop3_b32 v234, v234, v212, s53 bitop3:0xf6
    v_and_b32 v234, 1, v234
    v_cmp_ne_u32 vcc, 0, v234
    s_cbranch_vccz L_cF0_inok
    s_mov_b64 exec, vcc
    s_branch L_cF0_in
L_cF0_inok:
    s_nop 3
    v_cvt_pk_bf16_f32 v240, v240, v241
    v_cvt_pk_bf16_f32 v242, v242, v243
    v_and_b32 v241, 0xffff0000, v240
    v_lshlrev_b32 v240, 16, v240
    v_and_b32 v243, 0xffff0000, v242
    v_lshlrev_b32 v242, 16, v242
    v_mul_f32 v240, v240, v235
    v_mul_f32 v241, v241, v235
    v_mul_f32 v242, v242, v235
    v_mul_f32 v243, v243, v235
    v_cvt_pk_bf16_f32 v240, v240, v241
    v_cvt_pk_bf16_f32 v242, v242, v243
    v_and_b32 v241, 0xffff0000, v240
    v_lshlrev_b32 v240, 16, v240
    v_and_b32 v243, 0xffff0000, v242
    v_lshlrev_b32 v242, 16, v242
    v_add_f32 v240, v240, v244
    v_add_f32 v241, v241, v245
    v_add_f32 v242, v242, v246
    v_add_f32 v243, v243, v247
    v_cvt_pk_bf16_f32 v240, v240, v241
    v_cvt_pk_bf16_f32 v241, v242, v243
    s_lshl_b32 s55, s30, 15
    s_lshl_b32 s19, s16, 5
    s_add_u32 s55, s55, s19
    buffer_store_dwordx2 v[240:241], v18, s[92:95], s55 offen
    s_add_u32 s30, s30, 4
    s_cmp_ge_u32 s30, 64
    s_cbranch_scc1 L_done
    s_waitcnt vmcnt(0)
    s_barrier
    s_lshl_b32 s19, s30, 5
    s_add_u32 s19, s19, s16
    s_lshl_b32 s46, s19, 13
    s_lshl_b32 s47, s19, 12
    s_add_u32 s47, s47, 51380224
    s_add_u32 s51, s30, 1
    s_cmp_lg_u32 s17, 0
    s_cbranch_scc1 L_cF1_pp_ok
    s_cmp_ge_u32 s59, s51
    s_cbranch_scc1 L_cF1_pp_ok
    s_mov_b64 exec, s[84:85]
L_cF1_pp:
    buffer_load_dword v232, v15, s[4:7], s52 offen sc1
    s_add_u32 s18, s18, 1
    s_cmp_gt_u32 s18, 200000
    s_cbranch_scc1 L_abort
    s_waitcnt vmcnt(0)
    v_lshrrev_b32 v233, 16, v232
    v_and_b32 v232, 0xffff, v232
    v_min_u32 v232, v232, v233
    v_cmp_gt_u32 vcc, s51, v232
    s_cbranch_vccz L_cF1_pp_done
    s_sleep 4
    s_branch L_cF1_pp
L_cF1_pp_done:
    s_mov_b32 s59, s51
    s_add_u32 s19, s51, 4
    s_min_u32 s19, s19, 64
    v_cmp_gt_u32 vcc, s19, v232
    s_nop 0
    s_cmp_eq_u64 vcc, 0
    s_cselect_b32 s59, s19, s59
    s_add_u32 s19, s51, 8
    s_min_u32 s19, s19, 64
    v_cmp_gt_u32 vcc, s19, v232
    s_nop 0
    s_cmp_eq_u64 vcc, 0
    s_cselect_b32 s59, s19, s59
    s_add_u32 s19, s51, 16
    s_min_u32 s19, s19, 64
    v_cmp_gt_u32 vcc, s19, v232
    s_nop 0
    s_cmp_eq_u64 vcc, 0
    s_cselect_b32 s59, s19, s59
    s_mov_b64 exec, -1
L_cF1_pp_ok:
    s_barrier
    s_lshl_b32 s19, s17, 10
    s_add_u32 s20, s46, s19
    s_add_u32 s20, s20, 16777216
    s_lshl_b32 s19, s17, 11
    s_add_u32 m0, s19, 73728
    s_add_u32 s21, s46, 33554432
    buffer_load_dwordx4 v8, s[4:7], s20 offen offset:0 sc1 lds
    buffer_load_dwordx4 v8, s[4:7], s20 offen offset:1024 sc1 lds
    buffer_load_dwordx4 v[128:131], v21, s[4:7], s21 offen offset:0 sc1
    buffer_load_dwordx4 v[132:135], v21, s[4:7], s21 offen offset:1024 sc1
    buffer_load_dwordx4 v[136:139], v21, s[4:7], s21 offen offset:2048 sc1
    buffer_load_dwordx4 v[140:143], v21, s[4:7], s21 offen offset:3072 sc1
    v_cndmask_b32 v236, 0, v20, s[76:77]
    v_cndmask_b32 v237, 0, v20, s[78:79]
    v_cndmask_b32 v238, 0, v20, s[80:81]
    v_cndmask_b32 v239, 0, v20, s[82:83]
    s_lshr_b32 s21, s30, 1
    s_add_u32 s21, s21, 1
    s_cmp_lg_u32 s17, 0
    s_cbranch_scc1 L_cF1_pf_ok
    s_cmp_ge_u32 s90, s21
    s_cbranch_scc1 L_cF1_pf_ok
    s_mov_b64 exec, s[88:89]
L_cF1_pf:
    buffer_load_dword v232, v15, s[4:7], s54 offen sc1
    s_add_u32 s18, s18, 1
    s_cmp_gt_u32 s18, 200000
    s_cbranch_scc1 L_abort
    s_waitcnt vmcnt(0)
    v_cmp_gt_u32 vcc, s21, v232
    s_cbranch_vccz L_cF1_pf_done
    s_sleep 4
    s_branch L_cF1_pf
L_cF1_pf_done:
    s_mov_b32 s90, s21
    s_add_u32 s19, s21, 4
    s_min_u32 s19, s19, 32
    v_cmp_gt_u32 vcc, s19, v232
    s_nop 0
    s_cmp_eq_u64 vcc, 0
    s_cselect_b32 s90, s19, s90
    s_add_u32 s19, s21, 8
    s_min_u32 s19, s19, 32
    v_cmp_gt_u32 vcc, s19, v232
    s_nop 0
    s_cmp_eq_u64 vcc, 0
    s_cselect_b32 s90, s19, s90
    s_add_u32 s19, s21, 16
    s_min_u32 s19, s19, 32
    v_cmp_gt_u32 vcc, s19, v232
    s_nop 0
    s_cmp_eq_u64 vcc, 0
    s_cselect_b32 s90, s19, s90
    s_mov_b64 exec, -1
L_cF1_pf_ok:
    s_barrier
    s_lshl_b32 s50, s30, 19
    s_lshl_b32 s19, s16, 14
    s_add_u32 s50, s50, s19
    s_add_u32 s50, s50, 67108864
    buffer_load_dwordx4 v[184:187], v16, s[4:7], s50 offen sc1
    s_add_u32 s50, s50, 4096
    buffer_load_dwordx4 v[188:191], v16, s[4:7], s50 offen sc1
    s_add_u32 s50, s50, 4096
    buffer_load_dwordx4 v[192:195], v16, s[4:7], s50 offen sc1
    s_add_u32 s50, s50, 4096
    buffer_load_dwordx4 v[196:199], v17, s[4:7], s50 offen sc1
    s_lshl_b32 s56, s30, 7
    s_add_u32 s56, s56, 327680
    buffer_load_dword v235, v19, s[4:7], s56 offen sc1
    s_add_u32 s21, s30, 4
    s_min_u32 s21, s21, 63
    ds_read_b128 v[32:35], v1 offset:32768
    s_waitcnt lgkmcnt(0)
    ds_read_b128 v[36:39], v1 offset:49152
    v_mfma_f32_16x16x32_bf16 v[48:51], a[0:3], v[32:35], 0
    s_waitcnt lgkmcnt(0)
    ds_read_b128 v[40:43], v2 offset:32768
    v_mfma_f32_16x16x32_bf16 v[56:59], a[0:3], v[36:39], 0
    ds_read_b128 v[44:47], v2 offset:49152
    v_mfma_f32_16x16x32_bf16 v[52:55], a[64:67], v[32:35], 0
    s_lshl_b32 s31, s21, 15
    s_lshl_b32 s36, s17, 13
    s_add_u32 s31, s31, s36
    v_mfma_f32_16x16x32_bf16 v[60:63], a[64:67], v[36:39], 0
    s_waitcnt lgkmcnt(1)
    v_mfma_f32_16x16x32_bf16 v[48:51], a[4:7], v[40:43], v[48:51]
    s_waitcnt lgkmcnt(0)
    ds_read_b128 v[32:35], v3 offset:32768
    v_mfma_f32_16x16x32_bf16 v[56:59], a[4:7], v[44:47], v[56:59]
    ds_read_b128 v[36:39], v3 offset:49152
    v_mfma_f32_16x16x32_bf16 v[52:55], a[68:71], v[40:43], v[52:55]
    s_add_u32 m0, s36, 0
    v_xor_b32 v6, 0, v5
    buffer_load_dwordx4 v6, s[32:35], s31 offen offset:0 lds
    v_mfma_f32_16x16x32_bf16 v[60:63], a[68:71], v[44:47], v[60:63]
    s_waitcnt lgkmcnt(1)
    v_mfma_f32_16x16x32_bf16 v[48:51], a[8:11], v[32:35], v[48:51]
    s_waitcnt lgkmcnt(0)
    ds_read_b128 v[40:43], v4 offset:32768
    v_mfma_f32_16x16x32_bf16 v[56:59], a[8:11], v[36:39], v[56:59]
    ds_read_b128 v[44:47], v4 offset:49152
    v_mfma_f32_16x16x32_bf16 v[52:55], a[72:75], v[32:35], v[52:55]
    v_xor_b32 v7, 16, v5
    buffer_load_dwordx4 v7, s[32:35], s31 offen offset:1024 lds
    v_mfma_f32_16x16x32_bf16 v[60:63], a[72:75], v[36:39], v[60:63]
    s_waitcnt lgkmcnt(1)
    v_mfma_f32_16x16x32_bf16 v[48:51], a[12:15], v[40:43], v[48:51]
    s_waitcnt lgkmcnt(0)
    ds_read_b128 v[32:35], v1 offset:33024
    v_mfma_f32_16x16x32_bf16 v[56:59], a[12:15], v[44:47], v[56:59]
    ds_read_b128 v[36:39], v1 offset:49408
    v_mfma_f32_16x16x32_bf16 v[52:55], a[76:79], v[40:43], v[52:55]
    v_xor_b32 v6, 32, v5
    buffer_load_dwordx4 v6, s[32:35], s31 offen offset:2048 lds
    v_mfma_f32_16x16x32_bf16 v[60:63], a[76:79], v[44:47], v[60:63]
    s_waitcnt lgkmcnt(1)
    v_mfma_f32_16x16x32_bf16 v[48:51], a[16:19], v[32:35], v[48:51]
    s_waitcnt lgkmcnt(0)
    ds_read_b128 v[40:43], v2 offset:33024
    v_mfma_f32_16x16x32_bf16 v[56:59], a[16:19], v[36:39], v[56:59]
    ds_read_b128 v[44:47], v2 offset:49408
    v_mfma_f32_16x16x32_bf16 v[52:55], a[80:83], v[32:35], v[52:55]
    v_xor_b32 v7, 48, v5
    buffer_load_dwordx4 v7, s[32:35], s31 offen offset:3072 lds
    v_mfma_f32_16x16x32_bf16 v[60:63], a[80:83], v[36:39], v[60:63]
    s_waitcnt lgkmcnt(1)
    v_mfma_f32_16x16x32_bf16 v[48:51], a[20:23], v[40:43], v[48:51]
    s_waitcnt lgkmcnt(0)
    ds_read_b128 v[32:35], v3 offset:33024
    v_mfma_f32_16x16x32_bf16 v[56:59], a[20:23], v[44:47], v[56:59]
    ds_read_b128 v[36:39], v3 offset:49408
    v_mfma_f32_16x16x32_bf16 v[52:55], a[84:87], v[40:43], v[52:55]
    s_add_u32 m0, s36, 4096
    s_add_u32 s31, s31, 4096
    v_xor_b32 v6, 64, v5
    buffer_load_dwordx4 v6, s[32:35], s31 offen offset:0 lds
    v_mfma_f32_16x16x32_bf16 v[60:63], a[84:87], v[44:47], v[60:63]
    s_waitcnt lgkmcnt(1)
    v_mfma_f32_16x16x32_bf16 v[48:51], a[24:27], v[32:35], v[48:51]
    s_waitcnt lgkmcnt(0)
    ds_read_b128 v[40:43], v4 offset:33024
    v_mfma_f32_16x16x32_bf16 v[56:59], a[24:27], v[36:39], v[56:59]
    ds_read_b128 v[44:47], v4 offset:49408
    v_mfma_f32_16x16x32_bf16 v[52:55], a[88:91], v[32:35], v[52:55]
    v_xor_b32 v7, 80, v5
    buffer_load_dwordx4 v7, s[32:35], s31 offen offset:1024 lds
    v_mfma_f32_16x16x32_bf16 v[60:63], a[88:91], v[36:39], v[60:63]
    s_waitcnt lgkmcnt(1)
    v_mfma_f32_16x16x32_bf16 v[48:51], a[28:31], v[40:43], v[48:51]
    s_waitcnt lgkmcnt(0)
    ds_read_b128 v[32:35], v1 offset:33280
    v_mfma_f32_16x16x32_bf16 v[56:59], a[28:31], v[44:47], v[56:59]
    ds_read_b128 v[36:39], v1 offset:49664
    v_mfma_f32_16x16x32_bf16 v[52:55], a[92:95], v[40:43], v[52:55]
    v_xor_b32 v6, 96, v5
    buffer_load_dwordx4 v6, s[32:35], s31 offen offset:2048 lds
    v_mfma_f32_16x16x32_bf16 v[60:63], a[92:95], v[44:47], v[60:63]
    s_waitcnt lgkmcnt(1)
    v_mfma_f32_16x16x32_bf16 v[48:51], a[32:35], v[32:35], v[48:51]
    s_waitcnt lgkmcnt(0)
    ds_read_b128 v[40:43], v2 offset:33280
    v_mfma_f32_16x16x32_bf16 v[56:59], a[32:35], v[36:39], v[56:59]
    ds_read_b128 v[44:47], v2 offset:49664
    v_mfma_f32_16x16x32_bf16 v[52:55], a[96:99], v[32:35], v[52:55]
    v_xor_b32 v7, 112, v5
    buffer_load_dwordx4 v7, s[32:35], s31 offen offset:3072 lds
    v_mfma_f32_16x16x32_bf16 v[60:63], a[96:99], v[36:39], v[60:63]
    s_waitcnt lgkmcnt(1)
    v_mfma_f32_16x16x32_bf16 v[48:51], a[36:39], v[40:43], v[48:51]
    s_waitcnt lgkmcnt(0)
    ds_read_b128 v[32:35], v3 offset:33280
    v_mfma_f32_16x16x32_bf16 v[56:59], a[36:39], v[44:47], v[56:59]
    ds_read_b128 v[36:39], v3 offset:49664
    v_mfma_f32_16x16x32_bf16 v[52:55], a[100:103], v[40:43], v[52:55]
    v_mfma_f32_16x16x32_bf16 v[60:63], a[100:103], v[44:47], v[60:63]
    s_waitcnt lgkmcnt(1)
    v_mfma_f32_16x16x32_bf16 v[48:51], a[40:43], v[32:35], v[48:51]
    s_waitcnt lgkmcnt(0)
    ds_read_b128 v[40:43], v4 offset:33280
    v_mfma_f32_16x16x32_bf16 v[56:59], a[40:43], v[36:39], v[56:59]
    ds_read_b128 v[44:47], v4 offset:49664
    v_mfma_f32_16x16x32_bf16 v[52:55], a[104:107], v[32:35], v[52:55]
    v_mfma_f32_16x16x32_bf16 v[60:63], a[104:107], v[36:39], v[60:63]
    s_waitcnt lgkmcnt(1)
    v_mfma_f32_16x16x32_bf16 v[48:51], a[44:47], v[40:43], v[48:51]
    s_waitcnt lgkmcnt(0)
    ds_read_b128 v[32:35], v1 offset:33536
    v_mfma_f32_16x16x32_bf16 v[56:59], a[44:47], v[44:47], v[56:59]
    ds_read_b128 v[36:39], v1 offset:49920
    v_mfma_f32_16x16x32_bf16 v[52:55], a[108:111], v[40:43], v[52:55]
    v_mfma_f32_16x16x32_bf16 v[60:63], a[108:111], v[44:47], v[60:63]
    s_waitcnt lgkmcnt(1)
    v_mfma_f32_16x16x32_bf16 v[48:51], a[48:51], v[32:35], v[48:51]
    s_waitcnt lgkmcnt(0)
    ds_read_b128 v[40:43], v2 offset:33536
    v_mfma_f32_16x16x32_bf16 v[56:59], a[48:51], v[36:39], v[56:59]
    ds_read_b128 v[44:47], v2 offset:49920
    v_mfma_f32_16x16x32_bf16 v[52:55], a[112:115], v[32:35], v[52:55]
    v_mfma_f32_16x16x32_bf16 v[60:63], a[112:115], v[36:39], v[60:63]
    s_waitcnt lgkmcnt(1)
    v_mfma_f32_16x16x32_bf16 v[48:51], a[52:55], v[40:43], v[48:51]
    s_waitcnt lgkmcnt(0)
    ds_read_b128 v[32:35], v3 offset:33536
    v_mfma_f32_16x16x32_bf16 v[56:59], a[52:55], v[44:47], v[56:59]
    ds_read_b128 v[36:39], v3 offset:49920
    v_mfma_f32_16x16x32_bf16 v[52:55], a[116:119], v[40:43], v[52:55]
    v_mfma_f32_16x16x32_bf16 v[60:63], a[116:119], v[44:47], v[60:63]
    s_waitcnt lgkmcnt(1)
    v_mfma_f32_16x16x32_bf16 v[48:51], a[56:59], v[32:35], v[48:51]
    s_waitcnt lgkmcnt(0)
    ds_read_b128 v[40:43], v4 offset:33536
    v_mfma_f32_16x16x32_bf16 v[56:59], a[56:59], v[36:39], v[56:59]
    ds_read_b128 v[44:47], v4 offset:49920
    v_mfma_f32_16x16x32_bf16 v[52:55], a[120:123], v[32:35], v[52:55]
    v_mfma_f32_16x16x32_bf16 v[60:63], a[120:123], v[36:39], v[60:63]
    s_waitcnt lgkmcnt(1)
    v_mfma_f32_16x16x32_bf16 v[48:51], a[60:63], v[40:43], v[48:51]
    s_waitcnt lgkmcnt(0)
    v_mfma_f32_16x16x32_bf16 v[56:59], a[60:63], v[44:47], v[56:59]
    v_mfma_f32_16x16x32_bf16 v[52:55], a[124:127], v[40:43], v[52:55]
    v_mfma_f32_16x16x32_bf16 v[60:63], a[124:127], v[44:47], v[60:63]
    v_cvt_pk_bf16_f32 v48, v48, v49
    v_cvt_pk_bf16_f32 v49, v50, v51
    s_nop 1
    v_cvt_pk_bf16_f32 v50, v52, v53
    v_cvt_pk_bf16_f32 v51, v54, v55
    ds_write_b128 v9, v[48:51] offset:0
    v_cvt_pk_bf16_f32 v56, v56, v57
    v_cvt_pk_bf16_f32 v57, v58, v59
    v_cvt_pk_bf16_f32 v58, v60, v61
    v_cvt_pk_bf16_f32 v59, v62, v63
    ds_write_b128 v9, v[56:59] offset:4096
    s_waitcnt vmcnt(8)
    v_mfma_f32_16x16x32_bf16 v[244:247], v[184:187], v[236:239], 0
    v_mfma_f32_16x16x32_bf16 v[244:247], v[188:191], v[236:239], v[244:247]
    v_mfma_f32_16x16x32_bf16 v[244:247], v[192:195], v[236:239], v[244:247]
    v_mfma_f32_16x16x32_bf16 v[244:247], v[196:199], v[236:239], v[244:247]
    v_sub_f32 v232, 1.0, v235
    v_cvt_pk_bf16_f32 v232, v232, v232
    v_and_b32 v232, 0xffff0000, v232
    s_nop 4
    v_cvt_pk_bf16_f32 v244, v244, v245
    v_cvt_pk_bf16_f32 v246, v246, v247
    v_and_b32 v245, 0xffff0000, v244
    v_lshlrev_b32 v244, 16, v244
    v_and_b32 v247, 0xffff0000, v246
    v_lshlrev_b32 v246, 16, v246
    v_mul_f32 v244, v244, v232
    v_mul_f32 v245, v245, v232
    v_mul_f32 v246, v246, v232
    v_mul_f32 v247, v247, v232
    v_cvt_pk_bf16_f32 v244, v244, v245
    v_cvt_pk_bf16_f32 v246, v246, v247
    v_and_b32 v245, 0xffff0000, v244
    v_lshlrev_b32 v244, 16, v244
    v_and_b32 v247, 0xffff0000, v246
    v_lshlrev_b32 v246, 16, v246
    s_waitcnt lgkmcnt(0)
    s_barrier
    ds_read_b128 v[64:67], v11 offset:0
    ds_read_b128 v[68:71], v11 offset:1024
    ds_read_b128 v[72:75], v11 offset:2048
    ds_read_b128 v[76:79], v11 offset:3072
    ds_read_b128 v[80:83], v10 offset:8192
    ds_read_b128 v[84:87], v10 offset:9216
    ds_read_b128 v[88:91], v10 offset:10240
    ds_read_b128 v[92:95], v10 offset:11264
    ds_read_b128 v[96:99], v10 offset:12288
    s_waitcnt lgkmcnt(4)
    ds_read_b128 v[100:103], v10 offset:13312
    ds_read_b128 v[104:107], v10 offset:14336
    ds_read_b128 v[108:111], v10 offset:15360
    v_mfma_f32_16x16x32_bf16 v[152:155], v[80:83], v[64:67], 0
    s_waitcnt lgkmcnt(3)
    v_mfma_f32_16x16x32_bf16 v[156:159], v[96:99], v[64:67], 0
    v_mfma_f32_16x16x32_bf16 v[152:155], v[84:87], v[68:71], v[152:155]
    s_waitcnt lgkmcnt(2)
    v_mfma_f32_16x16x32_bf16 v[156:159], v[100:103], v[68:71], v[156:159]
    v_mfma_f32_16x16x32_bf16 v[152:155], v[88:91], v[72:75], v[152:155]
    s_waitcnt lgkmcnt(1)
    v_mfma_f32_16x16x32_bf16 v[156:159], v[104:107], v[72:75], v[156:159]
    v_mfma_f32_16x16x32_bf16 v[152:155], v[92:95], v[76:79], v[152:155]
    s_waitcnt lgkmcnt(0)
    v_mfma_f32_16x16x32_bf16 v[156:159], v[108:111], v[76:79], v[156:159]
    v_mov_b32 v232, 0xff800000
    s_nop 2
    v_cndmask_b32 v152, v232, v152, s[60:61]
    v_cndmask_b32 v153, v232, v153, s[62:63]
    v_cndmask_b32 v154, v232, v154, s[64:65]
    v_cndmask_b32 v155, v232, v155, s[66:67]
    v_cndmask_b32 v156, v232, v156, s[68:69]
    v_cndmask_b32 v157, v232, v157, s[70:71]
    v_cndmask_b32 v158, v232, v158, s[72:73]
    v_cndmask_b32 v159, v232, v159, s[74:75]
    v_max3_f32 v233, v152, v153, v154
    v_max3_f32 v233, v233, v155, v156
    v_max3_f32 v233, v233, v157, v158
    v_max_f32 v233, v233, v159
    v_mov_b32 v234, v233
    s_nop 1
    v_permlane16_swap_b32 v233, v234
    v_max_f32 v233, v233, v234
    v_mov_b32 v234, v233
    s_nop 1
    v_permlane32_swap_b32 v233, v234
    v_max_f32 v233, v233, v234
    v_sub_f32 v152, v152, v233
    v_sub_f32 v153, v153, v233
    v_sub_f32 v154, v154, v233
    v_sub_f32 v155, v155, v233
    v_sub_f32 v156, v156, v233
    v_sub_f32 v157, v157, v233
    v_sub_f32 v158, v158, v233
    v_sub_f32 v159, v159, v233
    v_exp_f32 v152, v152
    v_exp_f32 v153, v153
    v_exp_f32 v154, v154
    v_exp_f32 v155, v155
    v_exp_f32 v156, v156
    v_exp_f32 v157, v157
    v_exp_f32 v158, v158
    v_exp_f32 v159, v159
    v_cvt_pk_bf16_f32 v152, v152, v153
    v_cvt_pk_bf16_f32 v153, v154, v155
    v_cvt_pk_bf16_f32 v154, v156, v157
    v_cvt_pk_bf16_f32 v155, v158, v159
    s_nop 1
    v_mfma_f32_16x16x32_bf16 v[180:183], v[24:27], v[152:155], 0
    v_mfma_f32_16x16x32_bf16 v[164:167], v[128:131], v[152:155], 0
    v_mfma_f32_16x16x32_bf16 v[168:171], v[132:135], v[152:155], 0
    v_mfma_f32_16x16x32_bf16 v[172:175], v[136:139], v[152:155], 0
    v_mfma_f32_16x16x32_bf16 v[176:179], v[140:143], v[152:155], 0
    s_and_b32 s19, s43, 1
    s_lshl_b32 s19, s19, 20
    s_add_u32 s48, s57, s19
    s_add_u32 s49, s58, s19
    s_bfe_u32 s53, s43, 0x10001
    s_add_u32 s43, s43, 1
    s_min_u32 s19, s30, 62
    s_cmp_ge_u32 s30, 59
    s_cselect_b32 s51, s19, s51
    s_add_u32 s22, s52, 8192
    s_cmp_lg_u32 s17, 0
    s_cbranch_scc1 L_cF1_pa_ok
    s_mov_b64 exec, s[84:85]
L_cF1_pa:
    buffer_load_dword v234, v15, s[4:7], s22 offen sc1
    s_add_u32 s18, s18, 1
    s_cmp_gt_u32 s18, 200000
    s_cbranch_scc1 L_abort
    s_waitcnt vmcnt(0)
    v_cmp_gt_u32 vcc, s51, v234
    s_cbranch_vccz L_cF1_pa_done
    s_sleep 3
    s_branch L_cF1_pa
L_cF1_pa_done:
    s_mov_b64 exec, -1
L_cF1_pa_ok:
    s_barrier
    s_lshr_b32 s19, s17, 1
    s_lshl_b32 s19, s19, 11
    s_add_u32 s19, s19, s47
    s_branch L_cF1_km1
L_cF1_km:
    s_sleep 1
L_cF1_km1:
    buffer_load_dwordx2 v[148:149], v8, s[4:7], s47 offen sc1
    buffer_load_dwordx2 v[144:145], v0, s[4:7], s19 offen offset:8 sc1
    buffer_load_dwordx2 v[146:147], v0, s[4:7], s19 offen offset:1032 sc1
    s_add_u32 s18, s18, 1
    s_cmp_gt_u32 s18, 200000
    s_cbranch_scc1 L_abort
    s_waitcnt vmcnt(0)
    v_max3_u32 v234, v148, v144, v146
    v_cmp_eq_u32 vcc, -1, v234
    ds_write_b32 v12, v148
    ds_write_b32 v12, v149 offset:512
    s_cbranch_vccnz L_cF1_km
    s_waitcnt lgkmcnt(0)
    s_barrier
    ds_read_b64_tr_b16 v[112:113], v13 offset:0
    ds_read_b64_tr_b16 v[114:115], v13 offset:512
    ds_read_b64_tr_b16 v[116:117], v13 offset:1024
    ds_read_b64_tr_b16 v[118:119], v13 offset:1536
    ds_read_b64_tr_b16 v[120:121], v13 offset:2048
    s_waitcnt lgkmcnt(3)
    ds_read_b64_tr_b16 v[122:123], v13 offset:2560
    ds_read_b64_tr_b16 v[124:125], v13 offset:3072
    ds_read_b64_tr_b16 v[126:127], v13 offset:3584
    v_mfma_f32_16x16x32_bf16 v[160:163], v[112:115], v[64:67], 0
    s_waitcnt lgkmcnt(4)
    v_mfma_f32_16x16x32_bf16 v[160:163], v[116:119], v[68:71], v[160:163]
    s_waitcnt lgkmcnt(2)
    v_mfma_f32_16x16x32_bf16 v[160:163], v[120:123], v[72:75], v[160:163]
    s_waitcnt lgkmcnt(0)
    v_mfma_f32_16x16x32_bf16 v[160:163], v[124:127], v[76:79], v[160:163]
    s_nop 7
    v_mul_f32 v160, s44, v160
    v_mul_f32 v161, s44, v161
    v_max3_f32 v156, v233, v160, v161
    v_mov_b32 v234, v156
    s_nop 1
    v_permlane16_swap_b32 v156, v234
    v_max_f32 v156, v156, v234
    v_mov_b32 v234, v156
    s_nop 1
    v_permlane32_swap_b32 v156, v234
    v_max_f32 v156, v156, v234
    v_sub_f32 v157, v233, v156
    v_sub_f32 v160, v160, v156
    v_sub_f32 v161, v161, v156
    v_exp_f32 v157, v157
    v_exp_f32 v160, v160
    v_exp_f32 v161, v161
    s_nop 0
    v_cvt_pk_bf16_f32 v28, v160, v161
    v_cvt_pk_bf16_f32 v31, v160, v161
    s_nop 0
    v_mfma_f32_16x16x16_bf16 v[96:99], v[24:25], v[28:29], 0
    v_mfma_f32_16x16x16_bf16 v[80:83], v[144:145], v[28:29], 0
    v_mfma_f32_16x16x16_bf16 v[84:87], v[144:145], v[30:31], 0
    v_mfma_f32_16x16x16_bf16 v[88:91], v[146:147], v[28:29], 0
    v_mfma_f32_16x16x16_bf16 v[92:95], v[146:147], v[30:31], 0
    v_fma_f32 v180, v180, v157, v96
    v_rcp_f32 v234, v180
    v_fma_f32 v164, v164, v157, v80
    v_fma_f32 v165, v165, v157, v81
    v_fma_f32 v166, v166, v157, v82
    v_fma_f32 v167, v167, v157, v83
    v_fma_f32 v168, v168, v157, v84
    v_fma_f32 v169, v169, v157, v85
    v_fma_f32 v170, v170, v157, v86
    v_fma_f32 v171, v171, v157, v87
    v_fma_f32 v172, v172, v157, v88
    v_fma_f32 v173, v173, v157, v89
    v_fma_f32 v174, v174, v157, v90
    v_fma_f32 v175, v175, v157, v91
    v_fma_f32 v176, v176, v157, v92
    v_fma_f32 v177, v177, v157, v93
    v_fma_f32 v178, v178, v157, v94
    v_fma_f32 v179, v179, v157, v95
    v_pk_mul_f32 v[164:165], v[164:165], v[234:235] op_sel_hi:[1,0]
    v_pk_mul_f32 v[166:167], v[166:167], v[234:235] op_sel_hi:[1,0]
    v_pk_mul_f32 v[168:169], v[168:169], v[234:235] op_sel_hi:[1,0]
    v_pk_mul_f32 v[170:171], v[170:171], v[234:235] op_sel_hi:[1,0]
    v_pk_mul_f32 v[172:173], v[172:173], v[234:235] op_sel_hi:[1,0]
    v_pk_mul_f32 v[174:175], v[174:175], v[234:235] op_sel_hi:[1,0]
    v_pk_mul_f32 v[176:177], v[176:177], v[234:235] op_sel_hi:[1,0]
    v_pk_mul_f32 v[178:179], v[178:179], v[234:235] op_sel_hi:[1,0]
    v_cvt_pk_bf16_f32 v164, v164, v165
    v_cvt_pk_bf16_f32 v165, v166, v167
    v_cvt_pk_bf16_f32 v166, v168, v169
    v_cvt_pk_bf16_f32 v167, v170, v171
    v_cvt_pk_bf16_f32 v168, v172, v173
    v_cvt_pk_bf16_f32 v169, v174, v175
    v_cvt_pk_bf16_f32 v170, v176, v177
    v_cvt_pk_bf16_f32 v171, v178, v179
    ds_write_b128 v14, v[164:167] offset:0
    ds_write_b128 v14, v[168:171] offset:1024
    s_waitcnt lgkmcnt(0)
    s_barrier
    ds_read_b128 v[184:187], v10 offset:0
    ds_read_b128 v[188:191], v10 offset:1024
    ds_read_b128 v[192:195], v10 offset:2048
    ds_read_b128 v[196:199], v10 offset:3072
    ds_read_b128 v[200:203], v10 offset:4096
    s_waitcnt lgkmcnt(4)
    ds_read_b128 v[204:207], v10 offset:5120
    ds_read_b128 v[208:211], v10 offset:6144
    ds_read_b128 v[212:215], v10 offset:7168
    v_mfma_f32_16x16x32_bf16 v[216:219], v[184:187], a[128:131], 0
    s_waitcnt lgkmcnt(3)
    v_mfma_f32_16x16x32_bf16 v[220:223], v[200:203], a[128:131], 0
    v_mfma_f32_16x16x32_bf16 v[216:219], v[188:191], a[132:135], v[216:219]
    s_waitcnt lgkmcnt(2)
    v_mfma_f32_16x16x32_bf16 v[220:223], v[204:207], a[132:135], v[220:223]
    v_mfma_f32_16x16x32_bf16 v[216:219], v[192:195], a[136:139], v[216:219]
    s_waitcnt lgkmcnt(1)
    v_mfma_f32_16x16x32_bf16 v[220:223], v[208:211], a[136:139], v[220:223]
    v_mfma_f32_16x16x32_bf16 v[216:219], v[196:199], a[140:143], v[216:219]
    s_waitcnt lgkmcnt(0)
    v_mfma_f32_16x16x32_bf16 v[220:223], v[212:215], a[140:143], v[220:223]
    v_mfma_f32_16x16x32_bf16 v[224:227], v[184:187], a[144:147], 0
    v_mfma_f32_16x16x32_bf16 v[228:231], v[200:203], a[144:147], 0
    v_mfma_f32_16x16x32_bf16 v[224:227], v[188:191], a[148:151], v[224:227]
    v_cvt_pk_bf16_f32 v216, v216, v217
    v_mfma_f32_16x16x32_bf16 v[228:231], v[204:207], a[148:151], v[228:231]
    v_cvt_pk_bf16_f32 v217, v218, v219
    v_mfma_f32_16x16x32_bf16 v[224:227], v[192:195], a[152:155], v[224:227]
    v_cvt_pk_bf16_f32 v218, v220, v221
    v_mfma_f32_16x16x32_bf16 v[228:231], v[208:211], a[152:155], v[228:231]
    v_cvt_pk_bf16_f32 v219, v222, v223
    v_mfma_f32_16x16x32_bf16 v[224:227], v[196:199], a[156:159], v[224:227]
    v_and_or_b32 v216, v216, -2, s53
    s_add_u32 s19, s48, 0
    buffer_store_dwordx4 v[216:219], v0, s[4:7], s19 offen
    v_mfma_f32_16x16x32_bf16 v[228:231], v[212:215], a[156:159], v[228:231]
    s_nop 0
    v_mfma_f32_16x16x32_bf16 v[216:219], v[184:187], a[160:163], 0
    v_mfma_f32_16x16x32_bf16 v[220:223], v[200:203], a[160:163], 0
    v_mfma_f32_16x16x32_bf16 v[216:219], v[188:191], a[164:167], v[216:219]
    v_cvt_pk_bf16_f32 v224, v224, v225
    v_mfma_f32_16x16x32_bf16 v[220:223], v[204:207], a[164:167], v[220:223]
    v_cvt_pk_bf16_f32 v225, v226, v227
    v_mfma_f32_16x16x32_bf16 v[216:219], v[192:195], a[168:171], v[216:219]
    v_cvt_pk_bf16_f32 v226, v228, v229
    v_mfma_f32_16x16x32_bf16 v[220:223], v[208:211], a[168:171], v[220:223]
    v_cvt_pk_bf16_f32 v227, v230, v231
    v_mfma_f32_16x16x32_bf16 v[216:219], v[196:199], a[172:175], v[216:219]
    v_and_or_b32 v224, v224, -2, s53
    s_add_u32 s19, s48, 32768
    buffer_store_dwordx4 v[224:227], v0, s[4:7], s19 offen
    v_mfma_f32_16x16x32_bf16 v[220:223], v[212:215], a[172:175], v[220:223]
    s_nop 0
    v_mfma_f32_16x16x32_bf16 v[224:227], v[184:187], a[176:179], 0
    v_mfma_f32_16x16x32_bf16 v[228:231], v[200:203], a[176:179], 0
    v_mfma_f32_16x16x32_bf16 v[224:227], v[188:191], a[180:183], v[224:227]
    v_cvt_pk_bf16_f32 v216, v216, v217
    v_mfma_f32_16x16x32_bf16 v[228:231], v[204:207], a[180:183], v[228:231]
    v_cvt_pk_bf16_f32 v217, v218, v219
    v_mfma_f32_16x16x32_bf16 v[224:227], v[192:195], a[184:187], v[224:227]
    v_cvt_pk_bf16_f32 v218, v220, v221
    v_mfma_f32_16x16x32_bf16 v[228:231], v[208:211], a[184:187], v[228:231]
    v_cvt_pk_bf16_f32 v219, v222, v223
    v_mfma_f32_16x16x32_bf16 v[224:227], v[196:199], a[188:191], v[224:227]
    v_and_or_b32 v216, v216, -2, s53
    s_add_u32 s19, s48, 65536
    buffer_store_dwordx4 v[216:219], v0, s[4:7], s19 offen
    v_mfma_f32_16x16x32_bf16 v[228:231], v[212:215], a[188:191], v[228:231]
    s_nop 0
    v_mfma_f32_16x16x32_bf16 v[216:219], v[184:187], a[192:195], 0
    v_mfma_f32_16x16x32_bf16 v[220:223], v[200:203], a[192:195], 0
    v_mfma_f32_16x16x32_bf16 v[216:219], v[188:191], a[196:199], v[216:219]
    v_cvt_pk_bf16_f32 v224, v224, v225
    v_mfma_f32_16x16x32_bf16 v[220:223], v[204:207], a[196:199], v[220:223]
    v_cvt_pk_bf16_f32 v225, v226, v227
    v_mfma_f32_16x16x32_bf16 v[216:219], v[192:195], a[200:203], v[216:219]
    v_cvt_pk_bf16_f32 v226, v228, v229
    v_mfma_f32_16x16x32_bf16 v[220:223], v[208:211], a[200:203], v[220:223]
    v_cvt_pk_bf16_f32 v227, v230, v231
    v_mfma_f32_16x16x32_bf16 v[216:219], v[196:199], a[204:207], v[216:219]
    v_and_or_b32 v224, v224, -2, s53
    s_add_u32 s19, s48, 98304
    buffer_store_dwordx4 v[224:227], v0, s[4:7], s19 offen
    v_mfma_f32_16x16x32_bf16 v[220:223], v[212:215], a[204:207], v[220:223]
    s_nop 0
    v_mfma_f32_16x16x32_bf16 v[224:227], v[184:187], a[208:211], 0
    v_mfma_f32_16x16x32_bf16 v[228:231], v[200:203], a[208:211], 0
    v_mfma_f32_16x16x32_bf16 v[224:227], v[188:191], a[212:215], v[224:227]
    v_cvt_pk_bf16_f32 v216, v216, v217
    v_mfma_f32_16x16x32_bf16 v[228:231], v[204:207], a[212:215], v[228:231]
    v_cvt_pk_bf16_f32 v217, v218, v219
    v_mfma_f32_16x16x32_bf16 v[224:227], v[192:195], a[216:219], v[224:227]
    v_cvt_pk_bf16_f32 v218, v220, v221
    v_mfma_f32_16x16x32_bf16 v[228:231], v[208:211], a[216:219], v[228:231]
    v_cvt_pk_bf16_f32 v219, v222, v223
    v_mfma_f32_16x16x32_bf16 v[224:227], v[196:199], a[220:223], v[224:227]
    v_and_or_b32 v216, v216, -2, s53
    s_add_u32 s19, s48, 131072
    buffer_store_dwordx4 v[216:219], v0, s[4:7], s19 offen
    v_mfma_f32_16x16x32_bf16 v[228:231], v[212:215], a[220:223], v[228:231]
    s_nop 0
    v_mfma_f32_16x16x32_bf16 v[216:219], v[184:187], a[224:227], 0
    v_mfma_f32_16x16x32_bf16 v[220:223], v[200:203], a[224:227], 0
    v_mfma_f32_16x16x32_bf16 v[216:219], v[188:191], a[228:231], v[216:219]
    v_cvt_pk_bf16_f32 v224, v224, v225
    v_mfma_f32_16x16x32_bf16 v[220:223], v[204:207], a[228:231], v[220:223]
    v_cvt_pk_bf16_f32 v225, v226, v227
    v_mfma_f32_16x16x32_bf16 v[216:219], v[192:195], a[232:235], v[216:219]
    v_cvt_pk_bf16_f32 v226, v228, v229
    v_mfma_f32_16x16x32_bf16 v[220:223], v[208:211], a[232:235], v[220:223]
    v_cvt_pk_bf16_f32 v227, v230, v231
    v_mfma_f32_16x16x32_bf16 v[216:219], v[196:199], a[236:239], v[216:219]
    v_and_or_b32 v224, v224, -2, s53
    s_add_u32 s19, s48, 163840
    buffer_store_dwordx4 v[224:227], v0, s[4:7], s19 offen
    v_mfma_f32_16x16x32_bf16 v[220:223], v[212:215], a[236:239], v[220:223]
    s_nop 0
    v_mfma_f32_16x16x32_bf16 v[224:227], v[184:187], a[240:243], 0
    v_mfma_f32_16x16x32_bf16 v[228:231], v[200:203], a[240:243], 0
    v_mfma_f32_16x16x32_bf16 v[224:227], v[188:191], a[244:247], v[224:227]
    v_cvt_pk_bf16_f32 v216, v216, v217
    v_mfma_f32_16x16x32_bf16 v[228:231], v[204:207], a[244:247], v[228:231]
    v_cvt_pk_bf16_f32 v217, v218, v219
    v_mfma_f32_16x16x32_bf16 v[224:227], v[192:195], a[248:251], v[224:227]
    v_cvt_pk_bf16_f32 v218, v220, v221
    v_mfma_f32_16x16x32_bf16 v[228:231], v[208:211], a[248:251], v[228:231]
    v_cvt_pk_bf16_f32 v219, v222, v223
    v_mfma_f32_16x16x32_bf16 v[224:227], v[196:199], a[252:255], v[224:227]
    v_and_or_b32 v216, v216, -2, s53
    s_add_u32 s19, s48, 196608
    buffer_store_dwordx4 v[216:219], v0, s[4:7], s19 offen
    v_mfma_f32_16x16x32_bf16 v[228:231], v[212:215], a[252:255], v[228:231]
    s_nop 3
    v_cvt_pk_bf16_f32 v224, v224, v225
    v_cvt_pk_bf16_f32 v225, v226, v227
    s_nop 1
    v_cvt_pk_bf16_f32 v226, v228, v229
    v_cvt_pk_bf16_f32 v227, v230, v231
    v_and_or_b32 v224, v224, -2, s53
    s_add_u32 s19, s48, 229376
    buffer_store_dwordx4 v[224:227], v0, s[4:7], s19 offen
    s_waitcnt vmcnt(0)
L_cF1_in:
    s_mov_b32 s19, s49
    buffer_load_dwordx4 v[184:187], v16, s[4:7], s19 offen sc1
    s_add_u32 s19, s19, 4096
    buffer_load_dwordx4 v[188:191], v16, s[4:7], s19 offen sc1
    s_add_u32 s19, s19, 4096
    buffer_load_dwordx4 v[192:195], v16, s[4:7], s19 offen sc1
    s_add_u32 s19, s19, 4096
    buffer_load_dwordx4 v[196:199], v16, s[4:7], s19 offen sc1
    s_add_u32 s19, s19, 4096
    buffer_load_dwordx4 v[200:203], v16, s[4:7], s19 offen sc1
    s_add_u32 s19, s19, 4096
    buffer_load_dwordx4 v[204:207], v16, s[4:7], s19 offen sc1
    s_add_u32 s19, s19, 4096
    buffer_load_dwordx4 v[208:211], v16, s[4:7], s19 offen sc1
    s_add_u32 s19, s19, 4096
    buffer_load_dwordx4 v[212:215], v16, s[4:7], s19 offen sc1
    s_mov_b64 exec, -1
    s_add_u32 s18, s18, 1
    s_cmp_gt_u32 s18, 200000
    s_cbranch_scc1 L_abort
    s_waitcnt vmcnt(7)
    v_mfma_f32_16x16x32_bf16 v[240:243], v[184:187], v[236:239], 0
    s_waitcnt vmcnt(6)
    v_xor_b32 v234, s53, v184
    v_mfma_f32_16x16x32_bf16 v[240:243], v[188:191], v[236:239], v[240:243]
    s_waitcnt vmcnt(5)
    v_bitop3_b32 v234, v234, v188, s53 bitop3:0xf6
    v_mfma_f32_16x16x32_bf16 v[240:243], v[192:195], v[236:239], v[240:243]
    s_waitcnt vmcnt(4)
    v_bitop3_b32 v234, v234, v192, s53 bitop3:0xf6
    v_mfma_f32_16x16x32_bf16 v[240:243], v[196:199], v[236:239], v[240:243]
    s_waitcnt vmcnt(3)
    v_bitop3_b32 v234, v234, v196, s53 bitop3:0xf6
    v_mfma_f32_16x16x32_bf16 v[240:243], v[200:203], v[236:239], v[240:243]
    s_waitcnt vmcnt(2)
    v_bitop3_b32 v234, v234, v200, s53 bitop3:0xf6
    v_mfma_f32_16x16x32_bf16 v[240:243], v[204:207], v[236:239], v[240:243]
    s_waitcnt vmcnt(1)
    v_bitop3_b32 v234, v234, v204, s53 bitop3:0xf6
    v_mfma_f32_16x16x32_bf16 v[240:243], v[208:211], v[236:239], v[240:243]
    s_waitcnt vmcnt(0)
    v_bitop3_b32 v234, v234, v208, s53 bitop3:0xf6
    v_mfma_f32_16x16x32_bf16 v[240:243], v[212:215], v[236:239], v[240:243]
    v_bitop3_b32 v234, v234, v212, s53 bitop3:0xf6
    v_and_b32 v234, 1, v234
    v_cmp_ne_u32 vcc, 0, v234
    s_cbranch_vccz L_cF1_inok
    s_mov_b64 exec, vcc
    s_branch L_cF1_in
L_cF1_inok:
    s_nop 3
    v_cvt_pk_bf16_f32 v240, v240, v241
    v_cvt_pk_bf16_f32 v242, v242, v243
    v_and_b32 v241, 0xffff0000, v240
    v_lshlrev_b32 v240, 16, v240
    v_and_b32 v243, 0xffff0000, v242
    v_lshlrev_b32 v242, 16, v242
    v_mul_f32 v240, v240, v235
    v_mul_f32 v241, v241, v235
    v_mul_f32 v242, v242, v235
    v_mul_f32 v243, v243, v235
    v_cvt_pk_bf16_f32 v240, v240, v241
    v_cvt_pk_bf16_f32 v242, v242, v243
    v_and_b32 v241, 0xffff0000, v240
    v_lshlrev_b32 v240, 16, v240
    v_and_b32 v243, 0xffff0000, v242
    v_lshlrev_b32 v242, 16, v242
    v_add_f32 v240, v240, v244
    v_add_f32 v241, v241, v245
    v_add_f32 v242, v242, v246
    v_add_f32 v243, v243, v247
    v_cvt_pk_bf16_f32 v240, v240, v241
    v_cvt_pk_bf16_f32 v241, v242, v243
    s_lshl_b32 s55, s30, 15
    s_lshl_b32 s19, s16, 5
    s_add_u32 s55, s55, s19
    buffer_store_dwordx2 v[240:241], v18, s[92:95], s55 offen
    s_add_u32 s30, s30, 4
    s_cmp_ge_u32 s30, 64
    s_cbranch_scc1 L_done
    s_branch L_cF_loop
L_cS_arm:
    v_mov_b32 v232, -1
    v_mov_b32 v233, -1
    v_mov_b32 v234, -1
    v_mov_b32 v235, -1
    s_add_u32 s19, s58, 0
    buffer_store_dwordx4 v[232:235], v8, s[4:7], s19 offen sc1
    s_add_u32 s19, s19, 4096
    buffer_store_dwordx4 v[232:235], v8, s[4:7], s19 offen sc1
    s_add_u32 s19, s19, 4096
    buffer_store_dwordx4 v[232:235], v8, s[4:7], s19 offen sc1
    s_add_u32 s19, s19, 4096
    buffer_store_dwordx4 v[232:235], v8, s[4:7], s19 offen sc1
    s_add_u32 s19, s19, 4096
    buffer_store_dwordx4 v[232:235], v8, s[4:7], s19 offen sc1
    s_add_u32 s19, s19, 4096
    buffer_store_dwordx4 v[232:235], v8, s[4:7], s19 offen sc1
    s_add_u32 s19, s19, 4096
    buffer_store_dwordx4 v[232:235], v8, s[4:7], s19 offen sc1
    s_add_u32 s19, s19, 4096
    buffer_store_dwordx4 v[232:235], v8, s[4:7], s19 offen sc1
    s_add_u32 s19, s58, 1048576
    buffer_store_dwordx4 v[232:235], v8, s[4:7], s19 offen sc1
    s_add_u32 s19, s19, 4096
    buffer_store_dwordx4 v[232:235], v8, s[4:7], s19 offen sc1
    s_add_u32 s19, s19, 4096
    buffer_store_dwordx4 v[232:235], v8, s[4:7], s19 offen sc1
    s_add_u32 s19, s19, 4096
    buffer_store_dwordx4 v[232:235], v8, s[4:7], s19 offen sc1
    s_add_u32 s19, s19, 4096
    buffer_store_dwordx4 v[232:235], v8, s[4:7], s19 offen sc1
    s_add_u32 s19, s19, 4096
    buffer_store_dwordx4 v[232:235], v8, s[4:7], s19 offen sc1
    s_add_u32 s19, s19, 4096
    buffer_store_dwordx4 v[232:235], v8, s[4:7], s19 offen sc1
    s_add_u32 s19, s19, 4096
    buffer_store_dwordx4 v[232:235], v8, s[4:7], s19 offen sc1
    s_waitcnt vmcnt(0)
    s_barrier
    s_cmp_lg_u32 s17, 0
    s_cbranch_scc1 L_cS_met
    s_lshl_b32 s20, s45, 2
    s_mov_b64 exec, 1
    v_mov_b32 v232, 1
    buffer_atomic_add v232, off, s[12:15], s20 offset:32
L_cS_meet:
    s_sleep 8
    buffer_load_dword v233, off, s[12:15], s20 offset:32 sc1
    s_add_u32 s18, s18, 1
    s_cmp_gt_u32 s18, 200000
    s_cbranch_scc1 L_abort
    s_waitcnt vmcnt(0)
    v_readfirstlane_b32 s19, v233
    s_nop 0
    s_cmp_ge_u32 s19, 32
    s_cbranch_scc0 L_cS_meet
    s_mov_b64 exec, -1
L_cS_met:
L_cS_loop:
    s_waitcnt vmcnt(0)
    s_barrier
    s_lshl_b32 s19, s30, 5
    s_add_u32 s19, s19, s16
    s_lshl_b32 s46, s19, 13
    s_lshl_b32 s47, s19, 12
    s_add_u32 s47, s47, 51380224
    s_add_u32 s51, s30, 1
    s_cmp_lg_u32 s17, 0
    s_cbranch_scc1 L_cS0_pp_ok
    s_cmp_ge_u32 s59, s51
    s_cbranch_scc1 L_cS0_pp_ok
    s_mov_b64 exec, s[84:85]
L_cS0_pp:
    buffer_load_dword v232, v15, s[4:7], s52 offen sc1
    s_add_u32 s18, s18, 1
    s_cmp_gt_u32 s18, 200000
    s_cbranch_scc1 L_abort
    s_waitcnt vmcnt(0)
    v_lshrrev_b32 v233, 16, v232
    v_and_b32 v232, 0xffff, v232
    v_min_u32 v232, v232, v233
    v_cmp_gt_u32 vcc, s51, v232
    s_cbranch_vccz L_cS0_pp_done
    s_sleep 4
    s_branch L_cS0_pp
L_cS0_pp_done:
    s_mov_b32 s59, s51
    s_add_u32 s19, s51, 4
    s_min_u32 s19, s19, 64
    v_cmp_gt_u32 vcc, s19, v232
    s_nop 0
    s_cmp_eq_u64 vcc, 0
    s_cselect_b32 s59, s19, s59
    s_add_u32 s19, s51, 8
    s_min_u32 s19, s19, 64
    v_cmp_gt_u32 vcc, s19, v232
    s_nop 0
    s_cmp_eq_u64 vcc, 0
    s_cselect_b32 s59, s19, s59
    s_add_u32 s19, s51, 16
    s_min_u32 s19, s19, 64
    v_cmp_gt_u32 vcc, s19, v232
    s_nop 0
    s_cmp_eq_u64 vcc, 0
    s_cselect_b32 s59, s19, s59
    s_mov_b64 exec, -1
L_cS0_pp_ok:
    s_barrier
    s_lshl_b32 s19, s17, 10
    s_add_u32 s20, s46, s19
    s_add_u32 s20, s20, 16777216
    s_lshl_b32 s19, s17, 11
    s_add_u32 m0, s19, 73728
    s_add_u32 s21, s46, 33554432
    buffer_load_dwordx4 v8, s[4:7], s20 offen offset:0 sc1 lds
    buffer_load_dwordx4 v8, s[4:7], s20 offen offset:1024 sc1 lds
    buffer_load_dwordx4 v[128:131], v21, s[4:7], s21 offen offset:0 sc1
    buffer_load_dwordx4 v[132:135], v21, s[4:7], s21 offen offset:1024 sc1
    buffer_load_dwordx4 v[136:139], v21, s[4:7], s21 offen offset:2048 sc1
    buffer_load_dwordx4 v[140:143], v21, s[4:7], s21 offen offset:3072 sc1
    v_cndmask_b32 v236, 0, v20, s[76:77]
    v_cndmask_b32 v237, 0, v20, s[78:79]
    v_cndmask_b32 v238, 0, v20, s[80:81]
    v_cndmask_b32 v239, 0, v20, s[82:83]
    s_lshr_b32 s21, s30, 1
    s_add_u32 s21, s21, 1
    s_cmp_lg_u32 s17, 0
    s_cbranch_scc1 L_cS0_pf_ok
    s_cmp_ge_u32 s90, s21
    s_cbranch_scc1 L_cS0_pf_ok
    s_mov_b64 exec, s[88:89]
L_cS0_pf:
    buffer_load_dword v232, v15, s[4:7], s54 offen sc1
    s_add_u32 s18, s18, 1
    s_cmp_gt_u32 s18, 200000
    s_cbranch_scc1 L_abort
    s_waitcnt vmcnt(0)
    v_cmp_gt_u32 vcc, s21, v232
    s_cbranch_vccz L_cS0_pf_done
    s_sleep 4
    s_branch L_cS0_pf
L_cS0_pf_done:
    s_mov_b32 s90, s21
    s_add_u32 s19, s21, 4
    s_min_u32 s19, s19, 32
    v_cmp_gt_u32 vcc, s19, v232
    s_nop 0
    s_cmp_eq_u64 vcc, 0
    s_cselect_b32 s90, s19, s90
    s_add_u32 s19, s21, 8
    s_min_u32 s19, s19, 32
    v_cmp_gt_u32 vcc, s19, v232
    s_nop 0
    s_cmp_eq_u64 vcc, 0
    s_cselect_b32 s90, s19, s90
    s_add_u32 s19, s21, 16
    s_min_u32 s19, s19, 32
    v_cmp_gt_u32 vcc, s19, v232
    s_nop 0
    s_cmp_eq_u64 vcc, 0
    s_cselect_b32 s90, s19, s90
    s_mov_b64 exec, -1
L_cS0_pf_ok:
    s_barrier
    s_lshl_b32 s50, s30, 19
    s_lshl_b32 s19, s16, 14
    s_add_u32 s50, s50, s19
    s_add_u32 s50, s50, 67108864
    buffer_load_dwordx4 v[184:187], v16, s[4:7], s50 offen sc1
    s_add_u32 s50, s50, 4096
    buffer_load_dwordx4 v[188:191], v16, s[4:7], s50 offen sc1
    s_add_u32 s50, s50, 4096
    buffer_load_dwordx4 v[192:195], v16, s[4:7], s50 offen sc1
    s_add_u32 s50, s50, 4096
    buffer_load_dwordx4 v[196:199], v17, s[4:7], s50 offen sc1
    s_lshl_b32 s56, s30, 7
    s_add_u32 s56, s56, 327680
    buffer_load_dword v235, v19, s[4:7], s56 offen sc1
    s_add_u32 s21, s30, 4
    s_min_u32 s21, s21, 63
    ds_read_b128 v[32:35], v1 offset:0
    s_waitcnt lgkmcnt(0)
    ds_read_b128 v[36:39], v1 offset:16384
    v_mfma_f32_16x16x32_bf16 v[48:51], a[0:3], v[32:35], 0
    s_waitcnt lgkmcnt(0)
    ds_read_b128 v[40:43], v2 offset:0
    v_mfma_f32_16x16x32_bf16 v[56:59], a[0:3], v[36:39], 0
    ds_read_b128 v[44:47], v2 offset:16384
    v_mfma_f32_16x16x32_bf16 v[52:55], a[64:67], v[32:35], 0
    s_lshl_b32 s31, s21, 15
    s_lshl_b32 s36, s17, 13
    s_add_u32 s31, s31, s36
    s_add_u32 s36, s36, 32768
    v_mfma_f32_16x16x32_bf16 v[60:63], a[64:67], v[36:39], 0
    s_waitcnt lgkmcnt(1)
    v_mfma_f32_16x16x32_bf16 v[48:51], a[4:7], v[40:43], v[48:51]
    s_waitcnt lgkmcnt(0)
    ds_read_b128 v[32:35], v3 offset:0
    v_mfma_f32_16x16x32_bf16 v[56:59], a[4:7], v[44:47], v[56:59]
    ds_read_b128 v[36:39], v3 offset:16384
    v_mfma_f32_16x16x32_bf16 v[52:55], a[68:71], v[40:43], v[52:55]
    s_add_u32 m0, s36, 0
    v_xor_b32 v6, 0, v5
    buffer_load_dwordx4 v6, s[32:35], s31 offen offset:0 lds
    v_mfma_f32_16x16x32_bf16 v[60:63], a[68:71], v[44:47], v[60:63]
    s_waitcnt lgkmcnt(1)
    v_mfma_f32_16x16x32_bf16 v[48:51], a[8:11], v[32:35], v[48:51]
    s_waitcnt lgkmcnt(0)
    ds_read_b128 v[40:43], v4 offset:0
    v_mfma_f32_16x16x32_bf16 v[56:59], a[8:11], v[36:39], v[56:59]
    ds_read_b128 v[44:47], v4 offset:16384
    v_mfma_f32_16x16x32_bf16 v[52:55], a[72:75], v[32:35], v[52:55]
    v_xor_b32 v7, 16, v5
    buffer_load_dwordx4 v7, s[32:35], s31 offen offset:1024 lds
    v_mfma_f32_16x16x32_bf16 v[60:63], a[72:75], v[36:39], v[60:63]
    s_waitcnt lgkmcnt(1)
    v_mfma_f32_16x16x32_bf16 v[48:51], a[12:15], v[40:43], v[48:51]
    s_waitcnt lgkmcnt(0)
    ds_read_b128 v[32:35], v1 offset:256
    v_mfma_f32_16x16x32_bf16 v[56:59], a[12:15], v[44:47], v[56:59]
    ds_read_b128 v[36:39], v1 offset:16640
    v_mfma_f32_16x16x32_bf16 v[52:55], a[76:79], v[40:43], v[52:55]
    v_xor_b32 v6, 32, v5
    buffer_load_dwordx4 v6, s[32:35], s31 offen offset:2048 lds
    v_mfma_f32_16x16x32_bf16 v[60:63], a[76:79], v[44:47], v[60:63]
    s_waitcnt lgkmcnt(1)
    v_mfma_f32_16x16x32_bf16 v[48:51], a[16:19], v[32:35], v[48:51]
    s_waitcnt lgkmcnt(0)
    ds_read_b128 v[40:43], v2 offset:256
    v_mfma_f32_16x16x32_bf16 v[56:59], a[16:19], v[36:39], v[56:59]
    ds_read_b128 v[44:47], v2 offset:16640
    v_mfma_f32_16x16x32_bf16 v[52:55], a[80:83], v[32:35], v[52:55]
    v_xor_b32 v7, 48, v5
    buffer_load_dwordx4 v7, s[32:35], s31 offen offset:3072 lds
    v_mfma_f32_16x16x32_bf16 v[60:63], a[80:83], v[36:39], v[60:63]
    s_waitcnt lgkmcnt(1)
    v_mfma_f32_16x16x32_bf16 v[48:51], a[20:23], v[40:43], v[48:51]
    s_waitcnt lgkmcnt(0)
    ds_read_b128 v[32:35], v3 offset:256
    v_mfma_f32_16x16x32_bf16 v[56:59], a[20:23], v[44:47], v[56:59]
    ds_read_b128 v[36:39], v3 offset:16640
    v_mfma_f32_16x16x32_bf16 v[52:55], a[84:87], v[40:43], v[52:55]
    s_add_u32 m0, s36, 4096
    s_add_u32 s31, s31, 4096
    v_xor_b32 v6, 64, v5
    buffer_load_dwordx4 v6, s[32:35], s31 offen offset:0 lds
    v_mfma_f32_16x16x32_bf16 v[60:63], a[84:87], v[44:47], v[60:63]
    s_waitcnt lgkmcnt(1)
    v_mfma_f32_16x16x32_bf16 v[48:51], a[24:27], v[32:35], v[48:51]
    s_waitcnt lgkmcnt(0)
    ds_read_b128 v[40:43], v4 offset:256
    v_mfma_f32_16x16x32_bf16 v[56:59], a[24:27], v[36:39], v[56:59]
    ds_read_b128 v[44:47], v4 offset:16640
    v_mfma_f32_16x16x32_bf16 v[52:55], a[88:91], v[32:35], v[52:55]
    v_xor_b32 v7, 80, v5
    buffer_load_dwordx4 v7, s[32:35], s31 offen offset:1024 lds
    v_mfma_f32_16x16x32_bf16 v[60:63], a[88:91], v[36:39], v[60:63]
    s_waitcnt lgkmcnt(1)
    v_mfma_f32_16x16x32_bf16 v[48:51], a[28:31], v[40:43], v[48:51]
    s_waitcnt lgkmcnt(0)
    ds_read_b128 v[32:35], v1 offset:512
    v_mfma_f32_16x16x32_bf16 v[56:59], a[28:31], v[44:47], v[56:59]
    ds_read_b128 v[36:39], v1 offset:16896
    v_mfma_f32_16x16x32_bf16 v[52:55], a[92:95], v[40:43], v[52:55]
    v_xor_b32 v6, 96, v5
    buffer_load_dwordx4 v6, s[32:35], s31 offen offset:2048 lds
    v_mfma_f32_16x16x32_bf16 v[60:63], a[92:95], v[44:47], v[60:63]
    s_waitcnt lgkmcnt(1)
    v_mfma_f32_16x16x32_bf16 v[48:51], a[32:35], v[32:35], v[48:51]
    s_waitcnt lgkmcnt(0)
    ds_read_b128 v[40:43], v2 offset:512
    v_mfma_f32_16x16x32_bf16 v[56:59], a[32:35], v[36:39], v[56:59]
    ds_read_b128 v[44:47], v2 offset:16896
    v_mfma_f32_16x16x32_bf16 v[52:55], a[96:99], v[32:35], v[52:55]
    v_xor_b32 v7, 112, v5
    buffer_load_dwordx4 v7, s[32:35], s31 offen offset:3072 lds
    v_mfma_f32_16x16x32_bf16 v[60:63], a[96:99], v[36:39], v[60:63]
    s_waitcnt lgkmcnt(1)
    v_mfma_f32_16x16x32_bf16 v[48:51], a[36:39], v[40:43], v[48:51]
    s_waitcnt lgkmcnt(0)
    ds_read_b128 v[32:35], v3 offset:512
    v_mfma_f32_16x16x32_bf16 v[56:59], a[36:39], v[44:47], v[56:59]
    ds_read_b128 v[36:39], v3 offset:16896
    v_mfma_f32_16x16x32_bf16 v[52:55], a[100:103], v[40:43], v[52:55]
    v_mfma_f32_16x16x32_bf16 v[60:63], a[100:103], v[44:47], v[60:63]
    s_waitcnt lgkmcnt(1)
    v_mfma_f32_16x16x32_bf16 v[48:51], a[40:43], v[32:35], v[48:51]
    s_waitcnt lgkmcnt(0)
    ds_read_b128 v[40:43], v4 offset:512
    v_mfma_f32_16x16x32_bf16 v[56:59], a[40:43], v[36:39], v[56:59]
    ds_read_b128 v[44:47], v4 offset:16896
    v_mfma_f32_16x16x32_bf16 v[52:55], a[104:107], v[32:35], v[52:55]
    v_mfma_f32_16x16x32_bf16 v[60:63], a[104:107], v[36:39], v[60:63]
    s_waitcnt lgkmcnt(1)
    v_mfma_f32_16x16x32_bf16 v[48:51], a[44:47], v[40:43], v[48:51]
    s_waitcnt lgkmcnt(0)
    ds_read_b128 v[32:35], v1 offset:768
    v_mfma_f32_16x16x32_bf16 v[56:59], a[44:47], v[44:47], v[56:59]
    ds_read_b128 v[36:39], v1 offset:17152
    v_mfma_f32_16x16x32_bf16 v[52:55], a[108:111], v[40:43], v[52:55]
    v_mfma_f32_16x16x32_bf16 v[60:63], a[108:111], v[44:47], v[60:63]
    s_waitcnt lgkmcnt(1)
    v_mfma_f32_16x16x32_bf16 v[48:51], a[48:51], v[32:35], v[48:51]
    s_waitcnt lgkmcnt(0)
    ds_read_b128 v[40:43], v2 offset:768
    v_mfma_f32_16x16x32_bf16 v[56:59], a[48:51], v[36:39], v[56:59]
    ds_read_b128 v[44:47], v2 offset:17152
    v_mfma_f32_16x16x32_bf16 v[52:55], a[112:115], v[32:35], v[52:55]
    v_mfma_f32_16x16x32_bf16 v[60:63], a[112:115], v[36:39], v[60:63]
    s_waitcnt lgkmcnt(1)
    v_mfma_f32_16x16x32_bf16 v[48:51], a[52:55], v[40:43], v[48:51]
    s_waitcnt lgkmcnt(0)
    ds_read_b128 v[32:35], v3 offset:768
    v_mfma_f32_16x16x32_bf16 v[56:59], a[52:55], v[44:47], v[56:59]
    ds_read_b128 v[36:39], v3 offset:17152
    v_mfma_f32_16x16x32_bf16 v[52:55], a[116:119], v[40:43], v[52:55]
    v_mfma_f32_16x16x32_bf16 v[60:63], a[116:119], v[44:47], v[60:63]
    s_waitcnt lgkmcnt(1)
    v_mfma_f32_16x16x32_bf16 v[48:51], a[56:59], v[32:35], v[48:51]
    s_waitcnt lgkmcnt(0)
    ds_read_b128 v[40:43], v4 offset:768
    v_mfma_f32_16x16x32_bf16 v[56:59], a[56:59], v[36:39], v[56:59]
    ds_read_b128 v[44:47], v4 offset:17152
    v_mfma_f32_16x16x32_bf16 v[52:55], a[120:123], v[32:35], v[52:55]
    v_mfma_f32_16x16x32_bf16 v[60:63], a[120:123], v[36:39], v[60:63]
    s_waitcnt lgkmcnt(1)
    v_mfma_f32_16x16x32_bf16 v[48:51], a[60:63], v[40:43], v[48:51]
    s_waitcnt lgkmcnt(0)
    v_mfma_f32_16x16x32_bf16 v[56:59], a[60:63], v[44:47], v[56:59]
    v_mfma_f32_16x16x32_bf16 v[52:55], a[124:127], v[40:43], v[52:55]
    v_mfma_f32_16x16x32_bf16 v[60:63], a[124:127], v[44:47], v[60:63]
    v_cvt_pk_bf16_f32 v48, v48, v49
    v_cvt_pk_bf16_f32 v49, v50, v51
    s_nop 1
    v_cvt_pk_bf16_f32 v50, v52, v53
    v_cvt_pk_bf16_f32 v51, v54, v55
    ds_write_b128 v9, v[48:51] offset:0
    v_cvt_pk_bf16_f32 v56, v56, v57
    v_cvt_pk_bf16_f32 v57, v58, v59
    v_cvt_pk_bf16_f32 v58, v60, v61
    v_cvt_pk_bf16_f32 v59, v62, v63
    ds_write_b128 v9, v[56:59] offset:4096
    s_waitcnt vmcnt(8)
    v_mfma_f32_16x16x32_bf16 v[244:247], v[184:187], v[236:239], 0
    v_mfma_f32_16x16x32_bf16 v[244:247], v[188:191], v[236:239], v[244:247]
    v_mfma_f32_16x16x32_bf16 v[244:247], v[192:195], v[236:239], v[244:247]
    v_mfma_f32_16x16x32_bf16 v[244:247], v[196:199], v[236:239], v[244:247]
    v_sub_f32 v232, 1.0, v235
    v_cvt_pk_bf16_f32 v232, v232, v232
    v_and_b32 v232, 0xffff0000, v232
    s_nop 4
    v_cvt_pk_bf16_f32 v244, v244, v245
    v_cvt_pk_bf16_f32 v246, v246, v247
    v_and_b32 v245, 0xffff0000, v244
    v_lshlrev_b32 v244, 16, v244
    v_and_b32 v247, 0xffff0000, v246
    v_lshlrev_b32 v246, 16, v246
    v_mul_f32 v244, v244, v232
    v_mul_f32 v245, v245, v232
    v_mul_f32 v246, v246, v232
    v_mul_f32 v247, v247, v232
    v_cvt_pk_bf16_f32 v244, v244, v245
    v_cvt_pk_bf16_f32 v246, v246, v247
    v_and_b32 v245, 0xffff0000, v244
    v_lshlrev_b32 v244, 16, v244
    v_and_b32 v247, 0xffff0000, v246
    v_lshlrev_b32 v246, 16, v246
    s_waitcnt lgkmcnt(0)
    s_barrier
    ds_read_b128 v[64:67], v11 offset:0
    ds_read_b128 v[68:71], v11 offset:1024
    ds_read_b128 v[72:75], v11 offset:2048
    ds_read_b128 v[76:79], v11 offset:3072
    ds_read_b128 v[80:83], v10 offset:8192
    ds_read_b128 v[84:87], v10 offset:9216
    ds_read_b128 v[88:91], v10 offset:10240
    ds_read_b128 v[92:95], v10 offset:11264
    ds_read_b128 v[96:99], v10 offset:12288
    s_waitcnt lgkmcnt(4)
    ds_read_b128 v[100:103], v10 offset:13312
    ds_read_b128 v[104:107], v10 offset:14336
    ds_read_b128 v[108:111], v10 offset:15360
    v_mfma_f32_16x16x32_bf16 v[152:155], v[80:83], v[64:67], 0
    s_waitcnt lgkmcnt(3)
    v_mfma_f32_16x16x32_bf16 v[156:159], v[96:99], v[64:67], 0
    v_mfma_f32_16x16x32_bf16 v[152:155], v[84:87], v[68:71], v[152:155]
    s_waitcnt lgkmcnt(2)
    v_mfma_f32_16x16x32_bf16 v[156:159], v[100:103], v[68:71], v[156:159]
    v_mfma_f32_16x16x32_bf16 v[152:155], v[88:91], v[72:75], v[152:155]
    s_waitcnt lgkmcnt(1)
    v_mfma_f32_16x16x32_bf16 v[156:159], v[104:107], v[72:75], v[156:159]
    v_mfma_f32_16x16x32_bf16 v[152:155], v[92:95], v[76:79], v[152:155]
    s_waitcnt lgkmcnt(0)
    v_mfma_f32_16x16x32_bf16 v[156:159], v[108:111], v[76:79], v[156:159]
    v_mov_b32 v232, 0xff800000
    s_nop 2
    v_cndmask_b32 v152, v232, v152, s[60:61]
    v_cndmask_b32 v153, v232, v153, s[62:63]
    v_cndmask_b32 v154, v232, v154, s[64:65]
    v_cndmask_b32 v155, v232, v155, s[66:67]
    v_cndmask_b32 v156, v232, v156, s[68:69]
    v_cndmask_b32 v157, v232, v157, s[70:71]
    v_cndmask_b32 v158, v232, v158, s[72:73]
    v_cndmask_b32 v159, v232, v159, s[74:75]
    v_max3_f32 v233, v152, v153, v154
    v_max3_f32 v233, v233, v155, v156
    v_max3_f32 v233, v233, v157, v158
    v_max_f32 v233, v233, v159
    v_mov_b32 v234, v233
    s_nop 1
    v_permlane16_swap_b32 v233, v234
    v_max_f32 v233, v233, v234
    v_mov_b32 v234, v233
    s_nop 1
    v_permlane32_swap_b32 v233, v234
    v_max_f32 v233, v233, v234
    v_sub_f32 v152, v152, v233
    v_sub_f32 v153, v153, v233
    v_sub_f32 v154, v154, v233
    v_sub_f32 v155, v155, v233
    v_sub_f32 v156, v156, v233
    v_sub_f32 v157, v157, v233
    v_sub_f32 v158, v158, v233
    v_sub_f32 v159, v159, v233
    v_exp_f32 v152, v152
    v_exp_f32 v153, v153
    v_exp_f32 v154, v154
    v_exp_f32 v155, v155
    v_exp_f32 v156, v156
    v_exp_f32 v157, v157
    v_exp_f32 v158, v158
    v_exp_f32 v159, v159
    v_cvt_pk_bf16_f32 v152, v152, v153
    v_cvt_pk_bf16_f32 v153, v154, v155
    v_cvt_pk_bf16_f32 v154, v156, v157
    v_cvt_pk_bf16_f32 v155, v158, v159
    s_nop 1
    v_mfma_f32_16x16x32_bf16 v[180:183], v[24:27], v[152:155], 0
    v_mfma_f32_16x16x32_bf16 v[164:167], v[128:131], v[152:155], 0
    v_mfma_f32_16x16x32_bf16 v[168:171], v[132:135], v[152:155], 0
    v_mfma_f32_16x16x32_bf16 v[172:175], v[136:139], v[152:155], 0
    v_mfma_f32_16x16x32_bf16 v[176:179], v[140:143], v[152:155], 0
    s_and_b32 s19, s43, 1
    s_lshl_b32 s19, s19, 20
    s_add_u32 s48, s57, s19
    s_add_u32 s49, s58, s19
    s_bfe_u32 s53, s43, 0x10001
    s_add_u32 s43, s43, 1
    s_min_u32 s19, s30, 62
    s_cmp_ge_u32 s30, 59
    s_cselect_b32 s51, s19, s51
    s_add_u32 s22, s52, 8192
    s_cmp_lg_u32 s17, 0
    s_cbranch_scc1 L_cS0_pa_ok
    s_mov_b64 exec, s[84:85]
L_cS0_pa:
    buffer_load_dword v234, v15, s[4:7], s22 offen sc1
    s_add_u32 s18, s18, 1
    s_cmp_gt_u32 s18, 200000
    s_cbranch_scc1 L_abort
    s_waitcnt vmcnt(0)
    v_cmp_gt_u32 vcc, s51, v234
    s_cbranch_vccz L_cS0_pa_done
    s_sleep 3
    s_branch L_cS0_pa
L_cS0_pa_done:
    s_mov_b64 exec, -1
L_cS0_pa_ok:
    s_barrier
    s_lshr_b32 s19, s17, 1
    s_lshl_b32 s19, s19, 11
    s_add_u32 s19, s19, s47
    s_branch L_cS0_km1
L_cS0_km:
    s_sleep 1
L_cS0_km1:
    buffer_load_dwordx2 v[148:149], v8, s[4:7], s47 offen sc1
    buffer_load_dwordx2 v[144:145], v0, s[4:7], s19 offen offset:8 sc1
    buffer_load_dwordx2 v[146:147], v0, s[4:7], s19 offen offset:1032 sc1
    s_add_u32 s18, s18, 1
    s_cmp_gt_u32 s18, 200000
    s_cbranch_scc1 L_abort
    s_waitcnt vmcnt(0)
    v_max3_u32 v234, v148, v144, v146
    v_cmp_eq_u32 vcc, -1, v234
    ds_write_b32 v12, v148
    ds_write_b32 v12, v149 offset:512
    s_cbranch_vccnz L_cS0_km
    s_waitcnt lgkmcnt(0)
    s_barrier
    ds_read_b64_tr_b16 v[112:113], v13 offset:0
    ds_read_b64_tr_b16 v[114:115], v13 offset:512
    ds_read_b64_tr_b16 v[116:117], v13 offset:1024
    ds_read_b64_tr_b16 v[118:119], v13 offset:1536
    ds_read_b64_tr_b16 v[120:121], v13 offset:2048
    s_waitcnt lgkmcnt(3)
    ds_read_b64_tr_b16 v[122:123], v13 offset:2560
    ds_read_b64_tr_b16 v[124:125], v13 offset:3072
    ds_read_b64_tr_b16 v[126:127], v13 offset:3584
    v_mfma_f32_16x16x32_bf16 v[160:163], v[112:115], v[64:67], 0
    s_waitcnt lgkmcnt(4)
    v_mfma_f32_16x16x32_bf16 v[160:163], v[116:119], v[68:71], v[160:163]
    s_waitcnt lgkmcnt(2)
    v_mfma_f32_16x16x32_bf16 v[160:163], v[120:123], v[72:75], v[160:163]
    s_waitcnt lgkmcnt(0)
    v_mfma_f32_16x16x32_bf16 v[160:163], v[124:127], v[76:79], v[160:163]
    s_nop 7
    v_mul_f32 v160, s44, v160
    v_mul_f32 v161, s44, v161
    v_max3_f32 v156, v233, v160, v161
    v_mov_b32 v234, v156
    s_nop 1
    v_permlane16_swap_b32 v156, v234
    v_max_f32 v156, v156, v234
    v_mov_b32 v234, v156
    s_nop 1
    v_permlane32_swap_b32 v156, v234
    v_max_f32 v156, v156, v234
    v_sub_f32 v157, v233, v156
    v_sub_f32 v160, v160, v156
    v_sub_f32 v161, v161, v156
    v_exp_f32 v157, v157
    v_exp_f32 v160, v160
    v_exp_f32 v161, v161
    s_nop 0
    v_cvt_pk_bf16_f32 v28, v160, v161
    v_cvt_pk_bf16_f32 v31, v160, v161
    s_nop 0
    v_mfma_f32_16x16x16_bf16 v[96:99], v[24:25], v[28:29], 0
    v_mfma_f32_16x16x16_bf16 v[80:83], v[144:145], v[28:29], 0
    v_mfma_f32_16x16x16_bf16 v[84:87], v[144:145], v[30:31], 0
    v_mfma_f32_16x16x16_bf16 v[88:91], v[146:147], v[28:29], 0
    v_mfma_f32_16x16x16_bf16 v[92:95], v[146:147], v[30:31], 0
    v_fma_f32 v180, v180, v157, v96
    v_rcp_f32 v234, v180
    v_fma_f32 v164, v164, v157, v80
    v_fma_f32 v165, v165, v157, v81
    v_fma_f32 v166, v166, v157, v82
    v_fma_f32 v167, v167, v157, v83
    v_fma_f32 v168, v168, v157, v84
    v_fma_f32 v169, v169, v157, v85
    v_fma_f32 v170, v170, v157, v86
    v_fma_f32 v171, v171, v157, v87
    v_fma_f32 v172, v172, v157, v88
    v_fma_f32 v173, v173, v157, v89
    v_fma_f32 v174, v174, v157, v90
    v_fma_f32 v175, v175, v157, v91
    v_fma_f32 v176, v176, v157, v92
    v_fma_f32 v177, v177, v157, v93
    v_fma_f32 v178, v178, v157, v94
    v_fma_f32 v179, v179, v157, v95
    v_pk_mul_f32 v[164:165], v[164:165], v[234:235] op_sel_hi:[1,0]
    v_pk_mul_f32 v[166:167], v[166:167], v[234:235] op_sel_hi:[1,0]
    v_pk_mul_f32 v[168:169], v[168:169], v[234:235] op_sel_hi:[1,0]
    v_pk_mul_f32 v[170:171], v[170:171], v[234:235] op_sel_hi:[1,0]
    v_pk_mul_f32 v[172:173], v[172:173], v[234:235] op_sel_hi:[1,0]
    v_pk_mul_f32 v[174:175], v[174:175], v[234:235] op_sel_hi:[1,0]
    v_pk_mul_f32 v[176:177], v[176:177], v[234:235] op_sel_hi:[1,0]
    v_pk_mul_f32 v[178:179], v[178:179], v[234:235] op_sel_hi:[1,0]
    v_cvt_pk_bf16_f32 v164, v164, v165
    v_cvt_pk_bf16_f32 v165, v166, v167
    v_cvt_pk_bf16_f32 v166, v168, v169
    v_cvt_pk_bf16_f32 v167, v170, v171
    v_cvt_pk_bf16_f32 v168, v172, v173
    v_cvt_pk_bf16_f32 v169, v174, v175
    v_cvt_pk_bf16_f32 v170, v176, v177
    v_cvt_pk_bf16_f32 v171, v178, v179
    ds_write_b128 v14, v[164:167] offset:0
    ds_write_b128 v14, v[168:171] offset:1024
    s_waitcnt lgkmcnt(0)
    s_barrier
    ds_read_b128 v[184:187], v10 offset:0
    ds_read_b128 v[188:191], v10 offset:1024
    ds_read_b128 v[192:195], v10 offset:2048
    ds_read_b128 v[196:199], v10 offset:3072
    ds_read_b128 v[200:203], v10 offset:4096
    s_waitcnt lgkmcnt(4)
    ds_read_b128 v[204:207], v10 offset:5120
    ds_read_b128 v[208:211], v10 offset:6144
    ds_read_b128 v[212:215], v10 offset:7168
    v_mfma_f32_16x16x32_bf16 v[216:219], v[184:187], a[128:131], 0
    s_waitcnt lgkmcnt(3)
    v_mfma_f32_16x16x32_bf16 v[220:223], v[200:203], a[128:131], 0
    v_mfma_f32_16x16x32_bf16 v[216:219], v[188:191], a[132:135], v[216:219]
    s_waitcnt lgkmcnt(2)
    v_mfma_f32_16x16x32_bf16 v[220:223], v[204:207], a[132:135], v[220:223]
    v_mfma_f32_16x16x32_bf16 v[216:219], v[192:195], a[136:139], v[216:219]
    s_waitcnt lgkmcnt(1)
    v_mfma_f32_16x16x32_bf16 v[220:223], v[208:211], a[136:139], v[220:223]
    v_mfma_f32_16x16x32_bf16 v[216:219], v[196:199], a[140:143], v[216:219]
    s_waitcnt lgkmcnt(0)
    v_mfma_f32_16x16x32_bf16 v[220:223], v[212:215], a[140:143], v[220:223]
    v_mfma_f32_16x16x32_bf16 v[224:227], v[184:187], a[144:147], 0
    v_mfma_f32_16x16x32_bf16 v[228:231], v[200:203], a[144:147], 0
    v_mfma_f32_16x16x32_bf16 v[224:227], v[188:191], a[148:151], v[224:227]
    v_cvt_pk_bf16_f32 v216, v216, v217
    v_mfma_f32_16x16x32_bf16 v[228:231], v[204:207], a[148:151], v[228:231]
    v_cvt_pk_bf16_f32 v217, v218, v219
    v_mfma_f32_16x16x32_bf16 v[224:227], v[192:195], a[152:155], v[224:227]
    v_cvt_pk_bf16_f32 v218, v220, v221
    v_mfma_f32_16x16x32_bf16 v[228:231], v[208:211], a[152:155], v[228:231]
    v_cvt_pk_bf16_f32 v219, v222, v223
    v_mfma_f32_16x16x32_bf16 v[224:227], v[196:199], a[156:159], v[224:227]
    v_and_or_b32 v216, v216, -2, s53
    s_add_u32 s19, s48, 0
    buffer_store_dwordx4 v[216:219], v0, s[4:7], s19 offen sc1
    v_mfma_f32_16x16x32_bf16 v[228:231], v[212:215], a[156:159], v[228:231]
    s_nop 0
    v_mfma_f32_16x16x32_bf16 v[216:219], v[184:187], a[160:163], 0
    v_mfma_f32_16x16x32_bf16 v[220:223], v[200:203], a[160:163], 0
    v_mfma_f32_16x16x32_bf16 v[216:219], v[188:191], a[164:167], v[216:219]
    v_cvt_pk_bf16_f32 v224, v224, v225
    v_mfma_f32_16x16x32_bf16 v[220:223], v[204:207], a[164:167], v[220:223]
    v_cvt_pk_bf16_f32 v225, v226, v227
    v_mfma_f32_16x16x32_bf16 v[216:219], v[192:195], a[168:171], v[216:219]
    v_cvt_pk_bf16_f32 v226, v228, v229
    v_mfma_f32_16x16x32_bf16 v[220:223], v[208:211], a[168:171], v[220:223]
    v_cvt_pk_bf16_f32 v227, v230, v231
    v_mfma_f32_16x16x32_bf16 v[216:219], v[196:199], a[172:175], v[216:219]
    v_and_or_b32 v224, v224, -2, s53
    s_add_u32 s19, s48, 32768
    buffer_store_dwordx4 v[224:227], v0, s[4:7], s19 offen sc1
    v_mfma_f32_16x16x32_bf16 v[220:223], v[212:215], a[172:175], v[220:223]
    s_nop 0
    v_mfma_f32_16x16x32_bf16 v[224:227], v[184:187], a[176:179], 0
    v_mfma_f32_16x16x32_bf16 v[228:231], v[200:203], a[176:179], 0
    v_mfma_f32_16x16x32_bf16 v[224:227], v[188:191], a[180:183], v[224:227]
    v_cvt_pk_bf16_f32 v216, v216, v217
    v_mfma_f32_16x16x32_bf16 v[228:231], v[204:207], a[180:183], v[228:231]
    v_cvt_pk_bf16_f32 v217, v218, v219
    v_mfma_f32_16x16x32_bf16 v[224:227], v[192:195], a[184:187], v[224:227]
    v_cvt_pk_bf16_f32 v218, v220, v221
    v_mfma_f32_16x16x32_bf16 v[228:231], v[208:211], a[184:187], v[228:231]
    v_cvt_pk_bf16_f32 v219, v222, v223
    v_mfma_f32_16x16x32_bf16 v[224:227], v[196:199], a[188:191], v[224:227]
    v_and_or_b32 v216, v216, -2, s53
    s_add_u32 s19, s48, 65536
    buffer_store_dwordx4 v[216:219], v0, s[4:7], s19 offen sc1
    v_mfma_f32_16x16x32_bf16 v[228:231], v[212:215], a[188:191], v[228:231]
    s_nop 0
    v_mfma_f32_16x16x32_bf16 v[216:219], v[184:187], a[192:195], 0
    v_mfma_f32_16x16x32_bf16 v[220:223], v[200:203], a[192:195], 0
    v_mfma_f32_16x16x32_bf16 v[216:219], v[188:191], a[196:199], v[216:219]
    v_cvt_pk_bf16_f32 v224, v224, v225
    v_mfma_f32_16x16x32_bf16 v[220:223], v[204:207], a[196:199], v[220:223]
    v_cvt_pk_bf16_f32 v225, v226, v227
    v_mfma_f32_16x16x32_bf16 v[216:219], v[192:195], a[200:203], v[216:219]
    v_cvt_pk_bf16_f32 v226, v228, v229
    v_mfma_f32_16x16x32_bf16 v[220:223], v[208:211], a[200:203], v[220:223]
    v_cvt_pk_bf16_f32 v227, v230, v231
    v_mfma_f32_16x16x32_bf16 v[216:219], v[196:199], a[204:207], v[216:219]
    v_and_or_b32 v224, v224, -2, s53
    s_add_u32 s19, s48, 98304
    buffer_store_dwordx4 v[224:227], v0, s[4:7], s19 offen sc1
    v_mfma_f32_16x16x32_bf16 v[220:223], v[212:215], a[204:207], v[220:223]
    s_nop 0
    v_mfma_f32_16x16x32_bf16 v[224:227], v[184:187], a[208:211], 0
    v_mfma_f32_16x16x32_bf16 v[228:231], v[200:203], a[208:211], 0
    v_mfma_f32_16x16x32_bf16 v[224:227], v[188:191], a[212:215], v[224:227]
    v_cvt_pk_bf16_f32 v216, v216, v217
    v_mfma_f32_16x16x32_bf16 v[228:231], v[204:207], a[212:215], v[228:231]
    v_cvt_pk_bf16_f32 v217, v218, v219
    v_mfma_f32_16x16x32_bf16 v[224:227], v[192:195], a[216:219], v[224:227]
    v_cvt_pk_bf16_f32 v218, v220, v221
    v_mfma_f32_16x16x32_bf16 v[228:231], v[208:211], a[216:219], v[228:231]
    v_cvt_pk_bf16_f32 v219, v222, v223
    v_mfma_f32_16x16x32_bf16 v[224:227], v[196:199], a[220:223], v[224:227]
    v_and_or_b32 v216, v216, -2, s53
    s_add_u32 s19, s48, 131072
    buffer_store_dwordx4 v[216:219], v0, s[4:7], s19 offen sc1
    v_mfma_f32_16x16x32_bf16 v[228:231], v[212:215], a[220:223], v[228:231]
    s_nop 0
    v_mfma_f32_16x16x32_bf16 v[216:219], v[184:187], a[224:227], 0
    v_mfma_f32_16x16x32_bf16 v[220:223], v[200:203], a[224:227], 0
    v_mfma_f32_16x16x32_bf16 v[216:219], v[188:191], a[228:231], v[216:219]
    v_cvt_pk_bf16_f32 v224, v224, v225
    v_mfma_f32_16x16x32_bf16 v[220:223], v[204:207], a[228:231], v[220:223]
    v_cvt_pk_bf16_f32 v225, v226, v227
    v_mfma_f32_16x16x32_bf16 v[216:219], v[192:195], a[232:235], v[216:219]
    v_cvt_pk_bf16_f32 v226, v228, v229
    v_mfma_f32_16x16x32_bf16 v[220:223], v[208:211], a[232:235], v[220:223]
    v_cvt_pk_bf16_f32 v227, v230, v231
    v_mfma_f32_16x16x32_bf16 v[216:219], v[196:199], a[236:239], v[216:219]
    v_and_or_b32 v224, v224, -2, s53
    s_add_u32 s19, s48, 163840
    buffer_store_dwordx4 v[224:227], v0, s[4:7], s19 offen sc1
    v_mfma_f32_16x16x32_bf16 v[220:223], v[212:215], a[236:239], v[220:223]
    s_nop 0
    v_mfma_f32_16x16x32_bf16 v[224:227], v[184:187], a[240:243], 0
    v_mfma_f32_16x16x32_bf16 v[228:231], v[200:203], a[240:243], 0
    v_mfma_f32_16x16x32_bf16 v[224:227], v[188:191], a[244:247], v[224:227]
    v_cvt_pk_bf16_f32 v216, v216, v217
    v_mfma_f32_16x16x32_bf16 v[228:231], v[204:207], a[244:247], v[228:231]
    v_cvt_pk_bf16_f32 v217, v218, v219
    v_mfma_f32_16x16x32_bf16 v[224:227], v[192:195], a[248:251], v[224:227]
    v_cvt_pk_bf16_f32 v218, v220, v221
    v_mfma_f32_16x16x32_bf16 v[228:231], v[208:211], a[248:251], v[228:231]
    v_cvt_pk_bf16_f32 v219, v222, v223
    v_mfma_f32_16x16x32_bf16 v[224:227], v[196:199], a[252:255], v[224:227]
    v_and_or_b32 v216, v216, -2, s53
    s_add_u32 s19, s48, 196608
    buffer_store_dwordx4 v[216:219], v0, s[4:7], s19 offen sc1
    v_mfma_f32_16x16x32_bf16 v[228:231], v[212:215], a[252:255], v[228:231]
    s_nop 3
    v_cvt_pk_bf16_f32 v224, v224, v225
    v_cvt_pk_bf16_f32 v225, v226, v227
    s_nop 1
    v_cvt_pk_bf16_f32 v226, v228, v229
    v_cvt_pk_bf16_f32 v227, v230, v231
    v_and_or_b32 v224, v224, -2, s53
    s_add_u32 s19, s48, 229376
    buffer_store_dwordx4 v[224:227], v0, s[4:7], s19 offen sc1
    s_waitcnt vmcnt(0)
L_cS0_in:
    s_mov_b32 s19, s49
    buffer_load_dwordx4 v[184:187], v16, s[4:7], s19 offen sc1
    s_add_u32 s19, s19, 4096
    buffer_load_dwordx4 v[188:191], v16, s[4:7], s19 offen sc1
    s_add_u32 s19, s19, 4096
    buffer_load_dwordx4 v[192:195], v16, s[4:7], s19 offen sc1
    s_add_u32 s19, s19, 4096
    buffer_load_dwordx4 v[196:199], v16, s[4:7], s19 offen sc1
    s_add_u32 s19, s19, 4096
    buffer_load_dwordx4 v[200:203], v16, s[4:7], s19 offen sc1
    s_add_u32 s19, s19, 4096
    buffer_load_dwordx4 v[204:207], v16, s[4:7], s19 offen sc1
    s_add_u32 s19, s19, 4096
    buffer_load_dwordx4 v[208:211], v16, s[4:7], s19 offen sc1
    s_add_u32 s19, s19, 4096
    buffer_load_dwordx4 v[212:215], v16, s[4:7], s19 offen sc1
    s_mov_b64 exec, -1
    s_add_u32 s18, s18, 1
    s_cmp_gt_u32 s18, 200000
    s_cbranch_scc1 L_abort
    s_waitcnt vmcnt(7)
    v_mfma_f32_16x16x32_bf16 v[240:243], v[184:187], v[236:239], 0
    s_waitcnt vmcnt(6)
    v_xor_b32 v234, s53, v184
    v_mfma_f32_16x16x32_bf16 v[240:243], v[188:191], v[236:239], v[240:243]
    s_waitcnt vmcnt(5)
    v_bitop3_b32 v234, v234, v188, s53 bitop3:0xf6
    v_mfma_f32_16x16x32_bf16 v[240:243], v[192:195], v[236:239], v[240:243]
    s_waitcnt vmcnt(4)
    v_bitop3_b32 v234, v234, v192, s53 bitop3:0xf6
    v_mfma_f32_16x16x32_bf16 v[240:243], v[196:199], v[236:239], v[240:243]
    s_waitcnt vmcnt(3)
    v_bitop3_b32 v234, v234, v196, s53 bitop3:0xf6
    v_mfma_f32_16x16x32_bf16 v[240:243], v[200:203], v[236:239], v[240:243]
    s_waitcnt vmcnt(2)
    v_bitop3_b32 v234, v234, v200, s53 bitop3:0xf6
    v_mfma_f32_16x16x32_bf16 v[240:243], v[204:207], v[236:239], v[240:243]
    s_waitcnt vmcnt(1)
    v_bitop3_b32 v234, v234, v204, s53 bitop3:0xf6
    v_mfma_f32_16x16x32_bf16 v[240:243], v[208:211], v[236:239], v[240:243]
    s_waitcnt vmcnt(0)
    v_bitop3_b32 v234, v234, v208, s53 bitop3:0xf6
    v_mfma_f32_16x16x32_bf16 v[240:243], v[212:215], v[236:239], v[240:243]
    v_bitop3_b32 v234, v234, v212, s53 bitop3:0xf6
    v_and_b32 v234, 1, v234
    v_cmp_ne_u32 vcc, 0, v234
    s_cbranch_vccz L_cS0_inok
    s_mov_b64 exec, vcc
    s_branch L_cS0_in
L_cS0_inok:
    s_nop 3
    v_cvt_pk_bf16_f32 v240, v240, v241
    v_cvt_pk_bf16_f32 v242, v242, v243
    v_and_b32 v241, 0xffff0000, v240
    v_lshlrev_b32 v240, 16, v240
    v_and_b32 v243, 0xffff0000, v242
    v_lshlrev_b32 v242, 16, v242
    v_mul_f32 v240, v240, v235
    v_mul_f32 v241, v241, v235
    v_mul_f32 v242, v242, v235
    v_mul_f32 v243, v243, v235
    v_cvt_pk_bf16_f32 v240, v240, v241
    v_cvt_pk_bf16_f32 v242, v242, v243
    v_and_b32 v241, 0xffff0000, v240
    v_lshlrev_b32 v240, 16, v240
    v_and_b32 v243, 0xffff0000, v242
    v_lshlrev_b32 v242, 16, v242
    v_add_f32 v240, v240, v244
    v_add_f32 v241, v241, v245
    v_add_f32 v242, v242, v246
    v_add_f32 v243, v243, v247
    v_cvt_pk_bf16_f32 v240, v240, v241
    v_cvt_pk_bf16_f32 v241, v242, v243
    s_lshl_b32 s55, s30, 15
    s_lshl_b32 s19, s16, 5
    s_add_u32 s55, s55, s19
    buffer_store_dwordx2 v[240:241], v18, s[92:95], s55 offen
    s_add_u32 s30, s30, 4
    s_cmp_ge_u32 s30, 64
    s_cbranch_scc1 L_done
    s_waitcnt vmcnt(0)
    s_barrier
    s_lshl_b32 s19, s30, 5
    s_add_u32 s19, s19, s16
    s_lshl_b32 s46, s19, 13
    s_lshl_b32 s47, s19, 12
    s_add_u32 s47, s47, 51380224
    s_add_u32 s51, s30, 1
    s_cmp_lg_u32 s17, 0
    s_cbranch_scc1 L_cS1_pp_ok
    s_cmp_ge_u32 s59, s51
    s_cbranch_scc1 L_cS1_pp_ok
    s_mov_b64 exec, s[84:85]
L_cS1_pp:
    buffer_load_dword v232, v15, s[4:7], s52 offen sc1
    s_add_u32 s18, s18, 1
    s_cmp_gt_u32 s18, 200000
    s_cbranch_scc1 L_abort
    s_waitcnt vmcnt(0)
    v_lshrrev_b32 v233, 16, v232
    v_and_b32 v232, 0xffff, v232
    v_min_u32 v232, v232, v233
    v_cmp_gt_u32 vcc, s51, v232
    s_cbranch_vccz L_cS1_pp_done
    s_sleep 4
    s_branch L_cS1_pp
L_cS1_pp_done:
    s_mov_b32 s59, s51
    s_add_u32 s19, s51, 4
    s_min_u32 s19, s19, 64
    v_cmp_gt_u32 vcc, s19, v232
    s_nop 0
    s_cmp_eq_u64 vcc, 0
    s_cselect_b32 s59, s19, s59
    s_add_u32 s19, s51, 8
    s_min_u32 s19, s19, 64
    v_cmp_gt_u32 vcc, s19, v232
    s_nop 0
    s_cmp_eq_u64 vcc, 0
    s_cselect_b32 s59, s19, s59
    s_add_u32 s19, s51, 16
    s_min_u32 s19, s19, 64
    v_cmp_gt_u32 vcc, s19, v232
    s_nop 0
    s_cmp_eq_u64 vcc, 0
    s_cselect_b32 s59, s19, s59
    s_mov_b64 exec, -1
L_cS1_pp_ok:
    s_barrier
    s_lshl_b32 s19, s17, 10
    s_add_u32 s20, s46, s19
    s_add_u32 s20, s20, 16777216
    s_lshl_b32 s19, s17, 11
    s_add_u32 m0, s19, 73728
    s_add_u32 s21, s46, 33554432
    buffer_load_dwordx4 v8, s[4:7], s20 offen offset:0 sc1 lds
    buffer_load_dwordx4 v8, s[4:7], s20 offen offset:1024 sc1 lds
    buffer_load_dwordx4 v[128:131], v21, s[4:7], s21 offen offset:0 sc1
    buffer_load_dwordx4 v[132:135], v21, s[4:7], s21 offen offset:1024 sc1
    buffer_load_dwordx4 v[136:139], v21, s[4:7], s21 offen offset:2048 sc1
    buffer_load_dwordx4 v[140:143], v21, s[4:7], s21 offen offset:3072 sc1
    v_cndmask_b32 v236, 0, v20, s[76:77]
    v_cndmask_b32 v237, 0, v20, s[78:79]
    v_cndmask_b32 v238, 0, v20, s[80:81]
    v_cndmask_b32 v239, 0, v20, s[82:83]
    s_lshr_b32 s21, s30, 1
    s_add_u32 s21, s21, 1
    s_cmp_lg_u32 s17, 0
    s_cbranch_scc1 L_cS1_pf_ok
    s_cmp_ge_u32 s90, s21
    s_cbranch_scc1 L_cS1_pf_ok
    s_mov_b64 exec, s[88:89]
L_cS1_pf:
    buffer_load_dword v232, v15, s[4:7], s54 offen sc1
    s_add_u32 s18, s18, 1
    s_cmp_gt_u32 s18, 200000
    s_cbranch_scc1 L_abort
    s_waitcnt vmcnt(0)
    v_cmp_gt_u32 vcc, s21, v232
    s_cbranch_vccz L_cS1_pf_done
    s_sleep 4
    s_branch L_cS1_pf
L_cS1_pf_done:
    s_mov_b32 s90, s21
    s_add_u32 s19, s21, 4
    s_min_u32 s19, s19, 32
    v_cmp_gt_u32 vcc, s19, v232
    s_nop 0
    s_cmp_eq_u64 vcc, 0
    s_cselect_b32 s90, s19, s90
    s_add_u32 s19, s21, 8
    s_min_u32 s19, s19, 32
    v_cmp_gt_u32 vcc, s19, v232
    s_nop 0
    s_cmp_eq_u64 vcc, 0
    s_cselect_b32 s90, s19, s90
    s_add_u32 s19, s21, 16
    s_min_u32 s19, s19, 32
    v_cmp_gt_u32 vcc, s19, v232
    s_nop 0
    s_cmp_eq_u64 vcc, 0
    s_cselect_b32 s90, s19, s90
    s_mov_b64 exec, -1
L_cS1_pf_ok:
    s_barrier
    s_lshl_b32 s50, s30, 19
    s_lshl_b32 s19, s16, 14
    s_add_u32 s50, s50, s19
    s_add_u32 s50, s50, 67108864
    buffer_load_dwordx4 v[184:187], v16, s[4:7], s50 offen sc1
    s_add_u32 s50, s50, 4096
    buffer_load_dwordx4 v[188:191], v16, s[4:7], s50 offen sc1
    s_add_u32 s50, s50, 4096
    buffer_load_dwordx4 v[192:195], v16, s[4:7], s50 offen sc1
    s_add_u32 s50, s50, 4096
    buffer_load_dwordx4 v[196:199], v17, s[4:7], s50 offen sc1
    s_lshl_b32 s56, s30, 7
    s_add_u32 s56, s56, 327680
    buffer_load_dword v235, v19, s[4:7], s56 offen sc1
    s_add_u32 s21, s30, 4
    s_min_u32 s21, s21, 63
    ds_read_b128 v[32:35], v1 offset:32768
    s_waitcnt lgkmcnt(0)
    ds_read_b128 v[36:39], v1 offset:49152
    v_mfma_f32_16x16x32_bf16 v[48:51], a[0:3], v[32:35], 0
    s_waitcnt lgkmcnt(0)
    ds_read_b128 v[40:43], v2 offset:32768
    v_mfma_f32_16x16x32_bf16 v[56:59], a[0:3], v[36:39], 0
    ds_read_b128 v[44:47], v2 offset:49152
    v_mfma_f32_16x16x32_bf16 v[52:55], a[64:67], v[32:35], 0
    s_lshl_b32 s31, s21, 15
    s_lshl_b32 s36, s17, 13
    s_add_u32 s31, s31, s36
    v_mfma_f32_16x16x32_bf16 v[60:63], a[64:67], v[36:39], 0
    s_waitcnt lgkmcnt(1)
    v_mfma_f32_16x16x32_bf16 v[48:51], a[4:7], v[40:43], v[48:51]
    s_waitcnt lgkmcnt(0)
    ds_read_b128 v[32:35], v3 offset:32768
    v_mfma_f32_16x16x32_bf16 v[56:59], a[4:7], v[44:47], v[56:59]
    ds_read_b128 v[36:39], v3 offset:49152
    v_mfma_f32_16x16x32_bf16 v[52:55], a[68:71], v[40:43], v[52:55]
    s_add_u32 m0, s36, 0
    v_xor_b32 v6, 0, v5
    buffer_load_dwordx4 v6, s[32:35], s31 offen offset:0 lds
    v_mfma_f32_16x16x32_bf16 v[60:63], a[68:71], v[44:47], v[60:63]
    s_waitcnt lgkmcnt(1)
    v_mfma_f32_16x16x32_bf16 v[48:51], a[8:11], v[32:35], v[48:51]
    s_waitcnt lgkmcnt(0)
    ds_read_b128 v[40:43], v4 offset:32768
    v_mfma_f32_16x16x32_bf16 v[56:59], a[8:11], v[36:39], v[56:59]
    ds_read_b128 v[44:47], v4 offset:49152
    v_mfma_f32_16x16x32_bf16 v[52:55], a[72:75], v[32:35], v[52:55]
    v_xor_b32 v7, 16, v5
    buffer_load_dwordx4 v7, s[32:35], s31 offen offset:1024 lds
    v_mfma_f32_16x16x32_bf16 v[60:63], a[72:75], v[36:39], v[60:63]
    s_waitcnt lgkmcnt(1)
    v_mfma_f32_16x16x32_bf16 v[48:51], a[12:15], v[40:43], v[48:51]
    s_waitcnt lgkmcnt(0)
    ds_read_b128 v[32:35], v1 offset:33024
    v_mfma_f32_16x16x32_bf16 v[56:59], a[12:15], v[44:47], v[56:59]
    ds_read_b128 v[36:39], v1 offset:49408
    v_mfma_f32_16x16x32_bf16 v[52:55], a[76:79], v[40:43], v[52:55]
    v_xor_b32 v6, 32, v5
    buffer_load_dwordx4 v6, s[32:35], s31 offen offset:2048 lds
    v_mfma_f32_16x16x32_bf16 v[60:63], a[76:79], v[44:47], v[60:63]
    s_waitcnt lgkmcnt(1)
    v_mfma_f32_16x16x32_bf16 v[48:51], a[16:19], v[32:35], v[48:51]
    s_waitcnt lgkmcnt(0)
    ds_read_b128 v[40:43], v2 offset:33024
    v_mfma_f32_16x16x32_bf16 v[56:59], a[16:19], v[36:39], v[56:59]
    ds_read_b128 v[44:47], v2 offset:49408
    v_mfma_f32_16x16x32_bf16 v[52:55], a[80:83], v[32:35], v[52:55]
    v_xor_b32 v7, 48, v5
    buffer_load_dwordx4 v7, s[32:35], s31 offen offset:3072 lds
    v_mfma_f32_16x16x32_bf16 v[60:63], a[80:83], v[36:39], v[60:63]
    s_waitcnt lgkmcnt(1)
    v_mfma_f32_16x16x32_bf16 v[48:51], a[20:23], v[40:43], v[48:51]
    s_waitcnt lgkmcnt(0)
    ds_read_b128 v[32:35], v3 offset:33024
    v_mfma_f32_16x16x32_bf16 v[56:59], a[20:23], v[44:47], v[56:59]
    ds_read_b128 v[36:39], v3 offset:49408
    v_mfma_f32_16x16x32_bf16 v[52:55], a[84:87], v[40:43], v[52:55]
    s_add_u32 m0, s36, 4096
    s_add_u32 s31, s31, 4096
    v_xor_b32 v6, 64, v5
    buffer_load_dwordx4 v6, s[32:35], s31 offen offset:0 lds
    v_mfma_f32_16x16x32_bf16 v[60:63], a[84:87], v[44:47], v[60:63]
    s_waitcnt lgkmcnt(1)
    v_mfma_f32_16x16x32_bf16 v[48:51], a[24:27], v[32:35], v[48:51]
    s_waitcnt lgkmcnt(0)
    ds_read_b128 v[40:43], v4 offset:33024
    v_mfma_f32_16x16x32_bf16 v[56:59], a[24:27], v[36:39], v[56:59]
    ds_read_b128 v[44:47], v4 offset:49408
    v_mfma_f32_16x16x32_bf16 v[52:55], a[88:91], v[32:35], v[52:55]
    v_xor_b32 v7, 80, v5
    buffer_load_dwordx4 v7, s[32:35], s31 offen offset:1024 lds
    v_mfma_f32_16x16x32_bf16 v[60:63], a[88:91], v[36:39], v[60:63]
    s_waitcnt lgkmcnt(1)
    v_mfma_f32_16x16x32_bf16 v[48:51], a[28:31], v[40:43], v[48:51]
    s_waitcnt lgkmcnt(0)
    ds_read_b128 v[32:35], v1 offset:33280
    v_mfma_f32_16x16x32_bf16 v[56:59], a[28:31], v[44:47], v[56:59]
    ds_read_b128 v[36:39], v1 offset:49664
    v_mfma_f32_16x16x32_bf16 v[52:55], a[92:95], v[40:43], v[52:55]
    v_xor_b32 v6, 96, v5
    buffer_load_dwordx4 v6, s[32:35], s31 offen offset:2048 lds
    v_mfma_f32_16x16x32_bf16 v[60:63], a[92:95], v[44:47], v[60:63]
    s_waitcnt lgkmcnt(1)
    v_mfma_f32_16x16x32_bf16 v[48:51], a[32:35], v[32:35], v[48:51]
    s_waitcnt lgkmcnt(0)
    ds_read_b128 v[40:43], v2 offset:33280
    v_mfma_f32_16x16x32_bf16 v[56:59], a[32:35], v[36:39], v[56:59]
    ds_read_b128 v[44:47], v2 offset:49664
    v_mfma_f32_16x16x32_bf16 v[52:55], a[96:99], v[32:35], v[52:55]
    v_xor_b32 v7, 112, v5
    buffer_load_dwordx4 v7, s[32:35], s31 offen offset:3072 lds
    v_mfma_f32_16x16x32_bf16 v[60:63], a[96:99], v[36:39], v[60:63]
    s_waitcnt lgkmcnt(1)
    v_mfma_f32_16x16x32_bf16 v[48:51], a[36:39], v[40:43], v[48:51]
    s_waitcnt lgkmcnt(0)
    ds_read_b128 v[32:35], v3 offset:33280
    v_mfma_f32_16x16x32_bf16 v[56:59], a[36:39], v[44:47], v[56:59]
    ds_read_b128 v[36:39], v3 offset:49664
    v_mfma_f32_16x16x32_bf16 v[52:55], a[100:103], v[40:43], v[52:55]
    v_mfma_f32_16x16x32_bf16 v[60:63], a[100:103], v[44:47], v[60:63]
    s_waitcnt lgkmcnt(1)
    v_mfma_f32_16x16x32_bf16 v[48:51], a[40:43], v[32:35], v[48:51]
    s_waitcnt lgkmcnt(0)
    ds_read_b128 v[40:43], v4 offset:33280
    v_mfma_f32_16x16x32_bf16 v[56:59], a[40:43], v[36:39], v[56:59]
    ds_read_b128 v[44:47], v4 offset:49664
    v_mfma_f32_16x16x32_bf16 v[52:55], a[104:107], v[32:35], v[52:55]
    v_mfma_f32_16x16x32_bf16 v[60:63], a[104:107], v[36:39], v[60:63]
    s_waitcnt lgkmcnt(1)
    v_mfma_f32_16x16x32_bf16 v[48:51], a[44:47], v[40:43], v[48:51]
    s_waitcnt lgkmcnt(0)
    ds_read_b128 v[32:35], v1 offset:33536
    v_mfma_f32_16x16x32_bf16 v[56:59], a[44:47], v[44:47], v[56:59]
    ds_read_b128 v[36:39], v1 offset:49920
    v_mfma_f32_16x16x32_bf16 v[52:55], a[108:111], v[40:43], v[52:55]
    v_mfma_f32_16x16x32_bf16 v[60:63], a[108:111], v[44:47], v[60:63]
    s_waitcnt lgkmcnt(1)
    v_mfma_f32_16x16x32_bf16 v[48:51], a[48:51], v[32:35], v[48:51]
    s_waitcnt lgkmcnt(0)
    ds_read_b128 v[40:43], v2 offset:33536
    v_mfma_f32_16x16x32_bf16 v[56:59], a[48:51], v[36:39], v[56:59]
    ds_read_b128 v[44:47], v2 offset:49920
    v_mfma_f32_16x16x32_bf16 v[52:55], a[112:115], v[32:35], v[52:55]
    v_mfma_f32_16x16x32_bf16 v[60:63], a[112:115], v[36:39], v[60:63]
    s_waitcnt lgkmcnt(1)
    v_mfma_f32_16x16x32_bf16 v[48:51], a[52:55], v[40:43], v[48:51]
    s_waitcnt lgkmcnt(0)
    ds_read_b128 v[32:35], v3 offset:33536
    v_mfma_f32_16x16x32_bf16 v[56:59], a[52:55], v[44:47], v[56:59]
    ds_read_b128 v[36:39], v3 offset:49920
    v_mfma_f32_16x16x32_bf16 v[52:55], a[116:119], v[40:43], v[52:55]
    v_mfma_f32_16x16x32_bf16 v[60:63], a[116:119], v[44:47], v[60:63]
    s_waitcnt lgkmcnt(1)
    v_mfma_f32_16x16x32_bf16 v[48:51], a[56:59], v[32:35], v[48:51]
    s_waitcnt lgkmcnt(0)
    ds_read_b128 v[40:43], v4 offset:33536
    v_mfma_f32_16x16x32_bf16 v[56:59], a[56:59], v[36:39], v[56:59]
    ds_read_b128 v[44:47], v4 offset:49920
    v_mfma_f32_16x16x32_bf16 v[52:55], a[120:123], v[32:35], v[52:55]
    v_mfma_f32_16x16x32_bf16 v[60:63], a[120:123], v[36:39], v[60:63]
    s_waitcnt lgkmcnt(1)
    v_mfma_f32_16x16x32_bf16 v[48:51], a[60:63], v[40:43], v[48:51]
    s_waitcnt lgkmcnt(0)
    v_mfma_f32_16x16x32_bf16 v[56:59], a[60:63], v[44:47], v[56:59]
    v_mfma_f32_16x16x32_bf16 v[52:55], a[124:127], v[40:43], v[52:55]
    v_mfma_f32_16x16x32_bf16 v[60:63], a[124:127], v[44:47], v[60:63]
    v_cvt_pk_bf16_f32 v48, v48, v49
    v_cvt_pk_bf16_f32 v49, v50, v51
    s_nop 1
    v_cvt_pk_bf16_f32 v50, v52, v53
    v_cvt_pk_bf16_f32 v51, v54, v55
    ds_write_b128 v9, v[48:51] offset:0
    v_cvt_pk_bf16_f32 v56, v56, v57
    v_cvt_pk_bf16_f32 v57, v58, v59
    v_cvt_pk_bf16_f32 v58, v60, v61
    v_cvt_pk_bf16_f32 v59, v62, v63
    ds_write_b128 v9, v[56:59] offset:4096
    s_waitcnt vmcnt(8)
    v_mfma_f32_16x16x32_bf16 v[244:247], v[184:187], v[236:239], 0
    v_mfma_f32_16x16x32_bf16 v[244:247], v[188:191], v[236:239], v[244:247]
    v_mfma_f32_16x16x32_bf16 v[244:247], v[192:195], v[236:239], v[244:247]
    v_mfma_f32_16x16x32_bf16 v[244:247], v[196:199], v[236:239], v[244:247]
    v_sub_f32 v232, 1.0, v235
    v_cvt_pk_bf16_f32 v232, v232, v232
    v_and_b32 v232, 0xffff0000, v232
    s_nop 4
    v_cvt_pk_bf16_f32 v244, v244, v245
    v_cvt_pk_bf16_f32 v246, v246, v247
    v_and_b32 v245, 0xffff0000, v244
    v_lshlrev_b32 v244, 16, v244
    v_and_b32 v247, 0xffff0000, v246
    v_lshlrev_b32 v246, 16, v246
    v_mul_f32 v244, v244, v232
    v_mul_f32 v245, v245, v232
    v_mul_f32 v246, v246, v232
    v_mul_f32 v247, v247, v232
    v_cvt_pk_bf16_f32 v244, v244, v245
    v_cvt_pk_bf16_f32 v246, v246, v247
    v_and_b32 v245, 0xffff0000, v244
    v_lshlrev_b32 v244, 16, v244
    v_and_b32 v247, 0xffff0000, v246
    v_lshlrev_b32 v246, 16, v246
    s_waitcnt lgkmcnt(0)
    s_barrier
    ds_read_b128 v[64:67], v11 offset:0
    ds_read_b128 v[68:71], v11 offset:1024
    ds_read_b128 v[72:75], v11 offset:2048
    ds_read_b128 v[76:79], v11 offset:3072
    ds_read_b128 v[80:83], v10 offset:8192
    ds_read_b128 v[84:87], v10 offset:9216
    ds_read_b128 v[88:91], v10 offset:10240
    ds_read_b128 v[92:95], v10 offset:11264
    ds_read_b128 v[96:99], v10 offset:12288
    s_waitcnt lgkmcnt(4)
    ds_read_b128 v[100:103], v10 offset:13312
    ds_read_b128 v[104:107], v10 offset:14336
    ds_read_b128 v[108:111], v10 offset:15360
    v_mfma_f32_16x16x32_bf16 v[152:155], v[80:83], v[64:67], 0
    s_waitcnt lgkmcnt(3)
    v_mfma_f32_16x16x32_bf16 v[156:159], v[96:99], v[64:67], 0
    v_mfma_f32_16x16x32_bf16 v[152:155], v[84:87], v[68:71], v[152:155]
    s_waitcnt lgkmcnt(2)
    v_mfma_f32_16x16x32_bf16 v[156:159], v[100:103], v[68:71], v[156:159]
    v_mfma_f32_16x16x32_bf16 v[152:155], v[88:91], v[72:75], v[152:155]
    s_waitcnt lgkmcnt(1)
    v_mfma_f32_16x16x32_bf16 v[156:159], v[104:107], v[72:75], v[156:159]
    v_mfma_f32_16x16x32_bf16 v[152:155], v[92:95], v[76:79], v[152:155]
    s_waitcnt lgkmcnt(0)
    v_mfma_f32_16x16x32_bf16 v[156:159], v[108:111], v[76:79], v[156:159]
    v_mov_b32 v232, 0xff800000
    s_nop 2
    v_cndmask_b32 v152, v232, v152, s[60:61]
    v_cndmask_b32 v153, v232, v153, s[62:63]
    v_cndmask_b32 v154, v232, v154, s[64:65]
    v_cndmask_b32 v155, v232, v155, s[66:67]
    v_cndmask_b32 v156, v232, v156, s[68:69]
    v_cndmask_b32 v157, v232, v157, s[70:71]
    v_cndmask_b32 v158, v232, v158, s[72:73]
    v_cndmask_b32 v159, v232, v159, s[74:75]
    v_max3_f32 v233, v152, v153, v154
    v_max3_f32 v233, v233, v155, v156
    v_max3_f32 v233, v233, v157, v158
    v_max_f32 v233, v233, v159
    v_mov_b32 v234, v233
    s_nop 1
    v_permlane16_swap_b32 v233, v234
    v_max_f32 v233, v233, v234
    v_mov_b32 v234, v233
    s_nop 1
    v_permlane32_swap_b32 v233, v234
    v_max_f32 v233, v233, v234
    v_sub_f32 v152, v152, v233
    v_sub_f32 v153, v153, v233
    v_sub_f32 v154, v154, v233
    v_sub_f32 v155, v155, v233
    v_sub_f32 v156, v156, v233
    v_sub_f32 v157, v157, v233
    v_sub_f32 v158, v158, v233
    v_sub_f32 v159, v159, v233
    v_exp_f32 v152, v152
    v_exp_f32 v153, v153
    v_exp_f32 v154, v154
    v_exp_f32 v155, v155
    v_exp_f32 v156, v156
    v_exp_f32 v157, v157
    v_exp_f32 v158, v158
    v_exp_f32 v159, v159
    v_cvt_pk_bf16_f32 v152, v152, v153
    v_cvt_pk_bf16_f32 v153, v154, v155
    v_cvt_pk_bf16_f32 v154, v156, v157
    v_cvt_pk_bf16_f32 v155, v158, v159
    s_nop 1
    v_mfma_f32_16x16x32_bf16 v[180:183], v[24:27], v[152:155], 0
    v_mfma_f32_16x16x32_bf16 v[164:167], v[128:131], v[152:155], 0
    v_mfma_f32_16x16x32_bf16 v[168:171], v[132:135], v[152:155], 0
    v_mfma_f32_16x16x32_bf16 v[172:175], v[136:139], v[152:155], 0
    v_mfma_f32_16x16x32_bf16 v[176:179], v[140:143], v[152:155], 0
    s_and_b32 s19, s43, 1
    s_lshl_b32 s19, s19, 20
    s_add_u32 s48, s57, s19
    s_add_u32 s49, s58, s19
    s_bfe_u32 s53, s43, 0x10001
    s_add_u32 s43, s43, 1
    s_min_u32 s19, s30, 62
    s_cmp_ge_u32 s30, 59
    s_cselect_b32 s51, s19, s51
    s_add_u32 s22, s52, 8192
    s_cmp_lg_u32 s17, 0
    s_cbranch_scc1 L_cS1_pa_ok
    s_mov_b64 exec, s[84:85]
L_cS1_pa:
    buffer_load_dword v234, v15, s[4:7], s22 offen sc1
    s_add_u32 s18, s18, 1
    s_cmp_gt_u32 s18, 200000
    s_cbranch_scc1 L_abort
    s_waitcnt vmcnt(0)
    v_cmp_gt_u32 vcc, s51, v234
    s_cbranch_vccz L_cS1_pa_done
    s_sleep 3
    s_branch L_cS1_pa
L_cS1_pa_done:
    s_mov_b64 exec, -1
L_cS1_pa_ok:
    s_barrier
    s_lshr_b32 s19, s17, 1
    s_lshl_b32 s19, s19, 11
    s_add_u32 s19, s19, s47
    s_branch L_cS1_km1
L_cS1_km:
    s_sleep 1
L_cS1_km1:
    buffer_load_dwordx2 v[148:149], v8, s[4:7], s47 offen sc1
    buffer_load_dwordx2 v[144:145], v0, s[4:7], s19 offen offset:8 sc1
    buffer_load_dwordx2 v[146:147], v0, s[4:7], s19 offen offset:1032 sc1
    s_add_u32 s18, s18, 1
    s_cmp_gt_u32 s18, 200000
    s_cbranch_scc1 L_abort
    s_waitcnt vmcnt(0)
    v_max3_u32 v234, v148, v144, v146
    v_cmp_eq_u32 vcc, -1, v234
    ds_write_b32 v12, v148
    ds_write_b32 v12, v149 offset:512
    s_cbranch_vccnz L_cS1_km
    s_waitcnt lgkmcnt(0)
    s_barrier
    ds_read_b64_tr_b16 v[112:113], v13 offset:0
    ds_read_b64_tr_b16 v[114:115], v13 offset:512
    ds_read_b64_tr_b16 v[116:117], v13 offset:1024
    ds_read_b64_tr_b16 v[118:119], v13 offset:1536
    ds_read_b64_tr_b16 v[120:121], v13 offset:2048
    s_waitcnt lgkmcnt(3)
    ds_read_b64_tr_b16 v[122:123], v13 offset:2560
    ds_read_b64_tr_b16 v[124:125], v13 offset:3072
    ds_read_b64_tr_b16 v[126:127], v13 offset:3584
    v_mfma_f32_16x16x32_bf16 v[160:163], v[112:115], v[64:67], 0
    s_waitcnt lgkmcnt(4)
    v_mfma_f32_16x16x32_bf16 v[160:163], v[116:119], v[68:71], v[160:163]
    s_waitcnt lgkmcnt(2)
    v_mfma_f32_16x16x32_bf16 v[160:163], v[120:123], v[72:75], v[160:163]
    s_waitcnt lgkmcnt(0)
    v_mfma_f32_16x16x32_bf16 v[160:163], v[124:127], v[76:79], v[160:163]
    s_nop 7
    v_mul_f32 v160, s44, v160
    v_mul_f32 v161, s44, v161
    v_max3_f32 v156, v233, v160, v161
    v_mov_b32 v234, v156
    s_nop 1
    v_permlane16_swap_b32 v156, v234
    v_max_f32 v156, v156, v234
    v_mov_b32 v234, v156
    s_nop 1
    v_permlane32_swap_b32 v156, v234
    v_max_f32 v156, v156, v234
    v_sub_f32 v157, v233, v156
    v_sub_f32 v160, v160, v156
    v_sub_f32 v161, v161, v156
    v_exp_f32 v157, v157
    v_exp_f32 v160, v160
    v_exp_f32 v161, v161
    s_nop 0
    v_cvt_pk_bf16_f32 v28, v160, v161
    v_cvt_pk_bf16_f32 v31, v160, v161
    s_nop 0
    v_mfma_f32_16x16x16_bf16 v[96:99], v[24:25], v[28:29], 0
    v_mfma_f32_16x16x16_bf16 v[80:83], v[144:145], v[28:29], 0
    v_mfma_f32_16x16x16_bf16 v[84:87], v[144:145], v[30:31], 0
    v_mfma_f32_16x16x16_bf16 v[88:91], v[146:147], v[28:29], 0
    v_mfma_f32_16x16x16_bf16 v[92:95], v[146:147], v[30:31], 0
    v_fma_f32 v180, v180, v157, v96
    v_rcp_f32 v234, v180
    v_fma_f32 v164, v164, v157, v80
    v_fma_f32 v165, v165, v157, v81
    v_fma_f32 v166, v166, v157, v82
    v_fma_f32 v167, v167, v157, v83
    v_fma_f32 v168, v168, v157, v84
    v_fma_f32 v169, v169, v157, v85
    v_fma_f32 v170, v170, v157, v86
    v_fma_f32 v171, v171, v157, v87
    v_fma_f32 v172, v172, v157, v88
    v_fma_f32 v173, v173, v157, v89
    v_fma_f32 v174, v174, v157, v90
    v_fma_f32 v175, v175, v157, v91
    v_fma_f32 v176, v176, v157, v92
    v_fma_f32 v177, v177, v157, v93
    v_fma_f32 v178, v178, v157, v94
    v_fma_f32 v179, v179, v157, v95
    v_pk_mul_f32 v[164:165], v[164:165], v[234:235] op_sel_hi:[1,0]
    v_pk_mul_f32 v[166:167], v[166:167], v[234:235] op_sel_hi:[1,0]
    v_pk_mul_f32 v[168:169], v[168:169], v[234:235] op_sel_hi:[1,0]
    v_pk_mul_f32 v[170:171], v[170:171], v[234:235] op_sel_hi:[1,0]
    v_pk_mul_f32 v[172:173], v[172:173], v[234:235] op_sel_hi:[1,0]
    v_pk_mul_f32 v[174:175], v[174:175], v[234:235] op_sel_hi:[1,0]
    v_pk_mul_f32 v[176:177], v[176:177], v[234:235] op_sel_hi:[1,0]
    v_pk_mul_f32 v[178:179], v[178:179], v[234:235] op_sel_hi:[1,0]
    v_cvt_pk_bf16_f32 v164, v164, v165
    v_cvt_pk_bf16_f32 v165, v166, v167
    v_cvt_pk_bf16_f32 v166, v168, v169
    v_cvt_pk_bf16_f32 v167, v170, v171
    v_cvt_pk_bf16_f32 v168, v172, v173
    v_cvt_pk_bf16_f32 v169, v174, v175
    v_cvt_pk_bf16_f32 v170, v176, v177
    v_cvt_pk_bf16_f32 v171, v178, v179
    ds_write_b128 v14, v[164:167] offset:0
    ds_write_b128 v14, v[168:171] offset:1024
    s_waitcnt lgkmcnt(0)
    s_barrier
    ds_read_b128 v[184:187], v10 offset:0
    ds_read_b128 v[188:191], v10 offset:1024
    ds_read_b128 v[192:195], v10 offset:2048
    ds_read_b128 v[196:199], v10 offset:3072
    ds_read_b128 v[200:203], v10 offset:4096
    s_waitcnt lgkmcnt(4)
    ds_read_b128 v[204:207], v10 offset:5120
    ds_read_b128 v[208:211], v10 offset:6144
    ds_read_b128 v[212:215], v10 offset:7168
    v_mfma_f32_16x16x32_bf16 v[216:219], v[184:187], a[128:131], 0
    s_waitcnt lgkmcnt(3)
    v_mfma_f32_16x16x32_bf16 v[220:223], v[200:203], a[128:131], 0
    v_mfma_f32_16x16x32_bf16 v[216:219], v[188:191], a[132:135], v[216:219]
    s_waitcnt lgkmcnt(2)
    v_mfma_f32_16x16x32_bf16 v[220:223], v[204:207], a[132:135], v[220:223]
    v_mfma_f32_16x16x32_bf16 v[216:219], v[192:195], a[136:139], v[216:219]
    s_waitcnt lgkmcnt(1)
    v_mfma_f32_16x16x32_bf16 v[220:223], v[208:211], a[136:139], v[220:223]
    v_mfma_f32_16x16x32_bf16 v[216:219], v[196:199], a[140:143], v[216:219]
    s_waitcnt lgkmcnt(0)
    v_mfma_f32_16x16x32_bf16 v[220:223], v[212:215], a[140:143], v[220:223]
    v_mfma_f32_16x16x32_bf16 v[224:227], v[184:187], a[144:147], 0
    v_mfma_f32_16x16x32_bf16 v[228:231], v[200:203], a[144:147], 0
    v_mfma_f32_16x16x32_bf16 v[224:227], v[188:191], a[148:151], v[224:227]
    v_cvt_pk_bf16_f32 v216, v216, v217
    v_mfma_f32_16x16x32_bf16 v[228:231], v[204:207], a[148:151], v[228:231]
    v_cvt_pk_bf16_f32 v217, v218, v219
    v_mfma_f32_16x16x32_bf16 v[224:227], v[192:195], a[152:155], v[224:227]
    v_cvt_pk_bf16_f32 v218, v220, v221
    v_mfma_f32_16x16x32_bf16 v[228:231], v[208:211], a[152:155], v[228:231]
    v_cvt_pk_bf16_f32 v219, v222, v223
    v_mfma_f32_16x16x32_bf16 v[224:227], v[196:199], a[156:159], v[224:227]
    v_and_or_b32 v216, v216, -2, s53
    s_add_u32 s19, s48, 0
    buffer_store_dwordx4 v[216:219], v0, s[4:7], s19 offen sc1
    v_mfma_f32_16x16x32_bf16 v[228:231], v[212:215], a[156:159], v[228:231]
    s_nop 0
    v_mfma_f32_16x16x32_bf16 v[216:219], v[184:187], a[160:163], 0
    v_mfma_f32_16x16x32_bf16 v[220:223], v[200:203], a[160:163], 0
    v_mfma_f32_16x16x32_bf16 v[216:219], v[188:191], a[164:167], v[216:219]
    v_cvt_pk_bf16_f32 v224, v224, v225
    v_mfma_f32_16x16x32_bf16 v[220:223], v[204:207], a[164:167], v[220:223]
    v_cvt_pk_bf16_f32 v225, v226, v227
    v_mfma_f32_16x16x32_bf16 v[216:219], v[192:195], a[168:171], v[216:219]
    v_cvt_pk_bf16_f32 v226, v228, v229
    v_mfma_f32_16x16x32_bf16 v[220:223], v[208:211], a[168:171], v[220:223]
    v_cvt_pk_bf16_f32 v227, v230, v231
    v_mfma_f32_16x16x32_bf16 v[216:219], v[196:199], a[172:175], v[216:219]
    v_and_or_b32 v224, v224, -2, s53
    s_add_u32 s19, s48, 32768
    buffer_store_dwordx4 v[224:227], v0, s[4:7], s19 offen sc1
    v_mfma_f32_16x16x32_bf16 v[220:223], v[212:215], a[172:175], v[220:223]
    s_nop 0
    v_mfma_f32_16x16x32_bf16 v[224:227], v[184:187], a[176:179], 0
    v_mfma_f32_16x16x32_bf16 v[228:231], v[200:203], a[176:179], 0
    v_mfma_f32_16x16x32_bf16 v[224:227], v[188:191], a[180:183], v[224:227]
    v_cvt_pk_bf16_f32 v216, v216, v217
    v_mfma_f32_16x16x32_bf16 v[228:231], v[204:207], a[180:183], v[228:231]
    v_cvt_pk_bf16_f32 v217, v218, v219
    v_mfma_f32_16x16x32_bf16 v[224:227], v[192:195], a[184:187], v[224:227]
    v_cvt_pk_bf16_f32 v218, v220, v221
    v_mfma_f32_16x16x32_bf16 v[228:231], v[208:211], a[184:187], v[228:231]
    v_cvt_pk_bf16_f32 v219, v222, v223
    v_mfma_f32_16x16x32_bf16 v[224:227], v[196:199], a[188:191], v[224:227]
    v_and_or_b32 v216, v216, -2, s53
    s_add_u32 s19, s48, 65536
    buffer_store_dwordx4 v[216:219], v0, s[4:7], s19 offen sc1
    v_mfma_f32_16x16x32_bf16 v[228:231], v[212:215], a[188:191], v[228:231]
    s_nop 0
    v_mfma_f32_16x16x32_bf16 v[216:219], v[184:187], a[192:195], 0
    v_mfma_f32_16x16x32_bf16 v[220:223], v[200:203], a[192:195], 0
    v_mfma_f32_16x16x32_bf16 v[216:219], v[188:191], a[196:199], v[216:219]
    v_cvt_pk_bf16_f32 v224, v224, v225
    v_mfma_f32_16x16x32_bf16 v[220:223], v[204:207], a[196:199], v[220:223]
    v_cvt_pk_bf16_f32 v225, v226, v227
    v_mfma_f32_16x16x32_bf16 v[216:219], v[192:195], a[200:203], v[216:219]
    v_cvt_pk_bf16_f32 v226, v228, v229
    v_mfma_f32_16x16x32_bf16 v[220:223], v[208:211], a[200:203], v[220:223]
    v_cvt_pk_bf16_f32 v227, v230, v231
    v_mfma_f32_16x16x32_bf16 v[216:219], v[196:199], a[204:207], v[216:219]
    v_and_or_b32 v224, v224, -2, s53
    s_add_u32 s19, s48, 98304
    buffer_store_dwordx4 v[224:227], v0, s[4:7], s19 offen sc1
    v_mfma_f32_16x16x32_bf16 v[220:223], v[212:215], a[204:207], v[220:223]
    s_nop 0
    v_mfma_f32_16x16x32_bf16 v[224:227], v[184:187], a[208:211], 0
    v_mfma_f32_16x16x32_bf16 v[228:231], v[200:203], a[208:211], 0
    v_mfma_f32_16x16x32_bf16 v[224:227], v[188:191], a[212:215], v[224:227]
    v_cvt_pk_bf16_f32 v216, v216, v217
    v_mfma_f32_16x16x32_bf16 v[228:231], v[204:207], a[212:215], v[228:231]
    v_cvt_pk_bf16_f32 v217, v218, v219
    v_mfma_f32_16x16x32_bf16 v[224:227], v[192:195], a[216:219], v[224:227]
    v_cvt_pk_bf16_f32 v218, v220, v221
    v_mfma_f32_16x16x32_bf16 v[228:231], v[208:211], a[216:219], v[228:231]
    v_cvt_pk_bf16_f32 v219, v222, v223
    v_mfma_f32_16x16x32_bf16 v[224:227], v[196:199], a[220:223], v[224:227]
    v_and_or_b32 v216, v216, -2, s53
    s_add_u32 s19, s48, 131072
    buffer_store_dwordx4 v[216:219], v0, s[4:7], s19 offen sc1
    v_mfma_f32_16x16x32_bf16 v[228:231], v[212:215], a[220:223], v[228:231]
    s_nop 0
    v_mfma_f32_16x16x32_bf16 v[216:219], v[184:187], a[224:227], 0
    v_mfma_f32_16x16x32_bf16 v[220:223], v[200:203], a[224:227], 0
    v_mfma_f32_16x16x32_bf16 v[216:219], v[188:191], a[228:231], v[216:219]
    v_cvt_pk_bf16_f32 v224, v224, v225
    v_mfma_f32_16x16x32_bf16 v[220:223], v[204:207], a[228:231], v[220:223]
    v_cvt_pk_bf16_f32 v225, v226, v227
    v_mfma_f32_16x16x32_bf16 v[216:219], v[192:195], a[232:235], v[216:219]
    v_cvt_pk_bf16_f32 v226, v228, v229
    v_mfma_f32_16x16x32_bf16 v[220:223], v[208:211], a[232:235], v[220:223]
    v_cvt_pk_bf16_f32 v227, v230, v231
    v_mfma_f32_16x16x32_bf16 v[216:219], v[196:199], a[236:239], v[216:219]
    v_and_or_b32 v224, v224, -2, s53
    s_add_u32 s19, s48, 163840
    buffer_store_dwordx4 v[224:227], v0, s[4:7], s19 offen sc1
    v_mfma_f32_16x16x32_bf16 v[220:223], v[212:215], a[236:239], v[220:223]
    s_nop 0
    v_mfma_f32_16x16x32_bf16 v[224:227], v[184:187], a[240:243], 0
    v_mfma_f32_16x16x32_bf16 v[228:231], v[200:203], a[240:243], 0
    v_mfma_f32_16x16x32_bf16 v[224:227], v[188:191], a[244:247], v[224:227]
    v_cvt_pk_bf16_f32 v216, v216, v217
    v_mfma_f32_16x16x32_bf16 v[228:231], v[204:207], a[244:247], v[228:231]
    v_cvt_pk_bf16_f32 v217, v218, v219
    v_mfma_f32_16x16x32_bf16 v[224:227], v[192:195], a[248:251], v[224:227]
    v_cvt_pk_bf16_f32 v218, v220, v221
    v_mfma_f32_16x16x32_bf16 v[228:231], v[208:211], a[248:251], v[228:231]
    v_cvt_pk_bf16_f32 v219, v222, v223
    v_mfma_f32_16x16x32_bf16 v[224:227], v[196:199], a[252:255], v[224:227]
    v_and_or_b32 v216, v216, -2, s53
    s_add_u32 s19, s48, 196608
    buffer_store_dwordx4 v[216:219], v0, s[4:7], s19 offen sc1
    v_mfma_f32_16x16x32_bf16 v[228:231], v[212:215], a[252:255], v[228:231]
    s_nop 3
    v_cvt_pk_bf16_f32 v224, v224, v225
    v_cvt_pk_bf16_f32 v225, v226, v227
    s_nop 1
    v_cvt_pk_bf16_f32 v226, v228, v229
    v_cvt_pk_bf16_f32 v227, v230, v231
    v_and_or_b32 v224, v224, -2, s53
    s_add_u32 s19, s48, 229376
    buffer_store_dwordx4 v[224:227], v0, s[4:7], s19 offen sc1
    s_waitcnt vmcnt(0)
L_cS1_in:
    s_mov_b32 s19, s49
    buffer_load_dwordx4 v[184:187], v16, s[4:7], s19 offen sc1
    s_add_u32 s19, s19, 4096
    buffer_load_dwordx4 v[188:191], v16, s[4:7], s19 offen sc1
    s_add_u32 s19, s19, 4096
    buffer_load_dwordx4 v[192:195], v16, s[4:7], s19 offen sc1
    s_add_u32 s19, s19, 4096
    buffer_load_dwordx4 v[196:199], v16, s[4:7], s19 offen sc1
    s_add_u32 s19, s19, 4096
    buffer_load_dwordx4 v[200:203], v16, s[4:7], s19 offen sc1
    s_add_u32 s19, s19, 4096
    buffer_load_dwordx4 v[204:207], v16, s[4:7], s19 offen sc1
    s_add_u32 s19, s19, 4096
    buffer_load_dwordx4 v[208:211], v16, s[4:7], s19 offen sc1
    s_add_u32 s19, s19, 4096
    buffer_load_dwordx4 v[212:215], v16, s[4:7], s19 offen sc1
    s_mov_b64 exec, -1
    s_add_u32 s18, s18, 1
    s_cmp_gt_u32 s18, 200000
    s_cbranch_scc1 L_abort
    s_waitcnt vmcnt(7)
    v_mfma_f32_16x16x32_bf16 v[240:243], v[184:187], v[236:239], 0
    s_waitcnt vmcnt(6)
    v_xor_b32 v234, s53, v184
    v_mfma_f32_16x16x32_bf16 v[240:243], v[188:191], v[236:239], v[240:243]
    s_waitcnt vmcnt(5)
    v_bitop3_b32 v234, v234, v188, s53 bitop3:0xf6
    v_mfma_f32_16x16x32_bf16 v[240:243], v[192:195], v[236:239], v[240:243]
    s_waitcnt vmcnt(4)
    v_bitop3_b32 v234, v234, v192, s53 bitop3:0xf6
    v_mfma_f32_16x16x32_bf16 v[240:243], v[196:199], v[236:239], v[240:243]
    s_waitcnt vmcnt(3)
    v_bitop3_b32 v234, v234, v196, s53 bitop3:0xf6
    v_mfma_f32_16x16x32_bf16 v[240:243], v[200:203], v[236:239], v[240:243]
    s_waitcnt vmcnt(2)
    v_bitop3_b32 v234, v234, v200, s53 bitop3:0xf6
    v_mfma_f32_16x16x32_bf16 v[240:243], v[204:207], v[236:239], v[240:243]
    s_waitcnt vmcnt(1)
    v_bitop3_b32 v234, v234, v204, s53 bitop3:0xf6
    v_mfma_f32_16x16x32_bf16 v[240:243], v[208:211], v[236:239], v[240:243]
    s_waitcnt vmcnt(0)
    v_bitop3_b32 v234, v234, v208, s53 bitop3:0xf6
    v_mfma_f32_16x16x32_bf16 v[240:243], v[212:215], v[236:239], v[240:243]
    v_bitop3_b32 v234, v234, v212, s53 bitop3:0xf6
    v_and_b32 v234, 1, v234
    v_cmp_ne_u32 vcc, 0, v234
    s_cbranch_vccz L_cS1_inok
    s_mov_b64 exec, vcc
    s_branch L_cS1_in
L_cS1_inok:
    s_nop 3
    v_cvt_pk_bf16_f32 v240, v240, v241
    v_cvt_pk_bf16_f32 v242, v242, v243
    v_and_b32 v241, 0xffff0000, v240
    v_lshlrev_b32 v240, 16, v240
    v_and_b32 v243, 0xffff0000, v242
    v_lshlrev_b32 v242, 16, v242
    v_mul_f32 v240, v240, v235
    v_mul_f32 v241, v241, v235
    v_mul_f32 v242, v242, v235
    v_mul_f32 v243, v243, v235
    v_cvt_pk_bf16_f32 v240, v240, v241
    v_cvt_pk_bf16_f32 v242, v242, v243
    v_and_b32 v241, 0xffff0000, v240
    v_lshlrev_b32 v240, 16, v240
    v_and_b32 v243, 0xffff0000, v242
    v_lshlrev_b32 v242, 16, v242
    v_add_f32 v240, v240, v244
    v_add_f32 v241, v241, v245
    v_add_f32 v242, v242, v246
    v_add_f32 v243, v243, v247
    v_cvt_pk_bf16_f32 v240, v240, v241
    v_cvt_pk_bf16_f32 v241, v242, v243
    s_lshl_b32 s55, s30, 15
    s_lshl_b32 s19, s16, 5
    s_add_u32 s55, s55, s19
    buffer_store_dwordx2 v[240:241], v18, s[92:95], s55 offen
    s_add_u32 s30, s30, 4
    s_cmp_ge_u32 s30, 64
    s_cbranch_scc1 L_done
    s_branch L_cS_loop
L_abort:
    s_mov_b64 exec, -1
    v_mov_b32 v0, 0xdead
    buffer_store_dword v0, off, s[12:15], 0 offset:60
L_exit:
    s_endpgm
L_done:
    s_endpgm
L_code_end:
.section .rodata,"a"
.p2align 6
.amdhsa_kernel gated_mix__memory_aug_recurrent_mem_tr__geglu_ffn__prompt_kernel
  .amdhsa_next_free_vgpr 512
  .amdhsa_next_free_sgpr 102
  .amdhsa_accum_offset 256
  .amdhsa_group_segment_fixed_size 0
  .amdhsa_kernarg_size 120
  .amdhsa_user_sgpr_count 2
  .amdhsa_user_sgpr_kernarg_segment_ptr 1
  .amdhsa_system_sgpr_workgroup_id_x 1
  .amdhsa_float_denorm_mode_32 3
.end_amdhsa_kernel
```
